```python
import torch

def _softmax(x, axis=-1):
    return torch.softmax(x, dim=axis)
def _gelu(x):
    return torch.nn.functional.gelu(x, approximate="tanh")
def _silu(x):
    return torch.nn.functional.silu(x)
def _sigmoid(x):
    return torch.sigmoid(x)
def _layernorm(x, axis=-1, eps=1e-5):
    m = x.mean(dim=axis, keepdim=True)
    v = x.var(dim=axis, keepdim=True, unbiased=False)
    return (x - m) / torch.sqrt(v + eps)
def _scatter_add(tgt, idx, src, axis=0):
    return tgt.clone().index_add_(axis, idx, src)
def _segment_sum(src, seg, n):
    out = torch.zeros((n,) + src.shape[1:], dtype=src.dtype)
    return out.index_add_(0, seg, src)
def _pad(x, pw):
    flat = tuple(v for pair in reversed(pw) for v in pair)
    return torch.nn.functional.pad(x, flat)

kernel_name = 'interleave_layers__mha_block__mixer_channel_mlp__prompt'

def setup_inputs():

    _w = (lambda a: (lambda t: t.to(torch.bfloat16) if t.is_floating_point() else t)(torch.as_tensor(a)))
    def _A_setup():
        B, S, D, H = 1, 2048, 512, 32
        return {
            "x": _w((lambda *s: torch.randn(*s, dtype=torch.bfloat16) * 0.05)(B, S, D)),
            "wqkv": _w((lambda *s: torch.randn(*s, dtype=torch.bfloat16) * 0.05)(D, 3 * D)),
            "wo": _w((lambda *s: torch.randn(*s, dtype=torch.bfloat16) * 0.05)(D, D)),
        }
    _A_in = _A_setup()

    def _B_setup():
        B, S, D, F = 1, 2048, 512, 1792
        return {
            "x": _w((lambda *s: torch.randn(*s, dtype=torch.bfloat16) * 0.05)(B, S, D)),
            "w1": _w((lambda *s: torch.randn(*s, dtype=torch.bfloat16) * 3.2)(D, F) * (D ** -0.5)),
            "b1": _w((lambda *s: torch.randn(*s, dtype=torch.bfloat16) * 0.8)(F)),
            "w2": _w((lambda *s: torch.randn(*s, dtype=torch.bfloat16) * 0.2)(F, D) * (F ** -0.5)),
            "b2": _w((lambda *s: torch.randn(*s, dtype=torch.bfloat16) * 0.2)(D)),
        }
    _B_in = _B_setup()

    return {
        "A_x": _A_in["x"],
        "A_wqkv": _A_in["wqkv"],
        "A_wo": _A_in["wo"],
        "B_x": _B_in["x"],
        "B_w1": _B_in["w1"],
        "B_b1": _B_in["b1"],
        "B_w2": _B_in["w2"],
        "B_b2": _B_in["b2"],
    }

def reference(A_x, A_wqkv, A_wo, B_x, B_w1, B_b1, B_w2, B_b2):
    def _A_ref(x, wqkv, wo):
        B, S, D = x.shape
        H = 32
        Dh = D // H
        qkv = (lambda x, *d: x.permute(*d))((x @ wqkv).reshape(B, S, 3, H, Dh), 2, 0, 3, 1, 4)
        q, k, v = qkv[0], qkv[1], qkv[2]
        scores = torch.einsum("bhqd,bhkd->bhqk", q, k) * (Dh ** -0.5)
        p = _softmax(scores, axis=-1)
        o = torch.einsum("bhqk,bhkd->bhqd", p, v)
        return (lambda x, *d: x.permute(*d))(o, 0, 2, 1, 3).reshape(B, S, D) @ wo

    def _B_ref(x, w1, b1, w2, b2):
        y = _layernorm(x, axis=-1)
        h = _gelu(torch.einsum("bsd,df->bsf", y, w1) + b1)
        return torch.einsum("bsf,fd->bsd", h, w2) + b2

    x = A_x
    x = x + _A_ref(_layernorm(x, axis=-1), A_wqkv, A_wo)
    x = x + _B_ref(_layernorm(x, axis=-1), B_w1, B_b1, B_w2, B_b2)
    x = x + _A_ref(_layernorm(x, axis=-1), A_wqkv, A_wo)
    x = x + _B_ref(_layernorm(x, axis=-1), B_w1, B_b1, B_w2, B_b2)
    return x
```

```asm
; @launch kernel=interleave_layers__mha_block__mixer_channel_mlp__prompt_kernel grid=(256,1,1) block=(256,1,1) lds=163840
.amdgcn_target "amdgcn-amd-amdhsa--gfx950"
.text
.globl interleave_layers__mha_block__mixer_channel_mlp__prompt_kernel
.p2align 12
.type interleave_layers__mha_block__mixer_channel_mlp__prompt_kernel,@function
interleave_layers__mha_block__mixer_channel_mlp__prompt_kernel:
    s_cmp_ge_u32 s2, 256
    s_cbranch_scc1 main_end
    s_load_dwordx2 s[8:9], s[0:1], 0
    s_load_dwordx2 s[12:13], s[0:1], 8
    s_load_dwordx2 s[4:5], s[0:1], 80
    s_load_dwordx2 s[68:69], s[0:1], 16
    s_load_dwordx4 s[72:75], s[0:1], 32
    s_load_dwordx4 s[76:79], s[0:1], 48
    s_load_dwordx2 s[70:71], s[0:1], 64
    s_getpc_b64 s[62:63]
main_pc:
    s_lshr_b32 s55, s2, 3
    s_lshl_b32 s64, s55, 12
    s_min_u32 s64, s64, code_end-main_pc-4096
    v_lshlrev_b32 v18, 4, v0
    s_add_u32 s62, s62, s64
    s_addc_u32 s63, s63, 0
    global_load_dwordx4 v[40:43], v18, s[62:63]
    v_lshrrev_b32 v1, 6, v0
    v_and_b32 v16, 63, v0
    v_readfirstlane_b32 s3, v1
    s_and_b32 s64, s2, 6
    s_lshr_b32 s57, s2, 6
    s_lshl1_add_u32 s57, s64, s57
    s_add_u32 s54, s55, s57
    s_and_b32 s54, s54, 3
    s_lshl_b32 s64, s54, 7
    v_lshrrev_b32 v19, 4, v16
    v_xor_b32 v19, v19, v16
    v_and_b32 v19, 7, v19
    v_lshl_add_u32 v19, v19, 4, s64
    v_lshrrev_b32 v20, 3, v16
    v_lshl_add_u32 v92, v20, 10, v19
    v_xor_b32 v93, 64, v92
    s_and_b32 s58, s3, 1
    s_lshr_b32 s59, s3, 1
    s_lshl_b32 s95, s57, 17
    s_lshl_b32 s65, s58, 16
    s_add_u32 s95, s95, s65
    s_lshl_b32 s65, s59, 9
    s_add_u32 s95, s95, s65
    s_lshl_b32 s53, s3, 14
    s_mov_b32 s10, 0x200000
    s_mov_b32 s11, 0x00020000
    s_mov_b32 s14, 0x180000
    s_mov_b32 s15, 0x00020000
    v_lshlrev_b32 v1, 4, v16
    v_lshrrev_b32 v17, 5, v16
    s_and_b32 s64, s2, 1
    s_and_b32 s56, s55, 7
    s_lshl3_add_u32 s56, s64, s56
    s_lshr_b32 s66, s56, 1
    s_and_b32 s67, s56, 1
    s_mul_i32 s64, s59, 0xc0000
    s_mul_i32 s65, s58, 0x18000
    s_add_u32 s64, s64, s65
    s_xor_b32 s65, s54, 0
    s_mul_i32 s65, s65, 0x30000
    s_add_u32 s60, s64, s65
    s_xor_b32 s65, s54, 1
    s_mul_i32 s65, s65, 0x30000
    s_add_u32 s61, s64, s65
    s_xor_b32 s65, s54, 2
    s_mul_i32 s65, s65, 0x30000
    s_add_u32 s62, s64, s65
    s_xor_b32 s65, s54, 3
    s_mul_i32 s65, s65, 0x30000
    s_add_u32 s63, s64, s65
    s_lshl_b32 s44, s3, 12
    s_lshl_b32 s49, s3, 11
    s_lshl_b32 s64, s67, 10
    s_lshl_b32 s65, s66, 7
    s_add_u32 s64, s64, s65
    v_lshrrev_b32 v19, 2, v16
    v_and_b32 v21, 4, v19
    v_xor_b32 v21, v21, v16
    v_and_b32 v21, 7, v21
    v_lshlrev_b32 v21, 4, v21
    v_mul_u32_u24 v20, 3072, v20
    v_add3_u32 v94, v20, v21, s64
    s_lshl_b32 s64, s56, 6
    s_add_u32 s64, s64, 0x800
    v_mul_u32_u24 v19, 3072, v19
    v_and_b32 v21, 48, v1
    v_add3_u32 v95, v19, v21, s64
    s_lshl_b32 s64, s66, 2
    s_lshl_b32 s65, s59, 1
    s_add_u32 s64, s64, s65
    s_lshl_b32 s27, s57, 12
    s_lshl_b32 s65, s58, 11
    s_add_u32 s27, s27, s65
    s_lshl_b32 s26, s64, 17
    s_add_u32 s26, s26, s27
    s_add_u32 s26, s26, 0x400000
    s_and_b32 s28, s64, 15
    s_lshr_b32 s64, s64, 4
    s_lshl_b32 s28, s28, 17
    s_lshl_b32 s65, s64, 10
    s_add_u32 s28, s28, s65
    s_add_u32 s28, s28, s27
    s_add_u32 s28, s28, 0x200000
    s_cmp_eq_u32 s67, 0
    s_cselect_b32 s26, s28, s26
    s_cselect_b32 s43, 0x3eb8aa3b, 1.0
    s_lshl_b32 s64, s56, 18
    s_lshl_b32 s65, s59, 9
    s_add_u32 s64, s64, s65
    s_add_u32 s64, s64, 0x400400
    s_add_u32 s27, s27, s64
    s_add_u32 s96, s26, 0x800000
    s_add_u32 s97, s27, 0x800000
    s_mov_b32 s6, 0x10000000
    s_mov_b32 s7, 0x00020000
    s_waitcnt lgkmcnt(0)
    s_add_u32 m0, s53, 0x10000
    s_mov_b32 s80, s95
    buffer_load_dwordx4 v92, s[8:11], s80 offen lds
    s_add_u32 s81, s95, 0x1c00
    buffer_load_dwordx4 v93, s[8:11], s81 offen offset:1024 lds
    s_add_u32 s82, s95, 0x3800
    buffer_load_dwordx4 v92, s[8:11], s82 offen offset:2048 lds
    s_add_u32 s83, s95, 0x5400
    buffer_load_dwordx4 v93, s[8:11], s83 offen offset:3072 lds
    v_xor_b32 v92, 128, v92
    v_xor_b32 v93, 128, v93
    s_add_u32 m0, s44, 0x20000
    s_mov_b32 s84, s60
    buffer_load_dwordx4 v94, s[12:15], s84 offen lds
    s_add_u32 s85, s60, 0x5c00
    buffer_load_dwordx4 v94, s[12:15], s85 offen offset:1024 lds
    s_add_u32 s86, s60, 0xb800
    buffer_load_dwordx4 v94, s[12:15], s86 offen offset:2048 lds
    s_add_u32 s87, s60, 0x11400
    buffer_load_dwordx4 v94, s[12:15], s87 offen offset:3072 lds
    s_add_u32 m0, s49, 0x8000
    s_nop 0
    buffer_load_dwordx4 v95, s[12:15], s84 offen lds
    s_add_u32 s88, s60, 0xbc00
    buffer_load_dwordx4 v95, s[12:15], s88 offen offset:1024 lds
    s_and_b32 s64, s55, 7
    s_lshl_b32 s64, s64, 12
    v_and_b32 v19, 48, v16
    v_and_b32 v20, 12, v16
    v_lshl_add_u32 v19, v19, 6, s64
    v_lshl_add_u32 v30, v20, 5, v19
    s_add_u32 m0, s53, 0x11000
    s_nop 0
    buffer_load_dwordx4 v92, s[8:11], s80 offen lds
    buffer_load_dwordx4 v93, s[8:11], s81 offen offset:1024 lds
    buffer_load_dwordx4 v92, s[8:11], s82 offen offset:2048 lds
    buffer_load_dwordx4 v93, s[8:11], s83 offen offset:3072 lds
    v_xor_b32 v92, 384, v92
    v_xor_b32 v93, 384, v93
    s_lshl_b32 s64, s59, 4
    v_and_b32 v19, 31, v16
    v_xor_b32 v20, s64, v19
    v_bfe_u32 v21, v20, 1, 3
    v_xor_b32 v21, v21, v17
    v_lshlrev_b32 v21, 4, v21
    v_lshl_add_u32 v21, v20, 7, v21
    s_add_u32 s64, s53, 65536
    v_add_u32 v88, s64, v21
    v_xor_b32 v89, 32, v88
    v_xor_b32 v90, 64, v88
    v_xor_b32 v91, 96, v88
    s_lshl_b32 s42, s66, 11
    s_lshl_b32 s65, s3, 9
    s_add_u32 s42, s42, s65
    s_lshl_b32 s65, s67, 8
    s_add_u32 s42, s42, s65
    s_lshl_b32 s64, s59, 8
    v_xor_b32 v3, s64, v1
    v_and_b32 v18, 0xf0, v1
    v_lshl_add_u32 v18, v17, 8, v18
    v_bfe_u32 v19, v16, 4, 1
    v_lshl_add_u32 v5, v19, 17, v18
    s_and_b32 s64, s57, 3
    s_lshr_b32 s28, s57, 2
    s_lshl_b32 s64, s64, 8
    s_lshl_b32 s65, s3, 14
    s_add_u32 s64, s64, s65
    s_lshl_b32 s65, s66, 11
    s_add_u32 s64, s64, s65
    s_lshl_b32 s65, s28, 4
    s_add_u32 s64, s64, s65
    s_lshl_b32 s65, s67, 3
    s_add_u32 s64, s64, s65
    s_lshl_b32 s28, s57, 14
    s_lshl_b32 s65, s67, 10
    s_add_u32 s28, s28, s65
    s_lshl_b32 s65, s3, 8
    s_add_u32 s28, s28, s65
    v_and_b32 v20, 6, v16
    v_and_b32 v21, 1, v16
    v_lshlrev_b32 v22, 10, v21
    v_lshl_add_u32 v20, v20, 15, v22
    v_add_u32 v8, s64, v20
    s_lshl_b32 s64, s66, 3
    s_add_u32 s64, s64, s28
    s_add_u32 s64, s64, 0x40
    v_and_b32 v20, 7, v16
    v_lshl_add_u32 v10, v20, 11, s64
    s_lshl_b32 s64, s66, 11
    s_add_u32 s64, s64, s28
    v_lshl_add_u32 v9, v20, 3, s64
    s_getreg_b32 s35, hwreg(HW_REG_XCC_ID, 0, 4)
    v_bfe_u32 v14, v16, 4, 2
    v_cmp_eq_u32 vcc, 1, v14
    v_mov_b32 v14, s35
    v_mov_b32 v15, 0
    v_cndmask_b32 v14, 0, v14, vcc
    v_and_b32 v20, 24, v16
    v_lshl_add_u32 v20, v20, 3, v9
    v_add_u32 v20, 0x150000, v20
    v_lshl_add_u32 v21, v21, 14, s42
    v_cmp_gt_u32 vcc, 32, v16
    v_mov_b32 v12, 1
    v_mov_b32 v13, 1
    v_cndmask_b32 v11, v21, v20, vcc
    v_accvgpr_write_b32 a208, -1
    v_accvgpr_write_b32 a209, -1
    v_accvgpr_write_b32 a210, -1
    v_accvgpr_write_b32 a211, -1
    v_mov_b32 v114, 0
    v_mov_b32 v115, 0
    v_mov_b32 v118, 0
    v_mov_b32 v119, 0
    v_accvgpr_write_b32 a206, 0
    v_accvgpr_write_b32 a207, 0
    s_mov_b32 s94, 20000
    s_mov_b32 s52, 0x3f803f80
    s_lshl_b32 s40, s2, 13
    s_lshl_b32 s65, s59, 10
    s_add_u32 s40, s40, s65
    s_add_u32 s40, s40, 0x800800
    s_sub_u32 s39, s40, 0x800
    s_lshl_b32 s38, s2, 13
    s_lshl_b32 s65, s3, 10
    s_add_u32 s38, s38, s65
    s_add_u32 s38, s38, 0x801000
    s_lshr_b32 s64, s57, 2
    s_lshl_b32 s55, s66, 2
    s_add_u32 s55, s55, s64
    s_and_b32 s64, s57, 3
    s_lshl_b32 s64, s64, 3
    s_lshl_b32 s65, s3, 1
    s_add_u32 s64, s64, s65
    s_add_u32 s64, s64, s67
    s_lshl_b32 s30, s64, 16
    s_lshl_b32 s65, s55, 10
    s_add_u32 s30, s30, s65
    s_add_u32 s30, s30, 0x800000
    s_and_b32 s28, s55, 15
    s_lshl_b32 s28, s28, 17
    s_lshl_b32 s65, s64, 11
    s_add_u32 s28, s28, s65
    s_add_u32 s28, s28, 0x200000
    s_lshr_b32 s64, s55, 4
    s_lshl_b32 s64, s64, 10
    s_add_u32 s28, s28, s64
    s_lshl_b32 s29, s55, 17
    s_lshl_b32 s65, s3, 12
    s_add_u32 s29, s29, s65
    s_add_u32 s29, s29, 0x400000
    s_lshr_b32 s33, s56, 3
    s_bfe_u32 s64, s57, 0x10001
    s_sub_u32 s33, s33, s64
    s_lshl1_add_u32 s57, s33, s57
    s_lshl_b32 s64, s33, 3
    s_sub_u32 s56, s56, s64
    s_lshr_b32 s66, s56, 1
    s_lshl_b32 s25, s57, 17
    s_lshl_b32 s65, s58, 16
    s_add_u32 s25, s25, s65
    s_lshl_b32 s65, s59, 14
    s_add_u32 s25, s25, s65
    s_lshl_b32 s54, s57, 2
    s_lshl_b32 s65, s67, 1
    s_add_u32 s54, s54, s65
    s_lshl_b32 s64, s66, 2
    s_add_u32 s64, s64, s3
    s_lshl_b32 s16, s54, 15
    s_lshl_b32 s65, s64, 10
    s_add_u32 s16, s16, s65
    s_lshl_b32 s48, s54, 15
    s_lshl_b32 s65, s64, 5
    s_add_u32 s48, s48, s65
    s_lshl_b32 s17, s54, 15
    s_lshl_b32 s65, s3, 13
    s_add_u32 s17, s17, s65
    s_lshr_b32 s64, s56, 2
    s_lshl_b32 s18, s54, 11
    s_lshl_b32 s65, s64, 9
    s_add_u32 s18, s18, s65
    s_and_b32 s64, s56, 2
    s_lshl_b32 s64, s64, 2
    s_add_u32 s18, s18, s64
    s_lshl_b32 s19, s57, 13
    s_lshl_b32 s20, s57, 13
    s_lshl_b32 s65, s58, 12
    s_add_u32 s20, s20, s65
    s_lshl_b32 s21, s57, 17
    s_lshl_b32 s65, s3, 12
    s_add_u32 s21, s21, s65
    s_mul_i32 s22, s3, 0x1010
    s_mul_i32 s24, s54, 0x1c000
    s_mul_i32 s65, s3, 0x7000
    s_add_u32 s24, s24, s65
    s_mul_i32 s36, s3, 0x18000
    s_lshl_b32 s65, s67, 10
    s_add_u32 s36, s36, s65
    s_lshl_b32 s65, s66, 7
    s_add_u32 s36, s36, s65
    s_mul_i32 s37, s3, 0x30000
    s_lshl_b32 s65, s56, 6
    s_add_u32 s37, s37, s65
    s_add_u32 s37, s37, 0x800
    s_mul_i32 s32, s3, 0x70000
    s_lshl_b32 s65, s66, 7
    s_add_u32 s32, s32, s65
    s_lshl_b32 s34, s3, 17
    s_lshl_b32 s65, s66, 7
    s_add_u32 s34, s34, s65
    s_cmp_ge_u32 s56, 14
    s_cselect_b32 s64, 2, 0
    s_sub_u32 s66, s56, s64
    s_lshl_b32 s66, s66, 2
    s_add_u32 s66, s66, s3
    s_mul_i32 s23, s57, 0x70000
    s_lshl_b32 s65, s66, 11
    s_add_u32 s23, s23, s65
    s_lshl_b32 s31, s66, 6
    s_lshl_b32 s46, s58, 5
    s_cmp_eq_u32 s59, 0
    s_mov_b32 s45, 0
    s_cmov_b32 s45, 65792
    s_mov_b32 s47, 82240
    s_cmov_b32 s47, 65792
    s_lshl_b32 s41, s2, 12
    s_lshl_b32 s65, s3, 10
    s_add_u32 s41, s41, s65
    s_lshl_b32 s64, s3, 3
    s_lshl_b32 s50, 0xff, s64
    s_mov_b32 s51, s50
    v_add_u32 v2, 0x10000, v1
    v_bfe_u32 v19, v16, 3, 2
    v_lshl_add_u32 v19, v19, 2, v1
    v_add_u32 v6, s22, v19
    v_add_u32 v125, 131584, v1
    s_xor_b32 s64, s3, 0
    s_mul_i32 s64, s64, 6144
    v_add_u32 v120, s64, v125
    s_xor_b32 s64, s3, 1
    s_mul_i32 s64, s64, 6144
    v_add_u32 v121, s64, v125
    s_xor_b32 s64, s3, 2
    s_mul_i32 s64, s64, 6144
    v_add_u32 v122, s64, v125
    s_xor_b32 s64, s3, 3
    s_mul_i32 s64, s64, 6144
    v_add_u32 v123, s64, v125
    v_xor_b32 v84, 256, v122
    s_lshl_b32 s64, s3, 2
    v_add_u32 v126, s64, v125
    v_and_b32 v19, 31, v16
    v_lshlrev_b32 v24, 4, v19
    v_lshl_add_u32 v127, v17, 2, v24
    s_lshl_b32 s64, s3, 8
    s_add_u32 s64, s64, 0x26c00
    v_lshlrev_b32 v20, 3, v19
    v_add_u32 v83, s64, v20
    v_xor_b32 v85, 0x280, v83
    v_bfe_u32 v23, v16, 2, 2
    v_lshl_add_u32 v20, v17, 3, v23
    v_and_b32 v21, 3, v16
    v_and_b32 v22, 16, v16
    v_lshlrev_b32 v22, 1, v22
    v_lshl_add_u32 v21, v21, 3, v22
    s_lshl_b32 s64, s59, 12
    v_lshl_add_u32 v22, v20, 6, v21
    v_add_u32 v82, s64, v22
    v_and_b32 v24, 8, v16
    v_lshl_add_u32 v21, v24, 3, v21
    v_lshl_add_u32 v22, v20, 7, v21
    s_mul_i32 s64, s59, 0x2040
    s_add_u32 s64, s64, 0x20000
    v_xor_b32 v80, s64, v22
    v_xor_b32 v81, 64, v80
    v_lshl_add_u32 v20, v17, 2, v23
    v_lshl_add_u32 v22, v20, 7, v21
    s_lshl_b32 s64, s3, 5
    v_xor_b32 v22, s64, v22
    s_add_u32 s64, s22, 32896
    v_add_u32 v124, s64, v22
    v_xad_u32 v4, v22, 64, s64
    v_lshrrev_b32 v20, 2, v16
    v_xor_b32 v20, v20, v16
    v_and_b32 v20, 4, v20
    v_cmp_eq_u32 vcc, 0, v20
    v_mov_b32 v20, s52
    s_nop 0
    v_cndmask_b32 v20, 0, v20, vcc
    v_accvgpr_write_b32 a220, v20
    v_accvgpr_write_b32 a221, v20
    v_accvgpr_write_b32 a222, v20
    v_accvgpr_write_b32 a223, v20
    v_cmp_gt_u32 vcc, 512, v1
    v_mov_b32 v51, s52
    s_nop 0
    v_cndmask_b32 v51, 0, v51, vcc
    v_mov_b32 v48, 0
    v_mov_b32 v49, 0
    v_mov_b32 v50, 0
    s_mov_b64 exec, 0
    s_cmp_eq_u32 s3, 0
    s_cbranch_scc1 PAD1
    s_cmp_eq_u32 s3, 1
    s_cbranch_scc1 PAD2
    s_cmp_eq_u32 s3, 2
    s_cbranch_scc1 PAD3
WARM8_3:
    s_mov_b64 exec, -1
    s_add_u32 m0, s53, 0x12000
    s_nop 0
    buffer_load_dwordx4 v92, s[8:11], s80 offen lds
    buffer_load_dwordx4 v93, s[8:11], s81 offen offset:1024 lds
    buffer_load_dwordx4 v92, s[8:11], s82 offen offset:2048 lds
    buffer_load_dwordx4 v93, s[8:11], s83 offen offset:3072 lds
    v_xor_b32 v92, 128, v92
    v_xor_b32 v93, 128, v93
    s_add_u32 m0, s44, 0x24000
    s_mov_b32 s89, s61
    buffer_load_dwordx4 v94, s[12:15], s89 offen lds
    s_add_u32 s90, s61, 0x5c00
    buffer_load_dwordx4 v94, s[12:15], s90 offen offset:1024 lds
    s_add_u32 s91, s61, 0xb800
    buffer_load_dwordx4 v94, s[12:15], s91 offen offset:2048 lds
    s_add_u32 s85, s61, 0x11400
    buffer_load_dwordx4 v94, s[12:15], s85 offen offset:3072 lds
    s_add_u32 m0, s49, 0xa000
    s_nop 0
    buffer_load_dwordx4 v95, s[12:15], s89 offen lds
    s_add_u32 s86, s61, 0xbc00
    buffer_load_dwordx4 v95, s[12:15], s86 offen offset:1024 lds
    s_waitcnt vmcnt(20)
    ds_read_b128 v[224:227], v88 offset:0
    ds_read_b128 v[228:231], v89 offset:0
    ds_read_b128 v[232:235], v90 offset:0
    ds_read_b128 v[236:239], v91 offset:0
    s_waitcnt vmcnt(10)
    ds_read_b128 v[240:243], v88 offset:4096
    ds_read_b128 v[244:247], v89 offset:4096
    ds_read_b128 v[248:251], v90 offset:4096
    ds_read_b128 v[252:255], v91 offset:4096
    s_waitcnt lgkmcnt(6)
    v_mfma_f32_16x16x32_bf16 v[52:55], a[220:223], v[224:227], 0
    v_dot2_f32_bf16 v56, v224, v224, 0
    v_dot2_f32_bf16 v57, v225, v225, 0
    v_dot2_f32_bf16 v58, v226, v226, 0
    v_dot2_f32_bf16 v59, v227, v227, 0
    v_mfma_f32_16x16x32_bf16 v[52:55], a[220:223], v[228:231], v[52:55]
    v_dot2_f32_bf16 v56, v228, v228, v56
    v_dot2_f32_bf16 v57, v229, v229, v57
    v_dot2_f32_bf16 v58, v230, v230, v58
    v_dot2_f32_bf16 v59, v231, v231, v59
    s_waitcnt lgkmcnt(4)
    v_mfma_f32_16x16x32_bf16 v[52:55], a[220:223], v[232:235], v[52:55]
    v_dot2_f32_bf16 v56, v232, v232, v56
    v_dot2_f32_bf16 v57, v233, v233, v57
    v_dot2_f32_bf16 v58, v234, v234, v58
    v_dot2_f32_bf16 v59, v235, v235, v59
    v_mfma_f32_16x16x32_bf16 v[52:55], a[220:223], v[236:239], v[52:55]
    v_dot2_f32_bf16 v56, v236, v236, v56
    v_dot2_f32_bf16 v57, v237, v237, v57
    v_dot2_f32_bf16 v58, v238, v238, v58
    v_dot2_f32_bf16 v59, v239, v239, v59
    s_barrier
    ds_read_b64_tr_b16 a[4:5], v81 offset:0
    ds_read_b64_tr_b16 a[6:7], v81 offset:512
    ds_read_b64_tr_b16 a[8:9], v82 offset:32768
    ds_read_b64_tr_b16 a[10:11], v82 offset:33024
    ds_read_b64_tr_b16 a[0:1], v80 offset:0
    ds_read_b64_tr_b16 a[2:3], v80 offset:512
    ds_read_b64_tr_b16 a[16:17], v81 offset:2048
    ds_read_b64_tr_b16 a[18:19], v81 offset:2560
    ds_read_b64_tr_b16 a[20:21], v82 offset:33792
    ds_read_b64_tr_b16 a[22:23], v82 offset:34048
    ds_read_b64_tr_b16 a[12:13], v80 offset:2048
    ds_read_b64_tr_b16 a[14:15], v80 offset:2560
    s_waitcnt lgkmcnt(9)
    v_mfma_f32_32x32x16_bf16 v[32:47], a[4:7], v[224:227], 0
    ds_read_b64_tr_b16 a[28:29], v81 offset:4096
    ds_read_b64_tr_b16 a[30:31], v81 offset:4608
    s_waitcnt lgkmcnt(9)
    v_mfma_f32_32x32x16_bf16 v[96:111], v[224:227], a[8:11], 0
    ds_read_b64_tr_b16 a[32:33], v82 offset:34816
    ds_read_b64_tr_b16 a[34:35], v82 offset:35072
    s_add_u32 m0, s53, 0x13000
    s_nop 0
    buffer_load_dwordx4 v92, s[8:11], s80 offen lds
    s_waitcnt lgkmcnt(9)
    v_mfma_f32_32x32x16_bf16 v[64:79], a[0:3], v[224:227], 0
    ds_read_b64_tr_b16 a[24:25], v80 offset:4096
    ds_read_b64_tr_b16 a[26:27], v80 offset:4608
    buffer_load_dwordx4 v93, s[8:11], s81 offen offset:1024 lds
    s_waitcnt lgkmcnt(9)
    v_mfma_f32_32x32x16_bf16 v[32:47], a[16:19], v[228:231], v[32:47]
    ds_read_b64_tr_b16 a[40:41], v81 offset:6144
    ds_read_b64_tr_b16 a[42:43], v81 offset:6656
    buffer_load_dwordx4 v92, s[8:11], s82 offen offset:2048 lds
    s_waitcnt lgkmcnt(9)
    v_mfma_f32_32x32x16_bf16 v[96:111], v[228:231], a[20:23], v[96:111]
    ds_read_b64_tr_b16 a[44:45], v82 offset:35840
    ds_read_b64_tr_b16 a[46:47], v82 offset:36096
    buffer_load_dwordx4 v93, s[8:11], s83 offen offset:3072 lds
    v_xor_b32 v92, 384, v92
    v_xor_b32 v93, 384, v93
    s_waitcnt lgkmcnt(9)
    v_mfma_f32_32x32x16_bf16 v[64:79], a[12:15], v[228:231], v[64:79]
    ds_read_b64_tr_b16 a[36:37], v80 offset:6144
    ds_read_b64_tr_b16 a[38:39], v80 offset:6656
    s_mov_b32 m0, s44
    s_mov_b32 s87, s62
    buffer_load_dwordx4 v94, s[12:15], s87 offen lds
    s_waitcnt lgkmcnt(9)
    v_mfma_f32_32x32x16_bf16 v[32:47], a[28:31], v[232:235], v[32:47]
    s_add_u32 s84, s62, 0x5c00
    buffer_load_dwordx4 v94, s[12:15], s84 offen offset:1024 lds
    v_dot2_f32_bf16 v56, v240, v240, v56
    s_waitcnt lgkmcnt(7)
    v_mfma_f32_32x32x16_bf16 v[96:111], v[232:235], a[32:35], v[96:111]
    s_add_u32 s88, s62, 0xb800
    buffer_load_dwordx4 v94, s[12:15], s88 offen offset:2048 lds
    v_dot2_f32_bf16 v57, v241, v241, v57
    s_waitcnt lgkmcnt(5)
    v_mfma_f32_32x32x16_bf16 v[64:79], a[24:27], v[232:235], v[64:79]
    s_add_u32 s90, s62, 0x11400
    buffer_load_dwordx4 v94, s[12:15], s90 offen offset:3072 lds
    v_dot2_f32_bf16 v58, v242, v242, v58
    s_waitcnt lgkmcnt(4)
    v_mfma_f32_32x32x16_bf16 v[32:47], a[40:43], v[236:239], v[32:47]
    s_add_u32 m0, s49, 0xc000
    s_nop 0
    buffer_load_dwordx4 v95, s[12:15], s87 offen lds
    v_dot2_f32_bf16 v59, v243, v243, v59
    s_waitcnt lgkmcnt(2)
    v_mfma_f32_32x32x16_bf16 v[96:111], v[236:239], a[44:47], v[96:111]
    s_add_u32 s91, s62, 0xbc00
    buffer_load_dwordx4 v95, s[12:15], s91 offen offset:1024 lds
    v_dot2_f32_bf16 v56, v244, v244, v56
    s_waitcnt lgkmcnt(0)
    v_mfma_f32_32x32x16_bf16 v[64:79], a[36:39], v[236:239], v[64:79]
    s_add_u32 m0, s44, 0x4000
    s_mov_b32 s85, s63
    buffer_load_dwordx4 v94, s[12:15], s85 offen lds
    v_dot2_f32_bf16 v57, v245, v245, v57
    v_mfma_f32_16x16x32_bf16 a[196:199], a[220:223], a[4:7], 0
    v_dot2_f32_bf16 v58, v246, v246, v58
    v_dot2_f32_bf16 v59, v247, v247, v59
    v_dot2_f32_bf16 v56, v248, v248, v56
    v_mfma_f32_16x16x32_bf16 a[200:203], a[220:223], a[8:11], 0
    v_dot2_f32_bf16 v57, v249, v249, v57
    v_dot2_f32_bf16 v58, v250, v250, v58
    v_dot2_f32_bf16 v59, v251, v251, v59
    v_mfma_f32_16x16x32_bf16 a[192:195], a[220:223], a[0:3], 0
    v_dot2_f32_bf16 v56, v252, v252, v56
    v_dot2_f32_bf16 v57, v253, v253, v57
    v_dot2_f32_bf16 v58, v254, v254, v58
    v_mfma_f32_16x16x32_bf16 v[52:55], a[220:223], v[240:243], v[52:55]
    v_dot2_f32_bf16 v59, v255, v255, v59
    v_mfma_f32_16x16x32_bf16 a[196:199], a[220:223], a[16:19], a[196:199]
    v_mfma_f32_16x16x32_bf16 a[200:203], a[220:223], a[20:23], a[200:203]
    v_mfma_f32_16x16x32_bf16 a[192:195], a[220:223], a[12:15], a[192:195]
    v_mfma_f32_16x16x32_bf16 v[52:55], a[220:223], v[244:247], v[52:55]
    v_mfma_f32_16x16x32_bf16 a[196:199], a[220:223], a[28:31], a[196:199]
    v_mfma_f32_16x16x32_bf16 a[200:203], a[220:223], a[32:35], a[200:203]
    v_mfma_f32_16x16x32_bf16 a[192:195], a[220:223], a[24:27], a[192:195]
    v_mfma_f32_16x16x32_bf16 v[52:55], a[220:223], v[248:251], v[52:55]
    v_mfma_f32_16x16x32_bf16 a[196:199], a[220:223], a[40:43], a[196:199]
    v_mfma_f32_16x16x32_bf16 a[200:203], a[220:223], a[44:47], a[200:203]
    v_mfma_f32_16x16x32_bf16 a[192:195], a[220:223], a[36:39], a[192:195]
    v_mfma_f32_16x16x32_bf16 v[52:55], a[220:223], v[252:255], v[52:55]
    s_waitcnt vmcnt(17)
    ds_read_b128 v[128:131], v88 offset:8192
    ds_read_b128 v[132:135], v89 offset:8192
    ds_read_b128 v[136:139], v90 offset:8192
    ds_read_b128 v[140:143], v91 offset:8192
    s_waitcnt vmcnt(11)
    s_barrier
    ds_read_b64_tr_b16 a[52:53], v81 offset:16384
    ds_read_b64_tr_b16 a[54:55], v81 offset:16896
    ds_read_b64_tr_b16 a[56:57], v82 offset:40960
    ds_read_b64_tr_b16 a[58:59], v82 offset:41216
    ds_read_b64_tr_b16 a[48:49], v80 offset:16384
    ds_read_b64_tr_b16 a[50:51], v80 offset:16896
    ds_read_b64_tr_b16 a[64:65], v81 offset:18432
    ds_read_b64_tr_b16 a[66:67], v81 offset:18944
    ds_read_b64_tr_b16 a[68:69], v82 offset:41984
    ds_read_b64_tr_b16 a[70:71], v82 offset:42240
    ds_read_b64_tr_b16 a[60:61], v80 offset:18432
    ds_read_b64_tr_b16 a[62:63], v80 offset:18944
    s_waitcnt lgkmcnt(9)
    v_mfma_f32_32x32x16_bf16 v[32:47], a[52:55], v[240:243], v[32:47]
    ds_read_b64_tr_b16 a[76:77], v81 offset:20480
    ds_read_b64_tr_b16 a[78:79], v81 offset:20992
    s_waitcnt lgkmcnt(9)
    v_mfma_f32_32x32x16_bf16 v[96:111], v[240:243], a[56:59], v[96:111]
    ds_read_b64_tr_b16 a[80:81], v82 offset:43008
    ds_read_b64_tr_b16 a[82:83], v82 offset:43264
    s_add_u32 s89, s63, 0x5c00
    buffer_load_dwordx4 v94, s[12:15], s89 offen offset:1024 lds
    s_waitcnt lgkmcnt(9)
    v_mfma_f32_32x32x16_bf16 v[64:79], a[48:51], v[240:243], v[64:79]
    ds_read_b64_tr_b16 a[72:73], v80 offset:20480
    ds_read_b64_tr_b16 a[74:75], v80 offset:20992
    s_add_u32 s86, s63, 0xb800
    buffer_load_dwordx4 v94, s[12:15], s86 offen offset:2048 lds
    s_waitcnt lgkmcnt(9)
    v_mfma_f32_32x32x16_bf16 v[32:47], a[64:67], v[244:247], v[32:47]
    ds_read_b64_tr_b16 a[88:89], v81 offset:22528
    ds_read_b64_tr_b16 a[90:91], v81 offset:23040
    s_add_u32 s80, s63, 0x11400
    buffer_load_dwordx4 v94, s[12:15], s80 offen offset:3072 lds
    s_waitcnt lgkmcnt(9)
    v_mfma_f32_32x32x16_bf16 v[96:111], v[244:247], a[68:71], v[96:111]
    ds_read_b64_tr_b16 a[92:93], v82 offset:44032
    ds_read_b64_tr_b16 a[94:95], v82 offset:44288
    s_add_u32 m0, s49, 0xe000
    s_nop 0
    buffer_load_dwordx4 v95, s[12:15], s85 offen lds
    s_waitcnt lgkmcnt(9)
    v_mfma_f32_32x32x16_bf16 v[64:79], a[60:63], v[244:247], v[64:79]
    ds_read_b64_tr_b16 a[84:85], v80 offset:22528
    ds_read_b64_tr_b16 a[86:87], v80 offset:23040
    s_add_u32 s81, s63, 0xbc00
    buffer_load_dwordx4 v95, s[12:15], s81 offen offset:1024 lds
    s_waitcnt lgkmcnt(9)
    v_mfma_f32_32x32x16_bf16 v[32:47], a[76:79], v[248:251], v[32:47]
    v_subrev_u32 v80, 0x20000, v80
    v_subrev_u32 v81, 0x20000, v81
    s_add_u32 m0, s53, 0x10000
    s_add_u32 s82, s95, 0x8000
    buffer_load_dwordx4 v92, s[8:11], s82 offen lds
    s_waitcnt lgkmcnt(7)
    v_mfma_f32_32x32x16_bf16 v[96:111], v[248:251], a[80:83], v[96:111]
    s_add_u32 s83, s95, 0x9c00
    buffer_load_dwordx4 v93, s[8:11], s83 offen offset:1024 lds
    v_dot2_f32_bf16 v56, v128, v128, v56
    s_waitcnt lgkmcnt(5)
    v_mfma_f32_32x32x16_bf16 v[64:79], a[72:75], v[248:251], v[64:79]
    s_add_u32 s84, s95, 0xb800
    buffer_load_dwordx4 v92, s[8:11], s84 offen offset:2048 lds
    v_dot2_f32_bf16 v57, v129, v129, v57
    s_waitcnt lgkmcnt(4)
    v_mfma_f32_32x32x16_bf16 v[32:47], a[88:91], v[252:255], v[32:47]
    s_add_u32 s88, s95, 0xd400
    buffer_load_dwordx4 v93, s[8:11], s88 offen offset:3072 lds
    v_xor_b32 v92, 128, v92
    v_xor_b32 v93, 128, v93
    s_waitcnt lgkmcnt(2)
    v_mfma_f32_32x32x16_bf16 v[96:111], v[252:255], a[92:95], v[96:111]
    s_add_u32 m0, s53, 0x11000
    s_nop 0
    buffer_load_dwordx4 v92, s[8:11], s82 offen lds
    v_dot2_f32_bf16 v58, v130, v130, v58
    s_waitcnt lgkmcnt(0)
    v_mfma_f32_32x32x16_bf16 v[64:79], a[84:87], v[252:255], v[64:79]
    buffer_load_dwordx4 v93, s[8:11], s83 offen offset:1024 lds
    v_dot2_f32_bf16 v59, v131, v131, v59
    v_mfma_f32_16x16x32_bf16 a[196:199], a[220:223], a[52:55], a[196:199]
    v_dot2_f32_bf16 v56, v132, v132, v56
    v_dot2_f32_bf16 v57, v133, v133, v57
    v_dot2_f32_bf16 v58, v134, v134, v58
    v_mfma_f32_16x16x32_bf16 a[200:203], a[220:223], a[56:59], a[200:203]
    v_dot2_f32_bf16 v59, v135, v135, v59
    v_dot2_f32_bf16 v56, v136, v136, v56
    v_dot2_f32_bf16 v57, v137, v137, v57
PAD1:
    s_cbranch_execz WARM8_3
    v_mfma_f32_16x16x32_bf16 a[192:195], a[220:223], a[48:51], a[192:195]
    v_dot2_f32_bf16 v58, v138, v138, v58
    v_dot2_f32_bf16 v59, v139, v139, v59
    v_dot2_f32_bf16 v56, v140, v140, v56
    v_mfma_f32_16x16x32_bf16 v[52:55], a[220:223], v[128:131], v[52:55]
    v_dot2_f32_bf16 v57, v141, v141, v57
    v_dot2_f32_bf16 v58, v142, v142, v58
    v_dot2_f32_bf16 v59, v143, v143, v59
    v_mfma_f32_16x16x32_bf16 a[196:199], a[220:223], a[64:67], a[196:199]
    v_mfma_f32_16x16x32_bf16 a[200:203], a[220:223], a[68:71], a[200:203]
    v_mfma_f32_16x16x32_bf16 a[192:195], a[220:223], a[60:63], a[192:195]
    v_mfma_f32_16x16x32_bf16 v[52:55], a[220:223], v[132:135], v[52:55]
    v_mfma_f32_16x16x32_bf16 a[196:199], a[220:223], a[76:79], a[196:199]
    v_mfma_f32_16x16x32_bf16 a[200:203], a[220:223], a[80:83], a[200:203]
    v_mfma_f32_16x16x32_bf16 a[192:195], a[220:223], a[72:75], a[192:195]
    v_mfma_f32_16x16x32_bf16 v[52:55], a[220:223], v[136:139], v[52:55]
    v_mfma_f32_16x16x32_bf16 a[196:199], a[220:223], a[88:91], a[196:199]
    v_mfma_f32_16x16x32_bf16 a[200:203], a[220:223], a[92:95], a[200:203]
    v_mfma_f32_16x16x32_bf16 a[192:195], a[220:223], a[84:87], a[192:195]
    v_mfma_f32_16x16x32_bf16 v[52:55], a[220:223], v[140:143], v[52:55]
    s_waitcnt vmcnt(18)
    ds_read_b128 v[144:147], v88 offset:12288
    ds_read_b128 v[148:151], v89 offset:12288
    ds_read_b128 v[152:155], v90 offset:12288
    ds_read_b128 v[156:159], v91 offset:12288
    s_waitcnt vmcnt(12)
    s_barrier
    ds_read_b64_tr_b16 a[100:101], v81 offset:0
    ds_read_b64_tr_b16 a[102:103], v81 offset:512
    ds_read_b64_tr_b16 a[104:105], v82 offset:49152
    ds_read_b64_tr_b16 a[106:107], v82 offset:49408
    ds_read_b64_tr_b16 a[96:97], v80 offset:0
    ds_read_b64_tr_b16 a[98:99], v80 offset:512
    ds_read_b64_tr_b16 a[112:113], v81 offset:2048
    ds_read_b64_tr_b16 a[114:115], v81 offset:2560
    ds_read_b64_tr_b16 a[116:117], v82 offset:50176
    ds_read_b64_tr_b16 a[118:119], v82 offset:50432
    ds_read_b64_tr_b16 a[108:109], v80 offset:2048
    ds_read_b64_tr_b16 a[110:111], v80 offset:2560
    s_waitcnt lgkmcnt(9)
    v_mfma_f32_32x32x16_bf16 v[32:47], a[100:103], v[128:131], v[32:47]
    ds_read_b64_tr_b16 a[124:125], v81 offset:4096
    ds_read_b64_tr_b16 a[126:127], v81 offset:4608
    s_waitcnt lgkmcnt(9)
    v_mfma_f32_32x32x16_bf16 v[96:111], v[128:131], a[104:107], v[96:111]
    ds_read_b64_tr_b16 a[128:129], v82 offset:51200
    ds_read_b64_tr_b16 a[130:131], v82 offset:51456
    buffer_load_dwordx4 v92, s[8:11], s84 offen offset:2048 lds
    s_waitcnt lgkmcnt(9)
    v_mfma_f32_32x32x16_bf16 v[64:79], a[96:99], v[128:131], v[64:79]
    ds_read_b64_tr_b16 a[120:121], v80 offset:4096
    ds_read_b64_tr_b16 a[122:123], v80 offset:4608
    buffer_load_dwordx4 v93, s[8:11], s88 offen offset:3072 lds
    v_xor_b32 v92, 384, v92
    v_xor_b32 v93, 384, v93
    s_waitcnt lgkmcnt(9)
    v_mfma_f32_32x32x16_bf16 v[32:47], a[112:115], v[132:135], v[32:47]
    ds_read_b64_tr_b16 a[136:137], v81 offset:6144
    ds_read_b64_tr_b16 a[138:139], v81 offset:6656
    s_add_u32 m0, s53, 0x12000
    s_nop 0
    buffer_load_dwordx4 v92, s[8:11], s82 offen lds
    s_waitcnt lgkmcnt(9)
    v_mfma_f32_32x32x16_bf16 v[96:111], v[132:135], a[116:119], v[96:111]
    ds_read_b64_tr_b16 a[140:141], v82 offset:52224
    ds_read_b64_tr_b16 a[142:143], v82 offset:52480
    buffer_load_dwordx4 v93, s[8:11], s83 offen offset:1024 lds
    s_waitcnt lgkmcnt(9)
    v_mfma_f32_32x32x16_bf16 v[64:79], a[108:111], v[132:135], v[64:79]
    ds_read_b64_tr_b16 a[132:133], v80 offset:6144
    ds_read_b64_tr_b16 a[134:135], v80 offset:6656
    buffer_load_dwordx4 v92, s[8:11], s84 offen offset:2048 lds
    s_waitcnt lgkmcnt(9)
    v_mfma_f32_32x32x16_bf16 v[32:47], a[124:127], v[136:139], v[32:47]
    buffer_load_dwordx4 v93, s[8:11], s88 offen offset:3072 lds
    v_xor_b32 v92, 128, v92
    v_xor_b32 v93, 128, v93
    s_waitcnt lgkmcnt(7)
    v_mfma_f32_32x32x16_bf16 v[96:111], v[136:139], a[128:131], v[96:111]
    s_add_u32 m0, s53, 0x13000
    s_nop 0
    buffer_load_dwordx4 v92, s[8:11], s82 offen lds
    v_dot2_f32_bf16 v56, v144, v144, v56
    s_waitcnt lgkmcnt(5)
    v_mfma_f32_32x32x16_bf16 v[64:79], a[120:123], v[136:139], v[64:79]
    buffer_load_dwordx4 v93, s[8:11], s83 offen offset:1024 lds
    v_dot2_f32_bf16 v57, v145, v145, v57
    s_waitcnt lgkmcnt(4)
    v_mfma_f32_32x32x16_bf16 v[32:47], a[136:139], v[140:143], v[32:47]
    buffer_load_dwordx4 v92, s[8:11], s84 offen offset:2048 lds
    v_dot2_f32_bf16 v58, v146, v146, v58
    s_waitcnt lgkmcnt(2)
    v_mfma_f32_32x32x16_bf16 v[96:111], v[140:143], a[140:143], v[96:111]
    buffer_load_dwordx4 v93, s[8:11], s88 offen offset:3072 lds
    v_dot2_f32_bf16 v59, v147, v147, v59
    s_waitcnt lgkmcnt(0)
    v_mfma_f32_32x32x16_bf16 v[64:79], a[132:135], v[140:143], v[64:79]
    s_mov_b32 s90, 0x5f0000
    buffer_store_dwordx2 v[14:15], v11, s[4:7], s90 offen sc1
    v_dot2_f32_bf16 v56, v148, v148, v56
    v_mfma_f32_16x16x32_bf16 a[196:199], a[220:223], a[100:103], a[196:199]
    v_dot2_f32_bf16 v57, v149, v149, v57
    v_dot2_f32_bf16 v58, v150, v150, v58
    v_dot2_f32_bf16 v59, v151, v151, v59
    v_mfma_f32_16x16x32_bf16 a[200:203], a[220:223], a[104:107], a[200:203]
    v_dot2_f32_bf16 v56, v152, v152, v56
    v_dot2_f32_bf16 v57, v153, v153, v57
    v_dot2_f32_bf16 v58, v154, v154, v58
    v_mfma_f32_16x16x32_bf16 a[192:195], a[220:223], a[96:99], a[192:195]
    v_dot2_f32_bf16 v59, v155, v155, v59
    v_dot2_f32_bf16 v56, v156, v156, v56
    v_dot2_f32_bf16 v57, v157, v157, v57
    v_mfma_f32_16x16x32_bf16 v[52:55], a[220:223], v[144:147], v[52:55]
    v_dot2_f32_bf16 v58, v158, v158, v58
    v_dot2_f32_bf16 v59, v159, v159, v59
    v_mfma_f32_16x16x32_bf16 a[196:199], a[220:223], a[112:115], a[196:199]
    v_mfma_f32_16x16x32_bf16 a[200:203], a[220:223], a[116:119], a[200:203]
    v_mfma_f32_16x16x32_bf16 a[192:195], a[220:223], a[108:111], a[192:195]
    v_mfma_f32_16x16x32_bf16 v[52:55], a[220:223], v[148:151], v[52:55]
    v_mfma_f32_16x16x32_bf16 a[196:199], a[220:223], a[124:127], a[196:199]
    v_mfma_f32_16x16x32_bf16 a[200:203], a[220:223], a[128:131], a[200:203]
    v_mfma_f32_16x16x32_bf16 a[192:195], a[220:223], a[120:123], a[192:195]
    v_mfma_f32_16x16x32_bf16 v[52:55], a[220:223], v[152:155], v[52:55]
    v_mfma_f32_16x16x32_bf16 a[196:199], a[220:223], a[136:139], a[196:199]
    v_mfma_f32_16x16x32_bf16 a[200:203], a[220:223], a[140:143], a[200:203]
    v_mfma_f32_16x16x32_bf16 a[192:195], a[220:223], a[132:135], a[192:195]
    v_mfma_f32_16x16x32_bf16 v[52:55], a[220:223], v[156:159], v[52:55]
    v_add_f32 v56, v56, v57
    v_add_f32 v58, v58, v59
    v_add_f32 v57, v56, v58
    v_add_f32 v56, v56, v58
    s_nop 1
    v_permlane32_swap_b32 v56, v57
    s_nop 0
    v_add_f32 v53, v56, v57
    ds_write_b64 v83, v[52:53] offset:0
    s_waitcnt vmcnt(17) lgkmcnt(0)
    s_barrier
    ds_read_b64_tr_b16 a[148:149], v81 offset:16384
    ds_read_b64_tr_b16 a[150:151], v81 offset:16896
    ds_read_b64_tr_b16 a[152:153], v82 offset:57344
    ds_read_b64_tr_b16 a[154:155], v82 offset:57600
    ds_read_b64_tr_b16 a[144:145], v80 offset:16384
    ds_read_b64_tr_b16 a[146:147], v80 offset:16896
    ds_read_b64_tr_b16 a[160:161], v81 offset:18432
    ds_read_b64_tr_b16 a[162:163], v81 offset:18944
    ds_read_b64_tr_b16 a[164:165], v82 offset:58368
    ds_read_b64_tr_b16 a[166:167], v82 offset:58624
    ds_read_b64_tr_b16 a[156:157], v80 offset:18432
    ds_read_b64_tr_b16 a[158:159], v80 offset:18944
    s_waitcnt lgkmcnt(9)
    v_mfma_f32_16x16x32_bf16 a[196:199], a[220:223], a[148:151], a[196:199]
    ds_read_b64_tr_b16 a[172:173], v81 offset:20480
    ds_read_b64_tr_b16 a[174:175], v81 offset:20992
    ds_read_b64 v[54:55], v85 offset:0
    s_waitcnt lgkmcnt(10)
    v_mfma_f32_16x16x32_bf16 a[200:203], a[220:223], a[152:155], a[200:203]
    ds_read_b64_tr_b16 a[176:177], v82 offset:59392
    ds_read_b64_tr_b16 a[178:179], v82 offset:59648
    s_add_u32 s87, s26, 0x800000
    buffer_store_dwordx4 a[208:211], v3, s[4:7], s87 offen sc1
    s_waitcnt lgkmcnt(10)
    v_mfma_f32_16x16x32_bf16 a[192:195], a[220:223], a[144:147], a[192:195]
    ds_read_b64_tr_b16 a[168:169], v80 offset:20480
    ds_read_b64_tr_b16 a[170:171], v80 offset:20992
    s_waitcnt lgkmcnt(10)
    v_mfma_f32_16x16x32_bf16 a[196:199], a[220:223], a[160:163], a[196:199]
    ds_read_b64_tr_b16 a[184:185], v81 offset:22528
    ds_read_b64_tr_b16 a[186:187], v81 offset:23040
    s_waitcnt lgkmcnt(10)
    v_mfma_f32_16x16x32_bf16 a[200:203], a[220:223], a[164:167], a[200:203]
    ds_read_b64_tr_b16 a[188:189], v82 offset:60416
    ds_read_b64_tr_b16 a[190:191], v82 offset:60672
    s_add_u32 s91, s26, 0x820000
    buffer_store_dwordx4 a[208:211], v3, s[4:7], s91 offen sc1
    s_waitcnt lgkmcnt(10)
    v_mfma_f32_16x16x32_bf16 a[192:195], a[220:223], a[156:159], a[192:195]
    ds_read_b64_tr_b16 a[180:181], v80 offset:22528
    ds_read_b64_tr_b16 a[182:183], v80 offset:23040
    v_mfma_f32_32x32x16_bf16 v[32:47], a[148:151], v[144:147], v[32:47]
    s_waitcnt lgkmcnt(10)
    v_add_f32 v52, v52, v54
    v_add_f32 v53, v53, v55
    v_mul_f32 v52, 0xbb000000, v52
    v_mul_f32 v53, 0x3b000000, v53
    v_fma_f32 v53, -v52, v52, v53
    v_max_f32 v53, 0, v53
    v_mfma_f32_32x32x16_bf16 v[96:111], v[144:147], a[152:155], v[96:111]
    v_add_f32 v56, 0x3727c5ac, v53
    v_rsq_f32 v54, v56
    v_cvt_pk_bf16_f32 v60, v52, v52
    v_lshlrev_b32 v57, 16, v60
    v_mfma_f32_32x32x16_bf16 v[64:79], a[144:147], v[144:147], v[64:79]
    s_add_u32 s89, s27, 0x800000
    buffer_store_dwordx4 a[208:211], v5, s[4:7], s89 offen sc1
    v_rcp_f32 v55, v54
    v_mfma_f32_16x16x32_bf16 a[196:199], a[220:223], a[172:175], a[196:199]
    v_sub_f32 v57, v52, v57
    v_cvt_pk_bf16_f32 v58, v54, v54
    v_cvt_pk_bf16_f32 v61, v57, v55
    v_lshlrev_b32 v58, 16, v58
    v_and_b32 v57, 0xffff0000, v61
    v_sub_f32 v58, v54, v58
    s_waitcnt lgkmcnt(7)
    v_mfma_f32_16x16x32_bf16 a[200:203], a[220:223], a[176:179], a[200:203]
    v_sub_f32 v57, v55, v57
    v_cvt_pk_bf16_f32 v63, v54, v58
    v_cvt_pk_bf16_f32 v62, v57, 0
    v_cmp_gt_u32 vcc, 512, v1
    v_mul_f32 v86, s43, v54
    s_nop 0
    v_cndmask_b32 v60, 0, v60, vcc
    v_cndmask_b32 v61, 0, v61, vcc
    s_waitcnt lgkmcnt(5)
    v_mfma_f32_16x16x32_bf16 a[192:195], a[220:223], a[168:171], a[192:195]
    s_waitcnt lgkmcnt(4)
    v_mfma_f32_16x16x32_bf16 a[196:199], a[220:223], a[184:187], a[196:199]
    s_waitcnt lgkmcnt(2)
    v_mfma_f32_16x16x32_bf16 a[200:203], a[220:223], a[188:191], a[200:203]
    s_waitcnt lgkmcnt(0)
    v_mfma_f32_16x16x32_bf16 a[192:195], a[220:223], a[180:183], a[192:195]
    v_mfma_f32_32x32x16_bf16 v[32:47], a[160:163], v[148:151], v[32:47]
    v_mfma_f32_32x32x16_bf16 v[96:111], v[148:151], a[164:167], v[96:111]
    s_nop 1
    v_accvgpr_read_b32 v18, a196
    s_nop 0
    v_accvgpr_read_b32 v20, a200
    s_nop 0
    v_accvgpr_read_b32 v16, a192
    v_cvt_pk_bf16_f32 v117, v18, 0
    v_cvt_pk_bf16_f32 v23, v20, 0
    v_cvt_pk_bf16_f32 v113, v16, 0
    v_mfma_f32_32x32x16_bf16 v[64:79], a[156:159], v[148:151], v[64:79]
    v_lshlrev_b32 v19, 16, v117
    v_lshlrev_b32 v21, 16, v23
    v_lshlrev_b32 v17, 16, v113
    v_sub_f32 v19, v18, v19
    v_sub_f32 v21, v20, v21
    v_sub_f32 v17, v16, v17
    v_mfma_f32_32x32x16_bf16 v[32:47], a[172:175], v[152:155], v[32:47]
    v_cvt_pk_bf16_f32 v116, v18, v19
    v_cvt_pk_bf16_f32 v22, v20, v21
    v_cvt_pk_bf16_f32 v112, v16, v17
    v_accvgpr_write_b32 a204, v22
    v_accvgpr_write_b32 a205, v23
    v_xor_b32 v19, 8, v126
    v_mfma_f32_32x32x16_bf16 v[96:111], v[152:155], a[176:179], v[96:111]
    ds_write_b32 v19, v18 offset:24576
    v_mfma_f32_32x32x16_bf16 v[64:79], a[168:171], v[152:155], v[64:79]
    v_mfma_f32_32x32x16_bf16 v[16:31], v[60:63], v[48:51], 0
    s_waitcnt vmcnt(16)
    ds_read_b128 v[160:163], v88 offset:0
    ds_read_b128 v[164:167], v89 offset:0
    ds_read_b128 v[168:171], v90 offset:0
    ds_read_b128 v[172:175], v91 offset:0
    v_mfma_f32_32x32x16_bf16 v[32:47], v[116:119], v[60:63], v[32:47]
    v_mfma_f32_32x32x16_bf16 v[96:111], v[60:63], a[204:207], v[96:111]
    v_mfma_f32_32x32x16_bf16 v[64:79], v[112:115], v[60:63], v[64:79]
    v_mfma_f32_32x32x16_bf16 v[32:47], a[184:187], v[156:159], v[32:47]
    v_mfma_f32_32x32x16_bf16 v[96:111], v[156:159], a[188:191], v[96:111]
    v_mfma_f32_32x32x16_bf16 v[64:79], a[180:183], v[156:159], v[64:79]
    s_nop 9
    ds_write_b128 v84, v[32:35] offset:0
    ds_write_b128 v84, v[36:39] offset:1024
    ds_write_b128 v84, v[40:43] offset:2048
    ds_write_b128 v84, v[44:47] offset:3072
    ds_write_b128 v122, v[104:107] offset:4096
    ds_write_b128 v122, v[108:111] offset:5120
    v_mul_f32 v64, v86, v64
    v_mul_f32 v65, v86, v65
    s_waitcnt lgkmcnt(8)
    v_mfma_f32_32x32x16_bf16 v[240:255], a[4:7], v[160:163], 0
    v_mul_f32 v66, v86, v66
    v_mul_f32 v67, v86, v67
    v_mul_f32 v68, v86, v68
    v_mul_f32 v69, v86, v69
    v_mul_f32 v70, v86, v70
    v_mul_f32 v71, v86, v71
    v_mul_f32 v72, v86, v72
    v_mul_f32 v73, v86, v73
    v_mul_f32 v74, v86, v74
    v_mul_f32 v75, v86, v75
    v_mfma_f32_32x32x16_bf16 v[128:143], v[160:163], a[8:11], 0
    v_mul_f32 v76, v86, v76
    v_mul_f32 v77, v86, v77
    v_mul_f32 v78, v86, v78
    v_mul_f32 v79, v86, v79
    s_waitcnt vmcnt(0)
    s_waitcnt lgkmcnt(0)
    s_barrier
    s_mov_b32 s86, 0x740000
    buffer_store_dword v12, v8, s[4:7], s86 offen sc1
    ds_read_b128 v[32:35], v120 offset:0
    v_mfma_f32_32x32x16_bf16 v[224:239], a[0:3], v[160:163], 0
    ds_read_b128 v[36:39], v120 offset:1024
    ds_read_b128 v[40:43], v120 offset:2048
    ds_read_b128 v[44:47], v120 offset:3072
    ds_read_b128 v[104:107], v120 offset:4096
    ds_read_b128 v[108:111], v120 offset:5120
    ds_read_b32 v15, v126 offset:24576
    v_mul_f32 v96, v16, v96
    v_mfma_f32_16x16x32_bf16 v[52:55], a[220:223], v[160:163], 0
    v_mul_f32 v97, v17, v97
    v_mul_f32 v98, v18, v98
    v_mul_f32 v99, v19, v99
    v_mul_f32 v100, v20, v100
    v_mul_f32 v101, v21, v101
    v_mul_f32 v102, v22, v102
    v_mul_f32 v103, v23, v103
    s_waitcnt lgkmcnt(6)
    v_fmac_f32 v64, v86, v32
    v_fmac_f32 v65, v86, v33
    v_fmac_f32 v66, v86, v34
    v_mfma_f32_16x16x32_bf16 v[52:55], a[220:223], v[164:167], v[52:55]
    v_fmac_f32 v67, v86, v35
    s_waitcnt lgkmcnt(5)
    v_fmac_f32 v68, v86, v36
    v_fmac_f32 v69, v86, v37
    v_fmac_f32 v70, v86, v38
    v_fmac_f32 v71, v86, v39
    v_cvt_pk_bf16_f32 v64, v64, v65
    v_cvt_pk_bf16_f32 v65, v66, v67
    v_cvt_pk_bf16_f32 v66, v68, v69
    v_cvt_pk_bf16_f32 v67, v70, v71
    v_mfma_f32_32x32x16_bf16 v[240:255], a[16:19], v[164:167], v[240:255]
    buffer_store_dwordx4 v[64:67], v3, s[4:7], s87 offen sc1
    s_waitcnt lgkmcnt(4)
    v_fmac_f32 v72, v86, v40
    v_fmac_f32 v73, v86, v41
    v_fmac_f32 v74, v86, v42
    v_fmac_f32 v75, v86, v43
    s_waitcnt lgkmcnt(3)
    v_fmac_f32 v76, v86, v44
    v_fmac_f32 v77, v86, v45
    v_mfma_f32_32x32x16_bf16 v[128:143], v[164:167], a[20:23], v[128:143]
    v_fmac_f32 v78, v86, v46
    v_fmac_f32 v79, v86, v47
    v_cvt_pk_bf16_f32 v72, v72, v73
    v_cvt_pk_bf16_f32 v73, v74, v75
    v_cvt_pk_bf16_f32 v74, v76, v77
    v_cvt_pk_bf16_f32 v75, v78, v79
    buffer_store_dwordx4 v[72:75], v3, s[4:7], s91 offen sc1
    v_mfma_f32_32x32x16_bf16 v[224:239], a[12:15], v[164:167], v[224:239]
    ds_read_b128 v[176:179], v88 offset:4096
    ds_read_b128 v[180:183], v89 offset:4096
    ds_read_b128 v[184:187], v90 offset:4096
    ds_read_b128 v[188:191], v91 offset:4096
    s_waitcnt lgkmcnt(6)
    v_fmac_f32 v96, v16, v104
    v_fmac_f32 v97, v17, v105
    v_fmac_f32 v98, v18, v106
    v_fmac_f32 v99, v19, v107
    v_mfma_f32_16x16x32_bf16 v[52:55], a[220:223], v[168:171], v[52:55]
    s_waitcnt lgkmcnt(5)
    v_fmac_f32 v100, v20, v108
    v_fmac_f32 v101, v21, v109
    v_fmac_f32 v102, v22, v110
    v_fmac_f32 v103, v23, v111
    v_cvt_pk_bf16_f32 v96, v96, v97
    v_cvt_pk_bf16_f32 v97, v98, v99
    v_cvt_pk_bf16_f32 v98, v100, v101
    v_cvt_pk_bf16_f32 v99, v102, v103
    v_mfma_f32_16x16x32_bf16 v[52:55], a[220:223], v[172:175], v[52:55]
    buffer_store_dwordx4 v[96:99], v5, s[4:7], s89 offen sc1
    v_mfma_f32_32x32x16_bf16 v[240:255], a[28:31], v[168:171], v[240:255]
    v_mfma_f32_32x32x16_bf16 v[128:143], v[168:171], a[32:35], v[128:143]
    v_mfma_f32_32x32x16_bf16 v[224:239], a[24:27], v[168:171], v[224:239]
    s_waitcnt lgkmcnt(3)
    v_mfma_f32_16x16x32_bf16 v[52:55], a[220:223], v[176:179], v[52:55]
    s_waitcnt lgkmcnt(2)
    v_mfma_f32_16x16x32_bf16 v[52:55], a[220:223], v[180:183], v[52:55]
    v_mfma_f32_32x32x16_bf16 v[240:255], a[40:43], v[172:175], v[240:255]
    v_mfma_f32_32x32x16_bf16 v[128:143], v[172:175], a[44:47], v[128:143]
    v_mfma_f32_32x32x16_bf16 v[224:239], a[36:39], v[172:175], v[224:239]
    ds_read_b128 v[192:195], v88 offset:8192
    ds_read_b128 v[196:199], v89 offset:8192
    ds_read_b128 v[200:203], v90 offset:8192
    ds_read_b128 v[204:207], v91 offset:8192
    s_waitcnt lgkmcnt(4)
    v_mfma_f32_16x16x32_bf16 v[52:55], a[220:223], v[184:187], v[52:55]
    v_mfma_f32_16x16x32_bf16 v[52:55], a[220:223], v[188:191], v[52:55]
    v_mfma_f32_32x32x16_bf16 v[240:255], a[52:55], v[176:179], v[240:255]
    v_mfma_f32_32x32x16_bf16 v[128:143], v[176:179], a[56:59], v[128:143]
    v_mfma_f32_32x32x16_bf16 v[224:239], a[48:51], v[176:179], v[224:239]
    s_waitcnt lgkmcnt(3)
    v_mfma_f32_16x16x32_bf16 v[52:55], a[220:223], v[192:195], v[52:55]
    s_waitcnt lgkmcnt(2)
    v_mfma_f32_16x16x32_bf16 v[52:55], a[220:223], v[196:199], v[52:55]
    v_mfma_f32_32x32x16_bf16 v[240:255], a[64:67], v[180:183], v[240:255]
    v_mfma_f32_32x32x16_bf16 v[128:143], v[180:183], a[68:71], v[128:143]
    v_mfma_f32_32x32x16_bf16 v[224:239], a[60:63], v[180:183], v[224:239]
    ds_read_b128 v[208:211], v88 offset:12288
    ds_read_b128 v[212:215], v89 offset:12288
    ds_read_b128 v[216:219], v90 offset:12288
    ds_read_b128 v[220:223], v91 offset:12288
    s_waitcnt lgkmcnt(4)
    v_mfma_f32_16x16x32_bf16 v[52:55], a[220:223], v[200:203], v[52:55]
    v_mfma_f32_16x16x32_bf16 v[52:55], a[220:223], v[204:207], v[52:55]
    v_mfma_f32_32x32x16_bf16 v[240:255], a[76:79], v[184:187], v[240:255]
    s_add_u32 s80, s26, 0x810000
    buffer_store_dwordx4 a[208:211], v3, s[4:7], s80 offen sc1
    v_dot2_f32_bf16 v56, v160, v160, 0
    v_dot2_f32_bf16 v57, v161, v161, 0
    v_mfma_f32_32x32x16_bf16 v[128:143], v[184:187], a[80:83], v[128:143]
    v_dot2_f32_bf16 v58, v162, v162, 0
    v_dot2_f32_bf16 v59, v163, v163, 0
    v_dot2_f32_bf16 v56, v164, v164, v56
    v_dot2_f32_bf16 v57, v165, v165, v57
    v_mfma_f32_32x32x16_bf16 v[224:239], a[72:75], v[184:187], v[224:239]
    v_dot2_f32_bf16 v58, v166, v166, v58
    v_dot2_f32_bf16 v59, v167, v167, v59
    v_dot2_f32_bf16 v56, v168, v168, v56
    v_dot2_f32_bf16 v57, v169, v169, v57
    s_waitcnt lgkmcnt(3)
    v_mfma_f32_16x16x32_bf16 v[52:55], a[220:223], v[208:211], v[52:55]
    v_dot2_f32_bf16 v58, v170, v170, v58
    v_dot2_f32_bf16 v59, v171, v171, v59
    v_dot2_f32_bf16 v56, v172, v172, v56
    v_dot2_f32_bf16 v57, v173, v173, v57
    s_waitcnt lgkmcnt(2)
    v_mfma_f32_16x16x32_bf16 v[52:55], a[220:223], v[212:215], v[52:55]
    s_add_u32 s85, s26, 0x830000
    buffer_store_dwordx4 a[208:211], v3, s[4:7], s85 offen sc1
    v_dot2_f32_bf16 v58, v174, v174, v58
    v_dot2_f32_bf16 v59, v175, v175, v59
    v_mfma_f32_32x32x16_bf16 v[240:255], a[88:91], v[188:191], v[240:255]
    v_dot2_f32_bf16 v56, v176, v176, v56
    v_dot2_f32_bf16 v57, v177, v177, v57
    v_dot2_f32_bf16 v58, v178, v178, v58
    v_dot2_f32_bf16 v59, v179, v179, v59
    v_mfma_f32_32x32x16_bf16 v[128:143], v[188:191], a[92:95], v[128:143]
    v_dot2_f32_bf16 v56, v180, v180, v56
    v_dot2_f32_bf16 v57, v181, v181, v57
    v_dot2_f32_bf16 v58, v182, v182, v58
    v_dot2_f32_bf16 v59, v183, v183, v59
    v_mfma_f32_32x32x16_bf16 v[224:239], a[84:87], v[188:191], v[224:239]
    v_dot2_f32_bf16 v56, v184, v184, v56
    v_dot2_f32_bf16 v57, v185, v185, v57
    v_dot2_f32_bf16 v58, v186, v186, v58
    v_dot2_f32_bf16 v59, v187, v187, v59
    s_waitcnt lgkmcnt(1)
    v_mfma_f32_16x16x32_bf16 v[52:55], a[220:223], v[216:219], v[52:55]
    s_add_u32 s81, s27, 0x810000
    buffer_store_dwordx4 a[208:211], v5, s[4:7], s81 offen sc1
    v_dot2_f32_bf16 v56, v188, v188, v56
    v_dot2_f32_bf16 v57, v189, v189, v57
    buffer_load_dword v11, v9, s[4:7], s86 offen sc1
    s_waitcnt lgkmcnt(0)
    v_mfma_f32_16x16x32_bf16 v[52:55], a[220:223], v[220:223], v[52:55]
    v_dot2_f32_bf16 v58, v190, v190, v58
    v_dot2_f32_bf16 v59, v191, v191, v59
    v_dot2_f32_bf16 v56, v192, v192, v56
    v_dot2_f32_bf16 v57, v193, v193, v57
    v_mfma_f32_32x32x16_bf16 v[240:255], a[100:103], v[192:195], v[240:255]
    v_dot2_f32_bf16 v58, v194, v194, v58
    v_dot2_f32_bf16 v59, v195, v195, v59
    v_dot2_f32_bf16 v56, v196, v196, v56
    v_dot2_f32_bf16 v57, v197, v197, v57
    v_mfma_f32_32x32x16_bf16 v[128:143], v[192:195], a[104:107], v[128:143]
    v_dot2_f32_bf16 v58, v198, v198, v58
    v_dot2_f32_bf16 v59, v199, v199, v59
    v_dot2_f32_bf16 v56, v200, v200, v56
    v_dot2_f32_bf16 v57, v201, v201, v57
    v_mfma_f32_32x32x16_bf16 v[224:239], a[96:99], v[192:195], v[224:239]
    v_dot2_f32_bf16 v58, v202, v202, v58
    v_dot2_f32_bf16 v59, v203, v203, v59
    v_dot2_f32_bf16 v56, v204, v204, v56
    v_dot2_f32_bf16 v57, v205, v205, v57
    v_mfma_f32_32x32x16_bf16 v[240:255], a[112:115], v[196:199], v[240:255]
    v_dot2_f32_bf16 v58, v206, v206, v58
    v_dot2_f32_bf16 v59, v207, v207, v59
    v_dot2_f32_bf16 v56, v208, v208, v56
    v_dot2_f32_bf16 v57, v209, v209, v57
    v_mfma_f32_32x32x16_bf16 v[128:143], v[196:199], a[116:119], v[128:143]
    v_dot2_f32_bf16 v58, v210, v210, v58
    v_dot2_f32_bf16 v59, v211, v211, v59
    v_dot2_f32_bf16 v56, v212, v212, v56
    v_dot2_f32_bf16 v57, v213, v213, v57
    v_mfma_f32_32x32x16_bf16 v[224:239], a[108:111], v[196:199], v[224:239]
    v_dot2_f32_bf16 v58, v214, v214, v58
    v_dot2_f32_bf16 v59, v215, v215, v59
    v_dot2_f32_bf16 v56, v216, v216, v56
    v_dot2_f32_bf16 v57, v217, v217, v57
    v_mfma_f32_32x32x16_bf16 v[240:255], a[124:127], v[200:203], v[240:255]
    v_dot2_f32_bf16 v58, v218, v218, v58
    v_dot2_f32_bf16 v59, v219, v219, v59
    v_dot2_f32_bf16 v56, v220, v220, v56
    v_dot2_f32_bf16 v57, v221, v221, v57
    v_mfma_f32_32x32x16_bf16 v[128:143], v[200:203], a[128:131], v[128:143]
    v_dot2_f32_bf16 v58, v222, v222, v58
    v_dot2_f32_bf16 v59, v223, v223, v59
    v_add_f32 v56, v56, v57
    s_nop 1
    v_add_f32 v58, v58, v59
    v_add_f32 v57, v56, v58
    v_add_f32 v56, v56, v58
    v_mfma_f32_32x32x16_bf16 v[224:239], a[120:123], v[200:203], v[224:239]
    s_nop 0
    v_permlane32_swap_b32 v56, v57
    v_add_f32 v53, v56, v57
    ds_write_b64 v83, v[52:53] offset:1024
    s_waitcnt lgkmcnt(0)
    s_barrier
    ds_read_b64 v[54:55], v85 offset:1024
    v_mfma_f32_32x32x16_bf16 v[240:255], a[136:139], v[204:207], v[240:255]
    s_waitcnt lgkmcnt(0)
    v_add_f32 v52, v52, v54
    v_add_f32 v53, v53, v55
    v_mul_f32 v52, 0xbb000000, v52
    v_mul_f32 v53, 0x3b000000, v53
    v_fma_f32 v53, -v52, v52, v53
    v_max_f32 v53, 0, v53
    v_mfma_f32_32x32x16_bf16 v[128:143], v[204:207], a[140:143], v[128:143]
    v_add_f32 v56, 0x3727c5ac, v53
    v_rsq_f32 v54, v56
    v_cvt_pk_bf16_f32 v60, v52, v52
    v_lshlrev_b32 v57, 16, v60
    v_and_b32 v16, 0x1ffff, v5
    v_mfma_f32_32x32x16_bf16 v[224:239], a[132:135], v[204:207], v[224:239]
    v_rcp_f32 v55, v54
    v_sub_f32 v57, v52, v57
    v_cvt_pk_bf16_f32 v58, v54, v54
    v_cvt_pk_bf16_f32 v61, v57, v55
    v_lshlrev_b32 v58, 16, v58
    v_mfma_f32_32x32x16_bf16 v[240:255], a[148:151], v[208:211], v[240:255]
    v_and_b32 v57, 0xffff0000, v61
    v_sub_f32 v58, v54, v58
    v_sub_f32 v57, v55, v57
    v_cvt_pk_bf16_f32 v63, v54, v58
    v_cvt_pk_bf16_f32 v62, v57, 0
    v_mov_b32 v17, 4096
    v_mfma_f32_32x32x16_bf16 v[128:143], v[208:211], a[152:155], v[128:143]
    v_cmp_gt_u32 vcc, 512, v1
    v_mul_f32 v87, s43, v54
    s_nop 0
    v_cndmask_b32 v60, 0, v60, vcc
    v_cndmask_b32 v61, 0, v61, vcc
    s_waitcnt vmcnt(0)
    v_cmp_ne_u32 vcc, 1, v11
    s_cbranch_vccnz Lre1
Lok1:
    v_mfma_f32_32x32x16_bf16 v[224:239], a[144:147], v[208:211], v[224:239]
    v_cmp_gt_u32 vcc, 0x20000, v5
    v_add_u32 v18, 1024, v16
    v_mov_b32 v19, s52
    v_cndmask_b32 v88, v17, v18, vcc
    v_add_u32 v92, 65792, v88
    s_mov_b32 m0, s22
    s_add_u32 s82, s29, 0x800000
    buffer_load_dwordx4 v1, s[4:7], s82 offen sc1 lds
    v_mfma_f32_32x32x16_bf16 v[240:255], a[160:163], v[212:215], v[240:255]
    v_cmp_gt_u32 vcc, 0x20000, v5
    v_add_u32 v18, 1536, v16
    v_mov_b32 v20, s52
    v_cndmask_b32 v89, v17, v18, vcc
    v_add_u32 v93, 65792, v89
    v_mfma_f32_32x32x16_bf16 v[128:143], v[212:215], a[164:167], v[128:143]
    v_cmp_gt_u32 vcc, 0x20000, v5
    v_add_u32 v18, 3072, v16
    v_mov_b32 v19, s52
    v_cndmask_b32 v90, v17, v18, vcc
    v_add_u32 v94, 65792, v90
    buffer_load_dwordx4 v1, s[4:7], s82 offen offset:1024 sc1 lds
    v_mfma_f32_32x32x16_bf16 v[224:239], a[156:159], v[212:215], v[224:239]
    v_cmp_gt_u32 vcc, 0x20000, v5
    v_add_u32 v18, 3584, v16
    v_mov_b32 v20, s52
    v_cndmask_b32 v91, v17, v18, vcc
    v_add_u32 v95, 65792, v91
    v_bfe_u32 v16, v1, 4, 5
    v_mfma_f32_32x32x16_bf16 v[240:255], a[172:175], v[216:219], v[240:255]
    v_mul_u32_u24 v16, 4112, v16
    v_mov_b32 v18, s52
    v_mov_b32 v21, s52
    buffer_load_dwordx4 v1, s[4:7], s82 offen offset:2048 sc1 lds
    v_mfma_f32_32x32x16_bf16 v[128:143], v[216:219], a[176:179], v[128:143]
    v_mfma_f32_32x32x16_bf16 v[224:239], a[168:171], v[216:219], v[224:239]
    buffer_load_dwordx4 v1, s[4:7], s82 offen offset:3072 sc1 lds
    v_mfma_f32_32x32x16_bf16 v[144:159], v[60:63], v[48:51], 0
    v_mfma_f32_32x32x16_bf16 v[240:255], v[116:119], v[60:63], v[240:255]
    s_add_u32 s83, s28, 0x800000
    buffer_load_dwordx4 v[96:99], v1, s[4:7], s83 offen sc1
    v_mfma_f32_32x32x16_bf16 v[128:143], v[60:63], a[204:207], v[128:143]
    v_mfma_f32_32x32x16_bf16 v[224:239], v[112:115], v[60:63], v[224:239]
    s_add_u32 m0, s22, 0x4040
    s_add_u32 s84, s29, 0x804000
    buffer_load_dwordx4 v1, s[4:7], s84 offen sc1 lds
    v_mfma_f32_32x32x16_bf16 v[240:255], a[184:187], v[220:223], v[240:255]
    v_mfma_f32_32x32x16_bf16 v[128:143], v[220:223], a[188:191], v[128:143]
    buffer_load_dwordx4 v1, s[4:7], s84 offen offset:1024 sc1 lds
    v_mfma_f32_32x32x16_bf16 v[224:239], a[180:183], v[220:223], v[224:239]
    s_nop 8
    ds_write_b128 v84, v[240:243] offset:0
    buffer_load_dwordx4 v1, s[4:7], s84 offen offset:2048 sc1 lds
    ds_write_b128 v84, v[244:247] offset:1024
    ds_write_b128 v84, v[248:251] offset:2048
    ds_write_b128 v84, v[252:255] offset:3072
    ds_write_b128 v122, v[136:139] offset:4096
    buffer_load_dwordx4 v1, s[4:7], s84 offen offset:3072 sc1 lds
PAD2:
    s_cbranch_execz WARM8_3
    ds_write_b128 v122, v[140:143] offset:5120
    v_mul_f32 v224, v87, v224
    v_mul_f32 v225, v87, v225
    v_mul_f32 v226, v87, v226
    s_add_u32 m0, s22, 0x8080
    s_add_u32 s88, s29, 0x808000
    buffer_load_dwordx4 v1, s[4:7], s88 offen sc1 lds
    v_mul_f32 v227, v87, v227
    v_mul_f32 v228, v87, v228
    v_mul_f32 v229, v87, v229
    v_mul_f32 v230, v87, v230
    buffer_load_dwordx4 v1, s[4:7], s88 offen offset:1024 sc1 lds
    v_mul_f32 v231, v87, v231
    v_mul_f32 v232, v87, v232
    v_mul_f32 v233, v87, v233
    v_mul_f32 v234, v87, v234
    buffer_load_dwordx4 v1, s[4:7], s88 offen offset:2048 sc1 lds
    v_mul_f32 v235, v87, v235
    v_mul_f32 v236, v87, v236
    v_mul_f32 v237, v87, v237
    v_mul_f32 v238, v87, v238
    buffer_load_dwordx4 v1, s[4:7], s88 offen offset:3072 sc1 lds
    v_mul_f32 v239, v87, v239
    s_waitcnt lgkmcnt(0)
    s_barrier
    buffer_store_dwordx2 v[12:13], v8, s[4:7], s86 offen sc1
    ds_read_b128 v[240:243], v120 offset:0
    ds_read_b128 v[244:247], v120 offset:1024
    s_add_u32 m0, s22, 0xc0c0
    s_add_u32 s90, s29, 0x80c000
    buffer_load_dwordx4 v1, s[4:7], s90 offen sc1 lds
    ds_read_b128 v[248:251], v120 offset:2048
    ds_read_b128 v[252:255], v120 offset:3072
    ds_read_b128 v[136:139], v120 offset:4096
    ds_read_b128 v[140:143], v120 offset:5120
    buffer_load_dwordx4 v1, s[4:7], s90 offen offset:1024 sc1 lds
    ds_write_b128 v16, v[18:21] offset:4096
    v_mul_f32 v128, v144, v128
    v_mul_f32 v129, v145, v129
    v_mul_f32 v130, v146, v130
    buffer_load_dwordx4 v1, s[4:7], s90 offen offset:2048 sc1 lds
    v_mul_f32 v131, v147, v131
    v_mul_f32 v132, v148, v132
    v_mul_f32 v133, v149, v133
    v_mul_f32 v134, v150, v134
    buffer_load_dwordx4 v1, s[4:7], s90 offen offset:3072 sc1 lds
    v_mul_f32 v135, v151, v135
    s_waitcnt lgkmcnt(6)
    v_fmac_f32 v224, v87, v240
    v_fmac_f32 v225, v87, v241
    v_fmac_f32 v226, v87, v242
    v_fmac_f32 v227, v87, v243
    s_waitcnt lgkmcnt(5)
    v_fmac_f32 v228, v87, v244
    v_fmac_f32 v229, v87, v245
    v_fmac_f32 v230, v87, v246
    v_fmac_f32 v231, v87, v247
    v_cvt_pk_bf16_f32 v224, v224, v225
    v_cvt_pk_bf16_f32 v225, v226, v227
    v_cvt_pk_bf16_f32 v226, v228, v229
    v_cvt_pk_bf16_f32 v227, v230, v231
    buffer_store_dwordx4 v[224:227], v3, s[4:7], s80 offen sc1
    s_waitcnt lgkmcnt(4)
    v_fmac_f32 v232, v87, v248
    v_fmac_f32 v233, v87, v249
    v_fmac_f32 v234, v87, v250
    v_fmac_f32 v235, v87, v251
    s_waitcnt lgkmcnt(3)
    v_fmac_f32 v236, v87, v252
    v_fmac_f32 v237, v87, v253
    v_fmac_f32 v238, v87, v254
    v_fmac_f32 v239, v87, v255
    v_cvt_pk_bf16_f32 v232, v232, v233
    v_cvt_pk_bf16_f32 v233, v234, v235
    v_cvt_pk_bf16_f32 v234, v236, v237
    v_cvt_pk_bf16_f32 v235, v238, v239
    buffer_store_dwordx4 v[232:235], v3, s[4:7], s85 offen sc1
    s_waitcnt lgkmcnt(2)
    v_fmac_f32 v128, v144, v136
    v_fmac_f32 v129, v145, v137
    v_fmac_f32 v130, v146, v138
    v_fmac_f32 v131, v147, v139
    s_waitcnt lgkmcnt(1)
    v_fmac_f32 v132, v148, v140
    v_fmac_f32 v133, v149, v141
    v_fmac_f32 v134, v150, v142
    v_fmac_f32 v135, v151, v143
    v_cvt_pk_bf16_f32 v128, v128, v129
    v_cvt_pk_bf16_f32 v129, v130, v131
    v_cvt_pk_bf16_f32 v130, v132, v133
    v_cvt_pk_bf16_f32 v131, v134, v135
    buffer_store_dwordx4 v[128:131], v5, s[4:7], s81 offen sc1
    s_mov_b64 exec, 0
    s_cmp_eq_u32 s3, 0
    s_cbranch_scc1 PAD4
    s_cmp_eq_u32 s3, 1
    s_cbranch_scc1 PAD5
    s_cmp_eq_u32 s3, 2
    s_cbranch_scc1 PAD6
    s_cmp_eq_u32 s3, 3
    s_cbranch_scc1 PAD7
WARM0_8:
    s_mov_b64 exec, -1
    v_add_u32 v36, 0x0, v6
    s_waitcnt vmcnt(17)
    ds_read2st64_b32 v[32:33], v36 offset0:0 offset1:4
    ds_read2st64_b32 v[34:35], v36 offset0:8 offset1:12
    v_add_u32 v44, 0x4040, v6
    s_waitcnt vmcnt(12)
    ds_read2st64_b32 v[40:41], v44 offset0:0 offset1:4
    ds_read2st64_b32 v[42:43], v44 offset0:8 offset1:12
    s_waitcnt lgkmcnt(2)
    v_max3_u32 v7, v32, v33, v34
    v_max_u32 v7, v7, v35
    v_cmp_eq_u32 vcc, -1, v7
    s_cbranch_vccnz Lre2
Lok2:
    s_waitcnt lgkmcnt(0)
    v_max3_u32 v7, v40, v41, v42
    v_max_u32 v7, v7, v43
    v_cmp_eq_u32 vcc, -1, v7
    s_cbranch_vccnz Lre3
Lok3:
    v_cmp_eq_u32 vcc, -1, v96
    s_cbranch_vccnz Lre4
Lok4:
    s_barrier
    ds_read_b128 a[232:235], v1 offset:0
    ds_read_b128 a[236:239], v1 offset:2048
    ds_read_b128 a[240:243], v88 offset:0
    ds_read_b128 a[248:251], v89 offset:0
    ds_read_b128 a[244:247], v90 offset:0
    s_waitcnt lgkmcnt(4)
    v_mfma_f32_32x32x16_bf16 v[16:31], a[232:235], v[96:99], 0
    ds_read_b128 a[232:235], v1 offset:4112
    ds_read_b128 a[252:255], v91 offset:0
    s_waitcnt lgkmcnt(4)
    v_mfma_f32_32x32x16_bf16 v[32:47], a[236:239], v[96:99], 0
    ds_read_b128 a[236:239], v1 offset:6160
    s_nop 6
    v_exp_f32 v16, v16
    v_exp_f32 v17, v17
    v_exp_f32 v18, v18
    v_exp_f32 v19, v19
    buffer_store_dword v12, v10, s[4:7], s86 offen sc1
    v_exp_f32 v20, v20
    v_exp_f32 v21, v21
    v_exp_f32 v22, v22
    v_exp_f32 v23, v23
    v_cvt_pk_bf16_f32 v80, v16, v17
    v_cvt_pk_bf16_f32 v81, v18, v19
    v_cvt_pk_bf16_f32 v82, v20, v21
    v_cvt_pk_bf16_f32 v83, v22, v23
    v_exp_f32 v24, v24
    v_exp_f32 v25, v25
    v_mfma_f32_32x32x16_bf16 v[48:63], a[240:243], v[80:83], 0
    ds_read_b128 a[240:243], v88 offset:4112
    v_exp_f32 v26, v26
    v_exp_f32 v27, v27
    v_exp_f32 v28, v28
    v_exp_f32 v29, v29
    v_exp_f32 v30, v30
    v_exp_f32 v31, v31
    v_cvt_pk_bf16_f32 v84, v24, v25
    v_cvt_pk_bf16_f32 v85, v26, v27
    v_cvt_pk_bf16_f32 v86, v28, v29
    v_cvt_pk_bf16_f32 v87, v30, v31
    s_waitcnt lgkmcnt(3)
    v_mfma_f32_32x32x16_bf16 v[16:31], a[232:235], v[96:99], 0
    ds_read_b128 a[232:235], v1 offset:8224
    v_exp_f32 v32, v32
    v_exp_f32 v33, v33
    v_exp_f32 v34, v34
    v_exp_f32 v35, v35
    v_mfma_f32_32x32x16_bf16 v[48:63], a[248:251], v[84:87], v[48:63]
    ds_read_b128 a[248:251], v89 offset:4112
    v_accvgpr_write_b32 a224, -1
    v_accvgpr_write_b32 a225, -1
    v_accvgpr_write_b32 a226, -1
    v_accvgpr_write_b32 a227, -1
    s_mov_b64 s[96:97], s[74:75]
    s_mov_b32 s98, 3584
    s_mov_b32 s99, 0x00020000
    s_mov_b32 s74, 0x1c0000
    s_mov_b32 s75, 0x00020000
    v_lshrrev_b32 v100, 3, v1
    v_exp_f32 v36, v36
    v_exp_f32 v37, v37
    v_exp_f32 v38, v38
    v_exp_f32 v39, v39
    v_cvt_pk_bf16_f32 v80, v32, v33
    v_cvt_pk_bf16_f32 v81, v34, v35
    v_cvt_pk_bf16_f32 v82, v36, v37
    v_cvt_pk_bf16_f32 v83, v38, v39
    v_exp_f32 v40, v40
    v_exp_f32 v41, v41
    v_mfma_f32_32x32x16_bf16 v[48:63], a[244:247], v[80:83], v[48:63]
    ds_read_b128 a[244:247], v90 offset:4112
    v_exp_f32 v42, v42
    v_exp_f32 v43, v43
    v_exp_f32 v44, v44
    v_exp_f32 v45, v45
    v_exp_f32 v46, v46
    v_exp_f32 v47, v47
    v_cvt_pk_bf16_f32 v84, v40, v41
    v_cvt_pk_bf16_f32 v85, v42, v43
    v_cvt_pk_bf16_f32 v86, v44, v45
    v_cvt_pk_bf16_f32 v87, v46, v47
    s_waitcnt lgkmcnt(3)
    v_mfma_f32_32x32x16_bf16 v[32:47], a[236:239], v[96:99], 0
    ds_read_b128 a[236:239], v1 offset:10272
    v_exp_f32 v16, v16
    v_exp_f32 v17, v17
    v_exp_f32 v18, v18
    v_exp_f32 v19, v19
    v_mfma_f32_32x32x16_bf16 v[48:63], a[252:255], v[84:87], v[48:63]
    ds_read_b128 a[252:255], v91 offset:4112
    v_and_b32 v101, 512, v1
    v_lshl_or_b32 v100, v101, 7, v100
    v_lshrrev_b32 v101, 6, v101
    buffer_load_ushort v14, v100, s[96:99], s31 offen
    s_mov_b64 s[96:97], s[78:79]
    s_mov_b32 s98, 1024
    v_exp_f32 v20, v20
    v_exp_f32 v21, v21
    v_exp_f32 v22, v22
    v_exp_f32 v23, v23
    v_cvt_pk_bf16_f32 v80, v16, v17
    v_cvt_pk_bf16_f32 v81, v18, v19
    v_cvt_pk_bf16_f32 v82, v20, v21
    v_cvt_pk_bf16_f32 v83, v22, v23
    v_exp_f32 v24, v24
    v_exp_f32 v25, v25
    v_mfma_f32_32x32x16_bf16 v[48:63], a[240:243], v[80:83], v[48:63]
    ds_read_b128 a[240:243], v88 offset:8224
    v_exp_f32 v26, v26
    v_exp_f32 v27, v27
    v_exp_f32 v28, v28
    v_exp_f32 v29, v29
    v_exp_f32 v30, v30
    v_exp_f32 v31, v31
    v_cvt_pk_bf16_f32 v84, v24, v25
    v_cvt_pk_bf16_f32 v85, v26, v27
    v_cvt_pk_bf16_f32 v86, v28, v29
    v_cvt_pk_bf16_f32 v87, v30, v31
    s_waitcnt lgkmcnt(3)
    v_mfma_f32_32x32x16_bf16 v[16:31], a[232:235], v[96:99], 0
    ds_read_b128 a[232:235], v1 offset:12336
    v_exp_f32 v32, v32
    v_exp_f32 v33, v33
    v_exp_f32 v34, v34
    v_exp_f32 v35, v35
    v_mfma_f32_32x32x16_bf16 v[48:63], a[248:251], v[84:87], v[48:63]
    ds_read_b128 a[248:251], v89 offset:8224
    buffer_load_dword v11, v9, s[4:7], s86 offen offset:4 sc1
    s_and_b32 s64, s48, 0x3ff
    buffer_load_dwordx2 v[116:117], v101, s[96:99], s64 offen
    buffer_load_dwordx2 v[118:119], v101, s[96:99], s64 offen offset:16
    s_mov_b64 s[96:97], s[70:71]
    s_mov_b32 s98, 0x200000
    s_mov_b32 s70, 0x80000
    v_exp_f32 v36, v36
    v_exp_f32 v37, v37
    v_exp_f32 v38, v38
    v_exp_f32 v39, v39
    v_cvt_pk_bf16_f32 v80, v32, v33
    v_cvt_pk_bf16_f32 v81, v34, v35
    v_cvt_pk_bf16_f32 v82, v36, v37
    v_cvt_pk_bf16_f32 v83, v38, v39
    v_exp_f32 v40, v40
    v_exp_f32 v41, v41
    v_mfma_f32_32x32x16_bf16 v[48:63], a[244:247], v[80:83], v[48:63]
    ds_read_b128 a[244:247], v90 offset:8224
    v_exp_f32 v42, v42
    v_exp_f32 v43, v43
    v_exp_f32 v44, v44
    v_exp_f32 v45, v45
    v_exp_f32 v46, v46
    v_exp_f32 v47, v47
    v_cvt_pk_bf16_f32 v84, v40, v41
    v_cvt_pk_bf16_f32 v85, v42, v43
    v_cvt_pk_bf16_f32 v86, v44, v45
    v_cvt_pk_bf16_f32 v87, v46, v47
    s_waitcnt lgkmcnt(3)
    v_mfma_f32_32x32x16_bf16 v[32:47], a[236:239], v[96:99], 0
    ds_read_b128 a[236:239], v1 offset:14384
    v_exp_f32 v16, v16
    v_exp_f32 v17, v17
    v_exp_f32 v18, v18
    v_exp_f32 v19, v19
    v_mfma_f32_32x32x16_bf16 v[48:63], a[252:255], v[84:87], v[48:63]
    ds_read_b128 a[252:255], v91 offset:8224
    s_mov_b32 s78, 0x1c0000
    s_mov_b32 s71, 0x00020000
    s_mov_b32 s79, 0x00020000
    v_accvgpr_read_b32 v102, a192
    v_add_f32 v102, v102, v15
    v_cmp_gt_u32 vcc, 512, v1
    v_mov_b32 v106, 0
    v_mov_b32 v107, 0
    v_cndmask_b32 v102, 0, v102, vcc
    v_exp_f32 v20, v20
    v_exp_f32 v21, v21
    v_exp_f32 v22, v22
    v_exp_f32 v23, v23
    v_cvt_pk_bf16_f32 v80, v16, v17
    v_cvt_pk_bf16_f32 v81, v18, v19
    v_cvt_pk_bf16_f32 v82, v20, v21
    v_cvt_pk_bf16_f32 v83, v22, v23
    v_exp_f32 v24, v24
    v_exp_f32 v25, v25
    v_mfma_f32_32x32x16_bf16 v[48:63], a[240:243], v[80:83], v[48:63]
    ds_read_b128 a[240:243], v88 offset:12336
    v_exp_f32 v26, v26
    v_exp_f32 v27, v27
    v_exp_f32 v28, v28
    v_exp_f32 v29, v29
    v_exp_f32 v30, v30
    v_exp_f32 v31, v31
    v_cvt_pk_bf16_f32 v84, v24, v25
    v_cvt_pk_bf16_f32 v85, v26, v27
    v_cvt_pk_bf16_f32 v86, v28, v29
    v_cvt_pk_bf16_f32 v87, v30, v31
    s_waitcnt lgkmcnt(3)
    v_mfma_f32_32x32x16_bf16 v[16:31], a[232:235], v[96:99], 0
    ds_read_b128 a[232:235], v1 offset:16448
    v_exp_f32 v32, v32
    v_exp_f32 v33, v33
    v_exp_f32 v34, v34
    v_exp_f32 v35, v35
    v_mfma_f32_32x32x16_bf16 v[48:63], a[248:251], v[84:87], v[48:63]
    ds_read_b128 a[248:251], v89 offset:12336
    v_cvt_pk_bf16_f32 v105, v102, 0
    v_lshlrev_b32 v103, 16, v105
    v_sub_f32 v103, v102, v103
    v_cvt_pk_bf16_f32 v104, v102, v103
    s_mov_b32 s87, s39
    buffer_store_dwordx4 v[104:107], v1, s[4:7], s87 offen sc1
    v_accvgpr_read_b32 v102, a200
    v_exp_f32 v36, v36
    v_exp_f32 v37, v37
    v_exp_f32 v38, v38
    v_exp_f32 v39, v39
    v_cvt_pk_bf16_f32 v80, v32, v33
    v_cvt_pk_bf16_f32 v81, v34, v35
    v_cvt_pk_bf16_f32 v82, v36, v37
    v_cvt_pk_bf16_f32 v83, v38, v39
    v_exp_f32 v40, v40
    v_exp_f32 v41, v41
    v_mfma_f32_32x32x16_bf16 v[48:63], a[244:247], v[80:83], v[48:63]
    ds_read_b128 a[244:247], v90 offset:12336
    v_exp_f32 v42, v42
    v_exp_f32 v43, v43
    v_exp_f32 v44, v44
    v_exp_f32 v45, v45
    v_exp_f32 v46, v46
    v_exp_f32 v47, v47
    v_cvt_pk_bf16_f32 v84, v40, v41
    v_cvt_pk_bf16_f32 v85, v42, v43
    v_cvt_pk_bf16_f32 v86, v44, v45
    v_cvt_pk_bf16_f32 v87, v46, v47
    s_waitcnt lgkmcnt(3)
    v_mfma_f32_32x32x16_bf16 v[32:47], a[236:239], v[96:99], 0
    ds_read_b128 a[236:239], v1 offset:18496
    v_exp_f32 v16, v16
    v_exp_f32 v17, v17
    v_exp_f32 v18, v18
    v_exp_f32 v19, v19
    v_mfma_f32_32x32x16_bf16 v[48:63], a[252:255], v[84:87], v[48:63]
    ds_read_b128 a[252:255], v91 offset:12336
    v_cmp_gt_u32 vcc, 512, v1
    v_mov_b32 v110, 0
    v_mov_b32 v111, 0
    v_cndmask_b32 v102, 0, v102, vcc
    v_cvt_pk_bf16_f32 v109, v102, 0
    v_lshlrev_b32 v103, 16, v109
    v_sub_f32 v103, v102, v103
    v_cvt_pk_bf16_f32 v108, v102, v103
    s_mov_b32 s91, s40
    buffer_store_dwordx4 v[108:111], v1, s[4:7], s91 offen sc1
    v_exp_f32 v20, v20
    v_exp_f32 v21, v21
    v_exp_f32 v22, v22
    v_exp_f32 v23, v23
    v_cvt_pk_bf16_f32 v80, v16, v17
    v_cvt_pk_bf16_f32 v81, v18, v19
    v_cvt_pk_bf16_f32 v82, v20, v21
    v_cvt_pk_bf16_f32 v83, v22, v23
    v_exp_f32 v24, v24
    v_exp_f32 v25, v25
    v_mfma_f32_32x32x16_bf16 v[48:63], a[240:243], v[80:83], v[48:63]
    ds_read_b128 a[240:243], v88 offset:16448
    v_exp_f32 v26, v26
    v_exp_f32 v27, v27
    v_exp_f32 v28, v28
    v_exp_f32 v29, v29
    v_exp_f32 v30, v30
    v_exp_f32 v31, v31
    v_cvt_pk_bf16_f32 v84, v24, v25
    v_cvt_pk_bf16_f32 v85, v26, v27
    v_cvt_pk_bf16_f32 v86, v28, v29
    v_cvt_pk_bf16_f32 v87, v30, v31
    s_waitcnt lgkmcnt(3)
    v_mfma_f32_32x32x16_bf16 v[16:31], a[232:235], v[96:99], 0
    ds_read_b128 a[232:235], v1 offset:20560
    v_exp_f32 v32, v32
    v_exp_f32 v33, v33
    v_exp_f32 v34, v34
    v_exp_f32 v35, v35
    v_mfma_f32_32x32x16_bf16 v[48:63], a[248:251], v[84:87], v[48:63]
    ds_read_b128 a[248:251], v89 offset:16448
    v_exp_f32 v36, v36
    v_exp_f32 v37, v37
    v_exp_f32 v38, v38
    v_exp_f32 v39, v39
    v_cvt_pk_bf16_f32 v80, v32, v33
    v_cvt_pk_bf16_f32 v81, v34, v35
    v_cvt_pk_bf16_f32 v82, v36, v37
    v_cvt_pk_bf16_f32 v83, v38, v39
    v_exp_f32 v40, v40
    v_exp_f32 v41, v41
    v_mfma_f32_32x32x16_bf16 v[48:63], a[244:247], v[80:83], v[48:63]
    ds_read_b128 a[244:247], v90 offset:16448
    v_exp_f32 v42, v42
    v_exp_f32 v43, v43
    v_exp_f32 v44, v44
    v_exp_f32 v45, v45
    v_exp_f32 v46, v46
    v_exp_f32 v47, v47
    v_cvt_pk_bf16_f32 v84, v40, v41
    v_cvt_pk_bf16_f32 v85, v42, v43
    v_cvt_pk_bf16_f32 v86, v44, v45
    v_cvt_pk_bf16_f32 v87, v46, v47
    s_waitcnt lgkmcnt(3)
    v_mfma_f32_32x32x16_bf16 v[32:47], a[236:239], v[96:99], 0
    ds_read_b128 a[236:239], v1 offset:22608
    v_exp_f32 v16, v16
    v_exp_f32 v17, v17
    v_exp_f32 v18, v18
    v_exp_f32 v19, v19
    v_mfma_f32_32x32x16_bf16 v[48:63], a[252:255], v[84:87], v[48:63]
    ds_read_b128 a[252:255], v91 offset:16448
    s_waitcnt vmcnt(4)
    v_cmp_ne_u32 vcc, 1, v11
    s_cbranch_vccnz Lre5
Lok5:
    v_exp_f32 v20, v20
    v_exp_f32 v21, v21
    v_exp_f32 v22, v22
    v_exp_f32 v23, v23
    v_cvt_pk_bf16_f32 v80, v16, v17
    v_cvt_pk_bf16_f32 v81, v18, v19
    v_cvt_pk_bf16_f32 v82, v20, v21
    v_cvt_pk_bf16_f32 v83, v22, v23
    v_exp_f32 v24, v24
    v_exp_f32 v25, v25
    v_mfma_f32_32x32x16_bf16 v[48:63], a[240:243], v[80:83], v[48:63]
    ds_read_b128 a[240:243], v88 offset:20560
    v_exp_f32 v26, v26
    v_exp_f32 v27, v27
    v_exp_f32 v28, v28
    v_exp_f32 v29, v29
    v_exp_f32 v30, v30
    v_exp_f32 v31, v31
    v_cvt_pk_bf16_f32 v84, v24, v25
    v_cvt_pk_bf16_f32 v85, v26, v27
    v_cvt_pk_bf16_f32 v86, v28, v29
    v_cvt_pk_bf16_f32 v87, v30, v31
    s_waitcnt lgkmcnt(3)
    v_mfma_f32_32x32x16_bf16 v[16:31], a[232:235], v[96:99], 0
    ds_read_b128 a[232:235], v1 offset:24672
    v_exp_f32 v32, v32
    v_exp_f32 v33, v33
    v_exp_f32 v34, v34
    v_exp_f32 v35, v35
    v_mfma_f32_32x32x16_bf16 v[48:63], a[248:251], v[84:87], v[48:63]
    ds_read_b128 a[248:251], v89 offset:20560
    v_add_u32 v108, 0x8080, v6
    ds_read2st64_b32 v[104:105], v108 offset0:0 offset1:4
    ds_read2st64_b32 v[106:107], v108 offset0:8 offset1:12
    v_exp_f32 v36, v36
    v_exp_f32 v37, v37
    v_exp_f32 v38, v38
    v_exp_f32 v39, v39
    v_cvt_pk_bf16_f32 v80, v32, v33
    v_cvt_pk_bf16_f32 v81, v34, v35
    v_cvt_pk_bf16_f32 v82, v36, v37
    v_cvt_pk_bf16_f32 v83, v38, v39
    v_exp_f32 v40, v40
    v_exp_f32 v41, v41
    v_mfma_f32_32x32x16_bf16 v[48:63], a[244:247], v[80:83], v[48:63]
    ds_read_b128 a[244:247], v90 offset:20560
    s_add_u32 s89, s28, 0x810000
    buffer_load_dwordx4 v[100:103], v1, s[4:7], s89 offen sc1
    v_exp_f32 v42, v42
    v_exp_f32 v43, v43
    v_exp_f32 v44, v44
    v_exp_f32 v45, v45
    v_exp_f32 v46, v46
    v_exp_f32 v47, v47
    v_cvt_pk_bf16_f32 v84, v40, v41
    v_cvt_pk_bf16_f32 v85, v42, v43
    v_cvt_pk_bf16_f32 v86, v44, v45
    v_cvt_pk_bf16_f32 v87, v46, v47
    s_waitcnt lgkmcnt(5)
    v_mfma_f32_32x32x16_bf16 v[32:47], a[236:239], v[96:99], 0
    ds_read_b128 a[236:239], v1 offset:26720
    v_exp_f32 v16, v16
    v_exp_f32 v17, v17
    v_exp_f32 v18, v18
    v_exp_f32 v19, v19
    v_mfma_f32_32x32x16_bf16 v[48:63], a[252:255], v[84:87], v[48:63]
    ds_read_b128 a[252:255], v91 offset:20560
    s_waitcnt lgkmcnt(3)
    v_max3_u32 v7, v104, v105, v106
    v_max_u32 v7, v7, v107
    v_cmp_eq_u32 vcc, -1, v7
    s_cbranch_vccnz Lre6
Lok6:
    s_mul_i32 s64, s41, 7
    s_lshr_b32 s64, s64, 2
    v_min_u32 v7, 208, v1
    v_lshl_add_u32 v7, v7, 3, s64
    global_load_dword a212, v7, s[72:73]
    v_exp_f32 v20, v20
    v_exp_f32 v21, v21
    v_exp_f32 v22, v22
    v_exp_f32 v23, v23
    v_cvt_pk_bf16_f32 v80, v16, v17
    v_cvt_pk_bf16_f32 v81, v18, v19
    v_cvt_pk_bf16_f32 v82, v20, v21
    v_cvt_pk_bf16_f32 v83, v22, v23
    v_exp_f32 v24, v24
    v_exp_f32 v25, v25
    v_mfma_f32_32x32x16_bf16 v[48:63], a[240:243], v[80:83], v[48:63]
    ds_read_b128 a[240:243], v88 offset:24672
    s_add_u32 s82, s30, 0x800000
    buffer_store_dwordx4 a[224:227], v1, s[4:7], s82 offen sc1
    v_exp_f32 v26, v26
    v_exp_f32 v27, v27
    v_exp_f32 v28, v28
    v_exp_f32 v29, v29
    v_exp_f32 v30, v30
    v_exp_f32 v31, v31
    v_cvt_pk_bf16_f32 v84, v24, v25
    v_cvt_pk_bf16_f32 v85, v26, v27
    v_cvt_pk_bf16_f32 v86, v28, v29
    v_cvt_pk_bf16_f32 v87, v30, v31
    s_waitcnt lgkmcnt(3)
    v_mfma_f32_32x32x16_bf16 v[16:31], a[232:235], v[96:99], 0
    ds_read_b128 a[232:235], v1 offset:28784
    v_exp_f32 v32, v32
    v_exp_f32 v33, v33
    v_exp_f32 v34, v34
    v_exp_f32 v35, v35
    v_mfma_f32_32x32x16_bf16 v[48:63], a[248:251], v[84:87], v[48:63]
    ds_read_b128 a[248:251], v89 offset:24672
    v_add_u32 v108, 0xc0c0, v6
    ds_read2st64_b32 v[104:105], v108 offset0:0 offset1:4
    ds_read2st64_b32 v[106:107], v108 offset0:8 offset1:12
    v_exp_f32 v36, v36
    v_exp_f32 v37, v37
    v_exp_f32 v38, v38
    v_exp_f32 v39, v39
    v_cvt_pk_bf16_f32 v80, v32, v33
    v_cvt_pk_bf16_f32 v81, v34, v35
    v_cvt_pk_bf16_f32 v82, v36, v37
    v_cvt_pk_bf16_f32 v83, v38, v39
    v_exp_f32 v40, v40
    v_exp_f32 v41, v41
    v_mfma_f32_32x32x16_bf16 v[48:63], a[244:247], v[80:83], v[48:63]
    ds_read_b128 a[244:247], v90 offset:24672
    v_exp_f32 v42, v42
    v_exp_f32 v43, v43
    v_exp_f32 v44, v44
    v_exp_f32 v45, v45
    v_exp_f32 v46, v46
    v_exp_f32 v47, v47
    v_cvt_pk_bf16_f32 v84, v40, v41
    v_cvt_pk_bf16_f32 v85, v42, v43
    v_cvt_pk_bf16_f32 v86, v44, v45
    v_cvt_pk_bf16_f32 v87, v46, v47
    s_waitcnt lgkmcnt(5)
    v_mfma_f32_32x32x16_bf16 v[32:47], a[236:239], v[96:99], 0
    ds_read_b128 a[236:239], v1 offset:30832
    v_exp_f32 v16, v16
    v_exp_f32 v17, v17
    v_exp_f32 v18, v18
    v_exp_f32 v19, v19
    v_mfma_f32_32x32x16_bf16 v[48:63], a[252:255], v[84:87], v[48:63]
    ds_read_b128 a[252:255], v91 offset:24672
    s_waitcnt lgkmcnt(3)
    v_max3_u32 v7, v104, v105, v106
    v_max_u32 v7, v7, v107
    v_cmp_eq_u32 vcc, -1, v7
    s_cbranch_vccnz Lre7
Lok7:
    s_barrier
    v_exp_f32 v20, v20
    v_exp_f32 v21, v21
    v_exp_f32 v22, v22
    v_exp_f32 v23, v23
    v_cvt_pk_bf16_f32 v80, v16, v17
    v_cvt_pk_bf16_f32 v81, v18, v19
    v_cvt_pk_bf16_f32 v82, v20, v21
    v_cvt_pk_bf16_f32 v83, v22, v23
    v_exp_f32 v24, v24
    v_exp_f32 v25, v25
    v_mfma_f32_32x32x16_bf16 v[48:63], a[240:243], v[80:83], v[48:63]
    ds_read_b128 a[240:243], v88 offset:28784
    v_exp_f32 v26, v26
    v_exp_f32 v27, v27
    v_exp_f32 v28, v28
    v_exp_f32 v29, v29
    v_exp_f32 v30, v30
    v_exp_f32 v31, v31
    v_cvt_pk_bf16_f32 v84, v24, v25
    v_cvt_pk_bf16_f32 v85, v26, v27
    v_cvt_pk_bf16_f32 v86, v28, v29
    v_cvt_pk_bf16_f32 v87, v30, v31
    s_waitcnt lgkmcnt(3)
    v_mfma_f32_32x32x16_bf16 v[16:31], a[232:235], v[96:99], 0
    ds_read_b128 a[232:235], v1 offset:32896
    v_exp_f32 v32, v32
    v_exp_f32 v33, v33
    v_exp_f32 v34, v34
    v_exp_f32 v35, v35
    v_mfma_f32_32x32x16_bf16 v[48:63], a[248:251], v[84:87], v[48:63]
    ds_read_b128 a[248:251], v89 offset:28784
    v_exp_f32 v36, v36
    v_exp_f32 v37, v37
    v_exp_f32 v38, v38
    v_exp_f32 v39, v39
    v_cvt_pk_bf16_f32 v80, v32, v33
    v_cvt_pk_bf16_f32 v81, v34, v35
    v_cvt_pk_bf16_f32 v82, v36, v37
    v_cvt_pk_bf16_f32 v83, v38, v39
    v_exp_f32 v40, v40
    v_exp_f32 v41, v41
    v_mfma_f32_32x32x16_bf16 v[48:63], a[244:247], v[80:83], v[48:63]
    ds_read_b128 a[244:247], v90 offset:28784
    v_exp_f32 v42, v42
    v_exp_f32 v43, v43
    v_exp_f32 v44, v44
    v_exp_f32 v45, v45
    v_exp_f32 v46, v46
    v_exp_f32 v47, v47
    v_cvt_pk_bf16_f32 v84, v40, v41
    v_cvt_pk_bf16_f32 v85, v42, v43
    v_cvt_pk_bf16_f32 v86, v44, v45
    v_cvt_pk_bf16_f32 v87, v46, v47
    s_waitcnt lgkmcnt(3)
    v_mfma_f32_32x32x16_bf16 v[32:47], a[236:239], v[96:99], 0
    ds_read_b128 a[236:239], v1 offset:34944
    v_exp_f32 v16, v16
    v_exp_f32 v17, v17
    v_exp_f32 v18, v18
    v_exp_f32 v19, v19
    v_mfma_f32_32x32x16_bf16 v[48:63], a[252:255], v[84:87], v[48:63]
    ds_read_b128 a[252:255], v91 offset:28784
    v_exp_f32 v20, v20
    v_exp_f32 v21, v21
    v_exp_f32 v22, v22
    v_exp_f32 v23, v23
    v_cvt_pk_bf16_f32 v80, v16, v17
    v_cvt_pk_bf16_f32 v81, v18, v19
    v_cvt_pk_bf16_f32 v82, v20, v21
    v_cvt_pk_bf16_f32 v83, v22, v23
    v_exp_f32 v24, v24
    v_exp_f32 v25, v25
    v_mfma_f32_32x32x16_bf16 v[48:63], a[240:243], v[80:83], v[48:63]
    ds_read_b128 a[240:243], v88 offset:32896
    s_add_u32 s83, s30, 0x808000
    buffer_store_dwordx4 a[224:227], v1, s[4:7], s83 offen sc1
    v_exp_f32 v26, v26
    v_exp_f32 v27, v27
    v_exp_f32 v28, v28
    v_exp_f32 v29, v29
    v_exp_f32 v30, v30
    v_exp_f32 v31, v31
    v_cvt_pk_bf16_f32 v84, v24, v25
    v_cvt_pk_bf16_f32 v85, v26, v27
    v_cvt_pk_bf16_f32 v86, v28, v29
    v_cvt_pk_bf16_f32 v87, v30, v31
    s_waitcnt lgkmcnt(3)
    v_mfma_f32_32x32x16_bf16 v[16:31], a[232:235], v[96:99], 0
    v_exp_f32 v32, v32
    v_exp_f32 v33, v33
    v_exp_f32 v34, v34
    v_exp_f32 v35, v35
    v_mfma_f32_32x32x16_bf16 v[48:63], a[248:251], v[84:87], v[48:63]
    ds_read_b128 a[248:251], v89 offset:32896
    s_waitcnt vmcnt(3)
    v_cmp_eq_u32 vcc, -1, v100
    s_cbranch_vccnz Lre8
Lok8:
    v_accvgpr_write_b32 a228, v100
    v_accvgpr_write_b32 a229, v101
    v_accvgpr_write_b32 a230, v102
    v_accvgpr_write_b32 a231, v103
    v_lshrrev_b32 v7, 2, v1
    v_and_b32 v7, 64, v7
    v_xor_b32 v7, v7, v1
    v_and_b32 v7, 0x70, v7
    v_lshrrev_b32 v111, 7, v1
    v_mul_u32_u24 v111, 1024, v111
    v_add_u32 v111, v111, v7
    v_exp_f32 v36, v36
    v_exp_f32 v37, v37
    v_exp_f32 v38, v38
    v_exp_f32 v39, v39
    v_cvt_pk_bf16_f32 v80, v32, v33
PAD3:
    s_cbranch_execz WARM8_3
    v_cvt_pk_bf16_f32 v81, v34, v35
    v_cvt_pk_bf16_f32 v82, v36, v37
    v_cvt_pk_bf16_f32 v83, v38, v39
    v_exp_f32 v40, v40
    v_exp_f32 v41, v41
    v_mfma_f32_32x32x16_bf16 v[48:63], a[244:247], v[80:83], v[48:63]
    ds_read_b128 a[244:247], v90 offset:32896
    v_exp_f32 v42, v42
    v_exp_f32 v43, v43
    v_exp_f32 v44, v44
    v_exp_f32 v45, v45
    v_exp_f32 v46, v46
    v_exp_f32 v47, v47
    v_cvt_pk_bf16_f32 v84, v40, v41
    v_cvt_pk_bf16_f32 v85, v42, v43
    v_cvt_pk_bf16_f32 v86, v44, v45
    v_cvt_pk_bf16_f32 v87, v46, v47
    s_waitcnt lgkmcnt(1)
    v_mfma_f32_32x32x16_bf16 v[32:47], a[232:235], a[228:231], 0
    ds_read_b128 a[232:235], v1 offset:37008
    v_exp_f32 v16, v16
    v_exp_f32 v17, v17
    v_exp_f32 v18, v18
    v_exp_f32 v19, v19
    v_mfma_f32_32x32x16_bf16 v[48:63], a[252:255], v[84:87], v[48:63]
    ds_read_b128 a[252:255], v91 offset:32896
    v_lshrrev_b32 v110, 6, v1
    v_mul_u32_u24 v110, 3584, v110
    v_and_or_b32 v110, v1, 48, v110
    s_add_u32 s56, s22, 0x14140
    v_lshrrev_b32 v109, 1, v1
    v_lshrrev_b32 v7, 3, v1
    v_and_b32 v109, 0x118, v109
    v_and_or_b32 v109, v7, 32, v109
    v_and_b32 v7, 0xc0, v1
    v_add3_u32 v109, v109, v7, s56
    v_add_u32 v102, 0x10100, v124
    v_add_u32 v103, 0x10100, v4
    v_exp_f32 v20, v20
    v_exp_f32 v21, v21
    v_exp_f32 v22, v22
    v_exp_f32 v23, v23
    v_cvt_pk_bf16_f32 v80, v16, v17
    v_cvt_pk_bf16_f32 v81, v18, v19
    v_cvt_pk_bf16_f32 v82, v20, v21
    v_cvt_pk_bf16_f32 v83, v22, v23
    v_exp_f32 v24, v24
    v_exp_f32 v25, v25
    v_mfma_f32_32x32x16_bf16 v[48:63], a[240:243], v[80:83], v[48:63]
    v_exp_f32 v26, v26
    v_exp_f32 v27, v27
    v_exp_f32 v28, v28
    v_exp_f32 v29, v29
    v_exp_f32 v30, v30
    v_exp_f32 v31, v31
    v_cvt_pk_bf16_f32 v84, v24, v25
    v_cvt_pk_bf16_f32 v85, v26, v27
    v_cvt_pk_bf16_f32 v86, v28, v29
    v_cvt_pk_bf16_f32 v87, v30, v31
    v_mfma_f32_32x32x16_bf16 v[16:31], a[236:239], v[96:99], 0
    s_add_u32 m0, s22, 0x14140
    s_mov_b32 s84, s31
    buffer_load_dwordx4 v110, s[72:75], s84 offen lds
    v_exp_f32 v32, v32
    v_exp_f32 v33, v33
    v_exp_f32 v34, v34
    v_exp_f32 v35, v35
    v_mfma_f32_32x32x16_bf16 v[48:63], a[248:251], v[84:87], v[48:63]
    s_mul_i32 s64, s33, 0xfe000
    s_add_u32 s39, s39, s64
    s_add_u32 s40, s40, s64
    s_mul_i32 s64, s33, -2088960
    s_add_u32 s27, s27, s64
    s_mul_i32 s33, s33, 7168
    s_cmp_eq_u32 s43, 1.0
    s_cmov_b32 s33, s64
    s_add_u32 s26, s26, s33
    v_lshlrev_b32 v112, 16, v116
    v_and_b32 v113, 0xffff0000, v116
    v_lshlrev_b32 v114, 16, v117
    v_and_b32 v115, 0xffff0000, v117
    v_lshlrev_b32 v116, 16, v118
    v_and_b32 v117, 0xffff0000, v118
    v_lshlrev_b32 v118, 16, v119
    v_and_b32 v119, 0xffff0000, v119
    v_exp_f32 v36, v36
    v_exp_f32 v37, v37
    v_exp_f32 v38, v38
    v_exp_f32 v39, v39
    v_cvt_pk_bf16_f32 v80, v32, v33
    v_cvt_pk_bf16_f32 v81, v34, v35
    v_cvt_pk_bf16_f32 v82, v36, v37
    v_cvt_pk_bf16_f32 v83, v38, v39
    v_exp_f32 v40, v40
    v_exp_f32 v41, v41
    v_mfma_f32_32x32x16_bf16 v[64:79], a[240:243], v[80:83], 0
    ds_read_b128 a[240:243], v88 offset:37008
    s_add_u32 s80, s31, 0xdc00
    buffer_load_dwordx4 v110, s[72:75], s80 offen offset:1024 lds
    v_exp_f32 v42, v42
    v_exp_f32 v43, v43
    v_exp_f32 v44, v44
    v_exp_f32 v45, v45
    v_exp_f32 v46, v46
    v_exp_f32 v47, v47
    v_cvt_pk_bf16_f32 v84, v40, v41
    v_cvt_pk_bf16_f32 v85, v42, v43
    v_cvt_pk_bf16_f32 v86, v44, v45
    v_cvt_pk_bf16_f32 v87, v46, v47
    s_waitcnt lgkmcnt(1)
    v_mfma_f32_32x32x16_bf16 v[32:47], a[236:239], a[228:231], 0
    ds_read_b128 a[236:239], v1 offset:39056
    s_add_u32 s81, s31, 0x1b800
    buffer_load_dwordx4 v110, s[72:75], s81 offen offset:2048 lds
    v_exp_f32 v16, v16
    v_exp_f32 v17, v17
    v_exp_f32 v18, v18
    v_exp_f32 v19, v19
    v_mfma_f32_32x32x16_bf16 v[64:79], a[248:251], v[84:87], v[64:79]
    ds_read_b128 a[248:251], v89 offset:37008
    s_mul_i32 s64, s41, 7
    s_lshr_b32 s64, s64, 2
    v_min_u32 v7, 208, v1
    v_lshl_add_u32 v7, v7, 3, s64
    global_load_dword a213, v7, s[76:77]
    v_exp_f32 v20, v20
    v_exp_f32 v21, v21
    v_exp_f32 v22, v22
    v_exp_f32 v23, v23
    v_cvt_pk_bf16_f32 v80, v16, v17
    v_cvt_pk_bf16_f32 v81, v18, v19
    v_cvt_pk_bf16_f32 v82, v20, v21
    v_cvt_pk_bf16_f32 v83, v22, v23
    v_exp_f32 v24, v24
    v_exp_f32 v25, v25
    v_mfma_f32_32x32x16_bf16 v[48:63], a[244:247], v[80:83], v[48:63]
    s_add_u32 s85, s41, 0x1200000
    buffer_store_dwordx4 a[224:227], v1, s[4:7], s85 offen sc1
    v_exp_f32 v26, v26
    v_exp_f32 v27, v27
    v_exp_f32 v28, v28
    v_exp_f32 v29, v29
    v_exp_f32 v30, v30
    v_exp_f32 v31, v31
    v_cvt_pk_bf16_f32 v84, v24, v25
    v_cvt_pk_bf16_f32 v85, v26, v27
    v_cvt_pk_bf16_f32 v86, v28, v29
    v_cvt_pk_bf16_f32 v87, v30, v31
    v_mfma_f32_32x32x16_bf16 v[16:31], a[232:235], v[96:99], 0
    s_add_u32 s87, s31, 0x29400
    buffer_load_dwordx4 v110, s[72:75], s87 offen offset:3072 lds
    v_exp_f32 v32, v32
    v_exp_f32 v33, v33
    v_exp_f32 v34, v34
    v_exp_f32 v35, v35
    v_mfma_f32_32x32x16_bf16 v[48:63], a[252:255], v[84:87], v[48:63]
    v_exp_f32 v36, v36
    v_exp_f32 v37, v37
    v_exp_f32 v38, v38
    v_exp_f32 v39, v39
    v_cvt_pk_bf16_f32 v80, v32, v33
    v_cvt_pk_bf16_f32 v81, v34, v35
    v_cvt_pk_bf16_f32 v82, v36, v37
    v_cvt_pk_bf16_f32 v83, v38, v39
    v_exp_f32 v40, v40
    v_exp_f32 v41, v41
    v_mfma_f32_32x32x16_bf16 v[64:79], a[244:247], v[80:83], v[64:79]
    ds_read_b128 a[244:247], v90 offset:37008
    v_exp_f32 v42, v42
    v_exp_f32 v43, v43
    v_exp_f32 v44, v44
    v_exp_f32 v45, v45
    v_exp_f32 v46, v46
    v_exp_f32 v47, v47
    v_cvt_pk_bf16_f32 v84, v40, v41
    v_cvt_pk_bf16_f32 v85, v42, v43
    v_cvt_pk_bf16_f32 v86, v44, v45
    v_cvt_pk_bf16_f32 v87, v46, v47
    s_waitcnt lgkmcnt(1)
    v_mfma_f32_32x32x16_bf16 v[32:47], a[232:235], a[228:231], 0
    ds_read_b128 a[232:235], v1 offset:41120
    v_exp_f32 v16, v16
    v_exp_f32 v17, v17
    v_exp_f32 v18, v18
    v_exp_f32 v19, v19
    v_mfma_f32_32x32x16_bf16 v[64:79], a[252:255], v[84:87], v[64:79]
    ds_read_b128 a[252:255], v91 offset:37008
    v_exp_f32 v20, v20
    v_exp_f32 v21, v21
    v_exp_f32 v22, v22
    v_exp_f32 v23, v23
    v_cvt_pk_bf16_f32 v80, v16, v17
    v_cvt_pk_bf16_f32 v81, v18, v19
    v_cvt_pk_bf16_f32 v82, v20, v21
    v_cvt_pk_bf16_f32 v83, v22, v23
    v_exp_f32 v24, v24
    v_exp_f32 v25, v25
    v_mfma_f32_32x32x16_bf16 v[48:63], a[240:243], v[80:83], v[48:63]
    s_add_u32 m0, s22, 0x18180
    s_add_u32 s91, s31, 0x38000
    buffer_load_dwordx4 v110, s[72:75], s91 offen lds
    v_exp_f32 v26, v26
    v_exp_f32 v27, v27
    v_exp_f32 v28, v28
    v_exp_f32 v29, v29
    v_exp_f32 v30, v30
    v_exp_f32 v31, v31
    v_cvt_pk_bf16_f32 v84, v24, v25
    v_cvt_pk_bf16_f32 v85, v26, v27
    v_cvt_pk_bf16_f32 v86, v28, v29
    v_cvt_pk_bf16_f32 v87, v30, v31
    v_mfma_f32_32x32x16_bf16 v[16:31], a[236:239], v[96:99], 0
    s_add_u32 s88, s31, 0x45c00
    buffer_load_dwordx4 v110, s[72:75], s88 offen offset:1024 lds
    v_exp_f32 v32, v32
    v_exp_f32 v33, v33
    v_exp_f32 v34, v34
    v_exp_f32 v35, v35
    v_mfma_f32_32x32x16_bf16 v[48:63], a[248:251], v[84:87], v[48:63]
    v_exp_f32 v36, v36
    v_exp_f32 v37, v37
    v_exp_f32 v38, v38
    v_exp_f32 v39, v39
    v_cvt_pk_bf16_f32 v80, v32, v33
    v_cvt_pk_bf16_f32 v81, v34, v35
    v_cvt_pk_bf16_f32 v82, v36, v37
    v_cvt_pk_bf16_f32 v83, v38, v39
    v_exp_f32 v40, v40
    v_exp_f32 v41, v41
    v_mfma_f32_32x32x16_bf16 v[64:79], a[240:243], v[80:83], v[64:79]
    ds_read_b128 a[240:243], v88 offset:41120
    s_add_u32 s90, s31, 0x53800
    buffer_load_dwordx4 v110, s[72:75], s90 offen offset:2048 lds
    v_exp_f32 v42, v42
    v_exp_f32 v43, v43
    v_exp_f32 v44, v44
    v_exp_f32 v45, v45
    v_exp_f32 v46, v46
    v_exp_f32 v47, v47
    v_cvt_pk_bf16_f32 v84, v40, v41
    v_cvt_pk_bf16_f32 v85, v42, v43
    v_cvt_pk_bf16_f32 v86, v44, v45
    v_cvt_pk_bf16_f32 v87, v46, v47
    s_waitcnt lgkmcnt(1)
    v_mfma_f32_32x32x16_bf16 v[32:47], a[236:239], a[228:231], 0
    ds_read_b128 a[236:239], v1 offset:43168
    s_add_u32 s86, s31, 0x61400
    buffer_load_dwordx4 v110, s[72:75], s86 offen offset:3072 lds
    v_exp_f32 v16, v16
    v_exp_f32 v17, v17
    v_exp_f32 v18, v18
    v_exp_f32 v19, v19
    v_mfma_f32_32x32x16_bf16 v[64:79], a[248:251], v[84:87], v[64:79]
    ds_read_b128 a[248:251], v89 offset:41120
    v_exp_f32 v20, v20
    v_exp_f32 v21, v21
    v_exp_f32 v22, v22
    v_exp_f32 v23, v23
    v_cvt_pk_bf16_f32 v80, v16, v17
    v_cvt_pk_bf16_f32 v81, v18, v19
    v_cvt_pk_bf16_f32 v82, v20, v21
    v_cvt_pk_bf16_f32 v83, v22, v23
    v_exp_f32 v24, v24
    v_exp_f32 v25, v25
    v_mfma_f32_32x32x16_bf16 v[48:63], a[244:247], v[80:83], v[48:63]
    s_add_u32 s89, s41, 0x1300000
    buffer_store_dwordx4 a[224:227], v1, s[4:7], s89 offen sc1
    v_exp_f32 v26, v26
    v_exp_f32 v27, v27
    v_exp_f32 v28, v28
    v_exp_f32 v29, v29
    v_exp_f32 v30, v30
    v_exp_f32 v31, v31
    v_cvt_pk_bf16_f32 v84, v24, v25
    v_cvt_pk_bf16_f32 v85, v26, v27
    v_cvt_pk_bf16_f32 v86, v28, v29
    v_cvt_pk_bf16_f32 v87, v30, v31
    v_mfma_f32_32x32x16_bf16 v[16:31], a[232:235], v[96:99], 0
    s_add_u32 m0, s22, 0x1c1c0
    s_add_u32 s82, s31, 0x70000
    buffer_load_dwordx4 v110, s[72:75], s82 offen lds
    v_exp_f32 v32, v32
    v_exp_f32 v33, v33
    v_exp_f32 v34, v34
    v_exp_f32 v35, v35
    v_mfma_f32_32x32x16_bf16 v[48:63], a[252:255], v[84:87], v[48:63]
    v_exp_f32 v36, v36
    v_exp_f32 v37, v37
    v_exp_f32 v38, v38
    v_exp_f32 v39, v39
    v_cvt_pk_bf16_f32 v80, v32, v33
    v_cvt_pk_bf16_f32 v81, v34, v35
    v_cvt_pk_bf16_f32 v82, v36, v37
    v_cvt_pk_bf16_f32 v83, v38, v39
    v_exp_f32 v40, v40
    v_exp_f32 v41, v41
    v_mfma_f32_32x32x16_bf16 v[64:79], a[244:247], v[80:83], v[64:79]
    ds_read_b128 a[244:247], v90 offset:41120
    v_exp_f32 v42, v42
    v_exp_f32 v43, v43
    v_exp_f32 v44, v44
    v_exp_f32 v45, v45
    v_exp_f32 v46, v46
    v_exp_f32 v47, v47
    v_cvt_pk_bf16_f32 v84, v40, v41
    v_cvt_pk_bf16_f32 v85, v42, v43
    v_cvt_pk_bf16_f32 v86, v44, v45
    v_cvt_pk_bf16_f32 v87, v46, v47
    s_waitcnt lgkmcnt(1)
    v_mfma_f32_32x32x16_bf16 v[32:47], a[232:235], a[228:231], 0
    ds_read_b128 a[232:235], v1 offset:45232
    v_exp_f32 v16, v16
    v_exp_f32 v17, v17
    v_exp_f32 v18, v18
    v_exp_f32 v19, v19
    v_mfma_f32_32x32x16_bf16 v[64:79], a[252:255], v[84:87], v[64:79]
    ds_read_b128 a[252:255], v91 offset:41120
    v_exp_f32 v20, v20
    v_exp_f32 v21, v21
    v_exp_f32 v22, v22
    v_exp_f32 v23, v23
    v_cvt_pk_bf16_f32 v80, v16, v17
    v_cvt_pk_bf16_f32 v81, v18, v19
    v_cvt_pk_bf16_f32 v82, v20, v21
    v_cvt_pk_bf16_f32 v83, v22, v23
    v_exp_f32 v24, v24
    v_exp_f32 v25, v25
    v_mfma_f32_32x32x16_bf16 v[48:63], a[240:243], v[80:83], v[48:63]
    s_add_u32 s83, s31, 0x7dc00
    buffer_load_dwordx4 v110, s[72:75], s83 offen offset:1024 lds
    v_exp_f32 v26, v26
    v_exp_f32 v27, v27
    v_exp_f32 v28, v28
    v_exp_f32 v29, v29
    v_exp_f32 v30, v30
    v_exp_f32 v31, v31
    v_cvt_pk_bf16_f32 v84, v24, v25
    v_cvt_pk_bf16_f32 v85, v26, v27
    v_cvt_pk_bf16_f32 v86, v28, v29
    v_cvt_pk_bf16_f32 v87, v30, v31
    v_mfma_f32_32x32x16_bf16 v[16:31], a[236:239], v[96:99], 0
    s_add_u32 s84, s31, 0x8b800
    buffer_load_dwordx4 v110, s[72:75], s84 offen offset:2048 lds
    v_exp_f32 v32, v32
    v_exp_f32 v33, v33
    v_exp_f32 v34, v34
    v_exp_f32 v35, v35
    v_mfma_f32_32x32x16_bf16 v[48:63], a[248:251], v[84:87], v[48:63]
    v_exp_f32 v36, v36
    v_exp_f32 v37, v37
    v_exp_f32 v38, v38
    v_exp_f32 v39, v39
    v_cvt_pk_bf16_f32 v80, v32, v33
    v_cvt_pk_bf16_f32 v81, v34, v35
    v_cvt_pk_bf16_f32 v82, v36, v37
    v_cvt_pk_bf16_f32 v83, v38, v39
    v_exp_f32 v40, v40
    v_exp_f32 v41, v41
    v_mfma_f32_32x32x16_bf16 v[64:79], a[240:243], v[80:83], v[64:79]
    ds_read_b128 a[240:243], v88 offset:45232
    v_exp_f32 v42, v42
    v_exp_f32 v43, v43
    v_exp_f32 v44, v44
    v_exp_f32 v45, v45
    v_exp_f32 v46, v46
    v_exp_f32 v47, v47
    v_cvt_pk_bf16_f32 v84, v40, v41
    v_cvt_pk_bf16_f32 v85, v42, v43
    v_cvt_pk_bf16_f32 v86, v44, v45
    v_cvt_pk_bf16_f32 v87, v46, v47
    s_waitcnt lgkmcnt(1)
    v_mfma_f32_32x32x16_bf16 v[32:47], a[236:239], a[228:231], 0
    ds_read_b128 a[236:239], v1 offset:47280
    s_add_u32 s80, s31, 0x99400
    buffer_load_dwordx4 v110, s[72:75], s80 offen offset:3072 lds
    v_exp_f32 v16, v16
    v_exp_f32 v17, v17
    v_exp_f32 v18, v18
    v_exp_f32 v19, v19
    v_mfma_f32_32x32x16_bf16 v[64:79], a[248:251], v[84:87], v[64:79]
    ds_read_b128 a[248:251], v89 offset:45232
    v_exp_f32 v20, v20
    v_exp_f32 v21, v21
    v_exp_f32 v22, v22
    v_exp_f32 v23, v23
    v_cvt_pk_bf16_f32 v80, v16, v17
    v_cvt_pk_bf16_f32 v81, v18, v19
    v_cvt_pk_bf16_f32 v82, v20, v21
    v_cvt_pk_bf16_f32 v83, v22, v23
    v_exp_f32 v24, v24
    v_exp_f32 v25, v25
    v_mfma_f32_32x32x16_bf16 v[48:63], a[244:247], v[80:83], v[48:63]
    s_add_u32 m0, s22, 0x20200
    s_add_u32 s81, s31, 0xa8000
    buffer_load_dwordx4 v110, s[72:75], s81 offen lds
    v_exp_f32 v26, v26
    v_exp_f32 v27, v27
    v_exp_f32 v28, v28
    v_exp_f32 v29, v29
    v_exp_f32 v30, v30
    v_exp_f32 v31, v31
    v_cvt_pk_bf16_f32 v84, v24, v25
    v_cvt_pk_bf16_f32 v85, v26, v27
    v_cvt_pk_bf16_f32 v86, v28, v29
    v_cvt_pk_bf16_f32 v87, v30, v31
    v_mfma_f32_32x32x16_bf16 v[16:31], a[232:235], v[96:99], 0
    s_add_u32 m0, s22, 0x10100
    s_add_u32 s85, s29, 0x810000
    buffer_load_dwordx4 v1, s[4:7], s85 offen sc1 lds
    v_exp_f32 v32, v32
    v_exp_f32 v33, v33
    v_exp_f32 v34, v34
    v_exp_f32 v35, v35
    v_mfma_f32_32x32x16_bf16 v[48:63], a[252:255], v[84:87], v[48:63]
    s_waitcnt vmcnt(16)
    ds_read_b64_tr_b16 v[128:129], v109 offset:0
    ds_read_b64_tr_b16 v[130:131], v109 offset:512
    s_waitcnt vmcnt(15)
    ds_read_b64_tr_b16 v[132:133], v109 offset:1024
    ds_read_b64_tr_b16 v[134:135], v109 offset:1536
    v_exp_f32 v36, v36
    v_exp_f32 v37, v37
    v_exp_f32 v38, v38
    v_exp_f32 v39, v39
    v_cvt_pk_bf16_f32 v80, v32, v33
    v_cvt_pk_bf16_f32 v81, v34, v35
    v_cvt_pk_bf16_f32 v82, v36, v37
    v_cvt_pk_bf16_f32 v83, v38, v39
    v_exp_f32 v40, v40
    v_exp_f32 v41, v41
    v_mfma_f32_32x32x16_bf16 v[64:79], a[244:247], v[80:83], v[64:79]
    ds_read_b128 a[244:247], v90 offset:45232
    buffer_load_dwordx4 v1, s[4:7], s85 offen offset:1024 sc1 lds
    v_exp_f32 v42, v42
    v_exp_f32 v43, v43
    v_exp_f32 v44, v44
    v_exp_f32 v45, v45
    v_exp_f32 v46, v46
    v_exp_f32 v47, v47
    v_cvt_pk_bf16_f32 v84, v40, v41
    v_cvt_pk_bf16_f32 v85, v42, v43
    v_cvt_pk_bf16_f32 v86, v44, v45
    v_cvt_pk_bf16_f32 v87, v46, v47
    s_waitcnt lgkmcnt(5)
    v_mfma_f32_32x32x16_bf16 v[32:47], a[232:235], a[228:231], 0
    ds_read_b128 a[232:235], v1 offset:49344
    buffer_load_dwordx4 v1, s[4:7], s85 offen offset:2048 sc1 lds
    v_exp_f32 v16, v16
    v_exp_f32 v17, v17
    v_exp_f32 v18, v18
    v_exp_f32 v19, v19
    v_mfma_f32_32x32x16_bf16 v[64:79], a[252:255], v[84:87], v[64:79]
    ds_read_b128 a[252:255], v91 offset:45232
    s_waitcnt vmcnt(16)
    ds_read_b64_tr_b16 v[136:137], v109 offset:2048
    ds_read_b64_tr_b16 v[138:139], v109 offset:2560
    v_exp_f32 v20, v20
    v_exp_f32 v21, v21
    v_exp_f32 v22, v22
    v_exp_f32 v23, v23
    v_cvt_pk_bf16_f32 v80, v16, v17
    v_cvt_pk_bf16_f32 v81, v18, v19
    v_cvt_pk_bf16_f32 v82, v20, v21
    v_cvt_pk_bf16_f32 v83, v22, v23
    v_exp_f32 v24, v24
    v_exp_f32 v25, v25
    v_mfma_f32_32x32x16_bf16 v[48:63], a[240:243], v[80:83], v[48:63]
    buffer_load_dwordx4 v1, s[4:7], s85 offen offset:3072 sc1 lds
    v_exp_f32 v26, v26
    v_exp_f32 v27, v27
    v_exp_f32 v28, v28
    v_exp_f32 v29, v29
    s_waitcnt lgkmcnt(6)
    v_mfma_f32_16x16x32_bf16 a[216:219], a[220:223], v[128:131], 0
    v_exp_f32 v30, v30
    v_exp_f32 v31, v31
    v_cvt_pk_bf16_f32 v84, v24, v25
    v_cvt_pk_bf16_f32 v85, v26, v27
    v_cvt_pk_bf16_f32 v86, v28, v29
    v_cvt_pk_bf16_f32 v87, v30, v31
    v_mfma_f32_32x32x16_bf16 v[16:31], a[236:239], v[96:99], 0
    s_add_u32 m0, s22, 0x20600
    s_add_u32 s87, s31, 0xb6000
    buffer_load_dwordx4 v110, s[72:75], s87 offen lds
    v_exp_f32 v32, v32
    v_exp_f32 v33, v33
    v_exp_f32 v34, v34
    v_exp_f32 v35, v35
    v_mfma_f32_32x32x16_bf16 v[48:63], a[248:251], v[84:87], v[48:63]
    s_waitcnt vmcnt(15)
    ds_read_b64_tr_b16 v[140:141], v109 offset:3072
    ds_read_b64_tr_b16 v[142:143], v109 offset:3584
    v_exp_f32 v36, v36
    v_exp_f32 v37, v37
    v_exp_f32 v38, v38
    v_exp_f32 v39, v39
    v_cvt_pk_bf16_f32 v80, v32, v33
    v_cvt_pk_bf16_f32 v81, v34, v35
    v_cvt_pk_bf16_f32 v82, v36, v37
    v_cvt_pk_bf16_f32 v83, v38, v39
    v_exp_f32 v40, v40
    v_exp_f32 v41, v41
    v_mfma_f32_32x32x16_bf16 v[64:79], a[240:243], v[80:83], v[64:79]
    ds_read_b128 a[240:243], v88 offset:49344
    s_add_u32 s91, s31, 0xc3c00
    buffer_load_dwordx4 v110, s[72:75], s91 offen offset:1024 lds
    v_exp_f32 v42, v42
    v_exp_f32 v43, v43
    v_exp_f32 v44, v44
    v_exp_f32 v45, v45
    s_waitcnt lgkmcnt(7)
    v_mfma_f32_16x16x32_bf16 a[216:219], a[220:223], v[132:135], a[216:219]
    v_exp_f32 v46, v46
    v_exp_f32 v47, v47
    v_cvt_pk_bf16_f32 v84, v40, v41
    v_cvt_pk_bf16_f32 v85, v42, v43
    v_cvt_pk_bf16_f32 v86, v44, v45
    v_cvt_pk_bf16_f32 v87, v46, v47
    s_waitcnt lgkmcnt(5)
    v_mfma_f32_32x32x16_bf16 v[32:47], a[236:239], a[228:231], 0
    ds_read_b128 a[236:239], v1 offset:51392
    s_add_u32 s88, s31, 0xd1800
    buffer_load_dwordx4 v110, s[72:75], s88 offen offset:2048 lds
    v_exp_f32 v16, v16
    v_exp_f32 v17, v17
    v_exp_f32 v18, v18
    v_exp_f32 v19, v19
    v_mfma_f32_32x32x16_bf16 v[64:79], a[248:251], v[84:87], v[64:79]
    ds_read_b128 a[248:251], v89 offset:49344
    s_waitcnt vmcnt(16)
    ds_read_b64_tr_b16 v[144:145], v109 offset:16448
    ds_read_b64_tr_b16 v[146:147], v109 offset:16960
    v_exp_f32 v20, v20
    v_exp_f32 v21, v21
    v_exp_f32 v22, v22
    v_exp_f32 v23, v23
    v_cvt_pk_bf16_f32 v80, v16, v17
    v_cvt_pk_bf16_f32 v81, v18, v19
    v_cvt_pk_bf16_f32 v82, v20, v21
    v_cvt_pk_bf16_f32 v83, v22, v23
    v_exp_f32 v24, v24
    v_exp_f32 v25, v25
    v_mfma_f32_32x32x16_bf16 v[48:63], a[244:247], v[80:83], v[48:63]
    s_add_u32 m0, s22, 0x14140
    s_add_u32 s90, s31, 0xe0000
    buffer_load_dwordx4 v110, s[72:75], s90 offen lds
    v_exp_f32 v26, v26
    v_exp_f32 v27, v27
    v_exp_f32 v28, v28
    v_exp_f32 v29, v29
    s_waitcnt lgkmcnt(6)
    v_mfma_f32_16x16x32_bf16 a[216:219], a[220:223], v[136:139], a[216:219]
    v_exp_f32 v30, v30
    v_exp_f32 v31, v31
    v_cvt_pk_bf16_f32 v84, v24, v25
    v_cvt_pk_bf16_f32 v85, v26, v27
    v_cvt_pk_bf16_f32 v86, v28, v29
    v_cvt_pk_bf16_f32 v87, v30, v31
    v_mfma_f32_32x32x16_bf16 v[16:31], a[232:235], v[96:99], 0
    s_add_u32 s86, s31, 0xedc00
    buffer_load_dwordx4 v110, s[72:75], s86 offen offset:1024 lds
    v_exp_f32 v32, v32
    v_exp_f32 v33, v33
    v_exp_f32 v34, v34
    v_exp_f32 v35, v35
    v_mfma_f32_32x32x16_bf16 v[48:63], a[252:255], v[84:87], v[48:63]
    s_waitcnt vmcnt(17)
    ds_read_b64_tr_b16 v[148:149], v109 offset:17472
    ds_read_b64_tr_b16 v[150:151], v109 offset:17984
    s_waitcnt vmcnt(16)
    ds_read_b64_tr_b16 v[152:153], v109 offset:18496
    ds_read_b64_tr_b16 v[154:155], v109 offset:19008
    v_exp_f32 v36, v36
    v_exp_f32 v37, v37
    v_exp_f32 v38, v38
    v_exp_f32 v39, v39
    v_cvt_pk_bf16_f32 v80, v32, v33
    v_cvt_pk_bf16_f32 v81, v34, v35
    v_cvt_pk_bf16_f32 v82, v36, v37
    v_cvt_pk_bf16_f32 v83, v38, v39
    v_exp_f32 v40, v40
    v_exp_f32 v41, v41
    v_mfma_f32_32x32x16_bf16 v[64:79], a[244:247], v[80:83], v[64:79]
    ds_read_b128 a[244:247], v90 offset:49344
    s_add_u32 s89, s31, 0xfb800
    buffer_load_dwordx4 v110, s[72:75], s89 offen offset:2048 lds
    v_exp_f32 v42, v42
    v_exp_f32 v43, v43
    v_exp_f32 v44, v44
    v_exp_f32 v45, v45
    s_waitcnt lgkmcnt(9)
    v_mfma_f32_16x16x32_bf16 a[216:219], a[220:223], v[140:143], a[216:219]
    v_exp_f32 v46, v46
    v_exp_f32 v47, v47
    v_cvt_pk_bf16_f32 v84, v40, v41
    v_cvt_pk_bf16_f32 v85, v42, v43
    v_cvt_pk_bf16_f32 v86, v44, v45
    v_cvt_pk_bf16_f32 v87, v46, v47
    s_waitcnt lgkmcnt(7)
    v_mfma_f32_32x32x16_bf16 v[32:47], a[232:235], a[228:231], 0
    ds_read_b128 a[232:235], v1 offset:53456
    s_add_u32 s82, s31, 0x109400
    buffer_load_dwordx4 v110, s[72:75], s82 offen offset:3072 lds
    v_exp_f32 v16, v16
    v_exp_f32 v17, v17
    v_exp_f32 v18, v18
    v_exp_f32 v19, v19
    v_mfma_f32_32x32x16_bf16 v[64:79], a[252:255], v[84:87], v[64:79]
    ds_read_b128 a[252:255], v91 offset:49344
    s_waitcnt vmcnt(17)
    ds_read_b64_tr_b16 v[156:157], v109 offset:19520
    ds_read_b64_tr_b16 v[158:159], v109 offset:20032
    v_exp_f32 v20, v20
    v_exp_f32 v21, v21
    v_exp_f32 v22, v22
    v_exp_f32 v23, v23
    v_cvt_pk_bf16_f32 v80, v16, v17
    v_cvt_pk_bf16_f32 v81, v18, v19
    v_cvt_pk_bf16_f32 v82, v20, v21
    v_cvt_pk_bf16_f32 v83, v22, v23
    v_exp_f32 v24, v24
    v_exp_f32 v25, v25
    v_mfma_f32_32x32x16_bf16 v[48:63], a[240:243], v[80:83], v[48:63]
    s_add_u32 s83, s41, 0x1400000
    buffer_store_dwordx4 a[224:227], v1, s[4:7], s83 offen sc1
    v_exp_f32 v26, v26
    v_exp_f32 v27, v27
    v_exp_f32 v28, v28
    v_exp_f32 v29, v29
    s_waitcnt lgkmcnt(8)
    v_mfma_f32_16x16x32_bf16 a[216:219], a[220:223], v[144:147], a[216:219]
    v_exp_f32 v30, v30
    v_exp_f32 v31, v31
    v_cvt_pk_bf16_f32 v84, v24, v25
    v_cvt_pk_bf16_f32 v85, v26, v27
    v_cvt_pk_bf16_f32 v86, v28, v29
    v_cvt_pk_bf16_f32 v87, v30, v31
    v_mfma_f32_32x32x16_bf16 v[16:31], a[236:239], v[96:99], 0
    s_add_u32 m0, s22, 0x18180
    s_add_u32 s84, s31, 0x118000
    buffer_load_dwordx4 v110, s[72:75], s84 offen lds
    v_exp_f32 v32, v32
    v_exp_f32 v33, v33
    v_exp_f32 v34, v34
    v_exp_f32 v35, v35
    v_mfma_f32_32x32x16_bf16 v[48:63], a[248:251], v[84:87], v[48:63]
    s_waitcnt vmcnt(17)
    ds_read_b64_tr_b16 v[160:161], v109 offset:32896
    ds_read_b64_tr_b16 v[162:163], v109 offset:33408
    v_exp_f32 v36, v36
    v_exp_f32 v37, v37
    v_exp_f32 v38, v38
    v_exp_f32 v39, v39
    v_cvt_pk_bf16_f32 v80, v32, v33
    v_cvt_pk_bf16_f32 v81, v34, v35
    v_cvt_pk_bf16_f32 v82, v36, v37
    v_cvt_pk_bf16_f32 v83, v38, v39
    v_exp_f32 v40, v40
    v_exp_f32 v41, v41
    v_mfma_f32_32x32x16_bf16 v[64:79], a[240:243], v[80:83], v[64:79]
    ds_read_b128 a[240:243], v88 offset:53456
    s_add_u32 s80, s41, 0x1500000
    buffer_store_dwordx4 a[224:227], v1, s[4:7], s80 offen sc1
    v_exp_f32 v42, v42
    v_exp_f32 v43, v43
    v_exp_f32 v44, v44
    v_exp_f32 v45, v45
    s_waitcnt lgkmcnt(9)
    v_mfma_f32_16x16x32_bf16 a[216:219], a[220:223], v[148:151], a[216:219]
    v_exp_f32 v46, v46
    v_exp_f32 v47, v47
    v_cvt_pk_bf16_f32 v84, v40, v41
    v_cvt_pk_bf16_f32 v85, v42, v43
    v_cvt_pk_bf16_f32 v86, v44, v45
    v_cvt_pk_bf16_f32 v87, v46, v47
    s_waitcnt lgkmcnt(5)
    v_mfma_f32_32x32x16_bf16 v[32:47], a[236:239], a[228:231], 0
    ds_read_b128 a[236:239], v1 offset:55504
    s_add_u32 s81, s31, 0x125c00
    buffer_load_dwordx4 v110, s[72:75], s81 offen offset:1024 lds
PAD4:
    s_cbranch_execz PAD8
    v_exp_f32 v16, v16
    v_exp_f32 v17, v17
    v_exp_f32 v18, v18
    v_exp_f32 v19, v19
    v_mfma_f32_32x32x16_bf16 v[64:79], a[248:251], v[84:87], v[64:79]
    ds_read_b128 a[248:251], v89 offset:53456
    s_waitcnt vmcnt(18)
    ds_read_b64_tr_b16 v[164:165], v109 offset:33920
    ds_read_b64_tr_b16 v[166:167], v109 offset:34432
    v_exp_f32 v20, v20
    v_exp_f32 v21, v21
    v_exp_f32 v22, v22
    v_exp_f32 v23, v23
    v_cvt_pk_bf16_f32 v80, v16, v17
    v_cvt_pk_bf16_f32 v81, v18, v19
    v_cvt_pk_bf16_f32 v82, v20, v21
    v_cvt_pk_bf16_f32 v83, v22, v23
    v_exp_f32 v24, v24
    v_exp_f32 v25, v25
    v_mfma_f32_32x32x16_bf16 v[48:63], a[244:247], v[80:83], v[48:63]
    s_add_u32 s85, s41, 0x1600000
    buffer_store_dwordx4 a[224:227], v1, s[4:7], s85 offen sc1
    v_exp_f32 v26, v26
    v_exp_f32 v27, v27
    v_exp_f32 v28, v28
    v_exp_f32 v29, v29
    v_mfma_f32_16x16x32_bf16 a[216:219], a[220:223], v[152:155], a[216:219]
    v_exp_f32 v30, v30
    v_exp_f32 v31, v31
    v_cvt_pk_bf16_f32 v84, v24, v25
    v_cvt_pk_bf16_f32 v85, v26, v27
    v_cvt_pk_bf16_f32 v86, v28, v29
    v_cvt_pk_bf16_f32 v87, v30, v31
    v_mfma_f32_32x32x16_bf16 v[16:31], a[232:235], v[96:99], 0
    s_add_u32 s87, s31, 0x133800
    buffer_load_dwordx4 v110, s[72:75], s87 offen offset:2048 lds
    v_exp_f32 v32, v32
    v_exp_f32 v33, v33
    v_exp_f32 v34, v34
    v_exp_f32 v35, v35
    v_mfma_f32_32x32x16_bf16 v[48:63], a[252:255], v[84:87], v[48:63]
    s_waitcnt vmcnt(19)
    ds_read_b64_tr_b16 v[168:169], v109 offset:34944
    ds_read_b64_tr_b16 v[170:171], v109 offset:35456
    v_exp_f32 v36, v36
    v_exp_f32 v37, v37
    v_exp_f32 v38, v38
    v_exp_f32 v39, v39
    v_cvt_pk_bf16_f32 v80, v32, v33
    v_cvt_pk_bf16_f32 v81, v34, v35
    v_cvt_pk_bf16_f32 v82, v36, v37
    v_cvt_pk_bf16_f32 v83, v38, v39
    v_exp_f32 v40, v40
    v_exp_f32 v41, v41
    v_mfma_f32_32x32x16_bf16 v[64:79], a[244:247], v[80:83], v[64:79]
    ds_read_b128 a[244:247], v90 offset:53456
    v_exp_f32 v42, v42
    v_exp_f32 v43, v43
    v_exp_f32 v44, v44
    v_exp_f32 v45, v45
    s_waitcnt lgkmcnt(9)
    v_mfma_f32_16x16x32_bf16 a[216:219], a[220:223], v[156:159], a[216:219]
    v_exp_f32 v46, v46
    v_exp_f32 v47, v47
    v_cvt_pk_bf16_f32 v84, v40, v41
    v_cvt_pk_bf16_f32 v85, v42, v43
    v_cvt_pk_bf16_f32 v86, v44, v45
    v_cvt_pk_bf16_f32 v87, v46, v47
    s_waitcnt lgkmcnt(5)
    v_mfma_f32_32x32x16_bf16 v[32:47], a[232:235], a[228:231], 0
    ds_read_b128 a[232:235], v1 offset:57568
    s_add_u32 s91, s31, 0x141400
    buffer_load_dwordx4 v110, s[72:75], s91 offen offset:3072 lds
    v_exp_f32 v16, v16
    v_exp_f32 v17, v17
    v_exp_f32 v18, v18
    v_exp_f32 v19, v19
    v_mfma_f32_32x32x16_bf16 v[64:79], a[252:255], v[84:87], v[64:79]
    ds_read_b128 a[252:255], v91 offset:53456
    s_waitcnt vmcnt(19)
    ds_read_b64_tr_b16 v[172:173], v109 offset:35968
    ds_read_b64_tr_b16 v[174:175], v109 offset:36480
    s_waitcnt vmcnt(18)
    ds_read_b64_tr_b16 v[176:177], v109 offset:49344
    ds_read_b64_tr_b16 v[178:179], v109 offset:49856
    v_exp_f32 v20, v20
    v_exp_f32 v21, v21
    v_exp_f32 v22, v22
    v_exp_f32 v23, v23
    v_cvt_pk_bf16_f32 v80, v16, v17
    v_cvt_pk_bf16_f32 v81, v18, v19
    v_cvt_pk_bf16_f32 v82, v20, v21
    v_cvt_pk_bf16_f32 v83, v22, v23
    v_exp_f32 v24, v24
    v_exp_f32 v25, v25
    v_mfma_f32_32x32x16_bf16 v[48:63], a[240:243], v[80:83], v[48:63]
    s_add_u32 m0, s22, 0x1c1c0
    s_add_u32 s88, s31, 0x150000
    buffer_load_dwordx4 v110, s[72:75], s88 offen lds
    v_exp_f32 v26, v26
    v_exp_f32 v27, v27
    v_exp_f32 v28, v28
    v_exp_f32 v29, v29
    v_mfma_f32_16x16x32_bf16 a[216:219], a[220:223], v[160:163], a[216:219]
    v_exp_f32 v30, v30
    v_exp_f32 v31, v31
    v_cvt_pk_bf16_f32 v84, v24, v25
    v_cvt_pk_bf16_f32 v85, v26, v27
    v_cvt_pk_bf16_f32 v86, v28, v29
    v_cvt_pk_bf16_f32 v87, v30, v31
    v_mfma_f32_32x32x16_bf16 v[16:31], a[236:239], v[96:99], 0
    s_waitcnt lgkmcnt(9)
    s_add_u32 s90, s31, 0x15dc00
    buffer_load_dwordx4 v110, s[72:75], s90 offen offset:1024 lds
    v_exp_f32 v32, v32
    v_exp_f32 v33, v33
    v_exp_f32 v34, v34
    v_exp_f32 v35, v35
    v_mfma_f32_32x32x16_bf16 v[48:63], a[248:251], v[84:87], v[48:63]
    v_exp_f32 v36, v36
    v_exp_f32 v37, v37
    v_exp_f32 v38, v38
    v_exp_f32 v39, v39
    v_cvt_pk_bf16_f32 v80, v32, v33
    v_cvt_pk_bf16_f32 v81, v34, v35
    v_cvt_pk_bf16_f32 v82, v36, v37
    v_cvt_pk_bf16_f32 v83, v38, v39
    v_exp_f32 v40, v40
    v_exp_f32 v41, v41
    v_mfma_f32_32x32x16_bf16 v[64:79], a[240:243], v[80:83], v[64:79]
    ds_read_b128 a[240:243], v88 offset:57568
    v_exp_f32 v42, v42
    v_exp_f32 v43, v43
    v_exp_f32 v44, v44
    v_exp_f32 v45, v45
    v_mfma_f32_16x16x32_bf16 a[216:219], a[220:223], v[164:167], a[216:219]
    v_exp_f32 v46, v46
    v_exp_f32 v47, v47
    v_cvt_pk_bf16_f32 v84, v40, v41
    v_cvt_pk_bf16_f32 v85, v42, v43
    v_cvt_pk_bf16_f32 v86, v44, v45
    v_cvt_pk_bf16_f32 v87, v46, v47
    s_waitcnt lgkmcnt(5)
    v_mfma_f32_32x32x16_bf16 v[32:47], a[236:239], a[228:231], 0
    ds_read_b128 a[236:239], v1 offset:59616
    v_exp_f32 v16, v16
    v_exp_f32 v17, v17
    v_exp_f32 v18, v18
    v_exp_f32 v19, v19
    v_mfma_f32_32x32x16_bf16 v[64:79], a[248:251], v[84:87], v[64:79]
    ds_read_b128 a[248:251], v89 offset:57568
    v_exp_f32 v20, v20
    v_exp_f32 v21, v21
    v_exp_f32 v22, v22
    v_exp_f32 v23, v23
    v_cvt_pk_bf16_f32 v80, v16, v17
    v_cvt_pk_bf16_f32 v81, v18, v19
    v_cvt_pk_bf16_f32 v82, v20, v21
    v_cvt_pk_bf16_f32 v83, v22, v23
    v_exp_f32 v24, v24
    v_exp_f32 v25, v25
    v_mfma_f32_32x32x16_bf16 v[48:63], a[244:247], v[80:83], v[48:63]
    s_add_u32 s86, s31, 0x16b800
    buffer_load_dwordx4 v110, s[72:75], s86 offen offset:2048 lds
    v_exp_f32 v26, v26
    v_exp_f32 v27, v27
    v_exp_f32 v28, v28
    v_exp_f32 v29, v29
    v_mfma_f32_16x16x32_bf16 a[216:219], a[220:223], v[168:171], a[216:219]
    v_exp_f32 v30, v30
    v_exp_f32 v31, v31
    v_cvt_pk_bf16_f32 v84, v24, v25
    v_cvt_pk_bf16_f32 v85, v26, v27
    v_cvt_pk_bf16_f32 v86, v28, v29
    v_cvt_pk_bf16_f32 v87, v30, v31
    v_mfma_f32_32x32x16_bf16 v[16:31], a[232:235], v[96:99], 0
    s_waitcnt lgkmcnt(5)
    s_add_u32 s89, s31, 0x179400
    buffer_load_dwordx4 v110, s[72:75], s89 offen offset:3072 lds
    v_exp_f32 v32, v32
    v_exp_f32 v33, v33
    v_exp_f32 v34, v34
    v_exp_f32 v35, v35
    v_mfma_f32_32x32x16_bf16 v[48:63], a[252:255], v[84:87], v[48:63]
    s_waitcnt vmcnt(17)
    ds_read_b64_tr_b16 v[180:181], v109 offset:50368
    ds_read_b64_tr_b16 v[182:183], v109 offset:50880
    s_waitcnt vmcnt(16)
    ds_read_b64_tr_b16 v[184:185], v109 offset:51392
    ds_read_b64_tr_b16 v[186:187], v109 offset:51904
    v_exp_f32 v36, v36
    v_exp_f32 v37, v37
    v_exp_f32 v38, v38
    v_exp_f32 v39, v39
    v_cvt_pk_bf16_f32 v80, v32, v33
    v_cvt_pk_bf16_f32 v81, v34, v35
    v_cvt_pk_bf16_f32 v82, v36, v37
    v_cvt_pk_bf16_f32 v83, v38, v39
    v_exp_f32 v40, v40
    v_exp_f32 v41, v41
    v_mfma_f32_32x32x16_bf16 v[64:79], a[244:247], v[80:83], v[64:79]
    ds_read_b128 a[244:247], v90 offset:57568
    s_add_u32 s82, s41, 0x1700000
    buffer_store_dwordx4 a[224:227], v1, s[4:7], s82 offen sc1
    v_exp_f32 v42, v42
    v_exp_f32 v43, v43
    v_exp_f32 v44, v44
    v_exp_f32 v45, v45
    v_mfma_f32_16x16x32_bf16 a[216:219], a[220:223], v[172:175], a[216:219]
    v_exp_f32 v46, v46
    v_exp_f32 v47, v47
    v_cvt_pk_bf16_f32 v84, v40, v41
    v_cvt_pk_bf16_f32 v85, v42, v43
    v_cvt_pk_bf16_f32 v86, v44, v45
    v_cvt_pk_bf16_f32 v87, v46, v47
    s_waitcnt lgkmcnt(5)
    v_mfma_f32_32x32x16_bf16 v[32:47], a[232:235], a[228:231], 0
    ds_read_b128 a[232:235], v1 offset:61680
    v_exp_f32 v16, v16
    v_exp_f32 v17, v17
    v_exp_f32 v18, v18
    v_exp_f32 v19, v19
    v_mfma_f32_32x32x16_bf16 v[64:79], a[252:255], v[84:87], v[64:79]
    ds_read_b128 a[252:255], v91 offset:57568
    s_lshr_b32 s64, s41, 1
    v_min_u32 v7, 48, v1
    v_lshl_add_u32 v7, v7, 3, s64
    global_load_dword a214, v7, s[68:69]
    s_waitcnt vmcnt(17)
    ds_read_b64_tr_b16 v[188:189], v109 offset:52416
    ds_read_b64_tr_b16 v[190:191], v109 offset:52928
    s_waitcnt vmcnt(16)
    ds_read_b64_tr_b16 v[192:193], v109 offset:0
    ds_read_b64_tr_b16 v[194:195], v109 offset:512
    v_exp_f32 v20, v20
    v_exp_f32 v21, v21
    v_exp_f32 v22, v22
    v_exp_f32 v23, v23
    v_cvt_pk_bf16_f32 v80, v16, v17
    v_cvt_pk_bf16_f32 v81, v18, v19
    v_cvt_pk_bf16_f32 v82, v20, v21
    v_cvt_pk_bf16_f32 v83, v22, v23
    v_exp_f32 v24, v24
    v_exp_f32 v25, v25
    v_mfma_f32_32x32x16_bf16 v[48:63], a[240:243], v[80:83], v[48:63]
    s_add_u32 m0, s22, 0x20200
    s_add_u32 s83, s31, 0x188000
    buffer_load_dwordx4 v110, s[72:75], s83 offen lds
    v_exp_f32 v26, v26
    v_exp_f32 v27, v27
    v_exp_f32 v28, v28
    v_exp_f32 v29, v29
    v_mfma_f32_16x16x32_bf16 a[216:219], a[220:223], v[176:179], a[216:219]
    v_exp_f32 v30, v30
    v_exp_f32 v31, v31
    v_cvt_pk_bf16_f32 v84, v24, v25
    v_cvt_pk_bf16_f32 v85, v26, v27
    v_cvt_pk_bf16_f32 v86, v28, v29
    v_cvt_pk_bf16_f32 v87, v30, v31
    v_mfma_f32_32x32x16_bf16 v[16:31], a[236:239], v[96:99], 0
    s_waitcnt lgkmcnt(9)
    s_add_u32 s84, s31, 0x195c00
    buffer_load_dwordx4 v110, s[72:75], s84 offen offset:1024 lds
    v_exp_f32 v32, v32
    v_exp_f32 v33, v33
    v_exp_f32 v34, v34
    v_exp_f32 v35, v35
    v_mfma_f32_32x32x16_bf16 v[48:63], a[248:251], v[84:87], v[48:63]
    v_add_u32 v108, 0x10100, v6
    ds_read2st64_b32 v[104:105], v108 offset0:0 offset1:4
    ds_read2st64_b32 v[106:107], v108 offset0:8 offset1:12
    s_waitcnt vmcnt(17)
    ds_read_b64_tr_b16 v[196:197], v109 offset:1024
    ds_read_b64_tr_b16 v[198:199], v109 offset:1536
    s_waitcnt vmcnt(16)
    ds_read_b64_tr_b16 v[200:201], v109 offset:2048
    ds_read_b64_tr_b16 v[202:203], v109 offset:2560
    v_exp_f32 v36, v36
    v_exp_f32 v37, v37
    v_exp_f32 v38, v38
    v_exp_f32 v39, v39
    v_cvt_pk_bf16_f32 v80, v32, v33
    v_cvt_pk_bf16_f32 v81, v34, v35
    v_cvt_pk_bf16_f32 v82, v36, v37
    v_cvt_pk_bf16_f32 v83, v38, v39
    v_exp_f32 v40, v40
    v_exp_f32 v41, v41
    v_mfma_f32_32x32x16_bf16 v[64:79], a[240:243], v[80:83], v[64:79]
    ds_read_b128 a[240:243], v88 offset:61680
    s_waitcnt lgkmcnt(14)
    s_add_u32 s80, s31, 0x1a3800
    buffer_load_dwordx4 v110, s[72:75], s80 offen offset:2048 lds
    v_exp_f32 v42, v42
    v_exp_f32 v43, v43
    v_exp_f32 v44, v44
    v_exp_f32 v45, v45
    v_mfma_f32_16x16x32_bf16 a[216:219], a[220:223], v[180:183], a[216:219]
    v_exp_f32 v46, v46
    v_exp_f32 v47, v47
    v_cvt_pk_bf16_f32 v84, v40, v41
    v_cvt_pk_bf16_f32 v85, v42, v43
    v_cvt_pk_bf16_f32 v86, v44, v45
    v_cvt_pk_bf16_f32 v87, v46, v47
    s_waitcnt lgkmcnt(11)
    v_mfma_f32_32x32x16_bf16 v[32:47], a[236:239], a[228:231], 0
    ds_read_b128 a[236:239], v1 offset:63728
    v_exp_f32 v16, v16
    v_exp_f32 v17, v17
    v_exp_f32 v18, v18
    v_exp_f32 v19, v19
    v_mfma_f32_32x32x16_bf16 v[64:79], a[248:251], v[84:87], v[64:79]
    ds_read_b128 a[248:251], v89 offset:61680
    s_waitcnt lgkmcnt(7)
    v_max3_u32 v7, v104, v105, v106
    v_max_u32 v7, v7, v107
    v_cmp_eq_u32 vcc, -1, v7
    s_cbranch_vccnz Lre9
Lok9:
    s_waitcnt vmcnt(16)
    ds_read_b64_tr_b16 v[204:205], v109 offset:3072
    ds_read_b64_tr_b16 v[206:207], v109 offset:3584
    v_exp_f32 v20, v20
    v_exp_f32 v21, v21
    v_exp_f32 v22, v22
    v_exp_f32 v23, v23
    v_cvt_pk_bf16_f32 v80, v16, v17
    v_cvt_pk_bf16_f32 v81, v18, v19
    v_cvt_pk_bf16_f32 v82, v20, v21
    v_cvt_pk_bf16_f32 v83, v22, v23
    v_exp_f32 v24, v24
    v_exp_f32 v25, v25
    v_mfma_f32_32x32x16_bf16 v[48:63], a[244:247], v[80:83], v[48:63]
    s_add_u32 s81, s31, 0x1b1400
    buffer_load_dwordx4 v110, s[72:75], s81 offen offset:3072 lds
    v_exp_f32 v26, v26
    v_exp_f32 v27, v27
    v_exp_f32 v28, v28
    v_exp_f32 v29, v29
    v_mfma_f32_16x16x32_bf16 a[216:219], a[220:223], v[184:187], a[216:219]
    v_exp_f32 v30, v30
    v_exp_f32 v31, v31
    v_cvt_pk_bf16_f32 v84, v24, v25
    v_cvt_pk_bf16_f32 v85, v26, v27
    v_cvt_pk_bf16_f32 v86, v28, v29
    v_cvt_pk_bf16_f32 v87, v30, v31
    v_mfma_f32_32x32x16_bf16 v[16:31], a[232:235], v[96:99], 0
    s_add_u32 m0, s22, 0x14140
    s_add_u32 s85, s29, 0x814000
    buffer_load_dwordx4 v1, s[4:7], s85 offen sc1 lds
    v_exp_f32 v32, v32
    v_exp_f32 v33, v33
    v_exp_f32 v34, v34
    v_exp_f32 v35, v35
    v_mfma_f32_32x32x16_bf16 v[48:63], a[252:255], v[84:87], v[48:63]
    s_barrier
    s_waitcnt vmcnt(16)
    ds_read_b64_tr_b16 v[208:209], v109 offset:16448
    ds_read_b64_tr_b16 v[210:211], v109 offset:16960
    v_exp_f32 v36, v36
    v_exp_f32 v37, v37
    v_exp_f32 v38, v38
    v_exp_f32 v39, v39
    v_cvt_pk_bf16_f32 v80, v32, v33
    v_cvt_pk_bf16_f32 v81, v34, v35
    v_cvt_pk_bf16_f32 v82, v36, v37
    v_cvt_pk_bf16_f32 v83, v38, v39
    v_exp_f32 v40, v40
    v_exp_f32 v41, v41
    v_mfma_f32_32x32x16_bf16 v[64:79], a[244:247], v[80:83], v[64:79]
    ds_read_b128 a[244:247], v90 offset:61680
    s_waitcnt lgkmcnt(10)
    buffer_load_dwordx4 v1, s[4:7], s85 offen offset:1024 sc1 lds
    v_exp_f32 v42, v42
    v_exp_f32 v43, v43
    v_exp_f32 v44, v44
    v_exp_f32 v45, v45
    v_mfma_f32_16x16x32_bf16 a[216:219], a[220:223], v[188:191], a[216:219]
    v_exp_f32 v46, v46
    v_exp_f32 v47, v47
    v_cvt_pk_bf16_f32 v84, v40, v41
    v_cvt_pk_bf16_f32 v85, v42, v43
    v_cvt_pk_bf16_f32 v86, v44, v45
    v_cvt_pk_bf16_f32 v87, v46, v47
    s_waitcnt lgkmcnt(5)
    v_mfma_f32_32x32x16_bf16 v[32:47], a[232:235], a[228:231], 0
    ds_read_b128 a[232:235], v2 offset:256
    buffer_load_dwordx4 v1, s[4:7], s85 offen offset:2048 sc1 lds
    v_exp_f32 v16, v16
    v_exp_f32 v17, v17
    v_exp_f32 v18, v18
    v_exp_f32 v19, v19
    v_mfma_f32_32x32x16_bf16 v[64:79], a[252:255], v[84:87], v[64:79]
    ds_read_b128 a[252:255], v91 offset:61680
    s_waitcnt vmcnt(16)
    ds_read_b64_tr_b16 v[212:213], v109 offset:17472
    ds_read_b64_tr_b16 v[214:215], v109 offset:17984
    v_exp_f32 v20, v20
    v_exp_f32 v21, v21
    v_exp_f32 v22, v22
    v_exp_f32 v23, v23
    v_cvt_pk_bf16_f32 v80, v16, v17
    v_cvt_pk_bf16_f32 v81, v18, v19
    v_cvt_pk_bf16_f32 v82, v20, v21
    v_cvt_pk_bf16_f32 v83, v22, v23
    v_exp_f32 v24, v24
    v_exp_f32 v25, v25
    v_mfma_f32_32x32x16_bf16 v[48:63], a[240:243], v[80:83], v[48:63]
    s_waitcnt lgkmcnt(7)
    buffer_load_dwordx4 v1, s[4:7], s85 offen offset:3072 sc1 lds
    v_exp_f32 v26, v26
    v_exp_f32 v27, v27
    v_exp_f32 v28, v28
    v_exp_f32 v29, v29
    v_mfma_f32_16x16x32_bf16 a[216:219], a[220:223], v[192:195], a[216:219]
    v_exp_f32 v30, v30
    v_exp_f32 v31, v31
    v_cvt_pk_bf16_f32 v84, v24, v25
    v_cvt_pk_bf16_f32 v85, v26, v27
    v_cvt_pk_bf16_f32 v86, v28, v29
    v_cvt_pk_bf16_f32 v87, v30, v31
    v_mfma_f32_32x32x16_bf16 v[16:31], a[236:239], v[96:99], 0
    s_waitcnt lgkmcnt(5)
    s_add_u32 m0, s22, 0x18180
    s_mov_b32 s87, s32
    buffer_load_dwordx4 v111, s[76:79], s87 offen lds
    v_exp_f32 v32, v32
    v_exp_f32 v33, v33
    v_exp_f32 v34, v34
    v_exp_f32 v35, v35
    v_mfma_f32_32x32x16_bf16 v[48:63], a[248:251], v[84:87], v[48:63]
    s_waitcnt vmcnt(16)
    ds_read_b64_tr_b16 v[216:217], v109 offset:18496
    ds_read_b64_tr_b16 v[218:219], v109 offset:19008
    v_exp_f32 v36, v36
    v_exp_f32 v37, v37
    v_exp_f32 v38, v38
    v_exp_f32 v39, v39
    v_cvt_pk_bf16_f32 v80, v32, v33
    v_cvt_pk_bf16_f32 v81, v34, v35
    v_cvt_pk_bf16_f32 v82, v36, v37
    v_cvt_pk_bf16_f32 v83, v38, v39
    v_exp_f32 v40, v40
    v_exp_f32 v41, v41
    v_mfma_f32_32x32x16_bf16 v[64:79], a[240:243], v[80:83], v[64:79]
    ds_read_b128 a[240:243], v92 offset:0
    s_waitcnt lgkmcnt(3)
    s_add_u32 s91, s32, 0x1c00
    buffer_load_dwordx4 v111, s[76:79], s91 offen offset:1024 lds
    v_exp_f32 v42, v42
    v_exp_f32 v43, v43
    v_exp_f32 v44, v44
    v_exp_f32 v45, v45
    v_mfma_f32_16x16x32_bf16 a[216:219], a[220:223], v[196:199], a[216:219]
    v_exp_f32 v46, v46
    v_exp_f32 v47, v47
    v_cvt_pk_bf16_f32 v84, v40, v41
    v_cvt_pk_bf16_f32 v85, v42, v43
    v_cvt_pk_bf16_f32 v86, v44, v45
    v_cvt_pk_bf16_f32 v87, v46, v47
    v_mfma_f32_32x32x16_bf16 v[32:47], a[236:239], a[228:231], 0
    ds_read_b128 a[236:239], v2 offset:2304
    s_waitcnt lgkmcnt(2)
    s_add_u32 s88, s32, 0x3800
    buffer_load_dwordx4 v111, s[76:79], s88 offen offset:2048 lds
    v_exp_f32 v16, v16
    v_exp_f32 v17, v17
    v_exp_f32 v18, v18
    v_exp_f32 v19, v19
    v_mfma_f32_32x32x16_bf16 v[64:79], a[248:251], v[84:87], v[64:79]
    ds_read_b128 a[248:251], v93 offset:0
    s_waitcnt vmcnt(17)
    ds_read_b64_tr_b16 v[220:221], v109 offset:19520
    ds_read_b64_tr_b16 v[222:223], v109 offset:20032
    s_waitcnt vmcnt(16)
    ds_read_b64_tr_b16 v[224:225], v109 offset:32896
    ds_read_b64_tr_b16 v[226:227], v109 offset:33408
    v_exp_f32 v20, v20
    v_exp_f32 v21, v21
    v_exp_f32 v22, v22
    v_exp_f32 v23, v23
    v_cvt_pk_bf16_f32 v80, v16, v17
    v_cvt_pk_bf16_f32 v81, v18, v19
    v_cvt_pk_bf16_f32 v82, v20, v21
    v_cvt_pk_bf16_f32 v83, v22, v23
    v_exp_f32 v24, v24
    v_exp_f32 v25, v25
    v_mfma_f32_32x32x16_bf16 v[48:63], a[244:247], v[80:83], v[48:63]
    s_add_u32 m0, s22, 0x8080
    s_add_u32 s90, s32, 0x6000
    buffer_load_dwordx4 v111, s[76:79], s90 offen lds
    v_exp_f32 v26, v26
    v_exp_f32 v27, v27
    v_exp_f32 v28, v28
    v_exp_f32 v29, v29
    v_mfma_f32_16x16x32_bf16 a[216:219], a[220:223], v[200:203], a[216:219]
    v_exp_f32 v30, v30
    v_exp_f32 v31, v31
    v_cvt_pk_bf16_f32 v84, v24, v25
    v_cvt_pk_bf16_f32 v85, v26, v27
    v_cvt_pk_bf16_f32 v86, v28, v29
    v_cvt_pk_bf16_f32 v87, v30, v31
    v_mfma_f32_32x32x16_bf16 v[16:31], a[232:235], v[96:99], 0
    s_add_u32 s86, s32, 0x7c00
    buffer_load_dwordx4 v111, s[76:79], s86 offen offset:1024 lds
    v_exp_f32 v32, v32
    v_exp_f32 v33, v33
    v_exp_f32 v34, v34
    v_exp_f32 v35, v35
    v_mfma_f32_32x32x16_bf16 v[48:63], a[252:255], v[84:87], v[48:63]
    s_waitcnt vmcnt(17)
    ds_read_b64_tr_b16 v[228:229], v109 offset:33920
    ds_read_b64_tr_b16 v[230:231], v109 offset:34432
    v_exp_f32 v36, v36
    v_exp_f32 v37, v37
    v_exp_f32 v38, v38
    v_exp_f32 v39, v39
    v_cvt_pk_bf16_f32 v80, v32, v33
    v_cvt_pk_bf16_f32 v81, v34, v35
    v_cvt_pk_bf16_f32 v82, v36, v37
    v_cvt_pk_bf16_f32 v83, v38, v39
    v_exp_f32 v40, v40
    v_exp_f32 v41, v41
    v_mfma_f32_32x32x16_bf16 v[64:79], a[244:247], v[80:83], v[64:79]
    ds_read_b128 a[244:247], v94 offset:0
    s_add_u32 s89, s32, 0x9800
    buffer_load_dwordx4 v111, s[76:79], s89 offen offset:2048 lds
    v_exp_f32 v42, v42
    v_exp_f32 v43, v43
    v_exp_f32 v44, v44
    v_exp_f32 v45, v45
    v_mfma_f32_16x16x32_bf16 a[216:219], a[220:223], v[204:207], a[216:219]
    v_exp_f32 v46, v46
    v_exp_f32 v47, v47
    v_cvt_pk_bf16_f32 v84, v40, v41
    v_cvt_pk_bf16_f32 v85, v42, v43
    v_cvt_pk_bf16_f32 v86, v44, v45
    v_cvt_pk_bf16_f32 v87, v46, v47
    s_waitcnt lgkmcnt(7)
    v_mfma_f32_32x32x16_bf16 v[32:47], a[232:235], a[228:231], 0
    ds_read_b128 a[232:235], v2 offset:4368
    s_add_u32 s82, s32, 0xb400
    buffer_load_dwordx4 v111, s[76:79], s82 offen offset:3072 lds
    v_exp_f32 v16, v16
    v_exp_f32 v17, v17
    v_exp_f32 v18, v18
    v_exp_f32 v19, v19
    v_mfma_f32_32x32x16_bf16 v[64:79], a[252:255], v[84:87], v[64:79]
    ds_read_b128 a[252:255], v95 offset:0
    s_waitcnt vmcnt(18)
    ds_read_b64_tr_b16 v[232:233], v109 offset:34944
    ds_read_b64_tr_b16 v[234:235], v109 offset:35456
    v_exp_f32 v20, v20
    v_exp_f32 v21, v21
    v_exp_f32 v22, v22
    v_exp_f32 v23, v23
    v_cvt_pk_bf16_f32 v80, v16, v17
    v_cvt_pk_bf16_f32 v81, v18, v19
    v_cvt_pk_bf16_f32 v82, v20, v21
    v_cvt_pk_bf16_f32 v83, v22, v23
    v_exp_f32 v24, v24
    v_exp_f32 v25, v25
    v_mfma_f32_32x32x16_bf16 v[48:63], a[240:243], v[80:83], v[48:63]
    s_add_u32 s83, s41, 0x1800000
    buffer_store_dwordx4 a[224:227], v1, s[4:7], s83 offen sc1
    v_exp_f32 v26, v26
    v_exp_f32 v27, v27
    v_exp_f32 v28, v28
    v_exp_f32 v29, v29
    v_mfma_f32_16x16x32_bf16 a[216:219], a[220:223], v[208:211], a[216:219]
    v_exp_f32 v30, v30
    v_exp_f32 v31, v31
    v_cvt_pk_bf16_f32 v84, v24, v25
    v_cvt_pk_bf16_f32 v85, v26, v27
    v_cvt_pk_bf16_f32 v86, v28, v29
    v_cvt_pk_bf16_f32 v87, v30, v31
    v_mfma_f32_32x32x16_bf16 v[16:31], a[236:239], v[96:99], 0
    s_waitcnt lgkmcnt(7)
    s_add_u32 m0, s22, 0x1c1c0
    s_add_u32 s84, s32, 0xe000
    buffer_load_dwordx4 v111, s[76:79], s84 offen lds
    v_exp_f32 v32, v32
    v_exp_f32 v33, v33
    v_exp_f32 v34, v34
    v_exp_f32 v35, v35
    v_mfma_f32_32x32x16_bf16 v[48:63], a[248:251], v[84:87], v[48:63]
    s_waitcnt vmcnt(19)
    ds_read_b64_tr_b16 v[236:237], v109 offset:35968
    ds_read_b64_tr_b16 v[238:239], v109 offset:36480
    v_exp_f32 v36, v36
    v_exp_f32 v37, v37
    v_exp_f32 v38, v38
    v_exp_f32 v39, v39
    v_cvt_pk_bf16_f32 v80, v32, v33
    v_cvt_pk_bf16_f32 v81, v34, v35
    v_cvt_pk_bf16_f32 v82, v36, v37
    v_cvt_pk_bf16_f32 v83, v38, v39
    v_exp_f32 v40, v40
    v_exp_f32 v41, v41
    v_mfma_f32_32x32x16_bf16 v[64:79], a[240:243], v[80:83], v[64:79]
    ds_read_b128 a[240:243], v92 offset:4112
    s_add_u32 s80, s41, 0x1900000
    buffer_store_dwordx4 a[224:227], v1, s[4:7], s80 offen sc1
    v_exp_f32 v42, v42
    v_exp_f32 v43, v43
    v_exp_f32 v44, v44
    v_exp_f32 v45, v45
    v_mfma_f32_16x16x32_bf16 a[216:219], a[220:223], v[212:215], a[216:219]
    v_exp_f32 v46, v46
    v_exp_f32 v47, v47
    v_cvt_pk_bf16_f32 v84, v40, v41
    v_cvt_pk_bf16_f32 v85, v42, v43
    v_cvt_pk_bf16_f32 v86, v44, v45
    v_cvt_pk_bf16_f32 v87, v46, v47
    s_waitcnt lgkmcnt(5)
    v_mfma_f32_32x32x16_bf16 v[32:47], a[236:239], a[228:231], 0
    ds_read_b128 a[236:239], v2 offset:6416
    s_add_u32 s81, s32, 0xfc00
    buffer_load_dwordx4 v111, s[76:79], s81 offen offset:1024 lds
    v_exp_f32 v16, v16
    v_exp_f32 v17, v17
    v_exp_f32 v18, v18
    v_exp_f32 v19, v19
    v_mfma_f32_32x32x16_bf16 v[64:79], a[248:251], v[84:87], v[64:79]
    ds_read_b128 a[248:251], v93 offset:4112
    s_waitcnt vmcnt(18)
    ds_read_b64_tr_b16 v[240:241], v109 offset:49344
    ds_read_b64_tr_b16 v[242:243], v109 offset:49856
    v_exp_f32 v20, v20
    v_exp_f32 v21, v21
    v_exp_f32 v22, v22
    v_exp_f32 v23, v23
    v_cvt_pk_bf16_f32 v80, v16, v17
    v_cvt_pk_bf16_f32 v81, v18, v19
    v_cvt_pk_bf16_f32 v82, v20, v21
    v_cvt_pk_bf16_f32 v83, v22, v23
    v_exp_f32 v24, v24
    v_exp_f32 v25, v25
    v_mfma_f32_32x32x16_bf16 v[48:63], a[244:247], v[80:83], v[48:63]
    s_mov_b32 s85, 0x740040
    buffer_load_dword v11, v9, s[4:7], s85 offen sc1
    v_exp_f32 v26, v26
    v_exp_f32 v27, v27
    v_exp_f32 v28, v28
    v_exp_f32 v29, v29
    v_mfma_f32_16x16x32_bf16 a[216:219], a[220:223], v[216:219], a[216:219]
    v_exp_f32 v30, v30
    v_exp_f32 v31, v31
    v_cvt_pk_bf16_f32 v84, v24, v25
    v_cvt_pk_bf16_f32 v85, v26, v27
    v_cvt_pk_bf16_f32 v86, v28, v29
    v_cvt_pk_bf16_f32 v87, v30, v31
    v_mfma_f32_32x32x16_bf16 v[16:31], a[232:235], v[96:99], 0
    s_waitcnt lgkmcnt(7)
    s_add_u32 s87, s32, 0x11800
    buffer_load_dwordx4 v111, s[76:79], s87 offen offset:2048 lds
    v_exp_f32 v32, v32
    v_exp_f32 v33, v33
    v_exp_f32 v34, v34
    v_exp_f32 v35, v35
    v_mfma_f32_32x32x16_bf16 v[48:63], a[252:255], v[84:87], v[48:63]
    s_waitcnt vmcnt(19)
    ds_read_b64_tr_b16 v[244:245], v109 offset:50368
    ds_read_b64_tr_b16 v[246:247], v109 offset:50880
    s_waitcnt vmcnt(18)
    ds_read_b64_tr_b16 v[248:249], v109 offset:51392
    ds_read_b64_tr_b16 v[250:251], v109 offset:51904
    v_exp_f32 v36, v36
    v_exp_f32 v37, v37
    v_exp_f32 v38, v38
    v_exp_f32 v39, v39
    v_cvt_pk_bf16_f32 v80, v32, v33
    v_cvt_pk_bf16_f32 v81, v34, v35
    v_cvt_pk_bf16_f32 v82, v36, v37
    v_cvt_pk_bf16_f32 v83, v38, v39
    v_exp_f32 v40, v40
    v_exp_f32 v41, v41
    v_mfma_f32_32x32x16_bf16 v[64:79], a[244:247], v[80:83], v[64:79]
    ds_read_b128 a[244:247], v94 offset:4112
PAD5:
    s_cbranch_execz PAD9
    s_waitcnt lgkmcnt(10)
    s_add_u32 s91, s32, 0x13400
    buffer_load_dwordx4 v111, s[76:79], s91 offen offset:3072 lds
    v_exp_f32 v42, v42
    v_exp_f32 v43, v43
    v_exp_f32 v44, v44
    v_exp_f32 v45, v45
    v_mfma_f32_16x16x32_bf16 a[216:219], a[220:223], v[220:223], a[216:219]
    v_exp_f32 v46, v46
    v_exp_f32 v47, v47
    v_cvt_pk_bf16_f32 v84, v40, v41
    v_cvt_pk_bf16_f32 v85, v42, v43
    v_cvt_pk_bf16_f32 v86, v44, v45
    v_cvt_pk_bf16_f32 v87, v46, v47
    s_waitcnt lgkmcnt(7)
    v_mfma_f32_32x32x16_bf16 v[32:47], a[232:235], a[228:231], 0
    ds_read_b128 a[232:235], v2 offset:8480
    s_waitcnt lgkmcnt(6)
    s_add_u32 m0, s22, 0x20200
    s_add_u32 s88, s32, 0x16000
    buffer_load_dwordx4 v111, s[76:79], s88 offen lds
    v_exp_f32 v16, v16
    v_exp_f32 v17, v17
    v_exp_f32 v18, v18
    v_exp_f32 v19, v19
    v_mfma_f32_32x32x16_bf16 v[64:79], a[252:255], v[84:87], v[64:79]
    ds_read_b128 a[252:255], v95 offset:4112
    s_waitcnt vmcnt(19)
    ds_read_b64_tr_b16 v[252:253], v109 offset:52416
    ds_read_b64_tr_b16 v[254:255], v109 offset:52928
    v_exp_f32 v20, v20
    v_exp_f32 v21, v21
    v_exp_f32 v22, v22
    v_exp_f32 v23, v23
    v_cvt_pk_bf16_f32 v80, v16, v17
    v_cvt_pk_bf16_f32 v81, v18, v19
    v_cvt_pk_bf16_f32 v82, v20, v21
    v_cvt_pk_bf16_f32 v83, v22, v23
    v_exp_f32 v24, v24
    v_exp_f32 v25, v25
    v_mfma_f32_32x32x16_bf16 v[48:63], a[240:243], v[80:83], v[48:63]
    s_add_u32 s90, s41, 0x1a00000
    buffer_store_dwordx4 a[224:227], v1, s[4:7], s90 offen sc1
    v_exp_f32 v26, v26
    v_exp_f32 v27, v27
    v_exp_f32 v28, v28
    v_exp_f32 v29, v29
    v_mfma_f32_16x16x32_bf16 a[216:219], a[220:223], v[224:227], a[216:219]
    v_exp_f32 v30, v30
    v_exp_f32 v31, v31
    v_cvt_pk_bf16_f32 v84, v24, v25
    v_cvt_pk_bf16_f32 v85, v26, v27
    v_cvt_pk_bf16_f32 v86, v28, v29
    v_cvt_pk_bf16_f32 v87, v30, v31
    v_mfma_f32_32x32x16_bf16 v[16:31], a[236:239], v[96:99], 0
    s_waitcnt lgkmcnt(7)
    s_add_u32 s86, s32, 0x17c00
    buffer_load_dwordx4 v111, s[76:79], s86 offen offset:1024 lds
    v_exp_f32 v32, v32
    v_exp_f32 v33, v33
    v_exp_f32 v34, v34
    v_exp_f32 v35, v35
    v_mfma_f32_32x32x16_bf16 v[48:63], a[248:251], v[84:87], v[48:63]
    v_exp_f32 v36, v36
    v_exp_f32 v37, v37
    v_exp_f32 v38, v38
    v_exp_f32 v39, v39
    v_cvt_pk_bf16_f32 v80, v32, v33
    v_cvt_pk_bf16_f32 v81, v34, v35
    v_cvt_pk_bf16_f32 v82, v36, v37
    v_cvt_pk_bf16_f32 v83, v38, v39
    v_exp_f32 v40, v40
    v_exp_f32 v41, v41
    v_mfma_f32_32x32x16_bf16 v[64:79], a[240:243], v[80:83], v[64:79]
    ds_read_b128 a[240:243], v92 offset:8224
    v_exp_f32 v42, v42
    v_exp_f32 v43, v43
    v_exp_f32 v44, v44
    v_exp_f32 v45, v45
    v_mfma_f32_16x16x32_bf16 a[216:219], a[220:223], v[228:231], a[216:219]
    v_exp_f32 v46, v46
    v_exp_f32 v47, v47
    v_cvt_pk_bf16_f32 v84, v40, v41
    v_cvt_pk_bf16_f32 v85, v42, v43
    v_cvt_pk_bf16_f32 v86, v44, v45
    v_cvt_pk_bf16_f32 v87, v46, v47
    s_waitcnt lgkmcnt(3)
    v_mfma_f32_32x32x16_bf16 v[32:47], a[236:239], a[228:231], 0
    ds_read_b128 a[236:239], v2 offset:10528
    v_exp_f32 v16, v16
    v_exp_f32 v17, v17
    v_exp_f32 v18, v18
    v_exp_f32 v19, v19
    v_mfma_f32_32x32x16_bf16 v[64:79], a[248:251], v[84:87], v[64:79]
    ds_read_b128 a[248:251], v93 offset:8224
    v_exp_f32 v20, v20
    v_exp_f32 v21, v21
    v_exp_f32 v22, v22
    v_exp_f32 v23, v23
    v_cvt_pk_bf16_f32 v80, v16, v17
    v_cvt_pk_bf16_f32 v81, v18, v19
    v_cvt_pk_bf16_f32 v82, v20, v21
    v_cvt_pk_bf16_f32 v83, v22, v23
    v_exp_f32 v24, v24
    v_exp_f32 v25, v25
    v_mfma_f32_32x32x16_bf16 v[48:63], a[244:247], v[80:83], v[48:63]
    s_add_u32 s89, s32, 0x19800
    buffer_load_dwordx4 v111, s[76:79], s89 offen offset:2048 lds
    v_exp_f32 v26, v26
    v_exp_f32 v27, v27
    v_exp_f32 v28, v28
    v_exp_f32 v29, v29
    v_mfma_f32_16x16x32_bf16 a[216:219], a[220:223], v[232:235], a[216:219]
    v_exp_f32 v30, v30
    v_exp_f32 v31, v31
    v_cvt_pk_bf16_f32 v84, v24, v25
    v_cvt_pk_bf16_f32 v85, v26, v27
    v_cvt_pk_bf16_f32 v86, v28, v29
    v_cvt_pk_bf16_f32 v87, v30, v31
    v_mfma_f32_32x32x16_bf16 v[16:31], a[232:235], v[96:99], 0
    s_waitcnt lgkmcnt(3)
    s_add_u32 s82, s32, 0x1b400
    buffer_load_dwordx4 v111, s[76:79], s82 offen offset:3072 lds
    v_exp_f32 v32, v32
    v_exp_f32 v33, v33
    v_exp_f32 v34, v34
    v_exp_f32 v35, v35
    v_mfma_f32_32x32x16_bf16 v[48:63], a[252:255], v[84:87], v[48:63]
    s_waitcnt vmcnt(18)
    ds_read_b64_tr_b16 a[0:1], v102 offset:0
    ds_read_b64_tr_b16 a[4:5], v103 offset:0
    s_waitcnt vmcnt(17)
    ds_read_b64_tr_b16 a[2:3], v102 offset:1024
    ds_read_b64_tr_b16 a[6:7], v103 offset:1024
    v_exp_f32 v36, v36
    v_exp_f32 v37, v37
    v_exp_f32 v38, v38
    v_exp_f32 v39, v39
    v_cvt_pk_bf16_f32 v80, v32, v33
    v_cvt_pk_bf16_f32 v81, v34, v35
    v_cvt_pk_bf16_f32 v82, v36, v37
    v_cvt_pk_bf16_f32 v83, v38, v39
    v_exp_f32 v40, v40
    v_exp_f32 v41, v41
    v_mfma_f32_32x32x16_bf16 v[64:79], a[244:247], v[80:83], v[64:79]
    ds_read_b128 a[244:247], v94 offset:8224
    s_add_u32 m0, s22, 0x24240
    s_add_u32 s83, s32, 0x1e000
    buffer_load_dwordx4 v111, s[76:79], s83 offen lds
    v_exp_f32 v42, v42
    v_exp_f32 v43, v43
    v_exp_f32 v44, v44
    v_exp_f32 v45, v45
    v_mfma_f32_16x16x32_bf16 a[216:219], a[220:223], v[236:239], a[216:219]
    v_exp_f32 v46, v46
    v_exp_f32 v47, v47
    v_cvt_pk_bf16_f32 v84, v40, v41
    v_cvt_pk_bf16_f32 v85, v42, v43
    v_cvt_pk_bf16_f32 v86, v44, v45
    v_cvt_pk_bf16_f32 v87, v46, v47
    s_waitcnt lgkmcnt(5)
    v_mfma_f32_32x32x16_bf16 v[32:47], a[232:235], a[228:231], 0
    ds_read_b128 a[232:235], v2 offset:12592
    s_add_u32 s84, s32, 0x1fc00
    buffer_load_dwordx4 v111, s[76:79], s84 offen offset:1024 lds
    v_exp_f32 v16, v16
    v_exp_f32 v17, v17
    v_exp_f32 v18, v18
    v_exp_f32 v19, v19
    v_mfma_f32_32x32x16_bf16 v[64:79], a[252:255], v[84:87], v[64:79]
    ds_read_b128 a[252:255], v95 offset:8224
    s_waitcnt vmcnt(18)
    ds_read_b64_tr_b16 a[8:9], v102 offset:2048
    ds_read_b64_tr_b16 a[12:13], v103 offset:2048
    s_waitcnt vmcnt(17)
    ds_read_b64_tr_b16 a[10:11], v124 offset:0
    ds_read_b64_tr_b16 a[14:15], v4 offset:0
    v_exp_f32 v20, v20
    v_exp_f32 v21, v21
    v_exp_f32 v22, v22
    v_exp_f32 v23, v23
    v_cvt_pk_bf16_f32 v80, v16, v17
    v_cvt_pk_bf16_f32 v81, v18, v19
    v_cvt_pk_bf16_f32 v82, v20, v21
    v_cvt_pk_bf16_f32 v83, v22, v23
    v_exp_f32 v24, v24
    v_exp_f32 v25, v25
    v_mfma_f32_32x32x16_bf16 v[48:63], a[240:243], v[80:83], v[48:63]
    s_add_u32 s80, s41, 0x1b00000
    buffer_store_dwordx4 a[224:227], v1, s[4:7], s80 offen sc1
    v_exp_f32 v26, v26
    v_exp_f32 v27, v27
    v_exp_f32 v28, v28
    v_exp_f32 v29, v29
    v_mfma_f32_16x16x32_bf16 a[216:219], a[220:223], v[240:243], a[216:219]
    v_exp_f32 v30, v30
    v_exp_f32 v31, v31
    v_cvt_pk_bf16_f32 v84, v24, v25
    v_cvt_pk_bf16_f32 v85, v26, v27
    v_cvt_pk_bf16_f32 v86, v28, v29
    v_cvt_pk_bf16_f32 v87, v30, v31
    v_mfma_f32_32x32x16_bf16 v[16:31], a[236:239], v[96:99], 0
    s_add_u32 s81, s32, 0x21800
    buffer_load_dwordx4 v111, s[76:79], s81 offen offset:2048 lds
    v_exp_f32 v32, v32
    v_exp_f32 v33, v33
    v_exp_f32 v34, v34
    v_exp_f32 v35, v35
    v_mfma_f32_32x32x16_bf16 v[48:63], a[248:251], v[84:87], v[48:63]
    v_add_u32 v108, 0x14140, v6
    ds_read2st64_b32 v[104:105], v108 offset0:0 offset1:4
    ds_read2st64_b32 v[106:107], v108 offset0:8 offset1:12
    s_waitcnt vmcnt(18)
    ds_read_b64_tr_b16 a[16:17], v124 offset:1024
    ds_read_b64_tr_b16 a[20:21], v4 offset:1024
    s_waitcnt vmcnt(17)
    ds_read_b64_tr_b16 a[18:19], v124 offset:2048
    ds_read_b64_tr_b16 a[22:23], v4 offset:2048
    v_exp_f32 v36, v36
    v_exp_f32 v37, v37
    v_exp_f32 v38, v38
    v_exp_f32 v39, v39
    v_cvt_pk_bf16_f32 v80, v32, v33
    v_cvt_pk_bf16_f32 v81, v34, v35
    v_cvt_pk_bf16_f32 v82, v36, v37
    v_cvt_pk_bf16_f32 v83, v38, v39
    v_exp_f32 v40, v40
    v_exp_f32 v41, v41
    v_mfma_f32_32x32x16_bf16 v[64:79], a[240:243], v[80:83], v[64:79]
    ds_read_b128 a[240:243], v92 offset:12336
    v_exp_f32 v42, v42
    v_exp_f32 v43, v43
    v_exp_f32 v44, v44
    v_exp_f32 v45, v45
    v_mfma_f32_16x16x32_bf16 a[216:219], a[220:223], v[244:247], a[216:219]
    v_exp_f32 v46, v46
    v_exp_f32 v47, v47
    v_cvt_pk_bf16_f32 v84, v40, v41
    v_cvt_pk_bf16_f32 v85, v42, v43
    v_cvt_pk_bf16_f32 v86, v44, v45
    v_cvt_pk_bf16_f32 v87, v46, v47
    s_waitcnt lgkmcnt(11)
    v_mfma_f32_32x32x16_bf16 v[32:47], a[236:239], a[228:231], 0
    ds_read_b128 a[236:239], v2 offset:14640
    v_exp_f32 v16, v16
    v_exp_f32 v17, v17
    v_exp_f32 v18, v18
    v_exp_f32 v19, v19
    v_mfma_f32_32x32x16_bf16 v[64:79], a[248:251], v[84:87], v[64:79]
    ds_read_b128 a[248:251], v93 offset:12336
    s_waitcnt lgkmcnt(7)
    v_max3_u32 v7, v104, v105, v106
    v_max_u32 v7, v7, v107
    v_cmp_eq_u32 vcc, -1, v7
    s_cbranch_vccnz Lre10
Lok10:
    s_waitcnt vmcnt(16)
    ds_read_b64_tr_b16 a[24:25], v124 offset:3072
    ds_read_b64_tr_b16 a[28:29], v4 offset:3072
    v_exp_f32 v20, v20
    v_exp_f32 v21, v21
    v_exp_f32 v22, v22
    v_exp_f32 v23, v23
    v_cvt_pk_bf16_f32 v80, v16, v17
    v_cvt_pk_bf16_f32 v81, v18, v19
    v_cvt_pk_bf16_f32 v82, v20, v21
    v_cvt_pk_bf16_f32 v83, v22, v23
    v_exp_f32 v24, v24
    v_exp_f32 v25, v25
    v_mfma_f32_32x32x16_bf16 v[48:63], a[244:247], v[80:83], v[48:63]
    s_add_u32 m0, s22, 0x8080
    s_add_u32 s85, s32, 0x24000
    buffer_load_dwordx4 v111, s[76:79], s85 offen lds
    v_exp_f32 v26, v26
    v_exp_f32 v27, v27
    v_exp_f32 v28, v28
    v_exp_f32 v29, v29
    v_mfma_f32_16x16x32_bf16 a[216:219], a[220:223], v[248:251], a[216:219]
    v_exp_f32 v30, v30
    v_exp_f32 v31, v31
    v_cvt_pk_bf16_f32 v84, v24, v25
    v_cvt_pk_bf16_f32 v85, v26, v27
    v_cvt_pk_bf16_f32 v86, v28, v29
    v_cvt_pk_bf16_f32 v87, v30, v31
    v_mfma_f32_32x32x16_bf16 v[16:31], a[232:235], v[96:99], 0
    s_add_u32 m0, s22, 0x18180
    s_add_u32 s87, s29, 0x818000
    buffer_load_dwordx4 v1, s[4:7], s87 offen sc1 lds
    v_exp_f32 v32, v32
    v_exp_f32 v33, v33
    v_exp_f32 v34, v34
    v_exp_f32 v35, v35
    v_mfma_f32_32x32x16_bf16 v[48:63], a[252:255], v[84:87], v[48:63]
    s_barrier
    s_waitcnt vmcnt(16)
    ds_read_b64_tr_b16 a[26:27], v102 offset:16448
    ds_read_b64_tr_b16 a[30:31], v103 offset:16448
    v_exp_f32 v36, v36
    v_exp_f32 v37, v37
    v_exp_f32 v38, v38
    v_exp_f32 v39, v39
    v_cvt_pk_bf16_f32 v80, v32, v33
    v_cvt_pk_bf16_f32 v81, v34, v35
    v_cvt_pk_bf16_f32 v82, v36, v37
    v_cvt_pk_bf16_f32 v83, v38, v39
    v_exp_f32 v40, v40
    v_exp_f32 v41, v41
    v_mfma_f32_32x32x16_bf16 v[64:79], a[244:247], v[80:83], v[64:79]
    ds_read_b128 a[244:247], v94 offset:12336
    buffer_load_dwordx4 v1, s[4:7], s87 offen offset:1024 sc1 lds
    v_exp_f32 v42, v42
    v_exp_f32 v43, v43
    v_exp_f32 v44, v44
    v_exp_f32 v45, v45
    v_mfma_f32_16x16x32_bf16 a[216:219], a[220:223], v[252:255], a[216:219]
    v_exp_f32 v46, v46
    v_exp_f32 v47, v47
    v_cvt_pk_bf16_f32 v84, v40, v41
    v_cvt_pk_bf16_f32 v85, v42, v43
    v_cvt_pk_bf16_f32 v86, v44, v45
    v_cvt_pk_bf16_f32 v87, v46, v47
    s_waitcnt lgkmcnt(5)
    v_mfma_f32_32x32x16_bf16 v[32:47], a[232:235], a[228:231], 0
    ds_read_b128 a[232:235], v2 offset:16704
    buffer_load_dwordx4 v1, s[4:7], s87 offen offset:2048 sc1 lds
    v_exp_f32 v16, v16
    v_exp_f32 v17, v17
    v_exp_f32 v18, v18
    v_exp_f32 v19, v19
    v_mfma_f32_32x32x16_bf16 v[64:79], a[252:255], v[84:87], v[64:79]
    ds_read_b128 a[252:255], v95 offset:12336
    s_waitcnt vmcnt(16)
    ds_read_b64_tr_b16 a[32:33], v102 offset:17472
    ds_read_b64_tr_b16 a[36:37], v103 offset:17472
    v_accvgpr_read_b32 v108, a216
    v_cmp_gt_u32 vcc, 512, v1
    v_mov_b32 v106, v14
    v_mov_b32 v107, 0
    v_cndmask_b32 v108, 0, v108, vcc
    v_cvt_pk_bf16_f32 v105, v108, 0
    v_lshlrev_b32 v109, 16, v105
    v_sub_f32 v109, v108, v109
    v_lshl_or_b32 v105, v14, 16, v105
    v_cvt_pk_bf16_f32 v104, v108, v109
    s_waitcnt vmcnt(15)
    v_cmp_ne_u32 vcc, 1, v11
    s_cbranch_vccnz Lre11
Lok11:
    s_mov_b32 s91, 0x740000
    buffer_store_dword v12, v10, s[4:7], s91 offen sc1
    v_exp_f32 v20, v20
    v_exp_f32 v21, v21
    v_exp_f32 v22, v22
    v_exp_f32 v23, v23
    v_cvt_pk_bf16_f32 v80, v16, v17
    v_cvt_pk_bf16_f32 v81, v18, v19
    v_cvt_pk_bf16_f32 v82, v20, v21
    v_cvt_pk_bf16_f32 v83, v22, v23
    v_exp_f32 v24, v24
    v_exp_f32 v25, v25
    v_mfma_f32_32x32x16_bf16 v[48:63], a[240:243], v[80:83], v[48:63]
    buffer_load_dwordx4 v1, s[4:7], s87 offen offset:3072 sc1 lds
    v_exp_f32 v26, v26
    v_exp_f32 v27, v27
    v_exp_f32 v28, v28
    v_exp_f32 v29, v29
    v_exp_f32 v30, v30
    v_exp_f32 v31, v31
    v_cvt_pk_bf16_f32 v84, v24, v25
    v_cvt_pk_bf16_f32 v85, v26, v27
    v_cvt_pk_bf16_f32 v86, v28, v29
    v_cvt_pk_bf16_f32 v87, v30, v31
    v_mfma_f32_32x32x16_bf16 v[16:31], a[236:239], v[96:99], 0
    s_add_u32 m0, s22, 0x8480
    s_add_u32 s88, s32, 0x26000
    buffer_load_dwordx4 v111, s[76:79], s88 offen lds
    v_exp_f32 v32, v32
    v_exp_f32 v33, v33
    v_exp_f32 v34, v34
    v_exp_f32 v35, v35
    v_mfma_f32_32x32x16_bf16 v[48:63], a[248:251], v[84:87], v[48:63]
    s_waitcnt vmcnt(17)
    ds_read_b64_tr_b16 a[34:35], v102 offset:18496
    ds_read_b64_tr_b16 a[38:39], v103 offset:18496
    s_waitcnt vmcnt(16)
    ds_read_b64_tr_b16 a[40:41], v102 offset:19520
    ds_read_b64_tr_b16 a[44:45], v103 offset:19520
    v_and_b32 v11, 0x363ff, v9
    v_and_b32 v7, 0x70, v1
    v_lshl_or_b32 v11, v7, 6, v11
    v_and_b32 v7, 0x80, v1
    v_lshl_or_b32 v7, v7, 8, v11
    buffer_load_dword v11, v7, s[4:7], s91 offen offset:128 sc1
    v_exp_f32 v36, v36
    v_exp_f32 v37, v37
    v_exp_f32 v38, v38
    v_exp_f32 v39, v39
    v_cvt_pk_bf16_f32 v80, v32, v33
    v_cvt_pk_bf16_f32 v81, v34, v35
    v_cvt_pk_bf16_f32 v82, v36, v37
    v_cvt_pk_bf16_f32 v83, v38, v39
    v_exp_f32 v40, v40
    v_exp_f32 v41, v41
    v_mfma_f32_32x32x16_bf16 v[64:79], a[240:243], v[80:83], v[64:79]
    ds_read_b128 a[240:243], v92 offset:16448
    s_add_u32 s90, s32, 0x27c00
    buffer_load_dwordx4 v111, s[76:79], s90 offen offset:1024 lds
    s_mov_b32 s86, s38
    buffer_store_dwordx4 v[104:107], v1, s[4:7], s86 offen
    v_exp_f32 v42, v42
    v_exp_f32 v43, v43
    v_exp_f32 v44, v44
    v_exp_f32 v45, v45
    v_exp_f32 v46, v46
    v_exp_f32 v47, v47
    v_cvt_pk_bf16_f32 v84, v40, v41
    v_cvt_pk_bf16_f32 v85, v42, v43
    v_cvt_pk_bf16_f32 v86, v44, v45
    v_cvt_pk_bf16_f32 v87, v46, v47
    s_waitcnt lgkmcnt(7)
    v_mfma_f32_32x32x16_bf16 v[32:47], a[236:239], a[228:231], 0
    ds_read_b128 a[236:239], v2 offset:18752
    s_add_u32 s89, s32, 0x29800
    buffer_load_dwordx4 v111, s[76:79], s89 offen offset:2048 lds
    v_exp_f32 v16, v16
    v_exp_f32 v17, v17
    v_exp_f32 v18, v18
    v_exp_f32 v19, v19
    v_mfma_f32_32x32x16_bf16 v[64:79], a[248:251], v[84:87], v[64:79]
    ds_read_b128 a[248:251], v93 offset:16448
    s_waitcnt vmcnt(19)
    ds_read_b64_tr_b16 a[42:43], v102 offset:32896
    ds_read_b64_tr_b16 a[46:47], v103 offset:32896
    v_exp_f32 v20, v20
    v_exp_f32 v21, v21
    v_exp_f32 v22, v22
    v_exp_f32 v23, v23
    v_cvt_pk_bf16_f32 v80, v16, v17
    v_cvt_pk_bf16_f32 v81, v18, v19
    v_cvt_pk_bf16_f32 v82, v20, v21
    v_cvt_pk_bf16_f32 v83, v22, v23
    v_exp_f32 v24, v24
    v_exp_f32 v25, v25
    v_mfma_f32_32x32x16_bf16 v[48:63], a[244:247], v[80:83], v[48:63]
    s_add_u32 m0, s22, 0x1c1c0
    s_add_u32 s82, s32, 0x2c000
    buffer_load_dwordx4 v111, s[76:79], s82 offen lds
    v_exp_f32 v26, v26
    v_exp_f32 v27, v27
    v_exp_f32 v28, v28
    v_exp_f32 v29, v29
    v_exp_f32 v30, v30
    v_exp_f32 v31, v31
    v_cvt_pk_bf16_f32 v84, v24, v25
    v_cvt_pk_bf16_f32 v85, v26, v27
    v_cvt_pk_bf16_f32 v86, v28, v29
    v_cvt_pk_bf16_f32 v87, v30, v31
    v_mfma_f32_32x32x16_bf16 v[16:31], a[232:235], v[96:99], 0
    s_waitcnt lgkmcnt(9)
    s_add_u32 s83, s32, 0x2dc00
    buffer_load_dwordx4 v111, s[76:79], s83 offen offset:1024 lds
    v_exp_f32 v32, v32
    v_exp_f32 v33, v33
    v_exp_f32 v34, v34
    v_exp_f32 v35, v35
    v_mfma_f32_32x32x16_bf16 v[48:63], a[252:255], v[84:87], v[48:63]
    s_waitcnt vmcnt(19)
    ds_read_b64_tr_b16 a[48:49], v102 offset:33920
    ds_read_b64_tr_b16 a[52:53], v103 offset:33920
    v_exp_f32 v36, v36
    v_exp_f32 v37, v37
    v_exp_f32 v38, v38
    v_exp_f32 v39, v39
    v_cvt_pk_bf16_f32 v80, v32, v33
    v_cvt_pk_bf16_f32 v81, v34, v35
    v_cvt_pk_bf16_f32 v82, v36, v37
    v_cvt_pk_bf16_f32 v83, v38, v39
    v_exp_f32 v40, v40
    v_exp_f32 v41, v41
    v_mfma_f32_32x32x16_bf16 v[64:79], a[244:247], v[80:83], v[64:79]
    ds_read_b128 a[244:247], v94 offset:16448
    s_waitcnt lgkmcnt(10)
    s_add_u32 s84, s32, 0x2f800
    buffer_load_dwordx4 v111, s[76:79], s84 offen offset:2048 lds
    v_exp_f32 v42, v42
    v_exp_f32 v43, v43
    v_exp_f32 v44, v44
    v_exp_f32 v45, v45
    v_exp_f32 v46, v46
    v_exp_f32 v47, v47
    v_cvt_pk_bf16_f32 v84, v40, v41
    v_cvt_pk_bf16_f32 v85, v42, v43
    v_cvt_pk_bf16_f32 v86, v44, v45
    v_cvt_pk_bf16_f32 v87, v46, v47
    s_waitcnt lgkmcnt(5)
    v_mfma_f32_32x32x16_bf16 v[32:47], a[232:235], a[228:231], 0
    ds_read_b128 a[232:235], v2 offset:20816
    s_add_u32 s80, s32, 0x31400
    buffer_load_dwordx4 v111, s[76:79], s80 offen offset:3072 lds
    v_exp_f32 v16, v16
    v_exp_f32 v17, v17
    v_exp_f32 v18, v18
    v_exp_f32 v19, v19
    v_mfma_f32_32x32x16_bf16 v[64:79], a[252:255], v[84:87], v[64:79]
    ds_read_b128 a[252:255], v95 offset:16448
    s_waitcnt vmcnt(20)
    ds_read_b64_tr_b16 a[50:51], v102 offset:34944
    ds_read_b64_tr_b16 a[54:55], v103 offset:34944
    v_exp_f32 v20, v20
    v_exp_f32 v21, v21
    v_exp_f32 v22, v22
    v_exp_f32 v23, v23
    v_cvt_pk_bf16_f32 v80, v16, v17
    v_cvt_pk_bf16_f32 v81, v18, v19
    v_cvt_pk_bf16_f32 v82, v20, v21
    v_cvt_pk_bf16_f32 v83, v22, v23
    v_exp_f32 v24, v24
    v_exp_f32 v25, v25
    v_mfma_f32_32x32x16_bf16 v[48:63], a[240:243], v[80:83], v[48:63]
    s_add_u32 s81, s41, 0x1c00000
    buffer_store_dwordx4 a[224:227], v1, s[4:7], s81 offen sc1
    v_exp_f32 v26, v26
    v_exp_f32 v27, v27
    v_exp_f32 v28, v28
    v_exp_f32 v29, v29
    v_exp_f32 v30, v30
    v_exp_f32 v31, v31
    v_cvt_pk_bf16_f32 v84, v24, v25
    v_cvt_pk_bf16_f32 v85, v26, v27
    v_cvt_pk_bf16_f32 v86, v28, v29
    v_cvt_pk_bf16_f32 v87, v30, v31
    v_mfma_f32_32x32x16_bf16 v[16:31], a[236:239], v[96:99], 0
    s_add_u32 m0, s22, 0xc0c0
    s_add_u32 s85, s32, 0x34000
    buffer_load_dwordx4 v111, s[76:79], s85 offen lds
    v_exp_f32 v32, v32
    v_exp_f32 v33, v33
    v_exp_f32 v34, v34
    v_exp_f32 v35, v35
    v_mfma_f32_32x32x16_bf16 v[48:63], a[248:251], v[84:87], v[48:63]
    s_waitcnt vmcnt(21)
    ds_read_b64_tr_b16 a[56:57], v102 offset:35968
    ds_read_b64_tr_b16 a[60:61], v103 offset:35968
    s_waitcnt vmcnt(20)
    ds_read_b64_tr_b16 a[58:59], v102 offset:49344
    ds_read_b64_tr_b16 a[62:63], v103 offset:49344
    v_exp_f32 v36, v36
    v_exp_f32 v37, v37
    v_exp_f32 v38, v38
    v_exp_f32 v39, v39
    v_cvt_pk_bf16_f32 v80, v32, v33
    v_cvt_pk_bf16_f32 v81, v34, v35
    v_cvt_pk_bf16_f32 v82, v36, v37
    v_cvt_pk_bf16_f32 v83, v38, v39
    v_exp_f32 v40, v40
    v_exp_f32 v41, v41
    v_mfma_f32_32x32x16_bf16 v[64:79], a[240:243], v[80:83], v[64:79]
    ds_read_b128 a[240:243], v92 offset:20560
    s_add_u32 s87, s32, 0x35c00
    buffer_load_dwordx4 v111, s[76:79], s87 offen offset:1024 lds
    v_exp_f32 v42, v42
    v_exp_f32 v43, v43
    v_exp_f32 v44, v44
    v_exp_f32 v45, v45
    v_exp_f32 v46, v46
    v_exp_f32 v47, v47
    v_cvt_pk_bf16_f32 v84, v40, v41
    v_cvt_pk_bf16_f32 v85, v42, v43
    v_cvt_pk_bf16_f32 v86, v44, v45
    v_cvt_pk_bf16_f32 v87, v46, v47
    s_waitcnt lgkmcnt(7)
    v_mfma_f32_32x32x16_bf16 v[32:47], a[236:239], a[228:231], 0
    ds_read_b128 a[236:239], v2 offset:22864
    s_add_u32 s88, s32, 0x37800
    buffer_load_dwordx4 v111, s[76:79], s88 offen offset:2048 lds
    v_exp_f32 v16, v16
    v_exp_f32 v17, v17
    v_exp_f32 v18, v18
    v_exp_f32 v19, v19
    v_mfma_f32_32x32x16_bf16 v[64:79], a[248:251], v[84:87], v[64:79]
    ds_read_b128 a[248:251], v93 offset:20560
    s_waitcnt vmcnt(21)
    ds_read_b64_tr_b16 a[64:65], v102 offset:50368
    ds_read_b64_tr_b16 a[68:69], v103 offset:50368
    v_exp_f32 v20, v20
    v_exp_f32 v21, v21
    v_exp_f32 v22, v22
    v_exp_f32 v23, v23
    v_cvt_pk_bf16_f32 v80, v16, v17
    v_cvt_pk_bf16_f32 v81, v18, v19
    v_cvt_pk_bf16_f32 v82, v20, v21
    v_cvt_pk_bf16_f32 v83, v22, v23
    v_exp_f32 v24, v24
    v_exp_f32 v25, v25
    v_mfma_f32_32x32x16_bf16 v[48:63], a[244:247], v[80:83], v[48:63]
    s_add_u32 s91, s41, 0x620000
    buffer_store_dwordx4 a[224:227], v1, s[4:7], s91 offen sc1
    v_exp_f32 v26, v26
    v_exp_f32 v27, v27
    v_exp_f32 v28, v28
    v_exp_f32 v29, v29
    v_exp_f32 v30, v30
    v_exp_f32 v31, v31
    v_cvt_pk_bf16_f32 v84, v24, v25
    v_cvt_pk_bf16_f32 v85, v26, v27
    v_cvt_pk_bf16_f32 v86, v28, v29
    v_cvt_pk_bf16_f32 v87, v30, v31
    v_mfma_f32_32x32x16_bf16 v[16:31], a[232:235], v[96:99], 0
    s_add_u32 s90, s32, 0x39400
    buffer_load_dwordx4 v111, s[76:79], s90 offen offset:3072 lds
    v_exp_f32 v32, v32
    v_exp_f32 v33, v33
    v_exp_f32 v34, v34
    v_exp_f32 v35, v35
    v_mfma_f32_32x32x16_bf16 v[48:63], a[252:255], v[84:87], v[48:63]
    s_waitcnt vmcnt(21)
    ds_read_b64_tr_b16 a[66:67], v102 offset:51392
    ds_read_b64_tr_b16 a[70:71], v103 offset:51392
    v_exp_f32 v36, v36
    v_exp_f32 v37, v37
    v_exp_f32 v38, v38
    v_exp_f32 v39, v39
    v_cvt_pk_bf16_f32 v80, v32, v33
    v_cvt_pk_bf16_f32 v81, v34, v35
    v_cvt_pk_bf16_f32 v82, v36, v37
    v_cvt_pk_bf16_f32 v83, v38, v39
    v_exp_f32 v40, v40
    v_exp_f32 v41, v41
    v_mfma_f32_32x32x16_bf16 v[64:79], a[244:247], v[80:83], v[64:79]
    ds_read_b128 a[244:247], v94 offset:20560
    v_exp_f32 v42, v42
    v_exp_f32 v43, v43
    v_exp_f32 v44, v44
    v_exp_f32 v45, v45
    v_exp_f32 v46, v46
    v_exp_f32 v47, v47
    v_cvt_pk_bf16_f32 v84, v40, v41
    v_cvt_pk_bf16_f32 v85, v42, v43
    v_cvt_pk_bf16_f32 v86, v44, v45
    v_cvt_pk_bf16_f32 v87, v46, v47
    s_waitcnt lgkmcnt(5)
    v_mfma_f32_32x32x16_bf16 v[32:47], a[232:235], a[228:231], 0
    ds_read_b128 a[232:235], v2 offset:24928
    s_add_u32 m0, s22, 0x20200
    s_add_u32 s86, s32, 0x3c000
    buffer_load_dwordx4 v111, s[76:79], s86 offen lds
    v_exp_f32 v16, v16
    v_exp_f32 v17, v17
    v_exp_f32 v18, v18
    v_exp_f32 v19, v19
    v_mfma_f32_32x32x16_bf16 v[64:79], a[252:255], v[84:87], v[64:79]
    ds_read_b128 a[252:255], v95 offset:20560
    s_waitcnt vmcnt(21)
    ds_read_b64_tr_b16 a[72:73], v124 offset:0
    ds_read_b64_tr_b16 a[76:77], v4 offset:0
    v_exp_f32 v20, v20
    v_exp_f32 v21, v21
    v_exp_f32 v22, v22
    v_exp_f32 v23, v23
    v_cvt_pk_bf16_f32 v80, v16, v17
    v_cvt_pk_bf16_f32 v81, v18, v19
    v_cvt_pk_bf16_f32 v82, v20, v21
    v_cvt_pk_bf16_f32 v83, v22, v23
    v_exp_f32 v24, v24
    v_exp_f32 v25, v25
    v_mfma_f32_32x32x16_bf16 v[48:63], a[240:243], v[80:83], v[48:63]
    s_add_u32 s89, s41, 0x1d00000
    buffer_store_dwordx4 a[224:227], v1, s[4:7], s89 offen sc1
    v_exp_f32 v26, v26
    v_exp_f32 v27, v27
    v_exp_f32 v28, v28
    v_exp_f32 v29, v29
    v_exp_f32 v30, v30
    v_exp_f32 v31, v31
    v_cvt_pk_bf16_f32 v84, v24, v25
    v_cvt_pk_bf16_f32 v85, v26, v27
    v_cvt_pk_bf16_f32 v86, v28, v29
PAD6:
    s_cbranch_execz PAD10
    v_cvt_pk_bf16_f32 v87, v30, v31
    v_mfma_f32_32x32x16_bf16 v[16:31], a[236:239], v[96:99], 0
    s_add_u32 s82, s32, 0x3dc00
    buffer_load_dwordx4 v111, s[76:79], s82 offen offset:1024 lds
    v_exp_f32 v32, v32
    v_exp_f32 v33, v33
    v_exp_f32 v34, v34
    v_exp_f32 v35, v35
    v_mfma_f32_32x32x16_bf16 v[48:63], a[248:251], v[84:87], v[48:63]
    v_exp_f32 v36, v36
    v_exp_f32 v37, v37
    v_exp_f32 v38, v38
    v_exp_f32 v39, v39
    v_cvt_pk_bf16_f32 v80, v32, v33
    v_cvt_pk_bf16_f32 v81, v34, v35
    v_cvt_pk_bf16_f32 v82, v36, v37
    v_cvt_pk_bf16_f32 v83, v38, v39
    v_exp_f32 v40, v40
    v_exp_f32 v41, v41
    v_mfma_f32_32x32x16_bf16 v[64:79], a[240:243], v[80:83], v[64:79]
    ds_read_b128 a[240:243], v92 offset:24672
    v_exp_f32 v42, v42
    v_exp_f32 v43, v43
    v_exp_f32 v44, v44
    v_exp_f32 v45, v45
    v_exp_f32 v46, v46
    v_exp_f32 v47, v47
    v_cvt_pk_bf16_f32 v84, v40, v41
    v_cvt_pk_bf16_f32 v85, v42, v43
    v_cvt_pk_bf16_f32 v86, v44, v45
    v_cvt_pk_bf16_f32 v87, v46, v47
    s_waitcnt lgkmcnt(3)
    v_mfma_f32_32x32x16_bf16 v[32:47], a[236:239], a[228:231], 0
    ds_read_b128 a[236:239], v2 offset:26976
    s_add_u32 s83, s32, 0x3f800
    buffer_load_dwordx4 v111, s[76:79], s83 offen offset:2048 lds
    v_exp_f32 v16, v16
    v_exp_f32 v17, v17
    v_exp_f32 v18, v18
    v_exp_f32 v19, v19
    v_mfma_f32_32x32x16_bf16 v[64:79], a[248:251], v[84:87], v[64:79]
    ds_read_b128 a[248:251], v93 offset:24672
    v_exp_f32 v20, v20
    v_exp_f32 v21, v21
    v_exp_f32 v22, v22
    v_exp_f32 v23, v23
    v_cvt_pk_bf16_f32 v80, v16, v17
    v_cvt_pk_bf16_f32 v81, v18, v19
    v_cvt_pk_bf16_f32 v82, v20, v21
    v_cvt_pk_bf16_f32 v83, v22, v23
    v_exp_f32 v24, v24
    v_exp_f32 v25, v25
    v_mfma_f32_32x32x16_bf16 v[48:63], a[244:247], v[80:83], v[48:63]
    s_add_u32 s84, s32, 0x41400
    buffer_load_dwordx4 v111, s[76:79], s84 offen offset:3072 lds
    v_exp_f32 v26, v26
    v_exp_f32 v27, v27
    v_exp_f32 v28, v28
    v_exp_f32 v29, v29
    v_exp_f32 v30, v30
    v_exp_f32 v31, v31
    v_cvt_pk_bf16_f32 v84, v24, v25
    v_cvt_pk_bf16_f32 v85, v26, v27
    v_cvt_pk_bf16_f32 v86, v28, v29
    v_cvt_pk_bf16_f32 v87, v30, v31
    v_mfma_f32_32x32x16_bf16 v[16:31], a[232:235], v[96:99], 0
    s_waitcnt lgkmcnt(3)
    s_add_u32 m0, s22, 0x8080
    s_add_u32 s80, s32, 0x44000
    buffer_load_dwordx4 v111, s[76:79], s80 offen lds
    v_exp_f32 v32, v32
    v_exp_f32 v33, v33
    v_exp_f32 v34, v34
    v_exp_f32 v35, v35
    v_mfma_f32_32x32x16_bf16 v[48:63], a[252:255], v[84:87], v[48:63]
    s_waitcnt vmcnt(20)
    ds_read_b64_tr_b16 a[74:75], v124 offset:1024
    ds_read_b64_tr_b16 a[78:79], v4 offset:1024
    s_waitcnt vmcnt(18)
    ds_read_b64_tr_b16 a[80:81], v124 offset:2048
    ds_read_b64_tr_b16 a[84:85], v4 offset:2048
    v_cmp_ne_u32 vcc, s35, v11
    s_cmp_lg_u64 vcc, 0
    s_cselect_b32 s33, 1, 0
    v_exp_f32 v36, v36
    v_exp_f32 v37, v37
    v_exp_f32 v38, v38
    v_exp_f32 v39, v39
    v_cvt_pk_bf16_f32 v80, v32, v33
    v_cvt_pk_bf16_f32 v81, v34, v35
    v_cvt_pk_bf16_f32 v82, v36, v37
    v_cvt_pk_bf16_f32 v83, v38, v39
    v_exp_f32 v40, v40
    v_exp_f32 v41, v41
    v_mfma_f32_32x32x16_bf16 v[64:79], a[244:247], v[80:83], v[64:79]
    ds_read_b128 a[244:247], v94 offset:24672
    v_exp_f32 v42, v42
    v_exp_f32 v43, v43
    v_exp_f32 v44, v44
    v_exp_f32 v45, v45
    v_exp_f32 v46, v46
    v_exp_f32 v47, v47
    v_cvt_pk_bf16_f32 v84, v40, v41
    v_cvt_pk_bf16_f32 v85, v42, v43
    v_cvt_pk_bf16_f32 v86, v44, v45
    v_cvt_pk_bf16_f32 v87, v46, v47
    s_waitcnt lgkmcnt(5)
    v_mfma_f32_32x32x16_bf16 v[32:47], a[232:235], a[228:231], 0
    ds_read_b128 a[232:235], v2 offset:29040
    v_exp_f32 v16, v16
    v_exp_f32 v17, v17
    v_exp_f32 v18, v18
    v_exp_f32 v19, v19
    v_mfma_f32_32x32x16_bf16 v[64:79], a[252:255], v[84:87], v[64:79]
    ds_read_b128 a[252:255], v95 offset:24672
    s_waitcnt vmcnt(16)
    ds_read_b64_tr_b16 a[82:83], v124 offset:3072
    ds_read_b64_tr_b16 a[86:87], v4 offset:3072
    s_waitcnt vmcnt(15)
    ds_read_b64_tr_b16 a[88:89], v102 offset:16448
    ds_read_b64_tr_b16 a[92:93], v103 offset:16448
    v_exp_f32 v20, v20
    v_exp_f32 v21, v21
    v_exp_f32 v22, v22
    v_exp_f32 v23, v23
    v_cvt_pk_bf16_f32 v80, v16, v17
    v_cvt_pk_bf16_f32 v81, v18, v19
    v_cvt_pk_bf16_f32 v82, v20, v21
    v_cvt_pk_bf16_f32 v83, v22, v23
    v_exp_f32 v24, v24
    v_exp_f32 v25, v25
    v_mfma_f32_32x32x16_bf16 v[48:63], a[240:243], v[80:83], v[48:63]
    s_waitcnt lgkmcnt(9)
    s_add_u32 s81, s32, 0x45c00
    buffer_load_dwordx4 v111, s[76:79], s81 offen offset:1024 lds
    v_exp_f32 v26, v26
    v_exp_f32 v27, v27
    v_exp_f32 v28, v28
    v_exp_f32 v29, v29
    v_exp_f32 v30, v30
    v_exp_f32 v31, v31
    v_cvt_pk_bf16_f32 v84, v24, v25
    v_cvt_pk_bf16_f32 v85, v26, v27
    v_cvt_pk_bf16_f32 v86, v28, v29
    v_cvt_pk_bf16_f32 v87, v30, v31
    v_mfma_f32_32x32x16_bf16 v[16:31], a[236:239], v[96:99], 0
    s_waitcnt lgkmcnt(7)
    s_add_u32 s85, s32, 0x47800
    buffer_load_dwordx4 v111, s[76:79], s85 offen offset:2048 lds
    v_exp_f32 v32, v32
    v_exp_f32 v33, v33
    v_exp_f32 v34, v34
    v_exp_f32 v35, v35
    v_mfma_f32_32x32x16_bf16 v[48:63], a[248:251], v[84:87], v[48:63]
    v_add_u32 v108, 0x18180, v6
    ds_read2st64_b32 v[104:105], v108 offset0:0 offset1:4
    ds_read2st64_b32 v[106:107], v108 offset0:8 offset1:12
    s_waitcnt vmcnt(16)
    ds_read_b64_tr_b16 a[90:91], v102 offset:17472
    ds_read_b64_tr_b16 a[94:95], v103 offset:17472
    s_waitcnt vmcnt(15)
    ds_read_b64_tr_b16 a[96:97], v102 offset:18496
    ds_read_b64_tr_b16 a[100:101], v103 offset:18496
    v_exp_f32 v36, v36
    v_exp_f32 v37, v37
    v_exp_f32 v38, v38
    v_exp_f32 v39, v39
    v_cvt_pk_bf16_f32 v80, v32, v33
    v_cvt_pk_bf16_f32 v81, v34, v35
    v_cvt_pk_bf16_f32 v82, v36, v37
    v_cvt_pk_bf16_f32 v83, v38, v39
    v_exp_f32 v40, v40
    v_exp_f32 v41, v41
    v_mfma_f32_32x32x16_bf16 v[64:79], a[240:243], v[80:83], v[64:79]
    ds_read_b128 a[240:243], v92 offset:28784
    v_exp_f32 v42, v42
    v_exp_f32 v43, v43
    v_exp_f32 v44, v44
    v_exp_f32 v45, v45
    v_exp_f32 v46, v46
    v_exp_f32 v47, v47
    v_cvt_pk_bf16_f32 v84, v40, v41
    v_cvt_pk_bf16_f32 v85, v42, v43
    v_cvt_pk_bf16_f32 v86, v44, v45
    v_cvt_pk_bf16_f32 v87, v46, v47
    s_waitcnt lgkmcnt(11)
    v_mfma_f32_32x32x16_bf16 v[32:47], a[236:239], a[228:231], 0
    ds_read_b128 a[236:239], v2 offset:31088
    s_waitcnt lgkmcnt(10)
    s_add_u32 s87, s32, 0x49400
    buffer_load_dwordx4 v111, s[76:79], s87 offen offset:3072 lds
    v_exp_f32 v16, v16
    v_exp_f32 v17, v17
    v_exp_f32 v18, v18
    v_exp_f32 v19, v19
    v_mfma_f32_32x32x16_bf16 v[64:79], a[248:251], v[84:87], v[64:79]
    ds_read_b128 a[248:251], v93 offset:28784
    s_waitcnt lgkmcnt(7)
    v_max3_u32 v7, v104, v105, v106
    v_max_u32 v7, v7, v107
    v_cmp_eq_u32 vcc, -1, v7
    s_cbranch_vccnz Lre12
Lok12:
    s_waitcnt vmcnt(15)
    ds_read_b64_tr_b16 a[98:99], v102 offset:19520
    ds_read_b64_tr_b16 a[102:103], v103 offset:19520
    v_exp_f32 v20, v20
    v_exp_f32 v21, v21
    v_exp_f32 v22, v22
    v_exp_f32 v23, v23
    v_cvt_pk_bf16_f32 v80, v16, v17
    v_cvt_pk_bf16_f32 v81, v18, v19
    v_cvt_pk_bf16_f32 v82, v20, v21
    v_cvt_pk_bf16_f32 v83, v22, v23
    v_exp_f32 v24, v24
    v_exp_f32 v25, v25
    v_mfma_f32_32x32x16_bf16 v[48:63], a[244:247], v[80:83], v[48:63]
    s_add_u32 s88, s41, 0x1e00000
    buffer_store_dwordx4 a[224:227], v1, s[4:7], s88 offen sc1
    v_exp_f32 v26, v26
    v_exp_f32 v27, v27
    v_exp_f32 v28, v28
    v_exp_f32 v29, v29
    v_exp_f32 v30, v30
    v_exp_f32 v31, v31
    v_cvt_pk_bf16_f32 v84, v24, v25
    v_cvt_pk_bf16_f32 v85, v26, v27
    v_cvt_pk_bf16_f32 v86, v28, v29
    v_cvt_pk_bf16_f32 v87, v30, v31
    v_mfma_f32_32x32x16_bf16 v[16:31], a[232:235], v[96:99], 0
    s_add_u32 m0, s22, 0x1c1c0
    s_add_u32 s91, s29, 0x81c000
    buffer_load_dwordx4 v1, s[4:7], s91 offen sc1 lds
    v_exp_f32 v32, v32
    v_exp_f32 v33, v33
    v_exp_f32 v34, v34
    v_exp_f32 v35, v35
    v_mfma_f32_32x32x16_bf16 v[48:63], a[252:255], v[84:87], v[48:63]
    s_barrier
    s_waitcnt vmcnt(15)
    ds_read_b64_tr_b16 a[104:105], v124 offset:16448
    ds_read_b64_tr_b16 a[108:109], v4 offset:16448
    s_waitcnt vmcnt(14)
    ds_read_b64_tr_b16 a[106:107], v124 offset:17472
    ds_read_b64_tr_b16 a[110:111], v4 offset:17472
    v_exp_f32 v36, v36
    v_exp_f32 v37, v37
    v_exp_f32 v38, v38
    v_exp_f32 v39, v39
    v_cvt_pk_bf16_f32 v80, v32, v33
    v_cvt_pk_bf16_f32 v81, v34, v35
    v_cvt_pk_bf16_f32 v82, v36, v37
    v_cvt_pk_bf16_f32 v83, v38, v39
    v_exp_f32 v40, v40
    v_exp_f32 v41, v41
    v_mfma_f32_32x32x16_bf16 v[64:79], a[244:247], v[80:83], v[64:79]
    ds_read_b128 a[244:247], v94 offset:28784
    s_waitcnt lgkmcnt(12)
    buffer_load_dwordx4 v1, s[4:7], s91 offen offset:1024 sc1 lds
    v_exp_f32 v42, v42
    v_exp_f32 v43, v43
    v_exp_f32 v44, v44
    v_exp_f32 v45, v45
    v_exp_f32 v46, v46
    v_exp_f32 v47, v47
    v_cvt_pk_bf16_f32 v84, v40, v41
    v_cvt_pk_bf16_f32 v85, v42, v43
    v_cvt_pk_bf16_f32 v86, v44, v45
    v_cvt_pk_bf16_f32 v87, v46, v47
    s_waitcnt lgkmcnt(7)
    v_mfma_f32_32x32x16_bf16 v[32:47], a[232:235], a[228:231], 0
    ds_read_b128 a[232:235], v2 offset:33152
    buffer_load_dwordx4 v1, s[4:7], s91 offen offset:2048 sc1 lds
    v_exp_f32 v16, v16
    v_exp_f32 v17, v17
    v_exp_f32 v18, v18
    v_exp_f32 v19, v19
    v_mfma_f32_32x32x16_bf16 v[64:79], a[252:255], v[84:87], v[64:79]
    ds_read_b128 a[252:255], v95 offset:28784
    s_waitcnt vmcnt(15)
    ds_read_b64_tr_b16 a[112:113], v124 offset:18496
    ds_read_b64_tr_b16 a[116:117], v4 offset:18496
    v_exp_f32 v20, v20
    v_exp_f32 v21, v21
    v_exp_f32 v22, v22
    v_exp_f32 v23, v23
    v_cvt_pk_bf16_f32 v80, v16, v17
    v_cvt_pk_bf16_f32 v81, v18, v19
    v_cvt_pk_bf16_f32 v82, v20, v21
    v_cvt_pk_bf16_f32 v83, v22, v23
    v_exp_f32 v24, v24
    v_exp_f32 v25, v25
    v_mfma_f32_32x32x16_bf16 v[48:63], a[240:243], v[80:83], v[48:63]
    s_waitcnt lgkmcnt(9)
    buffer_load_dwordx4 v1, s[4:7], s91 offen offset:3072 sc1 lds
    v_exp_f32 v26, v26
    v_exp_f32 v27, v27
    v_exp_f32 v28, v28
    v_exp_f32 v29, v29
    v_exp_f32 v30, v30
    v_exp_f32 v31, v31
    v_cvt_pk_bf16_f32 v84, v24, v25
    v_cvt_pk_bf16_f32 v85, v26, v27
    v_cvt_pk_bf16_f32 v86, v28, v29
    v_cvt_pk_bf16_f32 v87, v30, v31
    v_mfma_f32_32x32x16_bf16 v[16:31], a[236:239], v[96:99], 0
    s_waitcnt lgkmcnt(7)
    s_add_u32 m0, s22, 0xc0c0
    s_add_u32 s90, s32, 0x4c000
    buffer_load_dwordx4 v111, s[76:79], s90 offen lds
    v_exp_f32 v32, v32
    v_exp_f32 v33, v33
    v_exp_f32 v34, v34
    v_exp_f32 v35, v35
    v_mfma_f32_32x32x16_bf16 v[48:63], a[248:251], v[84:87], v[48:63]
    s_waitcnt vmcnt(15)
    ds_read_b64_tr_b16 a[114:115], v124 offset:19520
    ds_read_b64_tr_b16 a[118:119], v4 offset:19520
    v_exp_f32 v36, v36
    v_exp_f32 v37, v37
    v_exp_f32 v38, v38
    v_exp_f32 v39, v39
    v_cvt_pk_bf16_f32 v80, v32, v33
    v_cvt_pk_bf16_f32 v81, v34, v35
    v_cvt_pk_bf16_f32 v82, v36, v37
    v_cvt_pk_bf16_f32 v83, v38, v39
    v_exp_f32 v40, v40
    v_exp_f32 v41, v41
    v_mfma_f32_32x32x16_bf16 v[64:79], a[240:243], v[80:83], v[64:79]
    ds_read_b128 a[240:243], v92 offset:32896
    s_waitcnt lgkmcnt(8)
    s_add_u32 s86, s32, 0x4dc00
    buffer_load_dwordx4 v111, s[76:79], s86 offen offset:1024 lds
    v_exp_f32 v42, v42
    v_exp_f32 v43, v43
    v_exp_f32 v44, v44
    v_exp_f32 v45, v45
    v_exp_f32 v46, v46
    v_exp_f32 v47, v47
    v_cvt_pk_bf16_f32 v84, v40, v41
    v_cvt_pk_bf16_f32 v85, v42, v43
    v_cvt_pk_bf16_f32 v86, v44, v45
    v_cvt_pk_bf16_f32 v87, v46, v47
    s_waitcnt lgkmcnt(5)
    v_mfma_f32_32x32x16_bf16 v[32:47], a[236:239], a[228:231], 0
    ds_read_b128 a[236:239], v2 offset:35200
    s_waitcnt lgkmcnt(4)
    s_add_u32 s89, s32, 0x4f800
    buffer_load_dwordx4 v111, s[76:79], s89 offen offset:2048 lds
    v_exp_f32 v16, v16
    v_exp_f32 v17, v17
    v_exp_f32 v18, v18
    v_exp_f32 v19, v19
    v_mfma_f32_32x32x16_bf16 v[64:79], a[248:251], v[84:87], v[64:79]
    ds_read_b128 a[248:251], v93 offset:32896
    s_waitcnt vmcnt(16)
    ds_read_b64_tr_b16 a[120:121], v102 offset:32896
    ds_read_b64_tr_b16 a[124:125], v103 offset:32896
    v_mov_b32 v104, 1
    s_mov_b64 exec, 1
    s_add_u32 s82, s42, 0x5f0000
    buffer_atomic_add v104, off, s[4:7], s82 sc1
    s_mov_b64 exec, -1
    v_exp_f32 v20, v20
    v_exp_f32 v21, v21
    v_exp_f32 v22, v22
    v_exp_f32 v23, v23
    v_cvt_pk_bf16_f32 v80, v16, v17
    v_cvt_pk_bf16_f32 v81, v18, v19
    v_cvt_pk_bf16_f32 v82, v20, v21
    v_cvt_pk_bf16_f32 v83, v22, v23
    v_exp_f32 v24, v24
    v_exp_f32 v25, v25
    v_mfma_f32_32x32x16_bf16 v[48:63], a[244:247], v[80:83], v[48:63]
    s_waitcnt lgkmcnt(5)
    s_add_u32 s83, s32, 0x51400
    buffer_load_dwordx4 v111, s[76:79], s83 offen offset:3072 lds
    v_exp_f32 v26, v26
    v_exp_f32 v27, v27
    v_exp_f32 v28, v28
    v_exp_f32 v29, v29
    v_exp_f32 v30, v30
    v_exp_f32 v31, v31
    v_cvt_pk_bf16_f32 v84, v24, v25
    v_cvt_pk_bf16_f32 v85, v26, v27
    v_cvt_pk_bf16_f32 v86, v28, v29
    v_cvt_pk_bf16_f32 v87, v30, v31
    v_mfma_f32_32x32x16_bf16 v[16:31], a[232:235], v[96:99], 0
    s_add_u32 m0, s22, 0x10100
    s_add_u32 s84, s32, 0x54000
    buffer_load_dwordx4 v111, s[76:79], s84 offen lds
    v_exp_f32 v32, v32
    v_exp_f32 v33, v33
    v_exp_f32 v34, v34
    v_exp_f32 v35, v35
    v_mfma_f32_32x32x16_bf16 v[48:63], a[252:255], v[84:87], v[48:63]
    s_waitcnt vmcnt(17)
    ds_read_b64_tr_b16 a[122:123], v102 offset:33920
    ds_read_b64_tr_b16 a[126:127], v103 offset:33920
    v_exp_f32 v36, v36
    v_exp_f32 v37, v37
    v_exp_f32 v38, v38
    v_exp_f32 v39, v39
    v_cvt_pk_bf16_f32 v80, v32, v33
    v_cvt_pk_bf16_f32 v81, v34, v35
    v_cvt_pk_bf16_f32 v82, v36, v37
    v_cvt_pk_bf16_f32 v83, v38, v39
    v_exp_f32 v40, v40
    v_exp_f32 v41, v41
    v_mfma_f32_32x32x16_bf16 v[64:79], a[244:247], v[80:83], v[64:79]
    ds_read_b128 a[244:247], v94 offset:32896
    s_add_u32 s80, s32, 0x55c00
    buffer_load_dwordx4 v111, s[76:79], s80 offen offset:1024 lds
    v_exp_f32 v42, v42
    v_exp_f32 v43, v43
    v_exp_f32 v44, v44
    v_exp_f32 v45, v45
    v_exp_f32 v46, v46
    v_exp_f32 v47, v47
    v_cvt_pk_bf16_f32 v84, v40, v41
    v_cvt_pk_bf16_f32 v85, v42, v43
    v_cvt_pk_bf16_f32 v86, v44, v45
    v_cvt_pk_bf16_f32 v87, v46, v47
    s_waitcnt lgkmcnt(5)
    v_mfma_f32_32x32x16_bf16 v[32:47], a[232:235], a[228:231], 0
    ds_read_b128 a[232:235], v2 offset:37264
    s_add_u32 s81, s32, 0x57800
    buffer_load_dwordx4 v111, s[76:79], s81 offen offset:2048 lds
    v_exp_f32 v16, v16
    v_exp_f32 v17, v17
    v_exp_f32 v18, v18
    v_exp_f32 v19, v19
    v_mfma_f32_32x32x16_bf16 v[64:79], a[252:255], v[84:87], v[64:79]
    ds_read_b128 a[252:255], v95 offset:32896
    s_waitcnt vmcnt(18)
    ds_read_b64_tr_b16 a[128:129], v102 offset:34944
    ds_read_b64_tr_b16 a[132:133], v103 offset:34944
    s_waitcnt vmcnt(17)
    ds_read_b64_tr_b16 a[130:131], v102 offset:35968
    ds_read_b64_tr_b16 a[134:135], v103 offset:35968
    v_exp_f32 v20, v20
    v_exp_f32 v21, v21
    v_exp_f32 v22, v22
    v_exp_f32 v23, v23
    v_cvt_pk_bf16_f32 v80, v16, v17
    v_cvt_pk_bf16_f32 v81, v18, v19
    v_cvt_pk_bf16_f32 v82, v20, v21
    v_cvt_pk_bf16_f32 v83, v22, v23
    v_exp_f32 v24, v24
    v_exp_f32 v25, v25
    v_mfma_f32_32x32x16_bf16 v[48:63], a[240:243], v[80:83], v[48:63]
    s_add_u32 s85, s32, 0x59400
    buffer_load_dwordx4 v111, s[76:79], s85 offen offset:3072 lds
    v_exp_f32 v26, v26
    v_exp_f32 v27, v27
    v_exp_f32 v28, v28
    v_exp_f32 v29, v29
    v_exp_f32 v30, v30
    v_exp_f32 v31, v31
    v_cvt_pk_bf16_f32 v84, v24, v25
    v_cvt_pk_bf16_f32 v85, v26, v27
    v_cvt_pk_bf16_f32 v86, v28, v29
    v_cvt_pk_bf16_f32 v87, v30, v31
    v_mfma_f32_32x32x16_bf16 v[16:31], a[236:239], v[96:99], 0
    s_waitcnt lgkmcnt(9)
    s_add_u32 m0, s22, 0x20200
    s_add_u32 s87, s32, 0x5c000
    buffer_load_dwordx4 v111, s[76:79], s87 offen lds
    v_exp_f32 v32, v32
    v_exp_f32 v33, v33
    v_exp_f32 v34, v34
    v_exp_f32 v35, v35
    v_mfma_f32_32x32x16_bf16 v[48:63], a[248:251], v[84:87], v[48:63]
    s_waitcnt vmcnt(18)
    ds_read_b64_tr_b16 a[136:137], v124 offset:0
    ds_read_b64_tr_b16 a[140:141], v4 offset:0
    v_exp_f32 v36, v36
    v_exp_f32 v37, v37
    v_exp_f32 v38, v38
    v_exp_f32 v39, v39
    v_cvt_pk_bf16_f32 v80, v32, v33
    v_cvt_pk_bf16_f32 v81, v34, v35
    v_cvt_pk_bf16_f32 v82, v36, v37
    v_cvt_pk_bf16_f32 v83, v38, v39
    v_exp_f32 v40, v40
    v_exp_f32 v41, v41
    v_mfma_f32_32x32x16_bf16 v[64:79], a[240:243], v[80:83], v[64:79]
    ds_read_b128 a[240:243], v92 offset:37008
    s_add_u32 s88, s41, 0x1f00000
    buffer_store_dwordx4 a[224:227], v1, s[4:7], s88 offen sc1
    v_exp_f32 v42, v42
    v_exp_f32 v43, v43
    v_exp_f32 v44, v44
    v_exp_f32 v45, v45
    v_exp_f32 v46, v46
    v_exp_f32 v47, v47
    v_cvt_pk_bf16_f32 v84, v40, v41
    v_cvt_pk_bf16_f32 v85, v42, v43
    v_cvt_pk_bf16_f32 v86, v44, v45
    v_cvt_pk_bf16_f32 v87, v46, v47
    s_waitcnt lgkmcnt(7)
    v_mfma_f32_32x32x16_bf16 v[32:47], a[236:239], a[228:231], 0
    ds_read_b128 a[236:239], v2 offset:39312
    v_exp_f32 v16, v16
    v_exp_f32 v17, v17
    v_exp_f32 v18, v18
    v_exp_f32 v19, v19
    v_mfma_f32_32x32x16_bf16 v[64:79], a[248:251], v[84:87], v[64:79]
    ds_read_b128 a[248:251], v93 offset:37008
    s_waitcnt vmcnt(18)
    ds_read_b64_tr_b16 a[138:139], v124 offset:1024
    ds_read_b64_tr_b16 a[142:143], v4 offset:1024
    v_exp_f32 v20, v20
    v_exp_f32 v21, v21
    v_exp_f32 v22, v22
    v_exp_f32 v23, v23
    v_cvt_pk_bf16_f32 v80, v16, v17
    v_cvt_pk_bf16_f32 v81, v18, v19
    v_cvt_pk_bf16_f32 v82, v20, v21
    v_cvt_pk_bf16_f32 v83, v22, v23
    v_exp_f32 v24, v24
    v_exp_f32 v25, v25
    v_mfma_f32_32x32x16_bf16 v[48:63], a[244:247], v[80:83], v[48:63]
    s_add_u32 s91, s32, 0x5dc00
    buffer_load_dwordx4 v111, s[76:79], s91 offen offset:1024 lds
    v_exp_f32 v26, v26
    v_exp_f32 v27, v27
    v_exp_f32 v28, v28
    v_exp_f32 v29, v29
    v_exp_f32 v30, v30
    v_exp_f32 v31, v31
    v_cvt_pk_bf16_f32 v84, v24, v25
    v_cvt_pk_bf16_f32 v85, v26, v27
    v_cvt_pk_bf16_f32 v86, v28, v29
    v_cvt_pk_bf16_f32 v87, v30, v31
    v_mfma_f32_32x32x16_bf16 v[16:31], a[232:235], v[96:99], 0
    s_waitcnt lgkmcnt(9)
    s_add_u32 s90, s32, 0x5f800
    buffer_load_dwordx4 v111, s[76:79], s90 offen offset:2048 lds
    v_exp_f32 v32, v32
    v_exp_f32 v33, v33
    v_exp_f32 v34, v34
    v_exp_f32 v35, v35
    v_mfma_f32_32x32x16_bf16 v[48:63], a[252:255], v[84:87], v[48:63]
    s_waitcnt vmcnt(19)
    ds_read_b64_tr_b16 a[144:145], v124 offset:2048
    ds_read_b64_tr_b16 a[148:149], v4 offset:2048
    v_exp_f32 v36, v36
    v_exp_f32 v37, v37
    v_exp_f32 v38, v38
    v_exp_f32 v39, v39
    v_cvt_pk_bf16_f32 v80, v32, v33
    v_cvt_pk_bf16_f32 v81, v34, v35
    v_cvt_pk_bf16_f32 v82, v36, v37
    v_cvt_pk_bf16_f32 v83, v38, v39
    v_exp_f32 v40, v40
    v_exp_f32 v41, v41
    v_mfma_f32_32x32x16_bf16 v[64:79], a[244:247], v[80:83], v[64:79]
    ds_read_b128 a[244:247], v94 offset:37008
    v_exp_f32 v42, v42
    v_exp_f32 v43, v43
    v_exp_f32 v44, v44
    v_exp_f32 v45, v45
    v_exp_f32 v46, v46
    v_exp_f32 v47, v47
    v_cvt_pk_bf16_f32 v84, v40, v41
    v_cvt_pk_bf16_f32 v85, v42, v43
    v_cvt_pk_bf16_f32 v86, v44, v45
    v_cvt_pk_bf16_f32 v87, v46, v47
    s_waitcnt lgkmcnt(5)
    v_mfma_f32_32x32x16_bf16 v[32:47], a[232:235], a[228:231], 0
    ds_read_b128 a[232:235], v2 offset:41376
    v_exp_f32 v16, v16
    v_exp_f32 v17, v17
    v_exp_f32 v18, v18
    v_exp_f32 v19, v19
    v_mfma_f32_32x32x16_bf16 v[64:79], a[252:255], v[84:87], v[64:79]
    ds_read_b128 a[252:255], v95 offset:37008
    s_waitcnt vmcnt(18)
    ds_read_b64_tr_b16 a[146:147], v124 offset:3072
    ds_read_b64_tr_b16 a[150:151], v4 offset:3072
    v_exp_f32 v20, v20
    v_exp_f32 v21, v21
    v_exp_f32 v22, v22
    v_exp_f32 v23, v23
    v_cvt_pk_bf16_f32 v80, v16, v17
    v_cvt_pk_bf16_f32 v81, v18, v19
    v_cvt_pk_bf16_f32 v82, v20, v21
    v_cvt_pk_bf16_f32 v83, v22, v23
    v_exp_f32 v24, v24
    v_exp_f32 v25, v25
    v_mfma_f32_32x32x16_bf16 v[48:63], a[240:243], v[80:83], v[48:63]
    s_add_u32 s86, s32, 0x61400
    buffer_load_dwordx4 v111, s[76:79], s86 offen offset:3072 lds
    v_exp_f32 v26, v26
    v_exp_f32 v27, v27
    v_exp_f32 v28, v28
    v_exp_f32 v29, v29
    v_exp_f32 v30, v30
    v_exp_f32 v31, v31
    v_cvt_pk_bf16_f32 v84, v24, v25
    v_cvt_pk_bf16_f32 v85, v26, v27
    v_cvt_pk_bf16_f32 v86, v28, v29
    v_cvt_pk_bf16_f32 v87, v30, v31
    v_mfma_f32_32x32x16_bf16 v[16:31], a[236:239], v[96:99], 0
    s_add_u32 m0, s22, 0x24240
    s_add_u32 s89, s32, 0x64000
    buffer_load_dwordx4 v111, s[76:79], s89 offen lds
    v_exp_f32 v32, v32
    v_exp_f32 v33, v33
    v_exp_f32 v34, v34
    v_exp_f32 v35, v35
    v_mfma_f32_32x32x16_bf16 v[48:63], a[248:251], v[84:87], v[48:63]
    v_exp_f32 v36, v36
    v_exp_f32 v37, v37
    v_exp_f32 v38, v38
    v_exp_f32 v39, v39
    v_cvt_pk_bf16_f32 v80, v32, v33
    v_cvt_pk_bf16_f32 v81, v34, v35
    v_cvt_pk_bf16_f32 v82, v36, v37
    v_cvt_pk_bf16_f32 v83, v38, v39
    v_exp_f32 v40, v40
    v_exp_f32 v41, v41
    v_mfma_f32_32x32x16_bf16 v[64:79], a[240:243], v[80:83], v[64:79]
    ds_read_b128 a[240:243], v92 offset:41120
    s_add_u32 s82, s32, 0x65c00
    buffer_load_dwordx4 v111, s[76:79], s82 offen offset:1024 lds
    v_exp_f32 v42, v42
    v_exp_f32 v43, v43
    v_exp_f32 v44, v44
    v_exp_f32 v45, v45
    v_exp_f32 v46, v46
    v_exp_f32 v47, v47
    v_cvt_pk_bf16_f32 v84, v40, v41
    v_cvt_pk_bf16_f32 v85, v42, v43
    v_cvt_pk_bf16_f32 v86, v44, v45
    v_cvt_pk_bf16_f32 v87, v46, v47
    s_waitcnt lgkmcnt(3)
    v_mfma_f32_32x32x16_bf16 v[32:47], a[236:239], a[228:231], 0
    ds_read_b128 a[236:239], v2 offset:43424
    s_add_u32 s83, s32, 0x67800
    buffer_load_dwordx4 v111, s[76:79], s83 offen offset:2048 lds
    v_exp_f32 v16, v16
    v_exp_f32 v17, v17
    v_exp_f32 v18, v18
    v_exp_f32 v19, v19
    v_mfma_f32_32x32x16_bf16 v[64:79], a[248:251], v[84:87], v[64:79]
    ds_read_b128 a[248:251], v93 offset:41120
    v_exp_f32 v20, v20
    v_exp_f32 v21, v21
    v_exp_f32 v22, v22
    v_exp_f32 v23, v23
    v_cvt_pk_bf16_f32 v80, v16, v17
    v_cvt_pk_bf16_f32 v81, v18, v19
    v_cvt_pk_bf16_f32 v82, v20, v21
    v_cvt_pk_bf16_f32 v83, v22, v23
    v_exp_f32 v24, v24
    v_exp_f32 v25, v25
    v_mfma_f32_32x32x16_bf16 v[48:63], a[244:247], v[80:83], v[48:63]
    s_add_u32 s84, s41, 0x2000000
    buffer_store_dwordx4 a[224:227], v1, s[4:7], s84 offen sc1
    v_exp_f32 v26, v26
    v_exp_f32 v27, v27
    v_exp_f32 v28, v28
    v_exp_f32 v29, v29
    v_exp_f32 v30, v30
    v_exp_f32 v31, v31
    v_cvt_pk_bf16_f32 v84, v24, v25
    v_cvt_pk_bf16_f32 v85, v26, v27
    v_cvt_pk_bf16_f32 v86, v28, v29
    v_cvt_pk_bf16_f32 v87, v30, v31
    v_mfma_f32_32x32x16_bf16 v[16:31], a[232:235], v[96:99], 0
    v_exp_f32 v32, v32
    v_exp_f32 v33, v33
    v_exp_f32 v34, v34
    v_exp_f32 v35, v35
    v_mfma_f32_32x32x16_bf16 v[48:63], a[252:255], v[84:87], v[48:63]
    s_waitcnt vmcnt(17)
    ds_read_b64_tr_b16 a[152:153], v124 offset:16448
    ds_read_b64_tr_b16 a[156:157], v4 offset:16448
    s_waitcnt vmcnt(16)
    ds_read_b64_tr_b16 a[154:155], v124 offset:17472
    ds_read_b64_tr_b16 a[158:159], v4 offset:17472
    v_exp_f32 v36, v36
    v_exp_f32 v37, v37
    v_exp_f32 v38, v38
    v_exp_f32 v39, v39
PAD7:
    s_cbranch_execz WARM0_8
    v_cvt_pk_bf16_f32 v80, v32, v33
    v_cvt_pk_bf16_f32 v81, v34, v35
    v_cvt_pk_bf16_f32 v82, v36, v37
    v_cvt_pk_bf16_f32 v83, v38, v39
    v_exp_f32 v40, v40
    v_exp_f32 v41, v41
    v_mfma_f32_32x32x16_bf16 v[64:79], a[244:247], v[80:83], v[64:79]
    ds_read_b128 a[244:247], v94 offset:41120
    v_exp_f32 v42, v42
    v_exp_f32 v43, v43
    v_exp_f32 v44, v44
    v_exp_f32 v45, v45
    v_exp_f32 v46, v46
    v_exp_f32 v47, v47
    v_cvt_pk_bf16_f32 v84, v40, v41
    v_cvt_pk_bf16_f32 v85, v42, v43
    v_cvt_pk_bf16_f32 v86, v44, v45
    v_cvt_pk_bf16_f32 v87, v46, v47
    s_waitcnt lgkmcnt(5)
    v_mfma_f32_32x32x16_bf16 v[32:47], a[232:235], a[228:231], 0
    ds_read_b128 a[232:235], v2 offset:45488
    v_exp_f32 v16, v16
    v_exp_f32 v17, v17
    v_exp_f32 v18, v18
    v_exp_f32 v19, v19
    v_mfma_f32_32x32x16_bf16 v[64:79], a[252:255], v[84:87], v[64:79]
    ds_read_b128 a[252:255], v95 offset:41120
    s_waitcnt vmcnt(15)
    ds_read_b64_tr_b16 a[160:161], v124 offset:18496
    ds_read_b64_tr_b16 a[164:165], v4 offset:18496
    s_waitcnt vmcnt(13)
    ds_read_b64_tr_b16 a[162:163], v124 offset:19520
    ds_read_b64_tr_b16 a[166:167], v4 offset:19520
    v_exp_f32 v20, v20
    v_exp_f32 v21, v21
    v_exp_f32 v22, v22
    v_exp_f32 v23, v23
    v_cvt_pk_bf16_f32 v80, v16, v17
    v_cvt_pk_bf16_f32 v81, v18, v19
    v_cvt_pk_bf16_f32 v82, v20, v21
    v_cvt_pk_bf16_f32 v83, v22, v23
    v_exp_f32 v24, v24
    v_exp_f32 v25, v25
    v_mfma_f32_32x32x16_bf16 v[48:63], a[240:243], v[80:83], v[48:63]
    v_exp_f32 v26, v26
    v_exp_f32 v27, v27
    v_exp_f32 v28, v28
    v_exp_f32 v29, v29
    v_exp_f32 v30, v30
    v_exp_f32 v31, v31
    v_cvt_pk_bf16_f32 v84, v24, v25
    v_cvt_pk_bf16_f32 v85, v26, v27
    v_cvt_pk_bf16_f32 v86, v28, v29
    v_cvt_pk_bf16_f32 v87, v30, v31
    v_mfma_f32_32x32x16_bf16 v[16:31], a[236:239], v[96:99], 0
    v_exp_f32 v32, v32
    v_exp_f32 v33, v33
    v_exp_f32 v34, v34
    v_exp_f32 v35, v35
    v_mfma_f32_32x32x16_bf16 v[48:63], a[248:251], v[84:87], v[48:63]
    v_add_u32 v108, 0x1c1c0, v6
    ds_read2st64_b32 v[104:105], v108 offset0:0 offset1:4
    ds_read2st64_b32 v[106:107], v108 offset0:8 offset1:12
    s_waitcnt vmcnt(12)
    ds_read_b64_tr_b16 a[168:169], v124 offset:32896
    ds_read_b64_tr_b16 a[172:173], v4 offset:32896
    s_waitcnt vmcnt(11)
    ds_read_b64_tr_b16 a[170:171], v124 offset:33920
    ds_read_b64_tr_b16 a[174:175], v4 offset:33920
    v_exp_f32 v36, v36
    v_exp_f32 v37, v37
    v_exp_f32 v38, v38
    v_exp_f32 v39, v39
    v_cvt_pk_bf16_f32 v80, v32, v33
    v_cvt_pk_bf16_f32 v81, v34, v35
    v_cvt_pk_bf16_f32 v82, v36, v37
    v_cvt_pk_bf16_f32 v83, v38, v39
    v_exp_f32 v40, v40
    v_exp_f32 v41, v41
    v_mfma_f32_32x32x16_bf16 v[64:79], a[240:243], v[80:83], v[64:79]
    ds_read_b128 a[240:243], v92 offset:45232
    v_exp_f32 v42, v42
    v_exp_f32 v43, v43
    v_exp_f32 v44, v44
    v_exp_f32 v45, v45
    v_exp_f32 v46, v46
    v_exp_f32 v47, v47
    v_cvt_pk_bf16_f32 v84, v40, v41
    v_cvt_pk_bf16_f32 v85, v42, v43
    v_cvt_pk_bf16_f32 v86, v44, v45
    v_cvt_pk_bf16_f32 v87, v46, v47
    s_waitcnt lgkmcnt(11)
    v_mfma_f32_32x32x16_bf16 v[32:47], a[236:239], a[228:231], 0
    ds_read_b128 a[236:239], v2 offset:47536
    v_exp_f32 v16, v16
    v_exp_f32 v17, v17
    v_exp_f32 v18, v18
    v_exp_f32 v19, v19
    v_mfma_f32_32x32x16_bf16 v[64:79], a[248:251], v[84:87], v[64:79]
    ds_read_b128 a[248:251], v93 offset:45232
    s_waitcnt lgkmcnt(7)
    v_max3_u32 v7, v104, v105, v106
    v_max_u32 v7, v7, v107
    v_cmp_eq_u32 vcc, -1, v7
    s_cbranch_vccnz Lre13
Lok13:
    s_waitcnt vmcnt(10)
    ds_read_b64_tr_b16 a[176:177], v124 offset:34944
    ds_read_b64_tr_b16 a[180:181], v4 offset:34944
    s_waitcnt vmcnt(9)
    ds_read_b64_tr_b16 a[178:179], v124 offset:35968
    ds_read_b64_tr_b16 a[182:183], v4 offset:35968
    v_exp_f32 v20, v20
    v_exp_f32 v21, v21
    v_exp_f32 v22, v22
    v_exp_f32 v23, v23
    v_cvt_pk_bf16_f32 v80, v16, v17
    v_cvt_pk_bf16_f32 v81, v18, v19
    v_cvt_pk_bf16_f32 v82, v20, v21
    v_cvt_pk_bf16_f32 v83, v22, v23
    v_exp_f32 v24, v24
    v_exp_f32 v25, v25
    v_mfma_f32_32x32x16_bf16 v[48:63], a[244:247], v[80:83], v[48:63]
    v_exp_f32 v26, v26
    v_exp_f32 v27, v27
    v_exp_f32 v28, v28
    v_exp_f32 v29, v29
    v_exp_f32 v30, v30
    v_exp_f32 v31, v31
    v_cvt_pk_bf16_f32 v84, v24, v25
    v_cvt_pk_bf16_f32 v85, v26, v27
    v_cvt_pk_bf16_f32 v86, v28, v29
    v_cvt_pk_bf16_f32 v87, v30, v31
    v_mfma_f32_32x32x16_bf16 v[16:31], a[232:235], v[96:99], 0
    v_exp_f32 v32, v32
    v_exp_f32 v33, v33
    v_exp_f32 v34, v34
    v_exp_f32 v35, v35
    v_mfma_f32_32x32x16_bf16 v[48:63], a[252:255], v[84:87], v[48:63]
    s_barrier
    s_waitcnt vmcnt(8)
    ds_read_b64_tr_b16 a[184:185], v102 offset:32896
    ds_read_b64_tr_b16 a[188:189], v103 offset:32896
    v_exp_f32 v36, v36
    v_exp_f32 v37, v37
    v_exp_f32 v38, v38
    v_exp_f32 v39, v39
    v_cvt_pk_bf16_f32 v80, v32, v33
    v_cvt_pk_bf16_f32 v81, v34, v35
    v_cvt_pk_bf16_f32 v82, v36, v37
    v_cvt_pk_bf16_f32 v83, v38, v39
    v_exp_f32 v40, v40
    v_exp_f32 v41, v41
    v_mfma_f32_32x32x16_bf16 v[64:79], a[244:247], v[80:83], v[64:79]
    ds_read_b128 a[244:247], v94 offset:45232
    v_exp_f32 v42, v42
    v_exp_f32 v43, v43
    v_exp_f32 v44, v44
    v_exp_f32 v45, v45
    v_exp_f32 v46, v46
    v_exp_f32 v47, v47
    v_cvt_pk_bf16_f32 v84, v40, v41
    v_cvt_pk_bf16_f32 v85, v42, v43
    v_cvt_pk_bf16_f32 v86, v44, v45
    v_cvt_pk_bf16_f32 v87, v46, v47
    s_waitcnt lgkmcnt(7)
    v_mfma_f32_32x32x16_bf16 v[32:47], a[232:235], a[228:231], 0
    ds_read_b128 a[232:235], v2 offset:49600
    s_add_u32 m0, s22, 0x14140
    s_add_u32 s80, s34, 0x18000
    buffer_load_dwordx4 v111, s[68:71], s80 offen lds
    v_exp_f32 v16, v16
    v_exp_f32 v17, v17
    v_exp_f32 v18, v18
    v_exp_f32 v19, v19
    v_mfma_f32_32x32x16_bf16 v[64:79], a[252:255], v[84:87], v[64:79]
    ds_read_b128 a[252:255], v95 offset:45232
    s_waitcnt vmcnt(7)
    ds_read_b64_tr_b16 a[186:187], v102 offset:33920
    ds_read_b64_tr_b16 a[190:191], v103 offset:33920
    v_exp_f32 v20, v20
    v_exp_f32 v21, v21
    v_exp_f32 v22, v22
    v_exp_f32 v23, v23
    v_cvt_pk_bf16_f32 v80, v16, v17
    v_cvt_pk_bf16_f32 v81, v18, v19
    v_cvt_pk_bf16_f32 v82, v20, v21
    v_cvt_pk_bf16_f32 v83, v22, v23
    v_exp_f32 v24, v24
    v_exp_f32 v25, v25
    v_mfma_f32_32x32x16_bf16 v[48:63], a[240:243], v[80:83], v[48:63]
    s_add_u32 s81, s34, 0x19c00
    buffer_load_dwordx4 v111, s[68:71], s81 offen offset:1024 lds
    v_exp_f32 v26, v26
    v_exp_f32 v27, v27
    v_exp_f32 v28, v28
    v_exp_f32 v29, v29
    v_exp_f32 v30, v30
    v_exp_f32 v31, v31
    v_cvt_pk_bf16_f32 v84, v24, v25
    v_cvt_pk_bf16_f32 v85, v26, v27
    v_cvt_pk_bf16_f32 v86, v28, v29
    v_cvt_pk_bf16_f32 v87, v30, v31
    v_mfma_f32_32x32x16_bf16 v[16:31], a[236:239], v[96:99], 0
    s_add_u32 s85, s34, 0x1b800
    buffer_load_dwordx4 v111, s[68:71], s85 offen offset:2048 lds
    v_exp_f32 v32, v32
    v_exp_f32 v33, v33
    v_exp_f32 v34, v34
    v_exp_f32 v35, v35
    v_mfma_f32_32x32x16_bf16 v[48:63], a[248:251], v[84:87], v[48:63]
    s_waitcnt vmcnt(8)
    ds_read_b64_tr_b16 a[192:193], v102 offset:34944
    ds_read_b64_tr_b16 a[196:197], v103 offset:34944
    v_exp_f32 v36, v36
    v_exp_f32 v37, v37
    v_exp_f32 v38, v38
    v_exp_f32 v39, v39
    v_cvt_pk_bf16_f32 v80, v32, v33
    v_cvt_pk_bf16_f32 v81, v34, v35
    v_cvt_pk_bf16_f32 v82, v36, v37
    v_cvt_pk_bf16_f32 v83, v38, v39
    v_exp_f32 v40, v40
    v_exp_f32 v41, v41
    v_mfma_f32_32x32x16_bf16 v[64:79], a[240:243], v[80:83], v[64:79]
    ds_read_b128 a[240:243], v92 offset:49344
    s_add_u32 s87, s34, 0x1d400
    buffer_load_dwordx4 v111, s[68:71], s87 offen offset:3072 lds
    v_exp_f32 v42, v42
    v_exp_f32 v43, v43
    v_exp_f32 v44, v44
    v_exp_f32 v45, v45
    v_exp_f32 v46, v46
    v_exp_f32 v47, v47
    v_cvt_pk_bf16_f32 v84, v40, v41
    v_cvt_pk_bf16_f32 v85, v42, v43
    v_cvt_pk_bf16_f32 v86, v44, v45
    v_cvt_pk_bf16_f32 v87, v46, v47
    s_waitcnt lgkmcnt(5)
    v_mfma_f32_32x32x16_bf16 v[32:47], a[236:239], a[228:231], 0
    ds_read_b128 a[236:239], v2 offset:51648
    s_add_u32 m0, s22, 0x8080
    s_mov_b32 s88, s34
    buffer_load_dwordx4 v111, s[68:71], s88 offen lds
    v_exp_f32 v16, v16
    v_exp_f32 v17, v17
    v_exp_f32 v18, v18
    v_exp_f32 v19, v19
    v_mfma_f32_32x32x16_bf16 v[64:79], a[248:251], v[84:87], v[64:79]
    ds_read_b128 a[248:251], v93 offset:49344
    s_waitcnt vmcnt(9)
    ds_read_b64_tr_b16 a[194:195], v102 offset:35968
    ds_read_b64_tr_b16 a[198:199], v103 offset:35968
    v_exp_f32 v20, v20
    v_exp_f32 v21, v21
    v_exp_f32 v22, v22
    v_exp_f32 v23, v23
    v_cvt_pk_bf16_f32 v80, v16, v17
    v_cvt_pk_bf16_f32 v81, v18, v19
    v_cvt_pk_bf16_f32 v82, v20, v21
    v_cvt_pk_bf16_f32 v83, v22, v23
    v_exp_f32 v24, v24
    v_exp_f32 v25, v25
    v_mfma_f32_32x32x16_bf16 v[48:63], a[244:247], v[80:83], v[48:63]
    s_add_u32 s91, s34, 0x1c00
    buffer_load_dwordx4 v111, s[68:71], s91 offen offset:1024 lds
    v_exp_f32 v26, v26
    v_exp_f32 v27, v27
    v_exp_f32 v28, v28
    v_exp_f32 v29, v29
    v_exp_f32 v30, v30
    v_exp_f32 v31, v31
    v_cvt_pk_bf16_f32 v84, v24, v25
    v_cvt_pk_bf16_f32 v85, v26, v27
    v_cvt_pk_bf16_f32 v86, v28, v29
    v_cvt_pk_bf16_f32 v87, v30, v31
    v_mfma_f32_32x32x16_bf16 v[16:31], a[232:235], v[96:99], 0
    s_add_u32 s90, s34, 0x3800
    buffer_load_dwordx4 v111, s[68:71], s90 offen offset:2048 lds
    v_exp_f32 v32, v32
    v_exp_f32 v33, v33
    v_exp_f32 v34, v34
    v_exp_f32 v35, v35
    v_mfma_f32_32x32x16_bf16 v[48:63], a[252:255], v[84:87], v[48:63]
    s_waitcnt vmcnt(10)
    ds_read_b64_tr_b16 a[200:201], v102 offset:49344
    ds_read_b64_tr_b16 a[204:205], v103 offset:49344
    s_waitcnt vmcnt(9)
    ds_read_b64_tr_b16 a[202:203], v102 offset:50368
    ds_read_b64_tr_b16 a[206:207], v103 offset:50368
    v_exp_f32 v36, v36
    v_exp_f32 v37, v37
    v_exp_f32 v38, v38
    v_exp_f32 v39, v39
    v_cvt_pk_bf16_f32 v80, v32, v33
    v_cvt_pk_bf16_f32 v81, v34, v35
    v_cvt_pk_bf16_f32 v82, v36, v37
    v_cvt_pk_bf16_f32 v83, v38, v39
    v_exp_f32 v40, v40
    v_exp_f32 v41, v41
    v_mfma_f32_32x32x16_bf16 v[64:79], a[244:247], v[80:83], v[64:79]
    ds_read_b128 a[244:247], v94 offset:49344
    s_add_u32 s86, s34, 0x5400
    buffer_load_dwordx4 v111, s[68:71], s86 offen offset:3072 lds
    v_exp_f32 v42, v42
    v_exp_f32 v43, v43
    v_exp_f32 v44, v44
    v_exp_f32 v45, v45
    v_exp_f32 v46, v46
    v_exp_f32 v47, v47
    v_cvt_pk_bf16_f32 v84, v40, v41
    v_cvt_pk_bf16_f32 v85, v42, v43
    v_cvt_pk_bf16_f32 v86, v44, v45
    v_cvt_pk_bf16_f32 v87, v46, v47
    s_waitcnt lgkmcnt(7)
    v_mfma_f32_32x32x16_bf16 v[32:47], a[232:235], a[228:231], 0
    ds_read_b128 a[232:235], v2 offset:53712
    s_add_u32 m0, s22, 0xc0c0
    s_add_u32 s89, s34, 0x8000
    buffer_load_dwordx4 v111, s[68:71], s89 offen lds
    v_exp_f32 v16, v16
    v_exp_f32 v17, v17
    v_exp_f32 v18, v18
    v_exp_f32 v19, v19
    v_mfma_f32_32x32x16_bf16 v[64:79], a[252:255], v[84:87], v[64:79]
    ds_read_b128 a[252:255], v95 offset:49344
    s_waitcnt vmcnt(10)
    ds_read_b64_tr_b16 a[208:209], v102 offset:51392
    ds_read_b64_tr_b16 a[212:213], v103 offset:51392
    v_exp_f32 v20, v20
    v_exp_f32 v21, v21
    v_exp_f32 v22, v22
    v_exp_f32 v23, v23
    v_cvt_pk_bf16_f32 v80, v16, v17
    v_cvt_pk_bf16_f32 v81, v18, v19
    v_cvt_pk_bf16_f32 v82, v20, v21
    v_cvt_pk_bf16_f32 v83, v22, v23
    v_exp_f32 v24, v24
    v_exp_f32 v25, v25
    v_mfma_f32_32x32x16_bf16 v[48:63], a[240:243], v[80:83], v[48:63]
    s_add_u32 s82, s34, 0x9c00
    buffer_load_dwordx4 v111, s[68:71], s82 offen offset:1024 lds
    v_exp_f32 v26, v26
    v_exp_f32 v27, v27
    v_exp_f32 v28, v28
    v_exp_f32 v29, v29
    v_exp_f32 v30, v30
    v_exp_f32 v31, v31
    v_cvt_pk_bf16_f32 v84, v24, v25
    v_cvt_pk_bf16_f32 v85, v26, v27
    v_cvt_pk_bf16_f32 v86, v28, v29
    v_cvt_pk_bf16_f32 v87, v30, v31
    v_mfma_f32_32x32x16_bf16 v[16:31], a[236:239], v[96:99], 0
    s_add_u32 s83, s34, 0xb800
    buffer_load_dwordx4 v111, s[68:71], s83 offen offset:2048 lds
    v_exp_f32 v32, v32
    v_exp_f32 v33, v33
    v_exp_f32 v34, v34
    v_exp_f32 v35, v35
    v_mfma_f32_32x32x16_bf16 v[48:63], a[248:251], v[84:87], v[48:63]
    v_exp_f32 v36, v36
    v_exp_f32 v37, v37
    v_exp_f32 v38, v38
    v_exp_f32 v39, v39
    v_cvt_pk_bf16_f32 v80, v32, v33
    v_cvt_pk_bf16_f32 v81, v34, v35
    v_cvt_pk_bf16_f32 v82, v36, v37
    v_cvt_pk_bf16_f32 v83, v38, v39
    v_exp_f32 v40, v40
    v_exp_f32 v41, v41
    v_mfma_f32_32x32x16_bf16 v[64:79], a[240:243], v[80:83], v[64:79]
    ds_read_b128 a[240:243], v92 offset:53456
    s_add_u32 s84, s34, 0xd400
    buffer_load_dwordx4 v111, s[68:71], s84 offen offset:3072 lds
    v_exp_f32 v42, v42
    v_exp_f32 v43, v43
    v_exp_f32 v44, v44
    v_exp_f32 v45, v45
    v_exp_f32 v46, v46
    v_exp_f32 v47, v47
    v_cvt_pk_bf16_f32 v84, v40, v41
    v_cvt_pk_bf16_f32 v85, v42, v43
    v_cvt_pk_bf16_f32 v86, v44, v45
    v_cvt_pk_bf16_f32 v87, v46, v47
    s_waitcnt lgkmcnt(3)
    v_mfma_f32_32x32x16_bf16 v[32:47], a[236:239], a[228:231], 0
    ds_read_b128 a[236:239], v2 offset:55760
    s_add_u32 m0, s22, 0x10100
    s_add_u32 s80, s34, 0x10000
    buffer_load_dwordx4 v111, s[68:71], s80 offen lds
    v_exp_f32 v16, v16
    v_exp_f32 v17, v17
    v_exp_f32 v18, v18
    v_exp_f32 v19, v19
    v_mfma_f32_32x32x16_bf16 v[64:79], a[248:251], v[84:87], v[64:79]
    ds_read_b128 a[248:251], v93 offset:53456
    v_exp_f32 v20, v20
    v_exp_f32 v21, v21
    v_exp_f32 v22, v22
    v_exp_f32 v23, v23
    v_cvt_pk_bf16_f32 v80, v16, v17
    v_cvt_pk_bf16_f32 v81, v18, v19
    v_cvt_pk_bf16_f32 v82, v20, v21
    v_cvt_pk_bf16_f32 v83, v22, v23
    v_exp_f32 v24, v24
    v_exp_f32 v25, v25
    v_mfma_f32_32x32x16_bf16 v[48:63], a[244:247], v[80:83], v[48:63]
    s_add_u32 s81, s34, 0x11c00
    buffer_load_dwordx4 v111, s[68:71], s81 offen offset:1024 lds
    v_exp_f32 v26, v26
    v_exp_f32 v27, v27
    v_exp_f32 v28, v28
    v_exp_f32 v29, v29
    v_exp_f32 v30, v30
    v_exp_f32 v31, v31
    v_cvt_pk_bf16_f32 v84, v24, v25
    v_cvt_pk_bf16_f32 v85, v26, v27
    v_cvt_pk_bf16_f32 v86, v28, v29
    v_cvt_pk_bf16_f32 v87, v30, v31
    v_mfma_f32_32x32x16_bf16 v[16:31], a[232:235], v[96:99], 0
    s_add_u32 s85, s34, 0x13800
    buffer_load_dwordx4 v111, s[68:71], s85 offen offset:2048 lds
    v_exp_f32 v32, v32
    v_exp_f32 v33, v33
    v_exp_f32 v34, v34
    v_exp_f32 v35, v35
    v_mfma_f32_32x32x16_bf16 v[48:63], a[252:255], v[84:87], v[48:63]
    v_exp_f32 v36, v36
    v_exp_f32 v37, v37
    v_exp_f32 v38, v38
    v_exp_f32 v39, v39
    v_cvt_pk_bf16_f32 v80, v32, v33
    v_cvt_pk_bf16_f32 v81, v34, v35
    v_cvt_pk_bf16_f32 v82, v36, v37
    v_cvt_pk_bf16_f32 v83, v38, v39
    v_exp_f32 v40, v40
    v_exp_f32 v41, v41
    v_mfma_f32_32x32x16_bf16 v[64:79], a[244:247], v[80:83], v[64:79]
    ds_read_b128 a[244:247], v94 offset:53456
    s_add_u32 s87, s34, 0x15400
    buffer_load_dwordx4 v111, s[68:71], s87 offen offset:3072 lds
    v_exp_f32 v42, v42
    v_exp_f32 v43, v43
    v_exp_f32 v44, v44
    v_exp_f32 v45, v45
    v_exp_f32 v46, v46
    v_exp_f32 v47, v47
    v_cvt_pk_bf16_f32 v84, v40, v41
    v_cvt_pk_bf16_f32 v85, v42, v43
    v_cvt_pk_bf16_f32 v86, v44, v45
    v_cvt_pk_bf16_f32 v87, v46, v47
    s_waitcnt lgkmcnt(1)
    v_mfma_f32_32x32x16_bf16 v[32:47], a[232:235], a[228:231], 0
    ds_read_b128 a[232:235], v2 offset:57824
    s_add_u32 m0, s22, 0x24240
    s_add_u32 s88, s32, 0x6a000
    buffer_load_dwordx4 v111, s[76:79], s88 offen lds
    v_exp_f32 v16, v16
    v_exp_f32 v17, v17
    v_exp_f32 v18, v18
    v_exp_f32 v19, v19
    v_mfma_f32_32x32x16_bf16 v[64:79], a[252:255], v[84:87], v[64:79]
    ds_read_b128 a[252:255], v95 offset:53456
    v_exp_f32 v20, v20
    v_exp_f32 v21, v21
    v_exp_f32 v22, v22
    v_exp_f32 v23, v23
    v_cvt_pk_bf16_f32 v80, v16, v17
    v_cvt_pk_bf16_f32 v81, v18, v19
    v_cvt_pk_bf16_f32 v82, v20, v21
    v_cvt_pk_bf16_f32 v83, v22, v23
    v_exp_f32 v24, v24
    v_exp_f32 v25, v25
    v_mfma_f32_32x32x16_bf16 v[48:63], a[240:243], v[80:83], v[48:63]
    s_add_u32 s91, s32, 0x6bc00
    buffer_load_dwordx4 v111, s[76:79], s91 offen offset:1024 lds
    v_exp_f32 v26, v26
    v_exp_f32 v27, v27
    v_exp_f32 v28, v28
    v_exp_f32 v29, v29
    v_exp_f32 v30, v30
    v_exp_f32 v31, v31
    v_cvt_pk_bf16_f32 v84, v24, v25
    v_cvt_pk_bf16_f32 v85, v26, v27
    v_cvt_pk_bf16_f32 v86, v28, v29
    v_cvt_pk_bf16_f32 v87, v30, v31
    v_mfma_f32_32x32x16_bf16 v[16:31], a[236:239], v[96:99], 0
    s_add_u32 s90, s32, 0x6d800
    buffer_load_dwordx4 v111, s[76:79], s90 offen offset:2048 lds
    v_exp_f32 v32, v32
    v_exp_f32 v33, v33
    v_exp_f32 v34, v34
    v_exp_f32 v35, v35
    v_mfma_f32_32x32x16_bf16 v[48:63], a[248:251], v[84:87], v[48:63]
    v_exp_f32 v36, v36
    v_exp_f32 v37, v37
    v_exp_f32 v38, v38
    v_exp_f32 v39, v39
    v_cvt_pk_bf16_f32 v80, v32, v33
    v_cvt_pk_bf16_f32 v81, v34, v35
    v_cvt_pk_bf16_f32 v82, v36, v37
    v_cvt_pk_bf16_f32 v83, v38, v39
    v_exp_f32 v40, v40
    v_exp_f32 v41, v41
    v_mfma_f32_32x32x16_bf16 v[64:79], a[240:243], v[80:83], v[64:79]
    ds_read_b128 a[240:243], v92 offset:57568
    s_add_u32 s86, s41, 0x2100000
    buffer_store_dwordx4 a[224:227], v1, s[4:7], s86 offen sc1
    v_exp_f32 v42, v42
    v_exp_f32 v43, v43
    v_exp_f32 v44, v44
    v_exp_f32 v45, v45
    v_exp_f32 v46, v46
    v_exp_f32 v47, v47
    v_cvt_pk_bf16_f32 v84, v40, v41
    v_cvt_pk_bf16_f32 v85, v42, v43
    v_cvt_pk_bf16_f32 v86, v44, v45
    v_cvt_pk_bf16_f32 v87, v46, v47
    s_waitcnt lgkmcnt(1)
    v_mfma_f32_32x32x16_bf16 v[32:47], a[236:239], a[228:231], 0
    ds_read_b128 a[236:239], v2 offset:59872
    v_exp_f32 v16, v16
    v_exp_f32 v17, v17
    v_exp_f32 v18, v18
    v_exp_f32 v19, v19
    v_mfma_f32_32x32x16_bf16 v[64:79], a[248:251], v[84:87], v[64:79]
    ds_read_b128 a[248:251], v93 offset:57568
    v_and_b32 v104, 0x1f0, v1
    v_lshrrev_b32 v105, 6, v1
    v_lshlrev_b32 v104, 6, v104
    v_and_or_b32 v104, v105, 8, v104
    v_exp_f32 v20, v20
    v_exp_f32 v21, v21
    v_exp_f32 v22, v22
    v_exp_f32 v23, v23
    v_cvt_pk_bf16_f32 v80, v16, v17
    v_cvt_pk_bf16_f32 v81, v18, v19
    v_cvt_pk_bf16_f32 v82, v20, v21
    v_cvt_pk_bf16_f32 v83, v22, v23
    v_exp_f32 v24, v24
    v_exp_f32 v25, v25
    v_mfma_f32_32x32x16_bf16 v[48:63], a[244:247], v[80:83], v[48:63]
    s_add_u32 s89, s41, 0x2200000
    buffer_store_dwordx4 a[224:227], v1, s[4:7], s89 offen sc1
    v_exp_f32 v26, v26
    v_exp_f32 v27, v27
    v_exp_f32 v28, v28
    v_exp_f32 v29, v29
    v_exp_f32 v30, v30
    v_exp_f32 v31, v31
    v_cvt_pk_bf16_f32 v84, v24, v25
    v_cvt_pk_bf16_f32 v85, v26, v27
    v_cvt_pk_bf16_f32 v86, v28, v29
    v_cvt_pk_bf16_f32 v87, v30, v31
    v_mfma_f32_32x32x16_bf16 v[16:31], a[232:235], v[96:99], 0
    s_mov_b32 s82, s48
    buffer_load_dwordx2 v[8:9], v104, s[8:11], s82 offen
    v_exp_f32 v32, v32
    v_exp_f32 v33, v33
    v_exp_f32 v34, v34
    v_exp_f32 v35, v35
    v_mfma_f32_32x32x16_bf16 v[48:63], a[252:255], v[84:87], v[48:63]
    v_exp_f32 v36, v36
    v_exp_f32 v37, v37
    v_exp_f32 v38, v38
    v_exp_f32 v39, v39
    v_cvt_pk_bf16_f32 v80, v32, v33
    v_cvt_pk_bf16_f32 v81, v34, v35
    v_cvt_pk_bf16_f32 v82, v36, v37
    v_cvt_pk_bf16_f32 v83, v38, v39
    v_exp_f32 v40, v40
    v_exp_f32 v41, v41
    v_mfma_f32_32x32x16_bf16 v[64:79], a[244:247], v[80:83], v[64:79]
    ds_read_b128 a[244:247], v94 offset:57568
    buffer_load_dwordx2 v[10:11], v104, s[8:11], s82 offen offset:16
    s_add_u32 s83, s48, 0x8000
    buffer_load_dwordx2 v[12:13], v104, s[8:11], s83 offen
    v_exp_f32 v42, v42
    v_exp_f32 v43, v43
    v_exp_f32 v44, v44
    v_exp_f32 v45, v45
    v_exp_f32 v46, v46
    v_exp_f32 v47, v47
    v_cvt_pk_bf16_f32 v84, v40, v41
    v_cvt_pk_bf16_f32 v85, v42, v43
    v_cvt_pk_bf16_f32 v86, v44, v45
    v_cvt_pk_bf16_f32 v87, v46, v47
    s_waitcnt lgkmcnt(1)
    v_mfma_f32_32x32x16_bf16 v[32:47], a[232:235], a[228:231], 0
    ds_read_b128 a[232:235], v2 offset:61936
    v_exp_f32 v16, v16
    v_exp_f32 v17, v17
    v_exp_f32 v18, v18
    v_exp_f32 v19, v19
    v_mfma_f32_32x32x16_bf16 v[64:79], a[252:255], v[84:87], v[64:79]
    ds_read_b128 a[252:255], v95 offset:57568
    v_exp_f32 v20, v20
    v_exp_f32 v21, v21
    v_exp_f32 v22, v22
    v_exp_f32 v23, v23
    v_cvt_pk_bf16_f32 v80, v16, v17
    v_cvt_pk_bf16_f32 v81, v18, v19
    v_cvt_pk_bf16_f32 v82, v20, v21
    v_cvt_pk_bf16_f32 v83, v22, v23
    v_exp_f32 v24, v24
    v_exp_f32 v25, v25
    v_mfma_f32_32x32x16_bf16 v[48:63], a[240:243], v[80:83], v[48:63]
    buffer_load_dwordx2 v[14:15], v104, s[8:11], s83 offen offset:16
    v_exp_f32 v26, v26
    v_exp_f32 v27, v27
    v_exp_f32 v28, v28
    v_exp_f32 v29, v29
    v_exp_f32 v30, v30
    v_exp_f32 v31, v31
    v_cvt_pk_bf16_f32 v84, v24, v25
    v_cvt_pk_bf16_f32 v85, v26, v27
    v_cvt_pk_bf16_f32 v86, v28, v29
    v_cvt_pk_bf16_f32 v87, v30, v31
    v_mfma_f32_32x32x16_bf16 v[16:31], a[236:239], v[96:99], 0
    v_exp_f32 v32, v32
    v_exp_f32 v33, v33
    v_exp_f32 v34, v34
    v_exp_f32 v35, v35
    v_mfma_f32_32x32x16_bf16 v[48:63], a[248:251], v[84:87], v[48:63]
    v_exp_f32 v36, v36
    v_exp_f32 v37, v37
    v_exp_f32 v38, v38
    v_exp_f32 v39, v39
    v_cvt_pk_bf16_f32 v80, v32, v33
    v_cvt_pk_bf16_f32 v81, v34, v35
    v_cvt_pk_bf16_f32 v82, v36, v37
    v_cvt_pk_bf16_f32 v83, v38, v39
    v_exp_f32 v40, v40
    v_exp_f32 v41, v41
    v_mfma_f32_32x32x16_bf16 v[64:79], a[240:243], v[80:83], v[64:79]
    ds_read_b128 a[240:243], v92 offset:61680
    v_exp_f32 v42, v42
    v_exp_f32 v43, v43
    v_exp_f32 v44, v44
    v_exp_f32 v45, v45
    v_exp_f32 v46, v46
    v_exp_f32 v47, v47
    v_cvt_pk_bf16_f32 v84, v40, v41
    v_cvt_pk_bf16_f32 v85, v42, v43
    v_cvt_pk_bf16_f32 v86, v44, v45
    v_cvt_pk_bf16_f32 v87, v46, v47
    s_waitcnt lgkmcnt(1)
    v_mfma_f32_32x32x16_bf16 v[32:47], a[236:239], a[228:231], 0
    ds_read_b128 a[236:239], v2 offset:63984
    v_exp_f32 v16, v16
    v_exp_f32 v17, v17
    v_exp_f32 v18, v18
    v_exp_f32 v19, v19
    v_mfma_f32_32x32x16_bf16 v[64:79], a[248:251], v[84:87], v[64:79]
    ds_read_b128 a[248:251], v93 offset:61680
    v_exp_f32 v20, v20
    v_exp_f32 v21, v21
    v_exp_f32 v22, v22
    v_exp_f32 v23, v23
    v_cvt_pk_bf16_f32 v80, v16, v17
    v_cvt_pk_bf16_f32 v81, v18, v19
    v_cvt_pk_bf16_f32 v82, v20, v21
    v_cvt_pk_bf16_f32 v83, v22, v23
    v_exp_f32 v24, v24
    v_exp_f32 v25, v25
    v_mfma_f32_32x32x16_bf16 v[48:63], a[244:247], v[80:83], v[48:63]
    v_exp_f32 v26, v26
    v_exp_f32 v27, v27
    v_exp_f32 v28, v28
    v_exp_f32 v29, v29
    v_exp_f32 v30, v30
    v_exp_f32 v31, v31
    v_cvt_pk_bf16_f32 v84, v24, v25
    v_cvt_pk_bf16_f32 v85, v26, v27
    v_cvt_pk_bf16_f32 v86, v28, v29
    v_cvt_pk_bf16_f32 v87, v30, v31
    v_mfma_f32_32x32x16_bf16 v[16:31], a[232:235], v[96:99], 0
    v_exp_f32 v32, v32
    v_exp_f32 v33, v33
    v_exp_f32 v34, v34
    v_exp_f32 v35, v35
    v_mfma_f32_32x32x16_bf16 v[48:63], a[252:255], v[84:87], v[48:63]
    v_exp_f32 v36, v36
    v_exp_f32 v37, v37
    v_exp_f32 v38, v38
    v_exp_f32 v39, v39
    v_cvt_pk_bf16_f32 v80, v32, v33
    v_cvt_pk_bf16_f32 v81, v34, v35
    v_cvt_pk_bf16_f32 v82, v36, v37
PAD8:
    s_cbranch_execz WARM0_8
    v_cvt_pk_bf16_f32 v83, v38, v39
    v_exp_f32 v40, v40
    v_exp_f32 v41, v41
    v_mfma_f32_32x32x16_bf16 v[64:79], a[244:247], v[80:83], v[64:79]
    ds_read_b128 a[244:247], v94 offset:61680
    v_exp_f32 v42, v42
    v_exp_f32 v43, v43
    v_exp_f32 v44, v44
    v_exp_f32 v45, v45
    v_exp_f32 v46, v46
    v_exp_f32 v47, v47
    v_cvt_pk_bf16_f32 v84, v40, v41
    v_cvt_pk_bf16_f32 v85, v42, v43
    v_cvt_pk_bf16_f32 v86, v44, v45
    v_cvt_pk_bf16_f32 v87, v46, v47
    s_waitcnt lgkmcnt(1)
    v_mfma_f32_32x32x16_bf16 v[32:47], a[232:235], a[228:231], 0
    ds_read_b128 a[232:235], v1 offset:0
    v_exp_f32 v16, v16
    v_exp_f32 v17, v17
    v_exp_f32 v18, v18
    v_exp_f32 v19, v19
    v_mfma_f32_32x32x16_bf16 v[64:79], a[252:255], v[84:87], v[64:79]
    ds_read_b128 a[252:255], v95 offset:61680
    v_exp_f32 v20, v20
    v_exp_f32 v21, v21
    v_exp_f32 v22, v22
    v_exp_f32 v23, v23
    v_cvt_pk_bf16_f32 v80, v16, v17
    v_cvt_pk_bf16_f32 v81, v18, v19
    v_cvt_pk_bf16_f32 v82, v20, v21
    v_cvt_pk_bf16_f32 v83, v22, v23
    v_exp_f32 v24, v24
    v_exp_f32 v25, v25
    v_mfma_f32_32x32x16_bf16 v[48:63], a[240:243], v[80:83], v[48:63]
    v_exp_f32 v26, v26
    v_exp_f32 v27, v27
    v_exp_f32 v28, v28
    v_exp_f32 v29, v29
    v_exp_f32 v30, v30
    v_exp_f32 v31, v31
    v_cvt_pk_bf16_f32 v84, v24, v25
    v_cvt_pk_bf16_f32 v85, v26, v27
    v_cvt_pk_bf16_f32 v86, v28, v29
    v_cvt_pk_bf16_f32 v87, v30, v31
    v_mfma_f32_32x32x16_bf16 v[16:31], a[236:239], v[96:99], 0
    v_exp_f32 v32, v32
    v_exp_f32 v33, v33
    v_exp_f32 v34, v34
    v_exp_f32 v35, v35
    v_mfma_f32_32x32x16_bf16 v[48:63], a[248:251], v[84:87], v[48:63]
    v_exp_f32 v36, v36
    v_exp_f32 v37, v37
    v_exp_f32 v38, v38
    v_exp_f32 v39, v39
    v_cvt_pk_bf16_f32 v80, v32, v33
    v_cvt_pk_bf16_f32 v81, v34, v35
    v_cvt_pk_bf16_f32 v82, v36, v37
    v_cvt_pk_bf16_f32 v83, v38, v39
    v_exp_f32 v40, v40
    v_exp_f32 v41, v41
    v_mfma_f32_32x32x16_bf16 v[64:79], a[240:243], v[80:83], v[64:79]
    ds_read_b128 a[240:243], v88 offset:0
    v_exp_f32 v42, v42
    v_exp_f32 v43, v43
    v_exp_f32 v44, v44
    v_exp_f32 v45, v45
    v_exp_f32 v46, v46
    v_exp_f32 v47, v47
    v_cvt_pk_bf16_f32 v84, v40, v41
    v_cvt_pk_bf16_f32 v85, v42, v43
    v_cvt_pk_bf16_f32 v86, v44, v45
    v_cvt_pk_bf16_f32 v87, v46, v47
    s_waitcnt lgkmcnt(1)
    v_mfma_f32_32x32x16_bf16 v[32:47], a[236:239], a[228:231], 0
    ds_read_b128 a[236:239], v1 offset:2048
    v_exp_f32 v16, v16
    v_exp_f32 v17, v17
    v_exp_f32 v18, v18
    v_exp_f32 v19, v19
    v_mfma_f32_32x32x16_bf16 v[64:79], a[248:251], v[84:87], v[64:79]
    ds_read_b128 a[248:251], v89 offset:0
    s_waitcnt vmcnt(8)
    ds_read_b64_tr_b16 a[210:211], v102 offset:49344
    ds_read_b64_tr_b16 a[214:215], v103 offset:49344
    s_waitcnt vmcnt(7)
    ds_read_b64_tr_b16 a[216:217], v102 offset:50368
    ds_read_b64_tr_b16 a[220:221], v103 offset:50368
    v_exp_f32 v20, v20
    v_exp_f32 v21, v21
    v_exp_f32 v22, v22
    v_exp_f32 v23, v23
    v_cvt_pk_bf16_f32 v80, v16, v17
    v_cvt_pk_bf16_f32 v81, v18, v19
    v_cvt_pk_bf16_f32 v82, v20, v21
    v_cvt_pk_bf16_f32 v83, v22, v23
    v_exp_f32 v24, v24
    v_exp_f32 v25, v25
    v_mfma_f32_32x32x16_bf16 v[48:63], a[244:247], v[80:83], v[48:63]
    v_exp_f32 v26, v26
    v_exp_f32 v27, v27
    v_exp_f32 v28, v28
    v_exp_f32 v29, v29
    v_exp_f32 v30, v30
    v_exp_f32 v31, v31
    v_cvt_pk_bf16_f32 v84, v24, v25
    v_cvt_pk_bf16_f32 v85, v26, v27
    v_cvt_pk_bf16_f32 v86, v28, v29
    v_cvt_pk_bf16_f32 v87, v30, v31
    v_mfma_f32_32x32x16_bf16 v[16:31], a[232:235], a[228:231], 0
    ds_read_b128 a[232:235], v1 offset:4112
    v_exp_f32 v32, v32
    v_exp_f32 v33, v33
    v_exp_f32 v34, v34
    v_exp_f32 v35, v35
    v_mfma_f32_32x32x16_bf16 v[48:63], a[252:255], v[84:87], v[48:63]
    s_waitcnt vmcnt(6)
    ds_read_b64_tr_b16 a[218:219], v102 offset:51392
    ds_read_b64_tr_b16 a[222:223], v103 offset:51392
    v_exp_f32 v36, v36
    v_exp_f32 v37, v37
    v_exp_f32 v38, v38
    v_exp_f32 v39, v39
    v_cvt_pk_bf16_f32 v80, v32, v33
    v_cvt_pk_bf16_f32 v81, v34, v35
    v_cvt_pk_bf16_f32 v82, v36, v37
    v_cvt_pk_bf16_f32 v83, v38, v39
    v_exp_f32 v40, v40
    v_exp_f32 v41, v41
    v_mfma_f32_32x32x16_bf16 v[64:79], a[244:247], v[80:83], v[64:79]
    ds_read_b128 a[244:247], v90 offset:0
    v_exp_f32 v42, v42
    v_exp_f32 v43, v43
    v_exp_f32 v44, v44
    v_exp_f32 v45, v45
    v_exp_f32 v46, v46
    v_exp_f32 v47, v47
    v_cvt_pk_bf16_f32 v84, v40, v41
    v_cvt_pk_bf16_f32 v85, v42, v43
    v_cvt_pk_bf16_f32 v86, v44, v45
    v_cvt_pk_bf16_f32 v87, v46, v47
    s_waitcnt lgkmcnt(9)
    v_mfma_f32_32x32x16_bf16 v[32:47], a[236:239], a[228:231], 0
    ds_read_b128 a[236:239], v1 offset:6160
    v_exp_f32 v16, v16
    v_exp_f32 v17, v17
    v_exp_f32 v18, v18
    v_exp_f32 v19, v19
    v_mfma_f32_32x32x16_bf16 v[64:79], a[252:255], v[84:87], v[64:79]
    ds_read_b128 a[252:255], v91 offset:0
    v_subrev_u32 v7, 0x21800000, v56
    v_cmp_lt_u32 vcc, 0x32000000, v7
    s_mov_b64 s[54:55], vcc
    v_rcp_f32 v57, v56
    s_nop 0
    v_mul_f32 v48, v48, v57
    v_mul_f32 v49, v49, v57
    v_mul_f32 v50, v50, v57
    v_mul_f32 v51, v51, v57
    v_mul_f32 v52, v52, v57
    v_mul_f32 v53, v53, v57
    v_mul_f32 v54, v54, v57
    v_mul_f32 v55, v55, v57
    v_cvt_pk_bf16_f32 v48, v48, v49
    v_cvt_pk_bf16_f32 v49, v50, v51
    v_cvt_pk_bf16_f32 v50, v52, v53
    v_cvt_pk_bf16_f32 v51, v54, v55
    s_not_b64 exec, s[54:55]
    s_add_u32 s84, s30, 0x800000
    buffer_store_dwordx4 v[48:51], v1, s[4:7], s84 offen sc1
    s_mov_b64 exec, -1
    v_exp_f32 v20, v20
    v_exp_f32 v21, v21
    v_exp_f32 v22, v22
    v_exp_f32 v23, v23
    v_cvt_pk_bf16_f32 v80, v16, v17
    v_cvt_pk_bf16_f32 v81, v18, v19
    v_cvt_pk_bf16_f32 v82, v20, v21
    v_cvt_pk_bf16_f32 v83, v22, v23
    v_exp_f32 v24, v24
    v_exp_f32 v25, v25
    v_mfma_f32_32x32x16_bf16 v[64:79], a[240:243], v[80:83], v[64:79]
    ds_read_b128 a[240:243], v88 offset:4112
    v_exp_f32 v26, v26
    v_exp_f32 v27, v27
    v_exp_f32 v28, v28
    v_exp_f32 v29, v29
    v_exp_f32 v30, v30
    v_exp_f32 v31, v31
    v_cvt_pk_bf16_f32 v84, v24, v25
    v_cvt_pk_bf16_f32 v85, v26, v27
    v_cvt_pk_bf16_f32 v86, v28, v29
    v_cvt_pk_bf16_f32 v87, v30, v31
    s_waitcnt lgkmcnt(3)
    v_mfma_f32_32x32x16_bf16 v[16:31], a[232:235], a[228:231], 0
    ds_read_b128 a[232:235], v1 offset:8224
    v_exp_f32 v32, v32
    v_exp_f32 v33, v33
    v_exp_f32 v34, v34
    v_exp_f32 v35, v35
    v_mfma_f32_32x32x16_bf16 v[64:79], a[248:251], v[84:87], v[64:79]
    ds_read_b128 a[248:251], v89 offset:4112
    v_lshlrev_b32 v104, 4, v1
    s_mov_b32 s80, 0x5f0000
    buffer_load_dword v105, v104, s[4:7], s80 offen sc1
    v_exp_f32 v36, v36
    v_exp_f32 v37, v37
    v_exp_f32 v38, v38
    v_exp_f32 v39, v39
    v_cvt_pk_bf16_f32 v80, v32, v33
    v_cvt_pk_bf16_f32 v81, v34, v35
    v_cvt_pk_bf16_f32 v82, v36, v37
    v_cvt_pk_bf16_f32 v83, v38, v39
    v_exp_f32 v40, v40
    v_exp_f32 v41, v41
    v_mfma_f32_32x32x16_bf16 v[64:79], a[244:247], v[80:83], v[64:79]
    ds_read_b128 a[244:247], v90 offset:4112
    v_exp_f32 v42, v42
    v_exp_f32 v43, v43
    v_exp_f32 v44, v44
    v_exp_f32 v45, v45
    v_exp_f32 v46, v46
    v_exp_f32 v47, v47
    v_cvt_pk_bf16_f32 v84, v40, v41
    v_cvt_pk_bf16_f32 v85, v42, v43
    v_cvt_pk_bf16_f32 v86, v44, v45
    v_cvt_pk_bf16_f32 v87, v46, v47
    s_waitcnt lgkmcnt(3)
    v_mfma_f32_32x32x16_bf16 v[32:47], a[236:239], a[228:231], 0
    ds_read_b128 a[236:239], v1 offset:10272
    v_exp_f32 v16, v16
    v_exp_f32 v17, v17
    v_exp_f32 v18, v18
    v_exp_f32 v19, v19
    v_mfma_f32_32x32x16_bf16 v[64:79], a[252:255], v[84:87], v[64:79]
    ds_read_b128 a[252:255], v91 offset:4112
    v_exp_f32 v20, v20
    v_exp_f32 v21, v21
    v_exp_f32 v22, v22
    v_exp_f32 v23, v23
    v_cvt_pk_bf16_f32 v80, v16, v17
    v_cvt_pk_bf16_f32 v81, v18, v19
    v_cvt_pk_bf16_f32 v82, v20, v21
    v_cvt_pk_bf16_f32 v83, v22, v23
    v_exp_f32 v24, v24
    v_exp_f32 v25, v25
    v_mfma_f32_32x32x16_bf16 v[64:79], a[240:243], v[80:83], v[64:79]
    ds_read_b128 a[240:243], v88 offset:8224
    v_exp_f32 v26, v26
    v_exp_f32 v27, v27
    v_exp_f32 v28, v28
    v_exp_f32 v29, v29
    v_exp_f32 v30, v30
    v_exp_f32 v31, v31
    v_cvt_pk_bf16_f32 v84, v24, v25
    v_cvt_pk_bf16_f32 v85, v26, v27
    v_cvt_pk_bf16_f32 v86, v28, v29
    v_cvt_pk_bf16_f32 v87, v30, v31
    s_waitcnt lgkmcnt(3)
    v_mfma_f32_32x32x16_bf16 v[16:31], a[232:235], a[228:231], 0
    ds_read_b128 a[232:235], v1 offset:12336
    v_exp_f32 v32, v32
    v_exp_f32 v33, v33
    v_exp_f32 v34, v34
    v_exp_f32 v35, v35
    v_mfma_f32_32x32x16_bf16 v[64:79], a[248:251], v[84:87], v[64:79]
    ds_read_b128 a[248:251], v89 offset:8224
    v_exp_f32 v36, v36
    v_exp_f32 v37, v37
    v_exp_f32 v38, v38
    v_exp_f32 v39, v39
    v_cvt_pk_bf16_f32 v80, v32, v33
    v_cvt_pk_bf16_f32 v81, v34, v35
    v_cvt_pk_bf16_f32 v82, v36, v37
    v_cvt_pk_bf16_f32 v83, v38, v39
    v_exp_f32 v40, v40
    v_exp_f32 v41, v41
    v_mfma_f32_32x32x16_bf16 v[64:79], a[244:247], v[80:83], v[64:79]
    ds_read_b128 a[244:247], v90 offset:8224
    v_exp_f32 v42, v42
    v_exp_f32 v43, v43
    v_exp_f32 v44, v44
    v_exp_f32 v45, v45
    v_exp_f32 v46, v46
    v_exp_f32 v47, v47
    v_cvt_pk_bf16_f32 v84, v40, v41
    v_cvt_pk_bf16_f32 v85, v42, v43
    v_cvt_pk_bf16_f32 v86, v44, v45
    v_cvt_pk_bf16_f32 v87, v46, v47
    s_waitcnt lgkmcnt(3)
    v_mfma_f32_32x32x16_bf16 v[32:47], a[236:239], a[228:231], 0
    ds_read_b128 a[236:239], v1 offset:14384
    v_exp_f32 v16, v16
    v_exp_f32 v17, v17
    v_exp_f32 v18, v18
    v_exp_f32 v19, v19
    v_mfma_f32_32x32x16_bf16 v[64:79], a[252:255], v[84:87], v[64:79]
    ds_read_b128 a[252:255], v91 offset:8224
    v_exp_f32 v20, v20
    v_exp_f32 v21, v21
    v_exp_f32 v22, v22
    v_exp_f32 v23, v23
    v_cvt_pk_bf16_f32 v80, v16, v17
    v_cvt_pk_bf16_f32 v81, v18, v19
    v_cvt_pk_bf16_f32 v82, v20, v21
    v_cvt_pk_bf16_f32 v83, v22, v23
    v_exp_f32 v24, v24
    v_exp_f32 v25, v25
    v_mfma_f32_32x32x16_bf16 v[64:79], a[240:243], v[80:83], v[64:79]
    ds_read_b128 a[240:243], v88 offset:12336
    v_exp_f32 v26, v26
    v_exp_f32 v27, v27
    v_exp_f32 v28, v28
    v_exp_f32 v29, v29
    v_exp_f32 v30, v30
    v_exp_f32 v31, v31
    v_cvt_pk_bf16_f32 v84, v24, v25
    v_cvt_pk_bf16_f32 v85, v26, v27
    v_cvt_pk_bf16_f32 v86, v28, v29
    v_cvt_pk_bf16_f32 v87, v30, v31
    s_waitcnt lgkmcnt(3)
    v_mfma_f32_32x32x16_bf16 v[16:31], a[232:235], a[228:231], 0
    ds_read_b128 a[232:235], v1 offset:16448
    v_exp_f32 v32, v32
    v_exp_f32 v33, v33
    v_exp_f32 v34, v34
    v_exp_f32 v35, v35
    v_mfma_f32_32x32x16_bf16 v[64:79], a[248:251], v[84:87], v[64:79]
    ds_read_b128 a[248:251], v89 offset:12336
    v_exp_f32 v36, v36
    v_exp_f32 v37, v37
    v_exp_f32 v38, v38
    v_exp_f32 v39, v39
    v_cvt_pk_bf16_f32 v80, v32, v33
    v_cvt_pk_bf16_f32 v81, v34, v35
    v_cvt_pk_bf16_f32 v82, v36, v37
    v_cvt_pk_bf16_f32 v83, v38, v39
    v_exp_f32 v40, v40
    v_exp_f32 v41, v41
    v_mfma_f32_32x32x16_bf16 v[64:79], a[244:247], v[80:83], v[64:79]
    ds_read_b128 a[244:247], v90 offset:12336
    v_exp_f32 v42, v42
    v_exp_f32 v43, v43
    v_exp_f32 v44, v44
    v_exp_f32 v45, v45
    v_exp_f32 v46, v46
    v_exp_f32 v47, v47
    v_cvt_pk_bf16_f32 v84, v40, v41
    v_cvt_pk_bf16_f32 v85, v42, v43
    v_cvt_pk_bf16_f32 v86, v44, v45
    v_cvt_pk_bf16_f32 v87, v46, v47
    s_waitcnt lgkmcnt(3)
    v_mfma_f32_32x32x16_bf16 v[32:47], a[236:239], a[228:231], 0
    ds_read_b128 a[236:239], v1 offset:18496
    v_exp_f32 v16, v16
    v_exp_f32 v17, v17
    v_exp_f32 v18, v18
    v_exp_f32 v19, v19
    v_mfma_f32_32x32x16_bf16 v[64:79], a[252:255], v[84:87], v[64:79]
    ds_read_b128 a[252:255], v91 offset:12336
    v_exp_f32 v20, v20
    v_exp_f32 v21, v21
    v_exp_f32 v22, v22
    v_exp_f32 v23, v23
    v_cvt_pk_bf16_f32 v80, v16, v17
    v_cvt_pk_bf16_f32 v81, v18, v19
    v_cvt_pk_bf16_f32 v82, v20, v21
    v_cvt_pk_bf16_f32 v83, v22, v23
    v_exp_f32 v24, v24
    v_exp_f32 v25, v25
    v_mfma_f32_32x32x16_bf16 v[64:79], a[240:243], v[80:83], v[64:79]
    ds_read_b128 a[240:243], v88 offset:16448
    v_exp_f32 v26, v26
    v_exp_f32 v27, v27
    v_exp_f32 v28, v28
    v_exp_f32 v29, v29
    v_exp_f32 v30, v30
    v_exp_f32 v31, v31
    v_cvt_pk_bf16_f32 v84, v24, v25
    v_cvt_pk_bf16_f32 v85, v26, v27
    v_cvt_pk_bf16_f32 v86, v28, v29
    v_cvt_pk_bf16_f32 v87, v30, v31
    s_waitcnt lgkmcnt(3)
    v_mfma_f32_32x32x16_bf16 v[16:31], a[232:235], a[228:231], 0
    ds_read_b128 a[232:235], v1 offset:20560
    v_exp_f32 v32, v32
    v_exp_f32 v33, v33
    v_exp_f32 v34, v34
    v_exp_f32 v35, v35
    v_mfma_f32_32x32x16_bf16 v[64:79], a[248:251], v[84:87], v[64:79]
    ds_read_b128 a[248:251], v89 offset:16448
    v_exp_f32 v36, v36
    v_exp_f32 v37, v37
    v_exp_f32 v38, v38
    v_exp_f32 v39, v39
    v_cvt_pk_bf16_f32 v80, v32, v33
    v_cvt_pk_bf16_f32 v81, v34, v35
    v_cvt_pk_bf16_f32 v82, v36, v37
    v_cvt_pk_bf16_f32 v83, v38, v39
    v_exp_f32 v40, v40
    v_exp_f32 v41, v41
    v_mfma_f32_32x32x16_bf16 v[64:79], a[244:247], v[80:83], v[64:79]
    ds_read_b128 a[244:247], v90 offset:16448
    v_exp_f32 v42, v42
    v_exp_f32 v43, v43
    v_exp_f32 v44, v44
    v_exp_f32 v45, v45
    v_exp_f32 v46, v46
    v_exp_f32 v47, v47
    v_cvt_pk_bf16_f32 v84, v40, v41
    v_cvt_pk_bf16_f32 v85, v42, v43
    v_cvt_pk_bf16_f32 v86, v44, v45
    v_cvt_pk_bf16_f32 v87, v46, v47
    s_waitcnt lgkmcnt(3)
    v_mfma_f32_32x32x16_bf16 v[32:47], a[236:239], a[228:231], 0
    ds_read_b128 a[236:239], v1 offset:22608
    v_exp_f32 v16, v16
    v_exp_f32 v17, v17
    v_exp_f32 v18, v18
    v_exp_f32 v19, v19
    v_mfma_f32_32x32x16_bf16 v[64:79], a[252:255], v[84:87], v[64:79]
    ds_read_b128 a[252:255], v91 offset:16448
    s_waitcnt vmcnt(0)
    v_cmp_ne_u32 vcc, 16, v105
    s_cbranch_vccnz Lre14
Lok14:
    ds_read_b64_tr_b16 a[224:225], v4 offset:0
    ds_read_b64_tr_b16 a[226:227], v4 offset:1024
    v_exp_f32 v20, v20
    v_exp_f32 v21, v21
    v_exp_f32 v22, v22
    v_exp_f32 v23, v23
    v_cvt_pk_bf16_f32 v80, v16, v17
    v_cvt_pk_bf16_f32 v81, v18, v19
    v_cvt_pk_bf16_f32 v82, v20, v21
    v_cvt_pk_bf16_f32 v83, v22, v23
    v_exp_f32 v24, v24
    v_exp_f32 v25, v25
    v_mfma_f32_32x32x16_bf16 v[64:79], a[240:243], v[80:83], v[64:79]
    ds_read_b128 a[240:243], v88 offset:20560
    v_exp_f32 v26, v26
    v_exp_f32 v27, v27
    v_exp_f32 v28, v28
    v_exp_f32 v29, v29
    v_exp_f32 v30, v30
    v_exp_f32 v31, v31
    v_cvt_pk_bf16_f32 v84, v24, v25
    v_cvt_pk_bf16_f32 v85, v26, v27
    v_cvt_pk_bf16_f32 v86, v28, v29
    v_cvt_pk_bf16_f32 v87, v30, v31
    s_waitcnt lgkmcnt(5)
    v_mfma_f32_32x32x16_bf16 v[16:31], a[232:235], a[228:231], 0
    ds_read_b128 a[232:235], v1 offset:24672
    s_add_u32 s81, s17, 0x1000000
    buffer_load_dwordx4 v[48:51], v1, s[4:7], s81 offen sc1
    v_exp_f32 v32, v32
    v_exp_f32 v33, v33
    v_exp_f32 v34, v34
    v_exp_f32 v35, v35
    v_mfma_f32_32x32x16_bf16 v[64:79], a[248:251], v[84:87], v[64:79]
    ds_read_b128 a[248:251], v89 offset:20560
    v_exp_f32 v36, v36
    v_exp_f32 v37, v37
    v_exp_f32 v38, v38
    v_exp_f32 v39, v39
    v_cvt_pk_bf16_f32 v80, v32, v33
    v_cvt_pk_bf16_f32 v81, v34, v35
    v_cvt_pk_bf16_f32 v82, v36, v37
    v_cvt_pk_bf16_f32 v83, v38, v39
    v_exp_f32 v40, v40
    v_exp_f32 v41, v41
    v_mfma_f32_32x32x16_bf16 v[64:79], a[244:247], v[80:83], v[64:79]
    ds_read_b128 a[244:247], v90 offset:20560
    buffer_load_dwordx4 v[52:55], v1, s[4:7], s81 offen offset:1024 sc1
    v_exp_f32 v42, v42
    v_exp_f32 v43, v43
    v_exp_f32 v44, v44
    v_exp_f32 v45, v45
    v_exp_f32 v46, v46
    v_exp_f32 v47, v47
    v_cvt_pk_bf16_f32 v84, v40, v41
    v_cvt_pk_bf16_f32 v85, v42, v43
    v_cvt_pk_bf16_f32 v86, v44, v45
    v_cvt_pk_bf16_f32 v87, v46, v47
    s_waitcnt lgkmcnt(3)
    v_mfma_f32_32x32x16_bf16 v[32:47], a[236:239], a[228:231], 0
    ds_read_b128 a[236:239], v1 offset:26720
    buffer_load_dwordx4 v[56:59], v1, s[4:7], s81 offen offset:2048 sc1
    v_exp_f32 v16, v16
    v_exp_f32 v17, v17
    v_exp_f32 v18, v18
    v_exp_f32 v19, v19
    v_mfma_f32_32x32x16_bf16 v[64:79], a[252:255], v[84:87], v[64:79]
    ds_read_b128 a[252:255], v91 offset:20560
    v_exp_f32 v20, v20
    v_exp_f32 v21, v21
    v_exp_f32 v22, v22
    v_exp_f32 v23, v23
    v_cvt_pk_bf16_f32 v80, v16, v17
    v_cvt_pk_bf16_f32 v81, v18, v19
    v_cvt_pk_bf16_f32 v82, v20, v21
    v_cvt_pk_bf16_f32 v83, v22, v23
    v_exp_f32 v24, v24
    v_exp_f32 v25, v25
    v_mfma_f32_32x32x16_bf16 v[64:79], a[240:243], v[80:83], v[64:79]
    ds_read_b128 a[240:243], v88 offset:24672
    buffer_load_dwordx4 v[60:63], v1, s[4:7], s81 offen offset:3072 sc1
    v_exp_f32 v26, v26
    v_exp_f32 v27, v27
    v_exp_f32 v28, v28
    v_exp_f32 v29, v29
    v_exp_f32 v30, v30
    v_exp_f32 v31, v31
    v_cvt_pk_bf16_f32 v84, v24, v25
    v_cvt_pk_bf16_f32 v85, v26, v27
    v_cvt_pk_bf16_f32 v86, v28, v29
    v_cvt_pk_bf16_f32 v87, v30, v31
    s_waitcnt lgkmcnt(3)
    v_mfma_f32_32x32x16_bf16 v[16:31], a[232:235], a[228:231], 0
    ds_read_b128 a[232:235], v1 offset:28784
    s_add_u32 s85, s17, 0x1001000
    buffer_load_dwordx4 v[96:99], v1, s[4:7], s85 offen sc1
    v_exp_f32 v32, v32
    v_exp_f32 v33, v33
    v_exp_f32 v34, v34
    v_exp_f32 v35, v35
    v_mfma_f32_32x32x16_bf16 v[64:79], a[248:251], v[84:87], v[64:79]
    ds_read_b128 a[248:251], v89 offset:24672
    v_exp_f32 v36, v36
    v_exp_f32 v37, v37
    v_exp_f32 v38, v38
    v_exp_f32 v39, v39
    v_cvt_pk_bf16_f32 v80, v32, v33
    v_cvt_pk_bf16_f32 v81, v34, v35
    v_cvt_pk_bf16_f32 v82, v36, v37
    v_cvt_pk_bf16_f32 v83, v38, v39
    v_exp_f32 v40, v40
    v_exp_f32 v41, v41
    v_mfma_f32_32x32x16_bf16 v[64:79], a[244:247], v[80:83], v[64:79]
    ds_read_b128 a[244:247], v90 offset:24672
    buffer_load_dwordx4 v[100:103], v1, s[4:7], s85 offen offset:1024 sc1
    v_exp_f32 v42, v42
    v_exp_f32 v43, v43
    v_exp_f32 v44, v44
    v_exp_f32 v45, v45
    v_exp_f32 v46, v46
    v_exp_f32 v47, v47
    v_cvt_pk_bf16_f32 v84, v40, v41
    v_cvt_pk_bf16_f32 v85, v42, v43
    v_cvt_pk_bf16_f32 v86, v44, v45
    v_cvt_pk_bf16_f32 v87, v46, v47
    s_waitcnt lgkmcnt(3)
    v_mfma_f32_32x32x16_bf16 v[32:47], a[236:239], a[228:231], 0
    ds_read_b128 a[236:239], v1 offset:30832
    buffer_load_dwordx4 v[104:107], v1, s[4:7], s85 offen offset:2048 sc1
    v_exp_f32 v16, v16
    v_exp_f32 v17, v17
    v_exp_f32 v18, v18
    v_exp_f32 v19, v19
    v_mfma_f32_32x32x16_bf16 v[64:79], a[252:255], v[84:87], v[64:79]
    ds_read_b128 a[252:255], v91 offset:24672
    v_exp_f32 v20, v20
    v_exp_f32 v21, v21
    v_exp_f32 v22, v22
    v_exp_f32 v23, v23
    v_cvt_pk_bf16_f32 v80, v16, v17
    v_cvt_pk_bf16_f32 v81, v18, v19
    v_cvt_pk_bf16_f32 v82, v20, v21
    v_cvt_pk_bf16_f32 v83, v22, v23
    v_exp_f32 v24, v24
    v_exp_f32 v25, v25
    v_mfma_f32_32x32x16_bf16 v[64:79], a[240:243], v[80:83], v[64:79]
    ds_read_b128 a[240:243], v88 offset:28784
    buffer_load_dwordx4 v[108:111], v1, s[4:7], s85 offen offset:3072 sc1
    v_exp_f32 v26, v26
    v_exp_f32 v27, v27
    v_exp_f32 v28, v28
    v_exp_f32 v29, v29
    v_exp_f32 v30, v30
    v_exp_f32 v31, v31
    v_cvt_pk_bf16_f32 v84, v24, v25
    v_cvt_pk_bf16_f32 v85, v26, v27
    v_cvt_pk_bf16_f32 v86, v28, v29
    v_cvt_pk_bf16_f32 v87, v30, v31
    s_waitcnt lgkmcnt(3)
    v_mfma_f32_32x32x16_bf16 v[16:31], a[232:235], a[228:231], 0
    ds_read_b64_tr_b16 a[232:233], v124 offset:0
    ds_read_b64_tr_b16 a[234:235], v124 offset:1024
    v_exp_f32 v32, v32
    v_exp_f32 v33, v33
    v_exp_f32 v34, v34
    v_exp_f32 v35, v35
    v_mfma_f32_32x32x16_bf16 v[64:79], a[248:251], v[84:87], v[64:79]
    ds_read_b128 a[248:251], v89 offset:28784
    v_exp_f32 v36, v36
    v_exp_f32 v37, v37
    v_exp_f32 v38, v38
    v_exp_f32 v39, v39
    v_cvt_pk_bf16_f32 v80, v32, v33
    v_cvt_pk_bf16_f32 v81, v34, v35
    v_cvt_pk_bf16_f32 v82, v36, v37
    v_cvt_pk_bf16_f32 v83, v38, v39
    v_exp_f32 v40, v40
    v_exp_f32 v41, v41
    v_mfma_f32_32x32x16_bf16 v[64:79], a[244:247], v[80:83], v[64:79]
    ds_read_b128 a[244:247], v90 offset:28784
    v_exp_f32 v42, v42
    v_exp_f32 v43, v43
    v_exp_f32 v44, v44
    v_exp_f32 v45, v45
    v_exp_f32 v46, v46
    v_exp_f32 v47, v47
    v_cvt_pk_bf16_f32 v84, v40, v41
    v_cvt_pk_bf16_f32 v85, v42, v43
    v_cvt_pk_bf16_f32 v86, v44, v45
    v_cvt_pk_bf16_f32 v87, v46, v47
    s_waitcnt lgkmcnt(4)
    v_mfma_f32_32x32x16_bf16 v[32:47], a[236:239], a[228:231], 0
    ds_read_b64_tr_b16 a[236:237], v4 offset:2048
    ds_read_b64_tr_b16 a[238:239], v4 offset:3072
    ds_read_b64_tr_b16 a[228:229], v124 offset:2048
    ds_read_b64_tr_b16 a[230:231], v124 offset:3072
    v_exp_f32 v16, v16
    v_exp_f32 v17, v17
    v_exp_f32 v18, v18
    v_exp_f32 v19, v19
    v_mfma_f32_32x32x16_bf16 v[64:79], a[252:255], v[84:87], v[64:79]
    ds_read_b128 a[252:255], v91 offset:28784
    v_exp_f32 v20, v20
    v_exp_f32 v21, v21
    v_exp_f32 v22, v22
    v_exp_f32 v23, v23
    v_cvt_pk_bf16_f32 v80, v16, v17
    v_cvt_pk_bf16_f32 v81, v18, v19
    v_cvt_pk_bf16_f32 v82, v20, v21
    v_cvt_pk_bf16_f32 v83, v22, v23
    v_exp_f32 v24, v24
    v_exp_f32 v25, v25
    v_mfma_f32_32x32x16_bf16 v[64:79], a[240:243], v[80:83], v[64:79]
    ds_read_b64_tr_b16 a[240:241], v4 offset:16448
    ds_read_b64_tr_b16 a[242:243], v4 offset:17472
    v_exp_f32 v26, v26
    v_exp_f32 v27, v27
    v_exp_f32 v28, v28
    v_exp_f32 v29, v29
    v_exp_f32 v30, v30
    v_exp_f32 v31, v31
    v_cvt_pk_bf16_f32 v84, v24, v25
    v_cvt_pk_bf16_f32 v85, v26, v27
    v_cvt_pk_bf16_f32 v86, v28, v29
    v_cvt_pk_bf16_f32 v87, v30, v31
    v_exp_f32 v32, v32
    v_exp_f32 v33, v33
    v_exp_f32 v34, v34
    v_exp_f32 v35, v35
    s_waitcnt lgkmcnt(7)
    v_mfma_f32_32x32x16_bf16 v[64:79], a[248:251], v[84:87], v[64:79]
    ds_read_b64_tr_b16 a[248:249], v124 offset:16448
    ds_read_b64_tr_b16 a[250:251], v124 offset:17472
    v_exp_f32 v36, v36
    v_exp_f32 v37, v37
    v_exp_f32 v38, v38
    v_exp_f32 v39, v39
    v_cvt_pk_bf16_f32 v80, v32, v33
    v_cvt_pk_bf16_f32 v81, v34, v35
    v_cvt_pk_bf16_f32 v82, v36, v37
    v_cvt_pk_bf16_f32 v83, v38, v39
    v_exp_f32 v40, v40
    v_exp_f32 v41, v41
    v_mfma_f32_32x32x16_bf16 v[64:79], a[244:247], v[80:83], v[64:79]
    ds_read_b64_tr_b16 a[244:245], v4 offset:18496
    ds_read_b64_tr_b16 a[246:247], v4 offset:19520
    v_exp_f32 v42, v42
    v_exp_f32 v43, v43
    v_exp_f32 v44, v44
    v_exp_f32 v45, v45
    v_exp_f32 v46, v46
    v_exp_f32 v47, v47
    v_cvt_pk_bf16_f32 v84, v40, v41
    v_cvt_pk_bf16_f32 v85, v42, v43
    v_cvt_pk_bf16_f32 v86, v44, v45
    v_cvt_pk_bf16_f32 v87, v46, v47
    s_waitcnt lgkmcnt(5)
    s_nop 0
    v_mfma_f32_32x32x16_bf16 v[64:79], a[252:255], v[84:87], v[64:79]
    ds_read_b64_tr_b16 a[252:253], v124 offset:18496
    ds_read_b64_tr_b16 a[254:255], v124 offset:19520
    s_nop 9
    v_subrev_u32 v7, 0x21800000, v72
    v_cmp_lt_u32 vcc, 0x32000000, v7
    s_or_b64 s[54:55], s[54:55], vcc
    s_cbranch_scc1 att_slow0
att_back0:
    v_rcp_f32 v73, v72
    s_nop 0
    v_mul_f32 v64, v64, v73
    v_mul_f32 v65, v65, v73
    v_mul_f32 v66, v66, v73
    v_mul_f32 v67, v67, v73
    v_mul_f32 v68, v68, v73
    v_mul_f32 v69, v69, v73
    v_mul_f32 v70, v70, v73
    v_mul_f32 v71, v71, v73
    v_cvt_pk_bf16_f32 v64, v64, v65
PAD9:
    s_cbranch_execz WARM0_8
    v_cvt_pk_bf16_f32 v65, v66, v67
    v_cvt_pk_bf16_f32 v66, v68, v69
    v_cvt_pk_bf16_f32 v67, v70, v71
    s_add_u32 s87, s30, 0x808000
    buffer_store_dwordx4 v[64:67], v1, s[4:7], s87 offen sc1
    s_mov_b64 exec, 0
    s_cmp_eq_u32 s3, 0
    s_cbranch_scc1 PAD11
    s_cmp_eq_u32 s3, 1
    s_cbranch_scc1 PAD12
    s_cmp_eq_u32 s3, 2
    s_cbranch_scc1 PAD13
WARM2_4:
    s_mov_b64 exec, -1
    s_waitcnt vmcnt(6)
    v_max3_u32 v7, v48, v52, v56
    s_waitcnt vmcnt(5)
    v_max_u32 v7, v7, v60
    v_cmp_eq_u32 vcc, -1, v7
    s_cbranch_vccnz Lre15
Lok15:
    v_mfma_f32_32x32x16_bf16 v[32:47], a[224:227], v[48:51], 0
    ds_read_b64_tr_b16 a[224:225], v4 offset:32896
    ds_read_b64_tr_b16 a[226:227], v4 offset:33920
    v_mfma_f32_32x32x16_bf16 v[16:31], a[232:235], v[48:51], 0
    ds_read_b64_tr_b16 a[232:233], v124 offset:32896
    ds_read_b64_tr_b16 a[234:235], v124 offset:33920
    v_mfma_f32_32x32x16_bf16 v[32:47], a[236:239], v[52:55], v[32:47]
    ds_read_b64_tr_b16 a[236:237], v4 offset:34944
    ds_read_b64_tr_b16 a[238:239], v4 offset:35968
    v_mfma_f32_32x32x16_bf16 v[16:31], a[228:231], v[52:55], v[16:31]
    ds_read_b64_tr_b16 a[228:229], v124 offset:34944
    ds_read_b64_tr_b16 a[230:231], v124 offset:35968
    s_waitcnt lgkmcnt(13)
    v_mfma_f32_32x32x16_bf16 v[32:47], a[240:243], v[56:59], v[32:47]
    ds_read_b64_tr_b16 a[240:241], v4 offset:49344
    ds_read_b64_tr_b16 a[242:243], v4 offset:50368
    s_waitcnt lgkmcnt(13)
    v_mfma_f32_32x32x16_bf16 v[16:31], a[248:251], v[56:59], v[16:31]
    ds_read_b64_tr_b16 a[248:249], v124 offset:49344
    ds_read_b64_tr_b16 a[250:251], v124 offset:50368
    s_waitcnt lgkmcnt(13)
    v_mfma_f32_32x32x16_bf16 v[32:47], a[244:247], v[60:63], v[32:47]
    ds_read_b64_tr_b16 a[244:245], v4 offset:51392
    ds_read_b64_tr_b16 a[246:247], v4 offset:52416
    s_waitcnt lgkmcnt(13)
    v_mfma_f32_32x32x16_bf16 v[16:31], a[252:255], v[60:63], v[16:31]
    ds_read_b64_tr_b16 a[252:253], v124 offset:51392
    ds_read_b64_tr_b16 a[254:255], v124 offset:52416
    s_waitcnt vmcnt(2)
    v_max3_u32 v7, v96, v100, v104
    s_waitcnt vmcnt(1)
    v_max_u32 v7, v7, v108
    v_cmp_eq_u32 vcc, -1, v7
    s_cbranch_vccnz Lre16
Lok16:
    s_waitcnt lgkmcnt(13)
    v_mfma_f32_32x32x16_bf16 v[32:47], a[224:227], v[96:99], v[32:47]
    ds_read_b64_tr_b16 a[224:225], v4 offset:0
    ds_read_b64_tr_b16 a[226:227], v4 offset:1024
    s_waitcnt lgkmcnt(13)
    v_mfma_f32_32x32x16_bf16 v[16:31], a[232:235], v[96:99], v[16:31]
    ds_read_b64_tr_b16 a[232:233], v124 offset:0
    ds_read_b64_tr_b16 a[234:235], v124 offset:1024
    s_waitcnt lgkmcnt(13)
    v_mfma_f32_32x32x16_bf16 v[32:47], a[236:239], v[100:103], v[32:47]
    ds_read_b64_tr_b16 a[236:237], v4 offset:2048
    ds_read_b64_tr_b16 a[238:239], v4 offset:3072
    s_waitcnt lgkmcnt(13)
    v_mfma_f32_32x32x16_bf16 v[16:31], a[228:231], v[100:103], v[16:31]
    ds_read_b64_tr_b16 a[228:229], v124 offset:2048
    ds_read_b64_tr_b16 a[230:231], v124 offset:3072
    s_waitcnt lgkmcnt(13)
    v_mfma_f32_32x32x16_bf16 v[32:47], a[240:243], v[104:107], v[32:47]
    ds_read_b64_tr_b16 a[240:241], v4 offset:16448
    ds_read_b64_tr_b16 a[242:243], v4 offset:17472
    s_waitcnt lgkmcnt(13)
    v_mfma_f32_32x32x16_bf16 v[16:31], a[248:251], v[104:107], v[16:31]
    ds_read_b64_tr_b16 a[248:249], v124 offset:16448
    ds_read_b64_tr_b16 a[250:251], v124 offset:17472
    s_waitcnt lgkmcnt(13)
    v_mfma_f32_32x32x16_bf16 v[32:47], a[244:247], v[108:111], v[32:47]
    ds_read_b64_tr_b16 a[244:245], v4 offset:18496
    ds_read_b64_tr_b16 a[246:247], v4 offset:19520
    s_waitcnt lgkmcnt(13)
    v_mfma_f32_32x32x16_bf16 v[16:31], a[252:255], v[108:111], v[16:31]
    ds_read_b64_tr_b16 a[252:253], v124 offset:18496
    ds_read_b64_tr_b16 a[254:255], v124 offset:19520
    s_nop 5
    ds_write_b128 v122, v[32:35] offset:2048
    ds_write_b128 v122, v[36:39] offset:3072
    ds_write_b128 v123, v[40:43] offset:4096
    ds_write_b128 v123, v[44:47] offset:5120
    ds_write_b128 v121, v[24:27] offset:0
    ds_write_b128 v121, v[28:31] offset:1024
    v_lshlrev_b32 v85, 16, v8
    v_and_b32 v86, 0xffff0000, v8
    v_add_f32 v16, v16, v85
    v_add_f32 v17, v17, v86
    v_lshlrev_b32 v85, 16, v9
    v_and_b32 v86, 0xffff0000, v9
    v_add_f32 v18, v18, v85
    v_add_f32 v19, v19, v86
    v_lshlrev_b32 v85, 16, v10
    v_and_b32 v86, 0xffff0000, v10
    v_add_f32 v20, v20, v85
    v_add_f32 v21, v21, v86
    v_lshlrev_b32 v85, 16, v11
    v_and_b32 v86, 0xffff0000, v11
    v_add_f32 v22, v22, v85
    v_add_f32 v23, v23, v86
    s_waitcnt lgkmcnt(0)
    s_barrier
    ds_read_b128 v[24:27], v120 offset:0
    ds_read_b128 v[32:35], v120 offset:2048
    ds_read_b128 v[40:43], v120 offset:4096
    ds_read_b128 v[28:31], v120 offset:1024
    ds_read_b128 v[36:39], v120 offset:3072
    ds_read_b128 v[44:47], v120 offset:5120
    s_waitcnt lgkmcnt(5)
    v_add_f32 v16, v16, v24
    v_add_f32 v17, v17, v25
    v_add_f32 v18, v18, v26
    v_add_f32 v19, v19, v27
    s_waitcnt lgkmcnt(4)
    v_add_f32 v16, v16, v32
    v_add_f32 v17, v17, v33
    v_add_f32 v18, v18, v34
    v_add_f32 v19, v19, v35
    s_waitcnt lgkmcnt(3)
    v_add_f32 v16, v16, v40
    v_add_f32 v17, v17, v41
    v_add_f32 v18, v18, v42
    s_add_u32 s88, s17, 0x1008000
    buffer_load_dwordx4 v[64:67], v1, s[4:7], s88 offen sc1
    v_add_f32 v19, v19, v43
    v_cvt_pk_bf16_f32 v8, v16, v17
    v_cvt_pk_bf16_f32 v9, v18, v19
    buffer_load_dwordx4 v[68:71], v1, s[4:7], s88 offen offset:1024 sc1
    s_waitcnt lgkmcnt(2)
    v_add_f32 v20, v20, v28
    v_add_f32 v21, v21, v29
    v_add_f32 v22, v22, v30
    buffer_load_dwordx4 v[72:75], v1, s[4:7], s88 offen offset:2048 sc1
    v_add_f32 v23, v23, v31
    s_waitcnt lgkmcnt(1)
    v_add_f32 v20, v20, v36
    v_add_f32 v21, v21, v37
    buffer_load_dwordx4 v[76:79], v1, s[4:7], s88 offen offset:3072 sc1
    v_add_f32 v22, v22, v38
    v_add_f32 v23, v23, v39
    s_waitcnt lgkmcnt(0)
    v_add_f32 v20, v20, v44
    s_add_u32 s91, s17, 0x1009000
    buffer_load_dwordx4 v[48:51], v1, s[4:7], s91 offen sc1
    v_add_f32 v21, v21, v45
    v_add_f32 v22, v22, v46
    v_add_f32 v23, v23, v47
    buffer_load_dwordx4 v[52:55], v1, s[4:7], s91 offen offset:1024 sc1
    v_cvt_pk_bf16_f32 v10, v20, v21
    v_cvt_pk_bf16_f32 v11, v22, v23
    s_add_u32 s90, s16, 0x1200000
    s_bitcmp1_b32 s33, 0
    s_cbranch_scc1 Lre17
    buffer_store_dwordx4 v[8:11], v1, s[4:7], s90 offen
Lok17:
    buffer_load_dwordx4 v[56:59], v1, s[4:7], s91 offen offset:2048 sc1
    v_dot2_f32_bf16 v32, v8, s52, 0
    v_dot2_f32_bf16 v33, v8, v8, 0
    buffer_load_dwordx4 v[60:63], v1, s[4:7], s91 offen offset:3072 sc1
    v_dot2_f32_bf16 v32, v9, s52, v32
    v_dot2_f32_bf16 v33, v9, v9, v33
    v_dot2_f32_bf16 v32, v10, s52, v32
    v_dot2_f32_bf16 v33, v10, v10, v33
    v_dot2_f32_bf16 v32, v11, s52, v32
    v_dot2_f32_bf16 v33, v11, v11, v33
    s_nop 2
    v_permlane32_swap_b32 v32, v33
    v_add_f32 v32, v32, v33
    ds_write_b32 v126, v32 offset:24576
    s_waitcnt lgkmcnt(0)
    s_barrier
    ds_read_b128 v[36:39], v125 offset:24576
    s_waitcnt lgkmcnt(0)
    v_add_f32 v36, v36, v37
    v_add_f32 v38, v38, v39
    v_add_f32 v36, v36, v38
    s_mov_b64 exec, s[50:51]
    s_add_u32 s86, s18, 0x620000
    s_bitcmp1_b32 s33, 0
    s_cbranch_scc1 Lre18
    buffer_store_dword v36, v127, s[4:7], s86 offen
Lok18:
    s_mov_b64 exec, -1
    s_waitcnt vmcnt(7)
    v_max3_u32 v7, v64, v68, v72
    s_waitcnt vmcnt(6)
    v_max_u32 v7, v7, v76
    v_cmp_eq_u32 vcc, -1, v7
    s_cbranch_vccnz Lre19
Lok19:
    v_mfma_f32_32x32x16_bf16 v[32:47], a[224:227], v[64:67], 0
    ds_read_b64_tr_b16 a[224:225], v4 offset:32896
    ds_read_b64_tr_b16 a[226:227], v4 offset:33920
    s_mov_b32 m0, s22
    s_add_u32 s89, s21, 0x1200000
    buffer_load_dwordx4 v1, s[4:7], s89 offen sc1 lds
    v_mfma_f32_32x32x16_bf16 v[96:111], a[232:235], v[64:67], 0
    ds_read_b64_tr_b16 a[232:233], v124 offset:32896
    ds_read_b64_tr_b16 a[234:235], v124 offset:33920
    v_mfma_f32_32x32x16_bf16 v[32:47], a[236:239], v[68:71], v[32:47]
    ds_read_b64_tr_b16 a[236:237], v4 offset:34944
    ds_read_b64_tr_b16 a[238:239], v4 offset:35968
    buffer_load_dwordx4 v1, s[4:7], s89 offen offset:1024 sc1 lds
    v_mfma_f32_32x32x16_bf16 v[96:111], a[228:231], v[68:71], v[96:111]
    ds_read_b64_tr_b16 a[228:229], v124 offset:34944
    ds_read_b64_tr_b16 a[230:231], v124 offset:35968
    v_mfma_f32_32x32x16_bf16 v[32:47], a[240:243], v[72:75], v[32:47]
    ds_read_b64_tr_b16 a[240:241], v4 offset:49344
    ds_read_b64_tr_b16 a[242:243], v4 offset:50368
    buffer_load_dwordx4 v1, s[4:7], s89 offen offset:2048 sc1 lds
    v_mfma_f32_32x32x16_bf16 v[96:111], a[248:251], v[72:75], v[96:111]
    ds_read_b64_tr_b16 a[248:249], v124 offset:49344
    ds_read_b64_tr_b16 a[250:251], v124 offset:50368
    v_mfma_f32_32x32x16_bf16 v[32:47], a[244:247], v[76:79], v[32:47]
    ds_read_b64_tr_b16 a[244:245], v4 offset:51392
    ds_read_b64_tr_b16 a[246:247], v4 offset:52416
    buffer_load_dwordx4 v1, s[4:7], s89 offen offset:3072 sc1 lds
    v_mfma_f32_32x32x16_bf16 v[96:111], a[252:255], v[76:79], v[96:111]
    ds_read_b64_tr_b16 a[252:253], v124 offset:51392
    ds_read_b64_tr_b16 a[254:255], v124 offset:52416
    s_waitcnt vmcnt(6)
    v_max3_u32 v7, v48, v52, v56
    s_waitcnt vmcnt(5)
    v_max_u32 v7, v7, v60
    v_cmp_eq_u32 vcc, -1, v7
    s_cbranch_vccnz Lre20
Lok20:
    s_waitcnt lgkmcnt(13)
    v_mfma_f32_32x32x16_bf16 v[32:47], a[224:227], v[48:51], v[32:47]
    s_add_u32 m0, s22, 0x4040
    s_add_u32 s82, s21, 0x1204000
    buffer_load_dwordx4 v1, s[4:7], s82 offen sc1 lds
    s_waitcnt lgkmcnt(11)
    v_mfma_f32_32x32x16_bf16 v[96:111], a[232:235], v[48:51], v[96:111]
    s_waitcnt lgkmcnt(9)
    v_mfma_f32_32x32x16_bf16 v[32:47], a[236:239], v[52:55], v[32:47]
    buffer_load_dwordx4 v1, s[4:7], s82 offen offset:1024 sc1 lds
    s_waitcnt lgkmcnt(7)
    v_mfma_f32_32x32x16_bf16 v[96:111], a[228:231], v[52:55], v[96:111]
    s_waitcnt lgkmcnt(5)
    v_mfma_f32_32x32x16_bf16 v[32:47], a[240:243], v[56:59], v[32:47]
    buffer_load_dwordx4 v1, s[4:7], s82 offen offset:2048 sc1 lds
    s_waitcnt lgkmcnt(4)
    v_mfma_f32_32x32x16_bf16 v[96:111], a[248:251], v[56:59], v[96:111]
    s_waitcnt lgkmcnt(2)
    v_mfma_f32_32x32x16_bf16 v[32:47], a[244:247], v[60:63], v[32:47]
    buffer_load_dwordx4 v1, s[4:7], s82 offen offset:3072 sc1 lds
    s_waitcnt lgkmcnt(0)
    v_mfma_f32_32x32x16_bf16 v[96:111], a[252:255], v[60:63], v[96:111]
    s_nop 8
    ds_write_b128 v122, v[32:35] offset:2048
    ds_write_b128 v122, v[36:39] offset:3072
    ds_write_b128 v123, v[40:43] offset:4096
    ds_write_b128 v123, v[44:47] offset:5120
    ds_write_b128 v121, v[104:107] offset:0
    ds_write_b128 v121, v[108:111] offset:1024
    s_add_u32 m0, s22, 0x8080
    s_add_u32 s83, s21, 0x1210000
    buffer_load_dwordx4 v1, s[4:7], s83 offen sc1 lds
    v_lshlrev_b32 v85, 16, v12
    v_and_b32 v86, 0xffff0000, v12
    v_add_f32 v96, v96, v85
    buffer_load_dwordx4 v1, s[4:7], s83 offen offset:1024 sc1 lds
    v_add_f32 v97, v97, v86
    v_lshlrev_b32 v85, 16, v13
    v_and_b32 v86, 0xffff0000, v13
    buffer_load_dwordx4 v1, s[4:7], s83 offen offset:2048 sc1 lds
    v_add_f32 v98, v98, v85
    v_add_f32 v99, v99, v86
    v_lshlrev_b32 v85, 16, v14
    buffer_load_dwordx4 v1, s[4:7], s83 offen offset:3072 sc1 lds
    v_and_b32 v86, 0xffff0000, v14
    v_add_f32 v100, v100, v85
    v_add_f32 v101, v101, v86
    s_add_u32 m0, s22, 0xc0c0
    s_add_u32 s84, s21, 0x1214000
    buffer_load_dwordx4 v1, s[4:7], s84 offen sc1 lds
    v_lshlrev_b32 v85, 16, v15
    v_and_b32 v86, 0xffff0000, v15
    v_add_f32 v102, v102, v85
    buffer_load_dwordx4 v1, s[4:7], s84 offen offset:1024 sc1 lds
    v_add_f32 v103, v103, v86
    s_waitcnt lgkmcnt(0)
    s_barrier
    ds_read_b128 v[104:107], v120 offset:0
    buffer_load_dwordx4 v1, s[4:7], s84 offen offset:2048 sc1 lds
    ds_read_b128 v[32:35], v120 offset:2048
    ds_read_b128 v[40:43], v120 offset:4096
    ds_read_b128 v[108:111], v120 offset:1024
    buffer_load_dwordx4 v1, s[4:7], s84 offen offset:3072 sc1 lds
    ds_read_b128 v[36:39], v120 offset:3072
    ds_read_b128 v[44:47], v120 offset:5120
    s_waitcnt lgkmcnt(5)
    v_add_f32 v96, v96, v104
    v_add_f32 v97, v97, v105
    v_add_f32 v98, v98, v106
    v_add_f32 v99, v99, v107
    s_waitcnt lgkmcnt(4)
    v_add_f32 v96, v96, v32
    v_add_f32 v97, v97, v33
    v_add_f32 v98, v98, v34
    v_add_f32 v99, v99, v35
    s_waitcnt lgkmcnt(3)
    v_add_f32 v96, v96, v40
    v_add_f32 v97, v97, v41
    v_add_f32 v98, v98, v42
    v_add_f32 v99, v99, v43
    v_cvt_pk_bf16_f32 v12, v96, v97
    v_cvt_pk_bf16_f32 v13, v98, v99
    s_waitcnt lgkmcnt(2)
    v_add_f32 v100, v100, v108
    v_add_f32 v101, v101, v109
    v_add_f32 v102, v102, v110
    v_add_f32 v103, v103, v111
    s_waitcnt lgkmcnt(1)
    v_add_f32 v100, v100, v36
    v_add_f32 v101, v101, v37
    v_add_f32 v102, v102, v38
    v_add_f32 v103, v103, v39
    s_waitcnt lgkmcnt(0)
    v_add_f32 v100, v100, v44
    v_add_f32 v101, v101, v45
    v_add_f32 v102, v102, v46
    v_add_f32 v103, v103, v47
    v_cvt_pk_bf16_f32 v14, v100, v101
    v_cvt_pk_bf16_f32 v15, v102, v103
    s_add_u32 s80, s16, 0x1208000
    s_bitcmp1_b32 s33, 0
    s_cbranch_scc1 Lre21
    buffer_store_dwordx4 v[12:15], v1, s[4:7], s80 offen
Lok21:
    v_and_b32 v47, 512, v1
    v_mad_u32_u24 v47, v47, 7, v1
    s_add_u32 s81, s19, 0x620000
    buffer_load_dwordx4 v[64:67], v47, s[4:7], s81 offen sc1
    v_dot2_f32_bf16 v32, v12, s52, 0
    v_dot2_f32_bf16 v33, v12, v12, 0
    v_dot2_f32_bf16 v32, v13, s52, v32
    buffer_load_dwordx4 v[68:71], v47, s[4:7], s81 offen offset:512 sc1
    v_dot2_f32_bf16 v33, v13, v13, v33
    v_dot2_f32_bf16 v32, v14, s52, v32
    v_dot2_f32_bf16 v33, v14, v14, v33
    buffer_load_dwordx4 v[72:75], v47, s[4:7], s81 offen offset:1024 sc1
    v_dot2_f32_bf16 v32, v15, s52, v32
    v_dot2_f32_bf16 v33, v15, v15, v33
    s_nop 2
    v_permlane32_swap_b32 v32, v33
    buffer_load_dwordx4 v[76:79], v47, s[4:7], s81 offen offset:1536 sc1
    v_add_f32 v32, v32, v33
    ds_write_b32 v126, v32 offset:25600
    s_waitcnt lgkmcnt(0)
    s_barrier
    ds_read_b128 v[36:39], v125 offset:25600
    s_waitcnt lgkmcnt(0)
    v_add_f32 v36, v36, v37
    v_add_f32 v38, v38, v39
    v_add_f32 v36, v36, v38
    s_mov_b64 exec, s[50:51]
    s_bitcmp1_b32 s33, 0
    s_cbranch_scc1 Lre22
    buffer_store_dword v36, v127, s[4:7], s86 offen offset:2048
Lok22:
    s_mov_b64 exec, -1
    v_xor_b32 v80, 512, v1
    s_mov_b32 s85, s38
    buffer_load_dwordx4 a[248:251], v1, s[4:7], s85 offen
    buffer_load_dwordx4 a[252:255], v80, s[4:7], s85 offen
    v_add_u32 v108, 0x0, v6
    s_waitcnt vmcnt(20)
    ds_read2st64_b32 v[104:105], v108 offset0:0 offset1:4
    ds_read2st64_b32 v[106:107], v108 offset0:8 offset1:12
    v_add_u32 v86, 0x4040, v6
    s_waitcnt vmcnt(16)
    ds_read2st64_b32 v[82:83], v86 offset0:0 offset1:4
    ds_read2st64_b32 v[84:85], v86 offset0:8 offset1:12
    s_waitcnt lgkmcnt(2)
    v_max3_u32 v7, v104, v105, v106
    v_max_u32 v7, v7, v107
    v_cmp_eq_u32 vcc, -1, v7
    s_cbranch_vccnz Lre23
Lok23:
    s_waitcnt lgkmcnt(0)
    v_max3_u32 v7, v82, v83, v84
    v_max_u32 v7, v7, v85
    v_cmp_eq_u32 vcc, -1, v7
    s_cbranch_vccnz Lre24
Lok24:
    s_barrier
    ds_read_b128 a[224:227], v1 offset:0
    ds_read_b128 a[228:231], v1 offset:1024
    ds_read_b128 a[232:235], v1 offset:2048
    ds_read_b128 a[236:239], v1 offset:3072
    ds_read_b128 a[240:243], v1 offset:4112
    ds_read_b128 a[244:247], v1 offset:5136
    s_waitcnt lgkmcnt(4)
    v_mfma_f32_32x32x16_bf16 v[16:31], v[128:131], a[224:227], 0
    ds_read_b128 a[224:227], v1 offset:6160
    v_mfma_f32_32x32x16_bf16 v[16:31], v[132:135], a[228:231], v[16:31]
    ds_read_b128 a[228:231], v1 offset:7184
    v_mov_b32 v80, 1
    s_mov_b64 exec, 1
    s_add_u32 s87, s42, 0x5f0004
    buffer_atomic_add v80, off, s[4:7], s87 sc1
    s_mov_b64 exec, -1
    s_waitcnt lgkmcnt(4)
    v_mfma_f32_32x32x16_bf16 v[16:31], v[136:139], a[232:235], v[16:31]
    ds_read_b128 a[232:235], v1 offset:8224
    v_lshrrev_b32 v7, 2, v1
    v_and_b32 v7, 64, v7
    v_xor_b32 v7, v7, v1
    v_and_b32 v7, 0x70, v7
    v_lshrrev_b32 v111, 7, v1
    v_mul_u32_u24 v111, 3072, v111
    v_add_u32 v111, v111, v7
    v_mfma_f32_32x32x16_bf16 v[16:31], v[140:143], a[236:239], v[16:31]
    ds_read_b128 a[236:239], v1 offset:9248
    s_waitcnt lgkmcnt(4)
    v_mfma_f32_32x32x16_bf16 v[16:31], v[144:147], a[240:243], v[16:31]
    ds_read_b128 a[240:243], v1 offset:10272
    s_waitcnt vmcnt(7)
    v_max3_u32 v7, v64, v65, v66
    s_waitcnt vmcnt(6)
    v_max3_u32 v7, v7, v67, v68
    v_max3_u32 v7, v7, v69, v70
    s_waitcnt vmcnt(5)
    v_max3_u32 v7, v7, v71, v72
    v_max3_u32 v7, v7, v73, v74
    s_waitcnt vmcnt(4)
    v_max3_u32 v7, v7, v75, v76
    v_max3_u32 v7, v7, v77, v78
    v_max_u32 v7, v7, v79
    v_cmp_eq_u32 vcc, -1, v7
    s_cbranch_vccnz Lre25
Lok25:
    s_add_u32 m0, s22, 0x18180
    s_mov_b32 s88, s36
    buffer_load_dwordx4 v111, s[12:15], s88 offen lds
    v_mfma_f32_32x32x16_bf16 v[16:31], v[148:151], a[244:247], v[16:31]
    ds_read_b128 a[244:247], v1 offset:11296
    v_add_f32 v64, v64, v72
    v_add_f32 v65, v65, v73
    v_add_f32 v66, v66, v74
    v_add_f32 v67, v67, v75
    s_waitcnt lgkmcnt(4)
    v_mfma_f32_32x32x16_bf16 v[16:31], v[152:155], a[224:227], v[16:31]
    ds_read_b128 a[224:227], v1 offset:12336
    v_add_f32 v68, v68, v76
    v_add_f32 v69, v69, v77
    v_add_f32 v70, v70, v78
    v_add_f32 v71, v71, v79
    s_add_u32 s90, s36, 0x5c00
    buffer_load_dwordx4 v111, s[12:15], s90 offen offset:1024 lds
    v_mfma_f32_32x32x16_bf16 v[16:31], v[156:159], a[228:231], v[16:31]
    ds_read_b128 a[228:231], v1 offset:13360
    v_add_f32 v64, v64, v68
    v_add_f32 v65, v65, v69
    v_add_f32 v66, v66, v70
    v_add_f32 v67, v67, v71
    s_waitcnt lgkmcnt(4)
    v_mfma_f32_32x32x16_bf16 v[16:31], v[160:163], a[232:235], v[16:31]
    ds_read_b128 a[232:235], v1 offset:14384
    v_add_f32 v64, v64, v66
    v_add_f32 v65, v65, v67
    v_mul_f32 v64, 0xbb000000, v64
    v_mul_f32 v65, 0x3b000000, v65
    s_add_u32 s91, s36, 0xb800
    buffer_load_dwordx4 v111, s[12:15], s91 offen offset:2048 lds
    v_mfma_f32_32x32x16_bf16 v[16:31], v[164:167], a[236:239], v[16:31]
    ds_read_b128 a[236:239], v1 offset:15408
    v_fma_f32 v65, -v64, v64, v65
    v_max_f32 v65, 0, v65
    v_add_f32 v68, 0x3727c5ac, v65
    s_waitcnt lgkmcnt(4)
    v_mfma_f32_32x32x16_bf16 v[16:31], v[168:171], a[240:243], v[16:31]
    ds_read_b128 a[240:243], v1 offset:16448
    v_rsq_f32 v66, v68
    v_cvt_pk_bf16_f32 v32, v64, v64
    v_mul_f32 v68, v66, v66
    s_add_u32 s89, s36, 0x11400
    buffer_load_dwordx4 v111, s[12:15], s89 offen offset:3072 lds
    v_mfma_f32_32x32x16_bf16 v[16:31], v[172:175], a[244:247], v[16:31]
    ds_read_b128 a[244:247], v1 offset:17472
    v_mul_f32 v68, v68, v65
    v_add_f32 v68, 0x3727c5ac, v68
    v_rsq_f32 v68, v68
    s_waitcnt lgkmcnt(4)
    v_mfma_f32_32x32x16_bf16 v[16:31], v[176:179], a[224:227], v[16:31]
    ds_read_b128 a[224:227], v1 offset:18496
    v_lshlrev_b32 v69, 16, v32
    v_mul_f32 v66, v66, v68
    v_rcp_f32 v67, v66
    s_add_u32 m0, s22, 0x1c1c0
    s_add_u32 s82, s36, 0x60000
    buffer_load_dwordx4 v111, s[12:15], s82 offen lds
    v_mfma_f32_32x32x16_bf16 v[16:31], v[180:183], a[228:231], v[16:31]
    ds_read_b128 a[228:231], v1 offset:19520
    v_sub_f32 v69, v64, v69
    v_cvt_pk_bf16_f32 v70, v66, v66
    v_cvt_pk_bf16_f32 v33, v69, v67
    v_lshlrev_b32 v70, 16, v70
    s_waitcnt lgkmcnt(4)
    v_mfma_f32_32x32x16_bf16 v[16:31], v[184:187], a[232:235], v[16:31]
    ds_read_b128 a[232:235], v1 offset:20560
    v_and_b32 v69, 0xffff0000, v33
    v_sub_f32 v70, v66, v70
    v_sub_f32 v69, v67, v69
    v_cvt_pk_bf16_f32 v35, v66, v70
    s_add_u32 s83, s36, 0x65c00
    buffer_load_dwordx4 v111, s[12:15], s83 offen offset:1024 lds
    v_mfma_f32_32x32x16_bf16 v[16:31], v[188:191], a[236:239], v[16:31]
    ds_read_b128 a[236:239], v1 offset:21584
    v_cvt_pk_bf16_f32 v34, v69, 0
    v_mul_f32 v68, v66, v66
    v_mul_f32 v36, 0xc0135761, v66
    v_mul_f32 v39, 0xc0135761, v66
    s_waitcnt lgkmcnt(4)
    v_mfma_f32_32x32x16_bf16 v[16:31], v[192:195], a[240:243], v[16:31]
    ds_read_b128 a[240:243], v1 offset:22608
    v_mul_f32 v68, v68, v66
    v_mov_b32 v38, v67
    v_mov_b32 v41, v67
    v_mul_f32 v37, 0xbdd2d3e8, v68
    s_add_u32 s84, s36, 0x6b800
    buffer_load_dwordx4 v111, s[12:15], s84 offen offset:2048 lds
    v_mfma_f32_32x32x16_bf16 v[16:31], v[196:199], a[244:247], v[16:31]
    ds_read_b128 a[244:247], v1 offset:23632
    v_mul_f32 v40, 0xbdd2d3e8, v68
    v_permlane32_swap_b32 v36, v39
    s_waitcnt lgkmcnt(4)
    v_mfma_f32_32x32x16_bf16 v[16:31], v[200:203], a[224:227], v[16:31]
    ds_read_b128 a[224:227], v1 offset:24672
    v_permlane32_swap_b32 v38, v41
    v_permlane32_swap_b32 v37, v40
    s_add_u32 s80, s36, 0x71400
    buffer_load_dwordx4 v111, s[12:15], s80 offen offset:3072 lds
    v_mfma_f32_32x32x16_bf16 v[16:31], v[204:207], a[228:231], v[16:31]
    ds_read_b128 a[228:231], v1 offset:25696
    s_waitcnt lgkmcnt(4)
    v_mfma_f32_32x32x16_bf16 v[16:31], v[208:211], a[232:235], v[16:31]
    ds_read_b128 a[232:235], v1 offset:26720
    v_add_u32 v46, 0x8080, v6
    ds_read2st64_b32 v[42:43], v46 offset0:0 offset1:4
    ds_read2st64_b32 v[44:45], v46 offset0:8 offset1:12
    s_add_u32 m0, s22, 0x10100
    s_add_u32 s81, s21, 0x1208000
    buffer_load_dwordx4 v1, s[4:7], s81 offen sc1 lds
    v_mfma_f32_32x32x16_bf16 v[16:31], v[212:215], a[236:239], v[16:31]
    ds_read_b128 a[236:239], v1 offset:27744
    v_add_u32 v110, 0xc0c0, v6
    ds_read2st64_b32 v[106:107], v110 offset0:0 offset1:4
    s_waitcnt lgkmcnt(7)
    v_mfma_f32_32x32x16_bf16 v[16:31], v[216:219], a[240:243], v[16:31]
    ds_read_b128 a[240:243], v1 offset:28784
    ds_read2st64_b32 v[108:109], v110 offset0:8 offset1:12
    buffer_load_dwordx4 v1, s[4:7], s81 offen offset:1024 sc1 lds
    v_mfma_f32_32x32x16_bf16 v[16:31], v[220:223], a[244:247], v[16:31]
    ds_read_b128 a[244:247], v1 offset:29808
    s_waitcnt lgkmcnt(8)
    v_mfma_f32_32x32x16_bf16 v[16:31], v[224:227], a[224:227], v[16:31]
    ds_read_b128 a[224:227], v1 offset:30832
    s_waitcnt lgkmcnt(6)
    v_max3_u32 v7, v42, v43, v44
    v_max_u32 v7, v7, v45
    v_cmp_eq_u32 vcc, -1, v7
    s_cbranch_vccnz Lre26
Lok26:
    buffer_load_dwordx4 v1, s[4:7], s81 offen offset:2048 sc1 lds
    v_mfma_f32_32x32x16_bf16 v[16:31], v[228:231], a[228:231], v[16:31]
    ds_read_b128 a[228:231], v1 offset:31856
    s_waitcnt lgkmcnt(3)
    v_max3_u32 v7, v106, v107, v108
    v_max_u32 v7, v7, v109
    v_cmp_eq_u32 vcc, -1, v7
    s_cbranch_vccnz Lre27
Lok27:
    s_barrier
    v_mfma_f32_32x32x16_bf16 v[16:31], v[232:235], a[232:235], v[16:31]
    ds_read_b128 a[232:235], v1 offset:32896
    buffer_load_dwordx4 v1, s[4:7], s81 offen offset:3072 sc1 lds
    v_mfma_f32_32x32x16_bf16 v[16:31], v[236:239], a[236:239], v[16:31]
    ds_read_b128 a[236:239], v1 offset:33920
    v_mfma_f32_32x32x16_bf16 v[16:31], v[240:243], a[240:243], v[16:31]
    ds_read_b128 a[240:243], v1 offset:34944
    s_add_u32 m0, s22, 0x14140
    s_add_u32 s86, s21, 0x120c000
    buffer_load_dwordx4 v1, s[4:7], s86 offen sc1 lds
    s_waitcnt vmcnt(15)
    v_mfma_f32_32x32x16_bf16 v[16:31], a[248:251], v[32:35], v[16:31]
    s_waitcnt lgkmcnt(4)
    v_mfma_f32_32x32x16_bf16 v[16:31], v[244:247], a[244:247], v[16:31]
    ds_read_b128 a[244:247], v1 offset:35968
    buffer_load_dwordx4 v1, s[4:7], s86 offen offset:1024 sc1 lds
    v_mfma_f32_32x32x16_bf16 v[16:31], v[248:251], a[224:227], v[16:31]
    ds_read_b128 a[224:227], v1 offset:37008
    s_waitcnt lgkmcnt(4)
    v_mfma_f32_32x32x16_bf16 v[16:31], v[252:255], a[228:231], v[16:31]
    ds_read_b128 a[228:231], v1 offset:38032
    buffer_load_dwordx4 v1, s[4:7], s86 offen offset:2048 sc1 lds
    v_mfma_f32_32x32x16_bf16 v[48:63], v[128:131], a[232:235], 0
    ds_read_b128 a[232:235], v1 offset:39056
    s_waitcnt lgkmcnt(4)
    v_mfma_f32_32x32x16_bf16 v[48:63], v[132:135], a[236:239], v[48:63]
    ds_read_b128 a[236:239], v1 offset:40080
    s_barrier
    buffer_load_dwordx4 v1, s[4:7], s86 offen offset:3072 sc1 lds
    s_nop 2
    v_mul_f32 v80, v16, v16
    v_mul_f32 v81, v17, v17
    v_mul_f32 v82, v18, v18
    v_mfma_f32_32x32x16_bf16 v[48:63], v[136:139], a[240:243], v[48:63]
    ds_read_b128 a[240:243], v1 offset:41120
    v_mul_f32 v83, v19, v19
    v_mul_f32 v84, v20, v20
    v_mul_f32 v85, v21, v21
    v_mul_f32 v86, v22, v22
    v_mul_f32 v87, v23, v23
    v_fma_f32 v80, v80, v37, v36
    v_fma_f32 v81, v81, v37, v36
    s_waitcnt lgkmcnt(4)
    v_mfma_f32_32x32x16_bf16 v[48:63], v[140:143], a[244:247], v[48:63]
    ds_read_b128 a[244:247], v1 offset:42144
    s_mov_b32 m0, s22
    s_add_u32 s85, s21, 0x1218000
    buffer_load_dwordx4 v1, s[4:7], s85 offen sc1 lds
    v_fma_f32 v82, v82, v37, v36
    v_fma_f32 v83, v83, v37, v36
    v_fma_f32 v84, v84, v37, v36
    v_fma_f32 v85, v85, v37, v36
    v_mfma_f32_32x32x16_bf16 v[48:63], v[144:147], a[224:227], v[48:63]
    ds_read_b128 a[224:227], v1 offset:43168
    v_fma_f32 v86, v86, v37, v36
    v_fma_f32 v87, v87, v37, v36
    v_mul_f32 v80, v80, v16
    v_mul_f32 v81, v81, v17
    v_mul_f32 v82, v82, v18
    v_mul_f32 v83, v83, v19
    v_mul_f32 v84, v84, v20
    s_waitcnt lgkmcnt(4)
    v_mfma_f32_32x32x16_bf16 v[48:63], v[148:151], a[228:231], v[48:63]
    ds_read_b128 a[228:231], v1 offset:44192
    buffer_load_dwordx4 v1, s[4:7], s85 offen offset:1024 sc1 lds
    v_mul_f32 v85, v85, v21
    v_mul_f32 v86, v86, v22
    v_mul_f32 v87, v87, v23
    v_mfma_f32_32x32x16_bf16 v[48:63], v[152:155], a[232:235], v[48:63]
    ds_read_b128 a[232:235], v1 offset:45232
    v_exp_f32 v80, v80
    v_exp_f32 v81, v81
    v_exp_f32 v82, v82
    s_waitcnt lgkmcnt(4)
    v_mfma_f32_32x32x16_bf16 v[48:63], v[156:159], a[236:239], v[48:63]
    ds_read_b128 a[236:239], v1 offset:46256
    buffer_load_dwordx4 v1, s[4:7], s85 offen offset:2048 sc1 lds
    v_exp_f32 v83, v83
    v_exp_f32 v84, v84
    v_mfma_f32_32x32x16_bf16 v[48:63], v[160:163], a[240:243], v[48:63]
PAD10:
    s_cbranch_execz WARM0_8
    ds_read_b128 a[240:243], v1 offset:47280
    v_exp_f32 v85, v85
    v_exp_f32 v86, v86
    v_exp_f32 v87, v87
    v_fma_f32 v80, v80, v38, v38
    s_waitcnt lgkmcnt(4)
    v_mfma_f32_32x32x16_bf16 v[48:63], v[164:167], a[244:247], v[48:63]
    ds_read_b128 a[244:247], v1 offset:48304
    buffer_load_dwordx4 v1, s[4:7], s85 offen offset:3072 sc1 lds
    v_fma_f32 v81, v81, v38, v38
    v_fma_f32 v82, v82, v38, v38
    v_fma_f32 v83, v83, v38, v38
    v_fma_f32 v84, v84, v38, v38
    v_mfma_f32_32x32x16_bf16 v[48:63], v[168:171], a[224:227], v[48:63]
    ds_read_b128 a[224:227], v1 offset:49344
    v_fma_f32 v85, v85, v38, v38
    v_fma_f32 v86, v86, v38, v38
    v_fma_f32 v87, v87, v38, v38
    v_rcp_f32 v80, v80
    v_rcp_f32 v81, v81
    s_waitcnt lgkmcnt(4)
    v_mfma_f32_32x32x16_bf16 v[48:63], v[172:175], a[228:231], v[48:63]
    ds_read_b128 a[228:231], v1 offset:50368
    s_add_u32 m0, s22, 0x4040
    s_add_u32 s87, s21, 0x121c000
    buffer_load_dwordx4 v1, s[4:7], s87 offen sc1 lds
    v_rcp_f32 v82, v82
    v_rcp_f32 v83, v83
    v_mfma_f32_32x32x16_bf16 v[48:63], v[176:179], a[232:235], v[48:63]
    ds_read_b128 a[232:235], v1 offset:51392
    v_rcp_f32 v84, v84
    v_rcp_f32 v85, v85
    v_rcp_f32 v86, v86
    s_waitcnt lgkmcnt(4)
    v_mfma_f32_32x32x16_bf16 v[48:63], v[180:183], a[236:239], v[48:63]
    ds_read_b128 a[236:239], v1 offset:52416
    buffer_load_dwordx4 v1, s[4:7], s87 offen offset:1024 sc1 lds
    v_rcp_f32 v87, v87
    v_mul_f32 v80, v80, v16
    v_mul_f32 v81, v81, v17
    v_mfma_f32_32x32x16_bf16 v[48:63], v[184:187], a[240:243], v[48:63]
    ds_read_b128 a[240:243], v1 offset:53456
    v_mul_f32 v82, v82, v18
    v_mul_f32 v83, v83, v19
    v_mul_f32 v84, v84, v20
    v_mul_f32 v85, v85, v21
    v_mul_f32 v86, v86, v22
    v_mul_f32 v87, v87, v23
    v_cvt_pk_bf16_f32 v16, v80, v81
    s_waitcnt lgkmcnt(4)
    v_mfma_f32_32x32x16_bf16 v[48:63], v[188:191], a[244:247], v[48:63]
    ds_read_b128 a[244:247], v1 offset:54480
    buffer_load_dwordx4 v1, s[4:7], s87 offen offset:2048 sc1 lds
    v_cvt_pk_bf16_f32 v17, v82, v83
    v_cvt_pk_bf16_f32 v18, v84, v85
    v_cvt_pk_bf16_f32 v19, v86, v87
    v_mfma_f32_32x32x16_bf16 v[48:63], v[192:195], a[224:227], v[48:63]
    ds_read_b128 a[224:227], v1 offset:55504
    s_add_u32 s88, s23, 0x1400000
    s_bitcmp1_b32 s33, 0
    s_cbranch_scc1 Lre28
    buffer_store_dwordx4 v[16:19], v1, s[4:7], s88 offen
Lok28:
    v_mul_f32 v80, v24, v24
    v_mul_f32 v81, v25, v25
    s_waitcnt lgkmcnt(4)
    v_mfma_f32_32x32x16_bf16 v[48:63], v[196:199], a[228:231], v[48:63]
    ds_read_b128 a[228:231], v1 offset:56528
    buffer_load_dwordx4 v1, s[4:7], s87 offen offset:3072 sc1 lds
    v_mul_f32 v82, v26, v26
    v_mul_f32 v83, v27, v27
    v_mul_f32 v84, v28, v28
    v_mul_f32 v85, v29, v29
    v_mfma_f32_32x32x16_bf16 v[48:63], v[200:203], a[232:235], v[48:63]
    ds_read_b128 a[232:235], v1 offset:57568
    v_mul_f32 v86, v30, v30
    v_mul_f32 v87, v31, v31
    v_fma_f32 v80, v80, v37, v36
    v_fma_f32 v81, v81, v37, v36
    v_fma_f32 v82, v82, v37, v36
    v_fma_f32 v83, v83, v37, v36
    v_fma_f32 v84, v84, v37, v36
    s_waitcnt lgkmcnt(4)
    v_mfma_f32_32x32x16_bf16 v[48:63], v[204:207], a[236:239], v[48:63]
    ds_read_b128 a[236:239], v1 offset:58592
    s_add_u32 s90, s19, 0x620800
    buffer_load_dwordx4 v[64:67], v47, s[4:7], s90 offen sc1
    v_fma_f32 v85, v85, v37, v36
    v_fma_f32 v86, v86, v37, v36
    v_fma_f32 v87, v87, v37, v36
    v_mul_f32 v80, v80, v24
    v_mfma_f32_32x32x16_bf16 v[48:63], v[208:211], a[240:243], v[48:63]
    ds_read_b128 a[240:243], v1 offset:59616
    v_add_u32 v46, 0x10100, v6
    s_waitcnt vmcnt(14)
    ds_read2st64_b32 v[42:43], v46 offset0:0 offset1:4
    ds_read2st64_b32 v[44:45], v46 offset0:8 offset1:12
    v_mul_f32 v81, v81, v25
    v_mul_f32 v82, v82, v26
    v_mul_f32 v83, v83, v27
    s_waitcnt lgkmcnt(6)
    v_mfma_f32_32x32x16_bf16 v[48:63], v[212:215], a[244:247], v[48:63]
    ds_read_b128 a[244:247], v1 offset:60640
    v_add_u32 v110, 0x14140, v6
    s_waitcnt vmcnt(10)
    ds_read2st64_b32 v[106:107], v110 offset0:0 offset1:4
    buffer_load_dwordx4 v[68:71], v47, s[4:7], s90 offen offset:512 sc1
    v_mul_f32 v84, v84, v28
    v_mfma_f32_32x32x16_bf16 v[48:63], v[216:219], a[224:227], v[48:63]
    ds_read_b128 a[224:227], v1 offset:61680
    ds_read2st64_b32 v[108:109], v110 offset0:8 offset1:12
    v_mul_f32 v85, v85, v29
    v_mul_f32 v86, v86, v30
    v_mul_f32 v87, v87, v31
    v_exp_f32 v80, v80
    s_waitcnt lgkmcnt(8)
    v_mfma_f32_32x32x16_bf16 v[48:63], v[220:223], a[228:231], v[48:63]
    ds_read_b128 a[228:231], v1 offset:62704
    buffer_load_dwordx4 v[72:75], v47, s[4:7], s90 offen offset:1024 sc1
    v_exp_f32 v81, v81
    v_exp_f32 v82, v82
    v_mfma_f32_32x32x16_bf16 v[48:63], v[224:227], a[232:235], v[48:63]
    ds_read_b128 a[232:235], v1 offset:63728
    s_waitcnt lgkmcnt(6)
    v_max3_u32 v7, v42, v43, v44
    v_max_u32 v7, v7, v45
    v_cmp_eq_u32 vcc, -1, v7
    s_cbranch_vccnz Lre29
Lok29:
    v_exp_f32 v83, v83
    v_mfma_f32_32x32x16_bf16 v[48:63], v[228:231], a[236:239], v[48:63]
    ds_read_b128 a[236:239], v1 offset:64752
    s_waitcnt lgkmcnt(3)
    v_max3_u32 v7, v106, v107, v108
    v_max_u32 v7, v7, v109
    v_cmp_eq_u32 vcc, -1, v7
    s_cbranch_vccnz Lre30
Lok30:
    s_barrier
    buffer_load_dwordx4 v[76:79], v47, s[4:7], s90 offen offset:1536 sc1
    v_mfma_f32_32x32x16_bf16 v[48:63], v[232:235], a[240:243], v[48:63]
    ds_read_b128 a[240:243], v2 offset:256
    v_exp_f32 v84, v84
    v_exp_f32 v85, v85
    v_exp_f32 v86, v86
    v_mfma_f32_32x32x16_bf16 v[48:63], v[236:239], a[244:247], v[48:63]
    ds_read_b128 a[244:247], v2 offset:1280
    v_exp_f32 v87, v87
    v_fma_f32 v80, v80, v38, v38
    v_fma_f32 v81, v81, v38, v38
    v_fma_f32 v82, v82, v38, v38
    v_fma_f32 v83, v83, v38, v38
    v_fma_f32 v84, v84, v38, v38
    v_mfma_f32_32x32x16_bf16 v[48:63], v[240:243], a[224:227], v[48:63]
    ds_read_b128 a[224:227], v2 offset:2304
    v_fma_f32 v85, v85, v38, v38
    v_fma_f32 v86, v86, v38, v38
    v_fma_f32 v87, v87, v38, v38
    v_rcp_f32 v80, v80
    v_rcp_f32 v81, v81
    v_mfma_f32_32x32x16_bf16 v[48:63], a[252:255], v[32:35], v[48:63]
    v_rcp_f32 v82, v82
    v_rcp_f32 v83, v83
    v_rcp_f32 v84, v84
    v_rcp_f32 v85, v85
    s_waitcnt lgkmcnt(4)
    v_mfma_f32_32x32x16_bf16 v[48:63], v[244:247], a[228:231], v[48:63]
    ds_read_b128 a[228:231], v2 offset:3328
    v_rcp_f32 v86, v86
    v_rcp_f32 v87, v87
    v_mul_f32 v80, v80, v24
    v_mul_f32 v81, v81, v25
    v_mul_f32 v82, v82, v26
    v_mfma_f32_32x32x16_bf16 v[48:63], v[248:251], a[232:235], v[48:63]
    ds_read_b128 a[232:235], v2 offset:4368
    v_mul_f32 v83, v83, v27
    v_mul_f32 v84, v84, v28
    v_mul_f32 v85, v85, v29
    v_mul_f32 v86, v86, v30
    v_mul_f32 v87, v87, v31
    v_cvt_pk_bf16_f32 v24, v80, v81
    v_cvt_pk_bf16_f32 v25, v82, v83
    s_waitcnt lgkmcnt(4)
    v_mfma_f32_32x32x16_bf16 v[48:63], v[252:255], a[236:239], v[48:63]
    ds_read_b128 a[236:239], v2 offset:5392
    v_cvt_pk_bf16_f32 v26, v84, v85
    v_cvt_pk_bf16_f32 v27, v86, v87
    s_bitcmp1_b32 s33, 0
    s_cbranch_scc1 Lre31
    buffer_store_dwordx4 v[24:27], v1, s[4:7], s88 offen offset:1024
Lok31:
    s_nop 1
    v_mfma_f32_32x32x16_bf16 v[16:31], v[128:131], a[240:243], 0
    ds_read_b128 a[240:243], v2 offset:6416
    s_waitcnt lgkmcnt(4)
    v_mfma_f32_32x32x16_bf16 v[16:31], v[132:135], a[244:247], v[16:31]
    ds_read_b128 a[244:247], v2 offset:7440
    s_barrier
    v_mul_f32 v80, v48, v48
    v_mul_f32 v81, v49, v49
    v_mul_f32 v82, v50, v50
    v_mul_f32 v83, v51, v51
    v_mul_f32 v84, v52, v52
    v_mul_f32 v85, v53, v53
    v_mul_f32 v86, v54, v54
    v_mul_f32 v87, v55, v55
    v_mfma_f32_32x32x16_bf16 v[16:31], v[136:139], a[224:227], v[16:31]
    ds_read_b128 a[224:227], v2 offset:8480
    s_add_u32 m0, s22, 0x8080
    s_add_u32 s91, s36, 0xc0000
    buffer_load_dwordx4 v111, s[12:15], s91 offen lds
    v_fma_f32 v80, v80, v40, v39
    v_fma_f32 v81, v81, v40, v39
    v_fma_f32 v82, v82, v40, v39
    v_fma_f32 v83, v83, v40, v39
    v_fma_f32 v84, v84, v40, v39
    s_waitcnt lgkmcnt(4)
    v_mfma_f32_32x32x16_bf16 v[16:31], v[140:143], a[228:231], v[16:31]
    ds_read_b128 a[228:231], v2 offset:9504
    v_fma_f32 v85, v85, v40, v39
    v_fma_f32 v86, v86, v40, v39
    v_fma_f32 v87, v87, v40, v39
    v_mul_f32 v80, v80, v48
    v_mul_f32 v81, v81, v49
    v_mul_f32 v82, v82, v50
    v_mul_f32 v83, v83, v51
    v_mul_f32 v84, v84, v52
    v_mul_f32 v85, v85, v53
    v_mfma_f32_32x32x16_bf16 v[16:31], v[144:147], a[232:235], v[16:31]
    ds_read_b128 a[232:235], v2 offset:10528
    s_add_u32 s89, s36, 0xc5c00
    buffer_load_dwordx4 v111, s[12:15], s89 offen offset:1024 lds
    v_mul_f32 v86, v86, v54
    v_mul_f32 v87, v87, v55
    v_exp_f32 v80, v80
    s_waitcnt lgkmcnt(4)
    v_mfma_f32_32x32x16_bf16 v[16:31], v[148:151], a[236:239], v[16:31]
    ds_read_b128 a[236:239], v2 offset:11552
    v_exp_f32 v81, v81
    v_exp_f32 v82, v82
    v_exp_f32 v83, v83
    v_exp_f32 v84, v84
    v_mfma_f32_32x32x16_bf16 v[16:31], v[152:155], a[240:243], v[16:31]
    ds_read_b128 a[240:243], v2 offset:12592
    s_add_u32 s82, s36, 0xcb800
    buffer_load_dwordx4 v111, s[12:15], s82 offen offset:2048 lds
    v_exp_f32 v85, v85
    v_exp_f32 v86, v86
    s_waitcnt lgkmcnt(4)
    v_mfma_f32_32x32x16_bf16 v[16:31], v[156:159], a[244:247], v[16:31]
    ds_read_b128 a[244:247], v2 offset:13616
    v_exp_f32 v87, v87
    v_fma_f32 v80, v80, v41, v41
    v_fma_f32 v81, v81, v41, v41
    v_fma_f32 v82, v82, v41, v41
    v_fma_f32 v83, v83, v41, v41
    v_fma_f32 v84, v84, v41, v41
    v_fma_f32 v85, v85, v41, v41
    v_fma_f32 v86, v86, v41, v41
    v_mfma_f32_32x32x16_bf16 v[16:31], v[160:163], a[224:227], v[16:31]
    ds_read_b128 a[224:227], v2 offset:14640
    s_add_u32 s83, s36, 0xd1400
    buffer_load_dwordx4 v111, s[12:15], s83 offen offset:3072 lds
    s_waitcnt vmcnt(8)
    v_max3_u32 v7, v64, v65, v66
    s_waitcnt vmcnt(7)
    v_max3_u32 v7, v7, v67, v68
    v_max3_u32 v7, v7, v69, v70
    s_waitcnt vmcnt(6)
    v_max3_u32 v7, v7, v71, v72
    v_max3_u32 v7, v7, v73, v74
    s_waitcnt vmcnt(5)
    v_max3_u32 v7, v7, v75, v76
    v_max3_u32 v7, v7, v77, v78
    v_max_u32 v7, v7, v79
    v_cmp_eq_u32 vcc, -1, v7
    s_cbranch_vccnz Lre32
Lok32:
    s_waitcnt lgkmcnt(4)
    v_mfma_f32_32x32x16_bf16 v[16:31], v[164:167], a[228:231], v[16:31]
    ds_read_b128 a[228:231], v2 offset:15664
    v_fma_f32 v87, v87, v41, v41
    v_rcp_f32 v80, v80
    v_rcp_f32 v81, v81
    v_rcp_f32 v82, v82
    v_rcp_f32 v83, v83
    v_mfma_f32_32x32x16_bf16 v[16:31], v[168:171], a[232:235], v[16:31]
    ds_read_b128 a[232:235], v2 offset:16704
    s_add_u32 m0, s22, 0xc0c0
    s_add_u32 s84, s36, 0x120000
    buffer_load_dwordx4 v111, s[12:15], s84 offen lds
    v_rcp_f32 v84, v84
    v_rcp_f32 v85, v85
    s_waitcnt lgkmcnt(4)
    v_mfma_f32_32x32x16_bf16 v[16:31], v[172:175], a[236:239], v[16:31]
    ds_read_b128 a[236:239], v2 offset:17728
    v_add_f32 v64, v64, v72
    v_add_f32 v65, v65, v73
    v_add_f32 v66, v66, v74
    v_rcp_f32 v86, v86
    v_rcp_f32 v87, v87
    v_mul_f32 v80, v80, v48
    v_mul_f32 v81, v81, v49
    v_mfma_f32_32x32x16_bf16 v[16:31], v[176:179], a[240:243], v[16:31]
    ds_read_b128 a[240:243], v2 offset:18752
    s_add_u32 s80, s36, 0x125c00
    buffer_load_dwordx4 v111, s[12:15], s80 offen offset:1024 lds
    v_add_f32 v67, v67, v75
    v_add_f32 v68, v68, v76
    v_add_f32 v69, v69, v77
    v_mul_f32 v82, v82, v50
    v_mul_f32 v83, v83, v51
    s_waitcnt lgkmcnt(4)
    v_mfma_f32_32x32x16_bf16 v[16:31], v[180:183], a[244:247], v[16:31]
    ds_read_b128 a[244:247], v2 offset:19776
    v_add_f32 v70, v70, v78
    v_add_f32 v71, v71, v79
    v_add_f32 v64, v64, v68
    v_add_f32 v65, v65, v69
    v_mul_f32 v84, v84, v52
    v_mul_f32 v85, v85, v53
    v_mul_f32 v86, v86, v54
    v_mul_f32 v87, v87, v55
    v_cvt_pk_bf16_f32 v48, v80, v81
    v_mfma_f32_32x32x16_bf16 v[16:31], v[184:187], a[224:227], v[16:31]
    ds_read_b128 a[224:227], v2 offset:20816
    s_add_u32 s81, s36, 0x12b800
    buffer_load_dwordx4 v111, s[12:15], s81 offen offset:2048 lds
    v_add_f32 v66, v66, v70
    v_add_f32 v67, v67, v71
    v_add_f32 v64, v64, v66
    v_cvt_pk_bf16_f32 v49, v82, v83
    v_cvt_pk_bf16_f32 v50, v84, v85
    s_waitcnt lgkmcnt(4)
    v_mfma_f32_32x32x16_bf16 v[16:31], v[188:191], a[228:231], v[16:31]
    ds_read_b128 a[228:231], v2 offset:21840
    v_add_f32 v65, v65, v67
    v_mul_f32 v64, 0xbb000000, v64
    v_mul_f32 v65, 0x3b000000, v65
    v_cvt_pk_bf16_f32 v51, v86, v87
    s_add_u32 s86, s23, 0x1438000
    s_bitcmp1_b32 s33, 0
    s_cbranch_scc1 Lre33
    buffer_store_dwordx4 v[48:51], v1, s[4:7], s86 offen
Lok33:
    v_mfma_f32_32x32x16_bf16 v[16:31], v[192:195], a[232:235], v[16:31]
    ds_read_b128 a[232:235], v2 offset:22864
    s_add_u32 s85, s36, 0x131400
    buffer_load_dwordx4 v111, s[12:15], s85 offen offset:3072 lds
    v_fma_f32 v65, -v64, v64, v65
    v_max_f32 v65, 0, v65
    v_add_f32 v68, 0x3727c5ac, v65
    v_mul_f32 v80, v56, v56
    v_mul_f32 v81, v57, v57
    s_waitcnt lgkmcnt(4)
    v_mfma_f32_32x32x16_bf16 v[16:31], v[196:199], a[236:239], v[16:31]
    ds_read_b128 a[236:239], v2 offset:23888
    v_rsq_f32 v66, v68
    v_cvt_pk_bf16_f32 v96, v64, v64
    v_mul_f32 v82, v58, v58
    v_mul_f32 v83, v59, v59
    v_mul_f32 v84, v60, v60
    v_mul_f32 v85, v61, v61
    v_mul_f32 v86, v62, v62
    v_mul_f32 v87, v63, v63
    v_mfma_f32_32x32x16_bf16 v[16:31], v[200:203], a[240:243], v[16:31]
    ds_read_b128 a[240:243], v2 offset:24928
    v_mul_f32 v68, v66, v66
    v_mul_f32 v68, v68, v65
    v_add_f32 v68, 0x3727c5ac, v68
    v_rsq_f32 v68, v68
    v_fma_f32 v80, v80, v40, v39
    v_fma_f32 v81, v81, v40, v39
    v_fma_f32 v82, v82, v40, v39
    v_fma_f32 v83, v83, v40, v39
    s_waitcnt lgkmcnt(4)
    v_mfma_f32_32x32x16_bf16 v[16:31], v[204:207], a[244:247], v[16:31]
    ds_read_b128 a[244:247], v2 offset:25952
    v_lshlrev_b32 v69, 16, v96
    v_mul_f32 v66, v66, v68
    v_fma_f32 v84, v84, v40, v39
    v_fma_f32 v85, v85, v40, v39
    v_fma_f32 v86, v86, v40, v39
    v_fma_f32 v87, v87, v40, v39
    v_mul_f32 v80, v80, v56
    v_mul_f32 v81, v81, v57
    v_mul_f32 v82, v82, v58
    v_mfma_f32_32x32x16_bf16 v[16:31], v[208:211], a[224:227], v[16:31]
    ds_read_b128 a[224:227], v2 offset:26976
    v_add_u32 v46, 0x0, v6
    ds_read2st64_b32 v[42:43], v46 offset0:0 offset1:4
    ds_read2st64_b32 v[44:45], v46 offset0:8 offset1:12
    v_rcp_f32 v67, v66
    v_sub_f32 v69, v64, v69
    v_mul_f32 v83, v83, v59
    v_mul_f32 v84, v84, v60
    s_waitcnt lgkmcnt(6)
    v_mfma_f32_32x32x16_bf16 v[16:31], v[212:215], a[228:231], v[16:31]
    ds_read_b128 a[228:231], v2 offset:28000
    v_add_u32 v110, 0x4040, v6
    ds_read2st64_b32 v[106:107], v110 offset0:0 offset1:4
    v_cvt_pk_bf16_f32 v70, v66, v66
    v_cvt_pk_bf16_f32 v97, v69, v67
    v_lshlrev_b32 v70, 16, v70
    v_mul_f32 v85, v85, v61
    v_mul_f32 v86, v86, v62
    v_mul_f32 v87, v87, v63
    v_mfma_f32_32x32x16_bf16 v[16:31], v[216:219], a[232:235], v[16:31]
    ds_read_b128 a[232:235], v2 offset:29040
    ds_read2st64_b32 v[108:109], v110 offset0:8 offset1:12
    v_and_b32 v69, 0xffff0000, v97
    v_sub_f32 v70, v66, v70
    v_sub_f32 v69, v67, v69
    v_exp_f32 v80, v80
    v_exp_f32 v81, v81
    s_waitcnt lgkmcnt(8)
    v_mfma_f32_32x32x16_bf16 v[16:31], v[220:223], a[236:239], v[16:31]
    ds_read_b128 a[236:239], v2 offset:30064
    v_cvt_pk_bf16_f32 v99, v66, v70
    v_cvt_pk_bf16_f32 v98, v69, 0
    v_mul_f32 v68, v66, v66
    v_mul_f32 v100, 0xc0135761, v66
    v_exp_f32 v82, v82
    v_exp_f32 v83, v83
    v_mfma_f32_32x32x16_bf16 v[16:31], v[224:227], a[240:243], v[16:31]
    ds_read_b128 a[240:243], v2 offset:31088
    s_waitcnt lgkmcnt(6)
    v_max3_u32 v7, v42, v43, v44
    v_max_u32 v7, v7, v45
    v_cmp_eq_u32 vcc, -1, v7
    s_cbranch_vccnz Lre34
Lok34:
    v_mul_f32 v103, 0xc0135761, v66
    v_mul_f32 v68, v68, v66
    v_mov_b32 v102, v67
    v_exp_f32 v84, v84
    v_mfma_f32_32x32x16_bf16 v[16:31], v[228:231], a[244:247], v[16:31]
    ds_read_b128 a[244:247], v2 offset:32112
    s_waitcnt lgkmcnt(3)
    v_max3_u32 v7, v106, v107, v108
    v_max_u32 v7, v7, v109
    v_cmp_eq_u32 vcc, -1, v7
    s_cbranch_vccnz Lre35
Lok35:
    s_barrier
    v_mov_b32 v105, v67
    v_mul_f32 v101, 0xbdd2d3e8, v68
    v_mul_f32 v104, 0xbdd2d3e8, v68
    v_mfma_f32_32x32x16_bf16 v[16:31], v[232:235], a[224:227], v[16:31]
    ds_read_b128 a[224:227], v1 offset:0
    v_permlane32_swap_b32 v100, v103
    v_permlane32_swap_b32 v102, v105
    v_exp_f32 v85, v85
    v_exp_f32 v86, v86
    v_mfma_f32_32x32x16_bf16 v[16:31], v[236:239], a[228:231], v[16:31]
    ds_read_b128 a[228:231], v1 offset:1024
    v_permlane32_swap_b32 v101, v104
    v_exp_f32 v87, v87
    v_fma_f32 v80, v80, v41, v41
    v_fma_f32 v81, v81, v41, v41
    v_fma_f32 v82, v82, v41, v41
    v_fma_f32 v83, v83, v41, v41
    v_fma_f32 v84, v84, v41, v41
    v_mfma_f32_32x32x16_bf16 v[16:31], v[240:243], a[232:235], v[16:31]
    ds_read_b128 a[232:235], v1 offset:2048
    v_fma_f32 v85, v85, v41, v41
    v_fma_f32 v86, v86, v41, v41
    v_fma_f32 v87, v87, v41, v41
    v_rcp_f32 v80, v80
    v_rcp_f32 v81, v81
    v_rcp_f32 v82, v82
    v_mfma_f32_32x32x16_bf16 v[16:31], a[248:251], v[96:99], v[16:31]
    v_rcp_f32 v83, v83
    v_rcp_f32 v84, v84
    v_rcp_f32 v85, v85
    v_rcp_f32 v86, v86
    v_rcp_f32 v87, v87
    s_waitcnt lgkmcnt(4)
    v_mfma_f32_32x32x16_bf16 v[16:31], v[244:247], a[236:239], v[16:31]
    ds_read_b128 a[236:239], v1 offset:3072
    v_mul_f32 v80, v80, v56
    v_mul_f32 v81, v81, v57
    v_mul_f32 v82, v82, v58
    v_mul_f32 v83, v83, v59
    v_mul_f32 v84, v84, v60
    v_mul_f32 v85, v85, v61
    v_mul_f32 v86, v86, v62
    v_mul_f32 v87, v87, v63
    v_cvt_pk_bf16_f32 v56, v80, v81
    v_mfma_f32_32x32x16_bf16 v[16:31], v[248:251], a[240:243], v[16:31]
    ds_read_b128 a[240:243], v1 offset:4112
    v_cvt_pk_bf16_f32 v57, v82, v83
    v_cvt_pk_bf16_f32 v58, v84, v85
    v_cvt_pk_bf16_f32 v59, v86, v87
    s_bitcmp1_b32 s33, 0
    s_cbranch_scc1 Lre36
    buffer_store_dwordx4 v[56:59], v1, s[4:7], s86 offen offset:1024
Lok36:
    s_waitcnt lgkmcnt(4)
    v_mfma_f32_32x32x16_bf16 v[16:31], v[252:255], a[244:247], v[16:31]
    ds_read_b128 a[244:247], v1 offset:5136
    v_mfma_f32_32x32x16_bf16 v[48:63], v[128:131], a[224:227], 0
    ds_read_b128 a[224:227], v1 offset:6160
    v_lshrrev_b32 v111, 6, v1
    v_mul_u32_u24 v111, 3072, v111
    v_and_or_b32 v111, v1, 48, v111
    s_waitcnt lgkmcnt(4)
    v_mfma_f32_32x32x16_bf16 v[48:63], v[132:135], a[228:231], v[48:63]
    ds_read_b128 a[228:231], v1 offset:7184
    s_barrier
    s_nop 1
    v_mul_f32 v80, v16, v16
    v_mul_f32 v81, v17, v17
    v_mul_f32 v82, v18, v18
    v_mul_f32 v83, v19, v19
    v_mul_f32 v84, v20, v20
    v_mul_f32 v85, v21, v21
    v_mfma_f32_32x32x16_bf16 v[48:63], v[136:139], a[232:235], v[48:63]
    ds_read_b128 a[232:235], v1 offset:8224
    s_add_u32 m0, s22, 0x10100
    s_mov_b32 s87, s37
    buffer_load_dwordx4 v111, s[12:15], s87 offen lds
    v_mul_f32 v86, v22, v22
    v_mul_f32 v87, v23, v23
    v_fma_f32 v80, v80, v101, v100
    v_fma_f32 v81, v81, v101, v100
    s_waitcnt lgkmcnt(4)
    v_mfma_f32_32x32x16_bf16 v[48:63], v[140:143], a[236:239], v[48:63]
    ds_read_b128 a[236:239], v1 offset:9248
    v_fma_f32 v82, v82, v101, v100
    v_fma_f32 v83, v83, v101, v100
    v_fma_f32 v84, v84, v101, v100
    v_fma_f32 v85, v85, v101, v100
    v_fma_f32 v86, v86, v101, v100
    v_fma_f32 v87, v87, v101, v100
    v_mul_f32 v80, v80, v16
    v_mfma_f32_32x32x16_bf16 v[48:63], v[144:147], a[240:243], v[48:63]
    ds_read_b128 a[240:243], v1 offset:10272
    s_add_u32 s90, s37, 0xbc00
    buffer_load_dwordx4 v111, s[12:15], s90 offen offset:1024 lds
    v_mul_f32 v81, v81, v17
    v_mul_f32 v82, v82, v18
    v_mul_f32 v83, v83, v19
    v_mul_f32 v84, v84, v20
    s_waitcnt lgkmcnt(4)
    v_mfma_f32_32x32x16_bf16 v[48:63], v[148:151], a[244:247], v[48:63]
    ds_read_b128 a[244:247], v1 offset:11296
    v_mul_f32 v85, v85, v21
    v_mul_f32 v86, v86, v22
    v_mul_f32 v87, v87, v23
    v_exp_f32 v80, v80
    v_exp_f32 v81, v81
    v_mfma_f32_32x32x16_bf16 v[48:63], v[152:155], a[224:227], v[48:63]
    ds_read_b128 a[224:227], v1 offset:12336
    s_add_u32 s88, s37, 0x17800
    buffer_load_dwordx4 v111, s[12:15], s88 offen offset:2048 lds
    v_exp_f32 v82, v82
    v_exp_f32 v83, v83
    s_waitcnt lgkmcnt(4)
    v_mfma_f32_32x32x16_bf16 v[48:63], v[156:159], a[228:231], v[48:63]
    ds_read_b128 a[228:231], v1 offset:13360
    v_exp_f32 v84, v84
    v_exp_f32 v85, v85
    v_exp_f32 v86, v86
    v_mfma_f32_32x32x16_bf16 v[48:63], v[160:163], a[232:235], v[48:63]
    ds_read_b128 a[232:235], v1 offset:14384
    s_add_u32 s91, s37, 0x23400
    buffer_load_dwordx4 v111, s[12:15], s91 offen offset:3072 lds
    v_exp_f32 v87, v87
    v_fma_f32 v80, v80, v102, v102
    v_fma_f32 v81, v81, v102, v102
    s_waitcnt lgkmcnt(4)
    v_mfma_f32_32x32x16_bf16 v[48:63], v[164:167], a[236:239], v[48:63]
    ds_read_b128 a[236:239], v1 offset:15408
    v_fma_f32 v82, v82, v102, v102
    v_fma_f32 v83, v83, v102, v102
    v_fma_f32 v84, v84, v102, v102
    v_fma_f32 v85, v85, v102, v102
    v_fma_f32 v86, v86, v102, v102
    v_fma_f32 v87, v87, v102, v102
    v_mfma_f32_32x32x16_bf16 v[48:63], v[168:171], a[240:243], v[48:63]
    ds_read_b128 a[240:243], v1 offset:16448
    s_add_u32 m0, s22, 0x14140
    s_add_u32 s89, s37, 0xc0000
    buffer_load_dwordx4 v111, s[12:15], s89 offen lds
    s_add_u32 s82, s24, 0x1400000
    buffer_load_dwordx4 v[128:131], v1, s[4:7], s82 offen sc1
    s_waitcnt lgkmcnt(4)
    v_mfma_f32_32x32x16_bf16 v[48:63], v[172:175], a[244:247], v[48:63]
    ds_read_b128 a[244:247], v1 offset:17472
    v_rcp_f32 v80, v80
    v_rcp_f32 v81, v81
    v_rcp_f32 v82, v82
    v_mfma_f32_32x32x16_bf16 v[48:63], v[176:179], a[224:227], v[48:63]
    ds_read_b128 a[224:227], v1 offset:18496
    s_add_u32 s83, s37, 0xcbc00
    buffer_load_dwordx4 v111, s[12:15], s83 offen offset:1024 lds
    buffer_load_dwordx4 v[132:135], v1, s[4:7], s82 offen offset:2048 sc1
    s_waitcnt lgkmcnt(4)
    v_mfma_f32_32x32x16_bf16 v[48:63], v[180:183], a[228:231], v[48:63]
    ds_read_b128 a[228:231], v1 offset:19520
    v_rcp_f32 v83, v83
    v_rcp_f32 v84, v84
    v_rcp_f32 v85, v85
    v_mfma_f32_32x32x16_bf16 v[48:63], v[184:187], a[232:235], v[48:63]
    ds_read_b128 a[232:235], v1 offset:20560
    s_add_u32 s84, s37, 0xd7800
    buffer_load_dwordx4 v111, s[12:15], s84 offen offset:2048 lds
    s_add_u32 s80, s24, 0x1401000
    buffer_load_dwordx4 v[136:139], v1, s[4:7], s80 offen sc1
    s_waitcnt lgkmcnt(4)
    v_mfma_f32_32x32x16_bf16 v[48:63], v[188:191], a[236:239], v[48:63]
    ds_read_b128 a[236:239], v1 offset:21584
    v_rcp_f32 v86, v86
    v_rcp_f32 v87, v87
    v_mul_f32 v80, v80, v16
    v_mul_f32 v81, v81, v17
    v_mul_f32 v82, v82, v18
    v_mfma_f32_32x32x16_bf16 v[48:63], v[192:195], a[240:243], v[48:63]
    ds_read_b128 a[240:243], v1 offset:22608
    s_add_u32 s81, s37, 0xe3400
    buffer_load_dwordx4 v111, s[12:15], s81 offen offset:3072 lds
    buffer_load_dwordx4 v[140:143], v1, s[4:7], s80 offen offset:2048 sc1
    s_waitcnt lgkmcnt(4)
    v_mfma_f32_32x32x16_bf16 v[48:63], v[196:199], a[244:247], v[48:63]
    ds_read_b128 a[244:247], v1 offset:23632
    v_mul_f32 v83, v83, v19
    v_mul_f32 v84, v84, v20
    v_mul_f32 v85, v85, v21
    v_mul_f32 v86, v86, v22
    v_mul_f32 v87, v87, v23
    v_cvt_pk_bf16_f32 v16, v80, v81
    v_cvt_pk_bf16_f32 v17, v82, v83
    v_mfma_f32_32x32x16_bf16 v[48:63], v[200:203], a[224:227], v[48:63]
    ds_read_b128 a[224:227], v1 offset:24672
    s_add_u32 s85, s24, 0x1402000
    buffer_load_dwordx4 v[144:147], v1, s[4:7], s85 offen sc1
    v_cvt_pk_bf16_f32 v18, v84, v85
    v_cvt_pk_bf16_f32 v19, v86, v87
    s_waitcnt lgkmcnt(4)
    v_mfma_f32_32x32x16_bf16 v[48:63], v[204:207], a[228:231], v[48:63]
    ds_read_b128 a[228:231], v1 offset:25696
    s_add_u32 s86, s23, 0x141c000
    s_bitcmp1_b32 s33, 0
    s_cbranch_scc1 Lre37
    buffer_store_dwordx4 v[16:19], v1, s[4:7], s86 offen
Lok37:
    v_mul_f32 v80, v24, v24
    v_mul_f32 v81, v25, v25
    v_mfma_f32_32x32x16_bf16 v[48:63], v[208:211], a[232:235], v[48:63]
    ds_read_b128 a[232:235], v1 offset:26720
    buffer_load_dwordx4 v[148:151], v1, s[4:7], s85 offen offset:2048 sc1
    v_mul_f32 v82, v26, v26
    v_mul_f32 v83, v27, v27
    v_mul_f32 v84, v28, v28
    v_mul_f32 v85, v29, v29
    s_waitcnt lgkmcnt(4)
    v_mfma_f32_32x32x16_bf16 v[48:63], v[212:215], a[236:239], v[48:63]
    ds_read_b128 a[236:239], v1 offset:27744
    v_mul_f32 v86, v30, v30
    v_mul_f32 v87, v31, v31
    v_fma_f32 v80, v80, v101, v100
    v_fma_f32 v81, v81, v101, v100
    v_fma_f32 v82, v82, v101, v100
    v_fma_f32 v83, v83, v101, v100
    v_fma_f32 v84, v84, v101, v100
    v_mfma_f32_32x32x16_bf16 v[48:63], v[216:219], a[240:243], v[48:63]
    ds_read_b128 a[240:243], v1 offset:28784
    s_add_u32 s87, s24, 0x1403000
    buffer_load_dwordx4 v[152:155], v1, s[4:7], s87 offen sc1
    v_fma_f32 v85, v85, v101, v100
PAD11:
    s_cbranch_execz WARM2_4
    v_fma_f32 v86, v86, v101, v100
    v_fma_f32 v87, v87, v101, v100
    v_mul_f32 v80, v80, v24
    s_waitcnt lgkmcnt(4)
    v_mfma_f32_32x32x16_bf16 v[48:63], v[220:223], a[244:247], v[48:63]
    ds_read_b128 a[244:247], v1 offset:29808
    v_mul_f32 v81, v81, v25
    v_mul_f32 v82, v82, v26
    v_mul_f32 v83, v83, v27
    v_mul_f32 v84, v84, v28
    v_mul_f32 v85, v85, v29
    v_mul_f32 v86, v86, v30
    v_mul_f32 v87, v87, v31
    v_mfma_f32_32x32x16_bf16 v[48:63], v[224:227], a[224:227], v[48:63]
    ds_read_b128 a[224:227], v1 offset:30832
    buffer_load_dwordx4 v[156:159], v1, s[4:7], s87 offen offset:2048 sc1
    v_exp_f32 v80, v80
    v_exp_f32 v81, v81
    s_waitcnt lgkmcnt(4)
    v_mfma_f32_32x32x16_bf16 v[48:63], v[228:231], a[228:231], v[48:63]
    ds_read_b128 a[228:231], v1 offset:31856
    v_exp_f32 v82, v82
    v_exp_f32 v83, v83
    v_exp_f32 v84, v84
    v_mfma_f32_32x32x16_bf16 v[48:63], v[232:235], a[232:235], v[48:63]
    s_add_u32 s90, s24, 0x1404000
    buffer_load_dwordx4 v[160:163], v1, s[4:7], s90 offen sc1
    v_exp_f32 v85, v85
    v_exp_f32 v86, v86
    s_waitcnt lgkmcnt(4)
    v_mfma_f32_32x32x16_bf16 v[48:63], v[236:239], a[236:239], v[48:63]
    v_exp_f32 v87, v87
    v_fma_f32 v80, v80, v102, v102
    v_fma_f32 v81, v81, v102, v102
    v_fma_f32 v82, v82, v102, v102
    v_fma_f32 v83, v83, v102, v102
    v_fma_f32 v84, v84, v102, v102
    v_fma_f32 v85, v85, v102, v102
    v_fma_f32 v86, v86, v102, v102
    s_waitcnt lgkmcnt(3)
    v_mfma_f32_32x32x16_bf16 v[48:63], v[240:243], a[240:243], v[48:63]
    buffer_load_dwordx4 v[164:167], v1, s[4:7], s90 offen offset:2048 sc1
    v_fma_f32 v87, v87, v102, v102
    v_rcp_f32 v80, v80
    v_rcp_f32 v81, v81
    v_mfma_f32_32x32x16_bf16 v[48:63], a[252:255], v[96:99], v[48:63]
    v_rcp_f32 v82, v82
    v_rcp_f32 v83, v83
    v_rcp_f32 v84, v84
    v_rcp_f32 v85, v85
    s_waitcnt lgkmcnt(2)
    v_mfma_f32_32x32x16_bf16 v[48:63], v[244:247], a[244:247], v[48:63]
    s_add_u32 s88, s24, 0x1405000
    buffer_load_dwordx4 v[168:171], v1, s[4:7], s88 offen sc1
    v_rcp_f32 v86, v86
    v_rcp_f32 v87, v87
    v_mul_f32 v80, v80, v24
    s_waitcnt lgkmcnt(1)
    v_mfma_f32_32x32x16_bf16 v[48:63], v[248:251], a[224:227], v[48:63]
    v_mul_f32 v81, v81, v25
    v_mul_f32 v82, v82, v26
    v_mul_f32 v83, v83, v27
    v_mul_f32 v84, v84, v28
    v_mul_f32 v85, v85, v29
    v_mul_f32 v86, v86, v30
    v_mul_f32 v87, v87, v31
    v_cvt_pk_bf16_f32 v24, v80, v81
    v_cvt_pk_bf16_f32 v25, v82, v83
    s_waitcnt lgkmcnt(0)
    v_mfma_f32_32x32x16_bf16 v[48:63], v[252:255], a[228:231], v[48:63]
    buffer_load_dwordx4 v[172:175], v1, s[4:7], s88 offen offset:2048 sc1
    v_cvt_pk_bf16_f32 v26, v84, v85
    v_cvt_pk_bf16_f32 v27, v86, v87
    s_bitcmp1_b32 s33, 0
    s_cbranch_scc1 Lre38
    buffer_store_dwordx4 v[24:27], v1, s[4:7], s86 offen offset:1024
Lok38:
    s_nop 5
    v_mul_f32 v80, v48, v48
    v_mul_f32 v81, v49, v49
    v_mul_f32 v82, v50, v50
    v_mul_f32 v83, v51, v51
    s_add_u32 s91, s24, 0x1406000
    buffer_load_dwordx4 v[176:179], v1, s[4:7], s91 offen sc1
    v_mul_f32 v84, v52, v52
    v_mul_f32 v85, v53, v53
    v_mul_f32 v86, v54, v54
    v_mul_f32 v87, v55, v55
    v_fma_f32 v80, v80, v104, v103
    v_fma_f32 v81, v81, v104, v103
    v_fma_f32 v82, v82, v104, v103
    v_fma_f32 v83, v83, v104, v103
    buffer_load_dwordx4 v[180:183], v1, s[4:7], s91 offen offset:2048 sc1
    v_fma_f32 v84, v84, v104, v103
    v_fma_f32 v85, v85, v104, v103
    v_fma_f32 v86, v86, v104, v103
    v_fma_f32 v87, v87, v104, v103
    v_mul_f32 v80, v80, v48
    v_mul_f32 v81, v81, v49
    v_mul_f32 v82, v82, v50
    v_mul_f32 v83, v83, v51
    buffer_load_dwordx4 v[184:187], v1, s[4:7], s82 offen offset:1024 sc1
    v_mul_f32 v84, v84, v52
    v_mul_f32 v85, v85, v53
    v_mul_f32 v86, v86, v54
    v_mul_f32 v87, v87, v55
    v_exp_f32 v80, v80
    v_exp_f32 v81, v81
    v_exp_f32 v82, v82
    v_exp_f32 v83, v83
    buffer_load_dwordx4 v[188:191], v1, s[4:7], s82 offen offset:3072 sc1
    v_exp_f32 v84, v84
    v_exp_f32 v85, v85
    v_exp_f32 v86, v86
    v_exp_f32 v87, v87
    v_fma_f32 v80, v80, v105, v105
    v_fma_f32 v81, v81, v105, v105
    v_fma_f32 v82, v82, v105, v105
    v_fma_f32 v83, v83, v105, v105
    buffer_load_dwordx4 v[192:195], v1, s[4:7], s80 offen offset:1024 sc1
    v_fma_f32 v84, v84, v105, v105
    v_fma_f32 v85, v85, v105, v105
    v_fma_f32 v86, v86, v105, v105
    v_fma_f32 v87, v87, v105, v105
    v_rcp_f32 v80, v80
    v_rcp_f32 v81, v81
    v_rcp_f32 v82, v82
    v_rcp_f32 v83, v83
    buffer_load_dwordx4 v[196:199], v1, s[4:7], s80 offen offset:3072 sc1
    v_rcp_f32 v84, v84
    v_rcp_f32 v85, v85
    v_rcp_f32 v86, v86
    v_rcp_f32 v87, v87
    v_mul_f32 v80, v80, v48
    v_mul_f32 v81, v81, v49
    v_mul_f32 v82, v82, v50
    v_mul_f32 v83, v83, v51
    v_mul_f32 v84, v84, v52
    v_mul_f32 v85, v85, v53
    v_mul_f32 v86, v86, v54
    v_mul_f32 v87, v87, v55
    v_cvt_pk_bf16_f32 v48, v80, v81
    v_cvt_pk_bf16_f32 v49, v82, v83
    v_cvt_pk_bf16_f32 v50, v84, v85
    v_cvt_pk_bf16_f32 v51, v86, v87
    s_add_u32 s89, s23, 0x1454000
    s_bitcmp1_b32 s33, 0
    s_cbranch_scc1 Lre39
    buffer_store_dwordx4 v[48:51], v1, s[4:7], s89 offen
Lok39:
    s_waitcnt vmcnt(19)
    v_max3_u32 v7, v128, v132, v136
    s_waitcnt vmcnt(17)
    v_max_u32 v7, v7, v140
    v_cmp_eq_u32 vcc, -1, v7
    s_cbranch_vccnz Lre40
Lok40:
    v_mfma_f32_32x32x16_bf16 v[32:47], a[4:7], v[128:131], 0
    buffer_load_dwordx4 v[200:203], v1, s[4:7], s85 offen offset:1024 sc1
    v_mul_f32 v80, v56, v56
    v_mul_f32 v81, v57, v57
    v_mul_f32 v82, v58, v58
    v_mul_f32 v83, v59, v59
    v_mfma_f32_32x32x16_bf16 v[64:79], a[0:3], v[128:131], 0
    v_mul_f32 v84, v60, v60
    v_mul_f32 v85, v61, v61
    v_mul_f32 v86, v62, v62
    v_mul_f32 v87, v63, v63
    v_fma_f32 v80, v80, v104, v103
    v_fma_f32 v81, v81, v104, v103
    v_fma_f32 v82, v82, v104, v103
    v_mfma_f32_32x32x16_bf16 v[32:47], a[20:23], v[132:135], v[32:47]
    buffer_load_dwordx4 v[204:207], v1, s[4:7], s85 offen offset:3072 sc1
    v_fma_f32 v83, v83, v104, v103
    v_fma_f32 v84, v84, v104, v103
    v_fma_f32 v85, v85, v104, v103
    v_fma_f32 v86, v86, v104, v103
    v_mfma_f32_32x32x16_bf16 v[64:79], a[16:19], v[132:135], v[64:79]
    v_fma_f32 v87, v87, v104, v103
    v_mul_f32 v80, v80, v56
    v_mul_f32 v81, v81, v57
    v_mul_f32 v82, v82, v58
    v_mul_f32 v83, v83, v59
    v_mul_f32 v84, v84, v60
    v_mul_f32 v85, v85, v61
    v_mfma_f32_32x32x16_bf16 v[32:47], a[36:39], v[136:139], v[32:47]
    buffer_load_dwordx4 v[208:211], v1, s[4:7], s87 offen offset:1024 sc1
    v_mul_f32 v86, v86, v62
    v_mul_f32 v87, v87, v63
    v_exp_f32 v80, v80
    v_mfma_f32_32x32x16_bf16 v[64:79], a[32:35], v[136:139], v[64:79]
    v_exp_f32 v81, v81
    v_exp_f32 v82, v82
    v_exp_f32 v83, v83
    v_mfma_f32_32x32x16_bf16 v[32:47], a[52:55], v[140:143], v[32:47]
    buffer_load_dwordx4 v[212:215], v1, s[4:7], s87 offen offset:3072 sc1
    v_exp_f32 v84, v84
    v_exp_f32 v85, v85
    v_mfma_f32_32x32x16_bf16 v[64:79], a[48:51], v[140:143], v[64:79]
    v_exp_f32 v86, v86
    s_waitcnt vmcnt(17)
    v_max3_u32 v7, v144, v148, v152
    s_waitcnt vmcnt(16)
    v_max_u32 v7, v7, v156
    v_cmp_eq_u32 vcc, -1, v7
    s_cbranch_vccnz Lre41
Lok41:
    v_mfma_f32_32x32x16_bf16 v[32:47], a[68:71], v[144:147], v[32:47]
    buffer_load_dwordx4 v[216:219], v1, s[4:7], s90 offen offset:1024 sc1
    v_exp_f32 v87, v87
    v_fma_f32 v80, v80, v105, v105
    v_fma_f32 v81, v81, v105, v105
    v_mfma_f32_32x32x16_bf16 v[64:79], a[64:67], v[144:147], v[64:79]
    v_fma_f32 v82, v82, v105, v105
    v_fma_f32 v83, v83, v105, v105
    v_fma_f32 v84, v84, v105, v105
    v_fma_f32 v85, v85, v105, v105
    v_fma_f32 v86, v86, v105, v105
    v_fma_f32 v87, v87, v105, v105
    v_mfma_f32_32x32x16_bf16 v[32:47], a[84:87], v[148:151], v[32:47]
    buffer_load_dwordx4 v[220:223], v1, s[4:7], s90 offen offset:3072 sc1
    v_rcp_f32 v80, v80
    v_rcp_f32 v81, v81
    v_mfma_f32_32x32x16_bf16 v[64:79], a[80:83], v[148:151], v[64:79]
    v_rcp_f32 v82, v82
    v_rcp_f32 v83, v83
    v_rcp_f32 v84, v84
    v_mfma_f32_32x32x16_bf16 v[32:47], a[100:103], v[152:155], v[32:47]
    buffer_load_dwordx4 v[224:227], v1, s[4:7], s88 offen offset:1024 sc1
    v_rcp_f32 v85, v85
    v_rcp_f32 v86, v86
    v_mfma_f32_32x32x16_bf16 v[64:79], a[96:99], v[152:155], v[64:79]
    v_rcp_f32 v87, v87
    v_mul_f32 v80, v80, v56
    v_mul_f32 v81, v81, v57
    v_mul_f32 v82, v82, v58
    v_mul_f32 v83, v83, v59
    v_mul_f32 v84, v84, v60
    v_mfma_f32_32x32x16_bf16 v[32:47], a[116:119], v[156:159], v[32:47]
    buffer_load_dwordx4 v[228:231], v1, s[4:7], s88 offen offset:3072 sc1
    v_mul_f32 v85, v85, v61
    v_mul_f32 v86, v86, v62
    v_mul_f32 v87, v87, v63
    v_cvt_pk_bf16_f32 v56, v80, v81
    v_mfma_f32_32x32x16_bf16 v[64:79], a[112:115], v[156:159], v[64:79]
    v_cvt_pk_bf16_f32 v57, v82, v83
    v_cvt_pk_bf16_f32 v58, v84, v85
    v_cvt_pk_bf16_f32 v59, v86, v87
    s_waitcnt vmcnt(15)
    v_max3_u32 v7, v160, v164, v168
    s_waitcnt vmcnt(14)
    v_max_u32 v7, v7, v172
    v_cmp_eq_u32 vcc, -1, v7
    s_cbranch_vccnz Lre42
Lok42:
    v_mfma_f32_32x32x16_bf16 v[32:47], a[132:135], v[160:163], v[32:47]
    buffer_load_dwordx4 v[232:235], v1, s[4:7], s91 offen offset:1024 sc1
    s_bitcmp1_b32 s33, 0
    s_cbranch_scc1 Lre43
    buffer_store_dwordx4 v[56:59], v1, s[4:7], s89 offen offset:1024
Lok43:
    v_mfma_f32_32x32x16_bf16 v[64:79], a[128:131], v[160:163], v[64:79]
    v_lshlrev_b32 v16, 4, v1
    s_mov_b32 s83, 0x5f0004
    buffer_load_dword v17, v16, s[4:7], s83 offen sc1
    v_mfma_f32_32x32x16_bf16 v[32:47], a[148:151], v[164:167], v[32:47]
    buffer_load_dwordx4 v[236:239], v1, s[4:7], s91 offen offset:3072 sc1
    v_mfma_f32_32x32x16_bf16 v[64:79], a[144:147], v[164:167], v[64:79]
    v_mfma_f32_32x32x16_bf16 v[32:47], a[164:167], v[168:171], v[32:47]
    v_mfma_f32_32x32x16_bf16 v[64:79], a[160:163], v[168:171], v[64:79]
    v_mfma_f32_32x32x16_bf16 v[32:47], a[180:183], v[172:175], v[32:47]
    v_mfma_f32_32x32x16_bf16 v[64:79], a[176:179], v[172:175], v[64:79]
    s_waitcnt vmcnt(15)
    v_max3_u32 v7, v176, v180, v184
    s_waitcnt vmcnt(14)
    v_max_u32 v7, v7, v188
    v_cmp_eq_u32 vcc, -1, v7
    s_cbranch_vccnz Lre44
Lok44:
    v_mfma_f32_32x32x16_bf16 v[32:47], a[196:199], v[176:179], v[32:47]
    s_add_u32 s84, s24, 0x141c000
    buffer_load_dwordx4 v[240:243], v1, s[4:7], s84 offen sc1
    v_mfma_f32_32x32x16_bf16 v[64:79], a[192:195], v[176:179], v[64:79]
    v_mfma_f32_32x32x16_bf16 v[32:47], a[212:215], v[180:183], v[32:47]
    buffer_load_dwordx4 v[244:247], v1, s[4:7], s84 offen offset:2048 sc1
    v_mfma_f32_32x32x16_bf16 v[64:79], a[208:211], v[180:183], v[64:79]
    v_mfma_f32_32x32x16_bf16 v[32:47], a[12:15], v[184:187], v[32:47]
    s_add_u32 s81, s24, 0x141d000
    buffer_load_dwordx4 v[248:251], v1, s[4:7], s81 offen sc1
    v_mfma_f32_32x32x16_bf16 v[64:79], a[8:11], v[184:187], v[64:79]
    v_mfma_f32_32x32x16_bf16 v[32:47], a[28:31], v[188:191], v[32:47]
    buffer_load_dwordx4 v[252:255], v1, s[4:7], s81 offen offset:2048 sc1
    v_mfma_f32_32x32x16_bf16 v[64:79], a[24:27], v[188:191], v[64:79]
    s_waitcnt vmcnt(15)
    v_max3_u32 v7, v192, v196, v200
    s_waitcnt vmcnt(14)
    v_max_u32 v7, v7, v204
    v_cmp_eq_u32 vcc, -1, v7
    s_cbranch_vccnz Lre45
Lok45:
    v_mfma_f32_32x32x16_bf16 v[32:47], a[44:47], v[192:195], v[32:47]
    s_add_u32 s86, s24, 0x141e000
    buffer_load_dwordx4 v[128:131], v1, s[4:7], s86 offen sc1
    v_mfma_f32_32x32x16_bf16 v[64:79], a[40:43], v[192:195], v[64:79]
    v_mfma_f32_32x32x16_bf16 v[32:47], a[60:63], v[196:199], v[32:47]
    buffer_load_dwordx4 v[132:135], v1, s[4:7], s86 offen offset:2048 sc1
    v_mfma_f32_32x32x16_bf16 v[64:79], a[56:59], v[196:199], v[64:79]
    v_mfma_f32_32x32x16_bf16 v[32:47], a[76:79], v[200:203], v[32:47]
    s_add_u32 s82, s24, 0x141f000
    buffer_load_dwordx4 v[136:139], v1, s[4:7], s82 offen sc1
    v_mfma_f32_32x32x16_bf16 v[64:79], a[72:75], v[200:203], v[64:79]
    v_mfma_f32_32x32x16_bf16 v[32:47], a[92:95], v[204:207], v[32:47]
    buffer_load_dwordx4 v[140:143], v1, s[4:7], s82 offen offset:2048 sc1
    v_mfma_f32_32x32x16_bf16 v[64:79], a[88:91], v[204:207], v[64:79]
    s_waitcnt vmcnt(13)
    v_max3_u32 v7, v208, v212, v216
    s_waitcnt vmcnt(12)
    v_max_u32 v7, v7, v220
    v_cmp_eq_u32 vcc, -1, v7
    s_cbranch_vccnz Lre46
Lok46:
    v_mfma_f32_32x32x16_bf16 v[32:47], a[108:111], v[208:211], v[32:47]
    s_add_u32 s80, s24, 0x1420000
    buffer_load_dwordx4 v[144:147], v1, s[4:7], s80 offen sc1
    v_mfma_f32_32x32x16_bf16 v[64:79], a[104:107], v[208:211], v[64:79]
    v_mfma_f32_32x32x16_bf16 v[32:47], a[124:127], v[212:215], v[32:47]
    buffer_load_dwordx4 v[148:151], v1, s[4:7], s80 offen offset:2048 sc1
    v_mfma_f32_32x32x16_bf16 v[64:79], a[120:123], v[212:215], v[64:79]
    v_mfma_f32_32x32x16_bf16 v[32:47], a[140:143], v[216:219], v[32:47]
    s_add_u32 s85, s24, 0x1421000
    buffer_load_dwordx4 v[152:155], v1, s[4:7], s85 offen sc1
    v_mfma_f32_32x32x16_bf16 v[64:79], a[136:139], v[216:219], v[64:79]
    v_mfma_f32_32x32x16_bf16 v[32:47], a[156:159], v[220:223], v[32:47]
    buffer_load_dwordx4 v[156:159], v1, s[4:7], s85 offen offset:2048 sc1
    v_mfma_f32_32x32x16_bf16 v[64:79], a[152:155], v[220:223], v[64:79]
    s_waitcnt vmcnt(9)
    v_max3_u32 v7, v224, v228, v232
    s_waitcnt vmcnt(8)
    v_max_u32 v7, v7, v236
    v_cmp_eq_u32 vcc, -1, v7
    s_cbranch_vccnz Lre47
Lok47:
    v_mfma_f32_32x32x16_bf16 v[32:47], a[172:175], v[224:227], v[32:47]
    s_add_u32 s87, s24, 0x1422000
    buffer_load_dwordx4 v[160:163], v1, s[4:7], s87 offen sc1
    v_mfma_f32_32x32x16_bf16 v[64:79], a[168:171], v[224:227], v[64:79]
    v_mfma_f32_32x32x16_bf16 v[32:47], a[188:191], v[228:231], v[32:47]
    buffer_load_dwordx4 v[164:167], v1, s[4:7], s87 offen offset:2048 sc1
    v_mfma_f32_32x32x16_bf16 v[64:79], a[184:187], v[228:231], v[64:79]
    v_mfma_f32_32x32x16_bf16 v[32:47], a[204:207], v[232:235], v[32:47]
    buffer_load_dwordx4 v[168:171], v1, s[4:7], s84 offen offset:1024 sc1
    v_mfma_f32_32x32x16_bf16 v[64:79], a[200:203], v[232:235], v[64:79]
    v_cmp_ne_u32 vcc, 16, v17
    s_cbranch_vccnz Lre48
Lok48:
    v_mfma_f32_32x32x16_bf16 v[32:47], a[220:223], v[236:239], v[32:47]
    buffer_load_dwordx4 v[172:175], v1, s[4:7], s84 offen offset:3072 sc1
    v_mfma_f32_32x32x16_bf16 v[64:79], a[216:219], v[236:239], v[64:79]
    buffer_load_dwordx4 v[176:179], v1, s[4:7], s81 offen offset:1024 sc1
    v_max3_u32 v7, v240, v244, v248
    v_max_u32 v7, v7, v252
    v_cmp_eq_u32 vcc, -1, v7
    s_cbranch_vccnz Lre49
Lok49:
    v_mfma_f32_32x32x16_bf16 v[48:63], a[4:7], v[240:243], 0
    s_nop 3
    ds_write_b128 v122, v[32:35] offset:2048
    ds_write_b128 v122, v[36:39] offset:3072
    ds_write_b128 v123, v[40:43] offset:4096
    ds_write_b128 v123, v[44:47] offset:5120
    ds_write_b128 v121, v[72:75] offset:0
    ds_write_b128 v121, v[76:79] offset:1024
    v_lshlrev_b32 v85, 16, v8
    v_mfma_f32_32x32x16_bf16 v[16:31], a[0:3], v[240:243], 0
    buffer_load_dwordx4 v[180:183], v1, s[4:7], s81 offen offset:3072 sc1
    v_and_b32 v86, 0xffff0000, v8
    v_add_f32 v64, v64, v85
    v_add_f32 v65, v65, v86
    v_lshlrev_b32 v85, 16, v9
    v_and_b32 v86, 0xffff0000, v9
    v_add_f32 v66, v66, v85
    v_mfma_f32_32x32x16_bf16 v[48:63], a[20:23], v[244:247], v[48:63]
    v_add_f32 v67, v67, v86
    v_lshlrev_b32 v85, 16, v10
    v_and_b32 v86, 0xffff0000, v10
    v_add_f32 v68, v68, v85
    v_add_f32 v69, v69, v86
    v_lshlrev_b32 v85, 16, v11
    v_and_b32 v86, 0xffff0000, v11
    v_add_f32 v70, v70, v85
    v_add_f32 v71, v71, v86
    s_waitcnt lgkmcnt(0)
    s_barrier
    v_mfma_f32_32x32x16_bf16 v[16:31], a[16:19], v[244:247], v[16:31]
    buffer_load_dwordx4 v[184:187], v1, s[4:7], s86 offen offset:1024 sc1
    ds_read_b128 v[72:75], v120 offset:0
    ds_read_b128 v[32:35], v120 offset:2048
    ds_read_b128 v[40:43], v120 offset:4096
    ds_read_b128 v[76:79], v120 offset:1024
    v_mfma_f32_32x32x16_bf16 v[48:63], a[36:39], v[248:251], v[48:63]
    ds_read_b128 v[36:39], v120 offset:3072
    ds_read_b128 v[44:47], v120 offset:5120
    v_add_f32 v64, v64, v112
    v_add_f32 v65, v65, v113
    v_add_f32 v66, v66, v114
    v_add_f32 v67, v67, v115
    v_add_f32 v68, v68, v116
    v_add_f32 v69, v69, v117
    v_add_f32 v70, v70, v118
    v_mfma_f32_32x32x16_bf16 v[16:31], a[32:35], v[248:251], v[16:31]
    buffer_load_dwordx4 v[188:191], v1, s[4:7], s86 offen offset:3072 sc1
    v_add_f32 v71, v71, v119
    s_waitcnt lgkmcnt(5)
    v_add_f32 v64, v64, v72
    v_add_f32 v65, v65, v73
    v_add_f32 v66, v66, v74
    v_add_f32 v67, v67, v75
    s_waitcnt lgkmcnt(4)
    v_add_f32 v64, v64, v32
    v_mfma_f32_32x32x16_bf16 v[48:63], a[52:55], v[252:255], v[48:63]
    v_add_f32 v65, v65, v33
    v_add_f32 v66, v66, v34
    v_add_f32 v67, v67, v35
    s_waitcnt lgkmcnt(3)
    v_add_f32 v64, v64, v40
    v_add_f32 v65, v65, v41
    v_add_f32 v66, v66, v42
    v_add_f32 v67, v67, v43
    v_cvt_pk_bf16_f32 v8, v64, v65
    v_cvt_pk_bf16_f32 v9, v66, v67
    s_waitcnt lgkmcnt(2)
    v_add_f32 v68, v68, v76
    v_mfma_f32_32x32x16_bf16 v[16:31], a[48:51], v[252:255], v[16:31]
    buffer_load_dwordx4 v[192:195], v1, s[4:7], s82 offen offset:1024 sc1
    v_add_f32 v69, v69, v77
    v_add_f32 v70, v70, v78
    s_waitcnt vmcnt(14)
    v_max3_u32 v7, v128, v132, v136
    s_waitcnt vmcnt(13)
    v_max_u32 v7, v7, v140
    v_cmp_eq_u32 vcc, -1, v7
    s_cbranch_vccnz Lre50
Lok50:
    v_mfma_f32_32x32x16_bf16 v[48:63], a[68:71], v[128:131], v[48:63]
    v_add_f32 v71, v71, v79
    s_waitcnt lgkmcnt(1)
    v_add_f32 v68, v68, v36
    v_add_f32 v69, v69, v37
    v_add_f32 v70, v70, v38
    v_add_f32 v71, v71, v39
    s_waitcnt lgkmcnt(0)
    v_add_f32 v68, v68, v44
    v_add_f32 v69, v69, v45
    v_add_f32 v70, v70, v46
    v_add_f32 v71, v71, v47
    v_cvt_pk_bf16_f32 v10, v68, v69
    v_mfma_f32_32x32x16_bf16 v[16:31], a[64:67], v[128:131], v[16:31]
    buffer_load_dwordx4 v[196:199], v1, s[4:7], s82 offen offset:3072 sc1
    v_cvt_pk_bf16_f32 v11, v70, v71
    s_add_u32 s90, s16, 0x1b00000
    s_bitcmp1_b32 s33, 0
    s_cbranch_scc1 Lre51
    buffer_store_dwordx4 v[8:11], v1, s[4:7], s90 offen
Lok51:
    v_mfma_f32_32x32x16_bf16 v[48:63], a[84:87], v[132:135], v[48:63]
    v_dot2_f32_bf16 v32, v8, s52, 0
    v_dot2_f32_bf16 v33, v8, v8, 0
    v_dot2_f32_bf16 v32, v9, s52, v32
    v_mfma_f32_32x32x16_bf16 v[16:31], a[80:83], v[132:135], v[16:31]
    buffer_load_dwordx4 v[200:203], v1, s[4:7], s80 offen offset:1024 sc1
    v_dot2_f32_bf16 v33, v9, v9, v33
    v_mfma_f32_32x32x16_bf16 v[48:63], a[100:103], v[136:139], v[48:63]
    v_dot2_f32_bf16 v32, v10, s52, v32
    v_dot2_f32_bf16 v33, v10, v10, v33
    v_dot2_f32_bf16 v32, v11, s52, v32
    v_mfma_f32_32x32x16_bf16 v[16:31], a[96:99], v[136:139], v[16:31]
    buffer_load_dwordx4 v[204:207], v1, s[4:7], s80 offen offset:3072 sc1
    v_dot2_f32_bf16 v33, v11, v11, v33
    v_mfma_f32_32x32x16_bf16 v[48:63], a[116:119], v[140:143], v[48:63]
    s_nop 1
    v_permlane32_swap_b32 v32, v33
    v_add_f32 v32, v32, v33
    ds_write_b32 v126, v32 offset:24576
    s_waitcnt lgkmcnt(0)
    s_barrier
    v_mfma_f32_32x32x16_bf16 v[16:31], a[112:115], v[140:143], v[16:31]
    buffer_load_dwordx4 v[208:211], v1, s[4:7], s85 offen offset:1024 sc1
    s_waitcnt vmcnt(15)
    v_max3_u32 v7, v144, v148, v152
    s_waitcnt vmcnt(14)
    v_max_u32 v7, v7, v156
    v_cmp_eq_u32 vcc, -1, v7
    s_cbranch_vccnz Lre52
Lok52:
    v_mfma_f32_32x32x16_bf16 v[48:63], a[132:135], v[144:147], v[48:63]
    ds_read_b128 v[36:39], v125 offset:24576
    s_waitcnt lgkmcnt(0)
    v_add_f32 v36, v36, v37
    v_add_f32 v38, v38, v39
    v_add_f32 v36, v36, v38
    v_mfma_f32_32x32x16_bf16 v[16:31], a[128:131], v[144:147], v[16:31]
    buffer_load_dwordx4 v[212:215], v1, s[4:7], s85 offen offset:3072 sc1
    v_mfma_f32_32x32x16_bf16 v[48:63], a[148:151], v[148:151], v[48:63]
    s_mov_b64 exec, s[50:51]
    s_add_u32 s88, s18, 0x640000
    s_bitcmp1_b32 s33, 0
    s_cbranch_scc1 Lre53
    buffer_store_dword v36, v127, s[4:7], s88 offen
Lok53:
    s_mov_b64 exec, -1
    v_mfma_f32_32x32x16_bf16 v[16:31], a[144:147], v[148:151], v[16:31]
    buffer_load_dwordx4 v[216:219], v1, s[4:7], s87 offen offset:1024 sc1
    v_lshrrev_b32 v82, 1, v1
    v_lshrrev_b32 v80, 3, v1
    v_mfma_f32_32x32x16_bf16 v[48:63], a[164:167], v[152:155], v[48:63]
    v_and_b32 v82, 0x118, v82
    v_and_or_b32 v82, v80, 32, v82
    v_and_b32 v80, 0xc0, v1
    v_add3_u32 v82, v82, v80, s47
    v_subrev_u32 v80, s22, v124
    v_xor_b32 v80, s46, v80
    v_mfma_f32_32x32x16_bf16 v[16:31], a[160:163], v[152:155], v[16:31]
    buffer_load_dwordx4 v[220:223], v1, s[4:7], s87 offen offset:3072 sc1
    v_add_u32 v80, s45, v80
    v_xor_b32 v81, 64, v80
    v_mfma_f32_32x32x16_bf16 v[48:63], a[180:183], v[156:159], v[48:63]
    v_and_b32 v83, 512, v3
    v_add_u32 v83, v83, v3
    v_xor_b32 v84, 256, v122
    s_mov_b32 s89, s39
    buffer_load_dwordx4 a[248:251], v1, s[4:7], s89 offen sc1
    v_mfma_f32_32x32x16_bf16 v[16:31], a[176:179], v[156:159], v[16:31]
    s_waitcnt vmcnt(16)
    v_max3_u32 v7, v160, v164, v168
    s_waitcnt vmcnt(15)
    v_max_u32 v7, v7, v172
    v_cmp_eq_u32 vcc, -1, v7
    s_cbranch_vccnz Lre54
Lok54:
    v_mfma_f32_32x32x16_bf16 v[48:63], a[196:199], v[160:163], v[48:63]
    s_mov_b32 s83, s40
    buffer_load_dwordx4 a[252:255], v1, s[4:7], s83 offen sc1
    v_mfma_f32_32x32x16_bf16 v[16:31], a[192:195], v[160:163], v[16:31]
    ds_read_b64_tr_b16 a[224:225], v80 offset:0
    ds_read_b64_tr_b16 a[226:227], v80 offset:1024
    ds_read_b64_tr_b16 a[228:229], v81 offset:0
    ds_read_b64_tr_b16 a[230:231], v81 offset:1024
    v_mfma_f32_32x32x16_bf16 v[48:63], a[212:215], v[164:167], v[48:63]
    ds_read_b64_tr_b16 a[232:233], v82 offset:0
    ds_read_b64_tr_b16 a[234:235], v82 offset:512
    ds_read_b64_tr_b16 a[236:237], v80 offset:2048
    ds_read_b64_tr_b16 a[238:239], v80 offset:3072
    v_mfma_f32_32x32x16_bf16 v[16:31], a[208:211], v[164:167], v[16:31]
    ds_read_b64_tr_b16 a[240:241], v81 offset:2048
    ds_read_b64_tr_b16 a[242:243], v81 offset:3072
    ds_read_b64_tr_b16 a[244:245], v82 offset:1024
    ds_read_b64_tr_b16 a[246:247], v82 offset:1536
    v_mfma_f32_32x32x16_bf16 v[48:63], a[12:15], v[168:171], v[48:63]
    s_add_u32 s91, s25, 0x1b00000
    buffer_load_dwordx4 v[224:227], v3, s[4:7], s91 offen sc1
    v_mfma_f32_32x32x16_bf16 v[16:31], a[8:11], v[168:171], v[16:31]
    v_mfma_f32_32x32x16_bf16 v[48:63], a[28:31], v[172:175], v[48:63]
    buffer_load_dwordx4 v[228:231], v3, s[4:7], s91 offen offset:1024 sc1
    v_mfma_f32_32x32x16_bf16 v[16:31], a[24:27], v[172:175], v[16:31]
    s_waitcnt vmcnt(14)
    v_max3_u32 v7, v176, v180, v184
    s_waitcnt vmcnt(13)
    v_max_u32 v7, v7, v188
    v_cmp_eq_u32 vcc, -1, v7
    s_cbranch_vccnz Lre55
Lok55:
    v_mfma_f32_32x32x16_bf16 v[48:63], a[44:47], v[176:179], v[48:63]
    buffer_load_dwordx4 v[232:235], v3, s[4:7], s91 offen offset:2048 sc1
    v_mfma_f32_32x32x16_bf16 v[16:31], a[40:43], v[176:179], v[16:31]
    v_mfma_f32_32x32x16_bf16 v[48:63], a[60:63], v[180:183], v[48:63]
    buffer_load_dwordx4 v[236:239], v3, s[4:7], s91 offen offset:3072 sc1
    v_mfma_f32_32x32x16_bf16 v[16:31], a[56:59], v[180:183], v[16:31]
    v_mfma_f32_32x32x16_bf16 v[48:63], a[76:79], v[184:187], v[48:63]
    s_add_u32 s84, s25, 0x1b01000
    buffer_load_dwordx4 v[240:243], v3, s[4:7], s84 offen sc1
    v_mfma_f32_32x32x16_bf16 v[16:31], a[72:75], v[184:187], v[16:31]
    v_mfma_f32_32x32x16_bf16 v[48:63], a[92:95], v[188:191], v[48:63]
    buffer_load_dwordx4 v[244:247], v3, s[4:7], s84 offen offset:1024 sc1
    v_mfma_f32_32x32x16_bf16 v[16:31], a[88:91], v[188:191], v[16:31]
    s_waitcnt vmcnt(12)
    v_max3_u32 v7, v192, v196, v200
    s_waitcnt vmcnt(11)
    v_max_u32 v7, v7, v204
    v_cmp_eq_u32 vcc, -1, v7
    s_cbranch_vccnz Lre56
Lok56:
    v_mfma_f32_32x32x16_bf16 v[48:63], a[108:111], v[192:195], v[48:63]
    buffer_load_dwordx4 v[248:251], v3, s[4:7], s84 offen offset:2048 sc1
    v_mfma_f32_32x32x16_bf16 v[16:31], a[104:107], v[192:195], v[16:31]
    v_mfma_f32_32x32x16_bf16 v[48:63], a[124:127], v[196:199], v[48:63]
    buffer_load_dwordx4 v[252:255], v3, s[4:7], s84 offen offset:3072 sc1
    v_mfma_f32_32x32x16_bf16 v[16:31], a[120:123], v[196:199], v[16:31]
    v_mfma_f32_32x32x16_bf16 v[48:63], a[140:143], v[200:203], v[48:63]
    s_add_u32 s81, s25, 0x1b02000
    buffer_load_dwordx4 v[128:131], v3, s[4:7], s81 offen sc1
    v_mfma_f32_32x32x16_bf16 v[16:31], a[136:139], v[200:203], v[16:31]
    v_mfma_f32_32x32x16_bf16 v[48:63], a[156:159], v[204:207], v[48:63]
    buffer_load_dwordx4 v[132:135], v3, s[4:7], s81 offen offset:1024 sc1
    v_mfma_f32_32x32x16_bf16 v[16:31], a[152:155], v[204:207], v[16:31]
    s_waitcnt vmcnt(9)
    v_max3_u32 v7, v208, v212, v216
    s_waitcnt vmcnt(8)
    v_max_u32 v7, v7, v220
    v_cmp_eq_u32 vcc, -1, v7
    s_cbranch_vccnz Lre57
Lok57:
    v_mfma_f32_32x32x16_bf16 v[48:63], a[172:175], v[208:211], v[48:63]
    buffer_load_dwordx4 v[136:139], v3, s[4:7], s81 offen offset:2048 sc1
    v_mfma_f32_32x32x16_bf16 v[16:31], a[168:171], v[208:211], v[16:31]
    v_mfma_f32_32x32x16_bf16 v[48:63], a[188:191], v[212:215], v[48:63]
    buffer_load_dwordx4 v[140:143], v3, s[4:7], s81 offen offset:3072 sc1
    v_mfma_f32_32x32x16_bf16 v[16:31], a[184:187], v[212:215], v[16:31]
    v_mfma_f32_32x32x16_bf16 v[48:63], a[204:207], v[216:219], v[48:63]
    s_add_u32 s86, s25, 0x1b03000
    buffer_load_dwordx4 v[144:147], v3, s[4:7], s86 offen sc1
    v_mfma_f32_32x32x16_bf16 v[16:31], a[200:203], v[216:219], v[16:31]
    v_mfma_f32_32x32x16_bf16 v[48:63], a[220:223], v[220:223], v[48:63]
    buffer_load_dwordx4 v[148:151], v3, s[4:7], s86 offen offset:1024 sc1
    v_mfma_f32_32x32x16_bf16 v[16:31], a[216:219], v[220:223], v[16:31]
    s_nop 9
    ds_write_b128 v122, v[48:51] offset:2048
    ds_write_b128 v122, v[52:55] offset:3072
    buffer_load_dwordx4 v[152:155], v3, s[4:7], s86 offen offset:2048 sc1
    ds_write_b128 v123, v[56:59] offset:4096
    ds_write_b128 v123, v[60:63] offset:5120
    ds_write_b128 v121, v[24:27] offset:0
    ds_write_b128 v121, v[28:31] offset:1024
    buffer_load_dwordx4 v[156:159], v3, s[4:7], s86 offen offset:3072 sc1
    v_lshlrev_b32 v85, 16, v12
    v_and_b32 v86, 0xffff0000, v12
    v_add_f32 v16, v16, v85
    v_add_f32 v17, v17, v86
    v_lshlrev_b32 v85, 16, v13
    v_and_b32 v86, 0xffff0000, v13
    v_add_f32 v18, v18, v85
    v_add_f32 v19, v19, v86
    v_lshlrev_b32 v85, 16, v14
    v_and_b32 v86, 0xffff0000, v14
    v_add_f32 v20, v20, v85
    v_add_f32 v21, v21, v86
    v_lshlrev_b32 v85, 16, v15
    v_and_b32 v86, 0xffff0000, v15
    v_add_f32 v22, v22, v85
    v_add_f32 v23, v23, v86
    s_waitcnt vmcnt(13)
    v_max3_u32 v7, v224, v228, v232
    s_waitcnt vmcnt(12)
    v_max_u32 v7, v7, v236
    v_cmp_eq_u32 vcc, -1, v7
    s_cbranch_vccnz Lre58
Lok58:
    s_waitcnt lgkmcnt(15)
    v_mfma_f32_32x32x16_bf16 v[64:79], a[224:227], v[224:227], 0
    ds_read_b64_tr_b16 a[224:225], v80 offset:4112
    ds_read_b64_tr_b16 a[226:227], v80 offset:5136
    s_waitcnt lgkmcnt(2)
    s_barrier
    ds_read_b128 v[24:27], v120 offset:0
    ds_read_b128 v[48:51], v120 offset:2048
    ds_read_b128 v[56:59], v120 offset:4096
    ds_read_b128 v[28:31], v120 offset:1024
    ds_read_b128 v[52:55], v120 offset:3072
    ds_read_b128 v[60:63], v120 offset:5120
    v_add_f32 v16, v16, v112
    v_add_f32 v17, v17, v113
    v_mfma_f32_32x32x16_bf16 v[32:47], a[228:231], v[224:227], 0
    ds_read_b64_tr_b16 a[228:229], v81 offset:4112
    ds_read_b64_tr_b16 a[230:231], v81 offset:5136
    v_add_f32 v18, v18, v114
    v_add_f32 v19, v19, v115
    v_add_f32 v20, v20, v116
    v_add_f32 v21, v21, v117
    v_add_f32 v22, v22, v118
    v_add_f32 v23, v23, v119
    s_waitcnt lgkmcnt(7)
    v_add_f32 v16, v16, v24
    v_add_f32 v17, v17, v25
    v_add_f32 v18, v18, v26
    v_add_f32 v19, v19, v27
    s_waitcnt lgkmcnt(6)
    v_add_f32 v16, v16, v48
    v_add_f32 v17, v17, v49
    v_mfma_f32_32x32x16_bf16 v[96:111], v[224:227], a[232:235], 0
PAD12:
    s_cbranch_execz WARM2_4
    ds_read_b64_tr_b16 a[232:233], v82 offset:2048
    ds_read_b64_tr_b16 a[234:235], v82 offset:2560
    v_add_f32 v18, v18, v50
    v_add_f32 v19, v19, v51
    s_waitcnt lgkmcnt(7)
    v_add_f32 v16, v16, v56
    v_add_f32 v17, v17, v57
    v_add_f32 v18, v18, v58
    v_add_f32 v19, v19, v59
    v_cvt_pk_bf16_f32 v12, v16, v17
    v_cvt_pk_bf16_f32 v13, v18, v19
    s_waitcnt lgkmcnt(6)
    v_add_f32 v20, v20, v28
    v_add_f32 v21, v21, v29
    v_add_f32 v22, v22, v30
    v_add_f32 v23, v23, v31
    v_mfma_f32_32x32x16_bf16 v[64:79], a[236:239], v[228:231], v[64:79]
    ds_read_b64_tr_b16 a[236:237], v80 offset:6160
    ds_read_b64_tr_b16 a[238:239], v80 offset:7184
    s_waitcnt lgkmcnt(7)
    v_add_f32 v20, v20, v52
    v_add_f32 v21, v21, v53
    v_add_f32 v22, v22, v54
    v_add_f32 v23, v23, v55
    s_waitcnt lgkmcnt(6)
    v_add_f32 v20, v20, v60
    v_add_f32 v21, v21, v61
    v_add_f32 v22, v22, v62
    v_add_f32 v23, v23, v63
    v_cvt_pk_bf16_f32 v14, v20, v21
    v_cvt_pk_bf16_f32 v15, v22, v23
    v_mfma_f32_32x32x16_bf16 v[32:47], a[240:243], v[228:231], v[32:47]
    ds_read_b64_tr_b16 a[240:241], v81 offset:6160
    ds_read_b64_tr_b16 a[242:243], v81 offset:7184
    s_add_u32 s82, s16, 0x1b08000
    s_bitcmp1_b32 s33, 0
    s_cbranch_scc1 Lre59
    buffer_store_dwordx4 v[12:15], v1, s[4:7], s82 offen
Lok59:
    v_dot2_f32_bf16 v48, v12, s52, 0
    v_dot2_f32_bf16 v49, v12, v12, 0
    v_dot2_f32_bf16 v48, v13, s52, v48
    v_mfma_f32_32x32x16_bf16 v[96:111], v[228:231], a[244:247], v[96:111]
    ds_read_b64_tr_b16 a[244:245], v82 offset:3072
    ds_read_b64_tr_b16 a[246:247], v82 offset:3584
    v_dot2_f32_bf16 v49, v13, v13, v49
    v_dot2_f32_bf16 v48, v14, s52, v48
    v_dot2_f32_bf16 v49, v14, v14, v49
    v_dot2_f32_bf16 v48, v15, s52, v48
    v_dot2_f32_bf16 v49, v15, v15, v49
    s_nop 2
    v_permlane32_swap_b32 v48, v49
    v_mfma_f32_32x32x16_bf16 v[64:79], a[224:227], v[232:235], v[64:79]
    ds_read_b64_tr_b16 a[224:225], v80 offset:8224
    ds_read_b64_tr_b16 a[226:227], v80 offset:9248
    s_add_u32 s90, s20, 0x640000
    buffer_load_dwordx4 v[224:227], v83, s[4:7], s90 offen sc1
    v_add_f32 v48, v48, v49
    ds_write_b32 v126, v48 offset:25600
    s_waitcnt lgkmcnt(0)
    s_barrier
    ds_read_b128 v[52:55], v125 offset:25600
    s_waitcnt lgkmcnt(0)
    v_add_f32 v52, v52, v53
    v_add_f32 v54, v54, v55
    v_add_f32 v52, v52, v54
    v_mfma_f32_32x32x16_bf16 v[32:47], a[228:231], v[232:235], v[32:47]
    ds_read_b64_tr_b16 a[228:229], v81 offset:8224
    ds_read_b64_tr_b16 a[230:231], v81 offset:9248
    s_mov_b64 exec, s[50:51]
    s_bitcmp1_b32 s33, 0
    s_cbranch_scc1 Lre60
    buffer_store_dword v52, v127, s[4:7], s88 offen offset:2048
Lok60:
    s_mov_b64 exec, -1
    v_mfma_f32_32x32x16_bf16 v[96:111], v[232:235], a[232:235], v[96:111]
    ds_read_b64_tr_b16 a[232:233], v82 offset:4112
    ds_read_b64_tr_b16 a[234:235], v82 offset:4624
    buffer_load_dwordx4 v[228:231], v83, s[4:7], s90 offen offset:512 sc1
    v_mfma_f32_32x32x16_bf16 v[64:79], a[236:239], v[236:239], v[64:79]
    ds_read_b64_tr_b16 a[236:237], v80 offset:10272
    ds_read_b64_tr_b16 a[238:239], v80 offset:11296
    v_mfma_f32_32x32x16_bf16 v[32:47], a[240:243], v[236:239], v[32:47]
    ds_read_b64_tr_b16 a[240:241], v81 offset:10272
    ds_read_b64_tr_b16 a[242:243], v81 offset:11296
    v_mfma_f32_32x32x16_bf16 v[96:111], v[236:239], a[244:247], v[96:111]
    ds_read_b64_tr_b16 a[244:245], v82 offset:5136
    ds_read_b64_tr_b16 a[246:247], v82 offset:5648
    s_waitcnt vmcnt(13)
    v_max3_u32 v7, v240, v244, v248
    s_waitcnt vmcnt(12)
    v_max_u32 v7, v7, v252
    v_cmp_eq_u32 vcc, -1, v7
    s_cbranch_vccnz Lre61
Lok61:
    v_mfma_f32_32x32x16_bf16 v[64:79], a[224:227], v[240:243], v[64:79]
    ds_read_b64_tr_b16 a[224:225], v80 offset:12336
    ds_read_b64_tr_b16 a[226:227], v80 offset:13360
    s_waitcnt lgkmcnt(9)
    v_mfma_f32_32x32x16_bf16 v[32:47], a[228:231], v[240:243], v[32:47]
    ds_read_b64_tr_b16 a[228:229], v81 offset:12336
    ds_read_b64_tr_b16 a[230:231], v81 offset:13360
    s_waitcnt lgkmcnt(9)
    v_mfma_f32_32x32x16_bf16 v[96:111], v[240:243], a[232:235], v[96:111]
    ds_read_b64_tr_b16 a[232:233], v82 offset:6160
    ds_read_b64_tr_b16 a[234:235], v82 offset:6672
    s_waitcnt lgkmcnt(9)
    v_mfma_f32_32x32x16_bf16 v[64:79], a[236:239], v[244:247], v[64:79]
    ds_read_b64_tr_b16 a[236:237], v80 offset:14384
    ds_read_b64_tr_b16 a[238:239], v80 offset:15408
    s_waitcnt lgkmcnt(9)
    v_mfma_f32_32x32x16_bf16 v[32:47], a[240:243], v[244:247], v[32:47]
    ds_read_b64_tr_b16 a[240:241], v81 offset:14384
    ds_read_b64_tr_b16 a[242:243], v81 offset:15408
    s_waitcnt lgkmcnt(9)
    v_mfma_f32_32x32x16_bf16 v[96:111], v[244:247], a[244:247], v[96:111]
    ds_read_b64_tr_b16 a[244:245], v82 offset:7184
    ds_read_b64_tr_b16 a[246:247], v82 offset:7696
    s_waitcnt lgkmcnt(9)
    v_mfma_f32_32x32x16_bf16 v[64:79], a[224:227], v[248:251], v[64:79]
    ds_read_b64_tr_b16 a[224:225], v80 offset:16448
    ds_read_b64_tr_b16 a[226:227], v80 offset:17472
    s_waitcnt lgkmcnt(9)
    v_mfma_f32_32x32x16_bf16 v[32:47], a[228:231], v[248:251], v[32:47]
    ds_read_b64_tr_b16 a[228:229], v81 offset:16448
    ds_read_b64_tr_b16 a[230:231], v81 offset:17472
    s_waitcnt lgkmcnt(9)
    v_mfma_f32_32x32x16_bf16 v[96:111], v[248:251], a[232:235], v[96:111]
    ds_read_b64_tr_b16 a[232:233], v82 offset:8224
    ds_read_b64_tr_b16 a[234:235], v82 offset:8736
    s_waitcnt lgkmcnt(9)
    v_mfma_f32_32x32x16_bf16 v[64:79], a[236:239], v[252:255], v[64:79]
    ds_read_b64_tr_b16 a[236:237], v80 offset:18496
    ds_read_b64_tr_b16 a[238:239], v80 offset:19520
    s_waitcnt lgkmcnt(9)
    v_mfma_f32_32x32x16_bf16 v[32:47], a[240:243], v[252:255], v[32:47]
    ds_read_b64_tr_b16 a[240:241], v81 offset:18496
    ds_read_b64_tr_b16 a[242:243], v81 offset:19520
    s_waitcnt lgkmcnt(9)
    v_mfma_f32_32x32x16_bf16 v[96:111], v[252:255], a[244:247], v[96:111]
    ds_read_b64_tr_b16 a[244:245], v82 offset:9248
    ds_read_b64_tr_b16 a[246:247], v82 offset:9760
    s_waitcnt vmcnt(9)
    v_max3_u32 v7, v128, v132, v136
    s_waitcnt vmcnt(8)
    v_max_u32 v7, v7, v140
    v_cmp_eq_u32 vcc, -1, v7
    s_cbranch_vccnz Lre62
Lok62:
    s_waitcnt lgkmcnt(9)
    v_mfma_f32_32x32x16_bf16 v[64:79], a[224:227], v[128:131], v[64:79]
    ds_read_b64_tr_b16 a[224:225], v80 offset:20560
    ds_read_b64_tr_b16 a[226:227], v80 offset:21584
    s_add_u32 s80, s25, 0x1b08000
    buffer_load_dwordx4 v[160:163], v3, s[4:7], s80 offen sc1
    s_waitcnt lgkmcnt(9)
    v_mfma_f32_32x32x16_bf16 v[32:47], a[228:231], v[128:131], v[32:47]
    ds_read_b64_tr_b16 a[228:229], v81 offset:20560
    ds_read_b64_tr_b16 a[230:231], v81 offset:21584
    s_waitcnt lgkmcnt(9)
    v_mfma_f32_32x32x16_bf16 v[96:111], v[128:131], a[232:235], v[96:111]
    ds_read_b64_tr_b16 a[232:233], v82 offset:10272
    ds_read_b64_tr_b16 a[234:235], v82 offset:10784
    buffer_load_dwordx4 v[164:167], v3, s[4:7], s80 offen offset:1024 sc1
    s_waitcnt lgkmcnt(9)
    v_mfma_f32_32x32x16_bf16 v[64:79], a[236:239], v[132:135], v[64:79]
    ds_read_b64_tr_b16 a[236:237], v80 offset:22608
    ds_read_b64_tr_b16 a[238:239], v80 offset:23632
    s_waitcnt lgkmcnt(9)
    v_mfma_f32_32x32x16_bf16 v[32:47], a[240:243], v[132:135], v[32:47]
    ds_read_b64_tr_b16 a[240:241], v81 offset:22608
    ds_read_b64_tr_b16 a[242:243], v81 offset:23632
    buffer_load_dwordx4 v[168:171], v3, s[4:7], s80 offen offset:2048 sc1
    s_waitcnt lgkmcnt(9)
    v_mfma_f32_32x32x16_bf16 v[96:111], v[132:135], a[244:247], v[96:111]
    ds_read_b64_tr_b16 a[244:245], v82 offset:11296
    ds_read_b64_tr_b16 a[246:247], v82 offset:11808
    s_waitcnt vmcnt(5)
    v_max3_u32 v7, v224, v225, v226
    s_waitcnt vmcnt(3)
    v_max3_u32 v7, v7, v227, v228
    v_max3_u32 v7, v7, v229, v230
    v_max_u32 v7, v7, v231
    v_cmp_eq_u32 vcc, -1, v7
    s_cbranch_vccnz Lre63
Lok63:
    s_waitcnt lgkmcnt(9)
    v_mfma_f32_32x32x16_bf16 v[64:79], a[224:227], v[136:139], v[64:79]
    ds_read_b64_tr_b16 a[224:225], v80 offset:24672
    ds_read_b64_tr_b16 a[226:227], v80 offset:25696
    v_add_f32 v224, v224, v228
    v_add_f32 v225, v225, v229
    v_add_f32 v226, v226, v230
    buffer_load_dwordx4 v[172:175], v3, s[4:7], s80 offen offset:3072 sc1
    s_waitcnt lgkmcnt(9)
    v_mfma_f32_32x32x16_bf16 v[32:47], a[228:231], v[136:139], v[32:47]
    ds_read_b64_tr_b16 a[228:229], v81 offset:24672
    ds_read_b64_tr_b16 a[230:231], v81 offset:25696
    v_add_f32 v227, v227, v231
    v_add_f32 v224, v224, v226
    v_add_f32 v225, v225, v227
    v_mov_b32 v226, v224
    s_waitcnt lgkmcnt(9)
    v_mfma_f32_32x32x16_bf16 v[96:111], v[136:139], a[232:235], v[96:111]
    ds_read_b64_tr_b16 a[232:233], v82 offset:12336
    ds_read_b64_tr_b16 a[234:235], v82 offset:12848
    v_mov_b32 v227, v225
    v_permlane32_swap_b32 v224, v226
    s_nop 0
    v_permlane32_swap_b32 v225, v227
    s_add_u32 s85, s25, 0x1b09000
    buffer_load_dwordx4 v[176:179], v3, s[4:7], s85 offen sc1
    s_waitcnt lgkmcnt(9)
    v_mfma_f32_32x32x16_bf16 v[64:79], a[236:239], v[140:143], v[64:79]
    ds_read_b64_tr_b16 a[236:237], v80 offset:26720
    ds_read_b64_tr_b16 a[238:239], v80 offset:27744
    v_add_f32 v224, v224, v226
    v_add_f32 v225, v225, v227
    v_mul_f32 v224, 0xbb000000, v224
    v_mul_f32 v225, 0x3b000000, v225
    s_waitcnt lgkmcnt(9)
    v_mfma_f32_32x32x16_bf16 v[32:47], a[240:243], v[140:143], v[32:47]
    ds_read_b64_tr_b16 a[240:241], v81 offset:26720
    ds_read_b64_tr_b16 a[242:243], v81 offset:27744
    v_fma_f32 v225, -v224, v224, v225
    v_max_f32 v225, 0, v225
    v_add_f32 v228, 0x3727c5ac, v225
    v_rsq_f32 v226, v228
    buffer_load_dwordx4 v[180:183], v3, s[4:7], s85 offen offset:1024 sc1
    s_waitcnt lgkmcnt(9)
    v_mfma_f32_32x32x16_bf16 v[96:111], v[140:143], a[244:247], v[96:111]
    ds_read_b64_tr_b16 a[244:245], v82 offset:13360
    ds_read_b64_tr_b16 a[246:247], v82 offset:13872
    v_cvt_pk_bf16_f32 v232, v224, v224
    v_lshlrev_b32 v229, 16, v232
    v_rcp_f32 v227, v226
    v_max3_u32 v7, v144, v148, v152
    v_max_u32 v7, v7, v156
    v_cmp_eq_u32 vcc, -1, v7
    s_cbranch_vccnz Lre64
Lok64:
    s_waitcnt lgkmcnt(9)
    v_mfma_f32_32x32x16_bf16 v[64:79], a[224:227], v[144:147], v[64:79]
    ds_read_b64_tr_b16 a[224:225], v80 offset:28784
    ds_read_b64_tr_b16 a[226:227], v80 offset:29808
    v_sub_f32 v229, v224, v229
    v_cvt_pk_bf16_f32 v230, v226, v226
    v_cvt_pk_bf16_f32 v233, v229, v227
    v_lshlrev_b32 v230, 16, v230
    buffer_load_dwordx4 v[184:187], v3, s[4:7], s85 offen offset:2048 sc1
    s_waitcnt lgkmcnt(9)
    v_mfma_f32_32x32x16_bf16 v[32:47], a[228:231], v[144:147], v[32:47]
    ds_read_b64_tr_b16 a[228:229], v81 offset:28784
    ds_read_b64_tr_b16 a[230:231], v81 offset:29808
    v_and_b32 v229, 0xffff0000, v233
    v_sub_f32 v230, v226, v230
    v_sub_f32 v229, v227, v229
    v_cvt_pk_bf16_f32 v235, v226, v230
    s_waitcnt lgkmcnt(9)
    v_mfma_f32_32x32x16_bf16 v[96:111], v[144:147], a[232:235], v[96:111]
    ds_read_b64_tr_b16 a[232:233], v82 offset:14384
    ds_read_b64_tr_b16 a[234:235], v82 offset:14896
    v_cvt_pk_bf16_f32 v234, v229, 0
    v_mul_f32 v85, s43, v226
    v_cmp_gt_u32 vcc, 512, v1
    v_mov_b32 v51, s52
    s_nop 0
    v_cndmask_b32 v51, 0, v51, vcc
    buffer_load_dwordx4 v[188:191], v3, s[4:7], s85 offen offset:3072 sc1
    s_waitcnt lgkmcnt(9)
    v_mfma_f32_32x32x16_bf16 v[64:79], a[236:239], v[148:151], v[64:79]
    ds_read_b64_tr_b16 a[236:237], v80 offset:30832
    ds_read_b64_tr_b16 a[238:239], v80 offset:31856
    v_mov_b32 v48, 0
    v_mov_b32 v49, 0
    v_mov_b32 v50, 0
    s_waitcnt lgkmcnt(9)
    v_mfma_f32_32x32x16_bf16 v[32:47], a[240:243], v[148:151], v[32:47]
    ds_read_b64_tr_b16 a[240:241], v81 offset:30832
    ds_read_b64_tr_b16 a[242:243], v81 offset:31856
    s_add_u32 s87, s25, 0x1b0a000
    buffer_load_dwordx4 v[192:195], v3, s[4:7], s87 offen sc1
    v_mfma_f32_32x32x16_bf16 v[64:79], a[248:251], v[232:235], v[64:79]
    v_mfma_f32_32x32x16_bf16 v[16:31], v[232:235], v[48:51], 0
    buffer_load_dwordx4 v[196:199], v3, s[4:7], s87 offen offset:1024 sc1
    s_waitcnt lgkmcnt(9)
    v_mfma_f32_32x32x16_bf16 v[96:111], v[148:151], a[244:247], v[96:111]
    ds_read_b64_tr_b16 a[244:245], v82 offset:15408
    ds_read_b64_tr_b16 a[246:247], v82 offset:15920
    s_waitcnt lgkmcnt(9)
    v_mfma_f32_32x32x16_bf16 v[64:79], a[224:227], v[152:155], v[64:79]
    ds_read_b64_tr_b16 a[224:225], v80 offset:0
    ds_read_b64_tr_b16 a[226:227], v80 offset:1024
    buffer_load_dwordx4 v[200:203], v3, s[4:7], s87 offen offset:2048 sc1
    v_mfma_f32_32x32x16_bf16 v[96:111], v[232:235], a[252:255], v[96:111]
    s_waitcnt lgkmcnt(9)
    v_mfma_f32_32x32x16_bf16 v[32:47], a[228:231], v[152:155], v[32:47]
    ds_read_b64_tr_b16 a[228:229], v81 offset:0
    ds_read_b64_tr_b16 a[230:231], v81 offset:1024
    buffer_load_dwordx4 v[204:207], v3, s[4:7], s87 offen offset:3072 sc1
    s_waitcnt lgkmcnt(9)
    v_mfma_f32_32x32x16_bf16 v[96:111], v[152:155], a[232:235], v[96:111]
    ds_read_b64_tr_b16 a[232:233], v82 offset:0
    ds_read_b64_tr_b16 a[234:235], v82 offset:512
    s_waitcnt lgkmcnt(9)
    v_mfma_f32_32x32x16_bf16 v[64:79], a[236:239], v[156:159], v[64:79]
    ds_read_b64_tr_b16 a[236:237], v80 offset:2048
    ds_read_b64_tr_b16 a[238:239], v80 offset:3072
    s_add_u32 s89, s25, 0x1b0b000
    buffer_load_dwordx4 v[208:211], v3, s[4:7], s89 offen sc1
    s_waitcnt lgkmcnt(9)
    v_mfma_f32_32x32x16_bf16 v[32:47], a[240:243], v[156:159], v[32:47]
    ds_read_b64_tr_b16 a[240:241], v81 offset:2048
    ds_read_b64_tr_b16 a[242:243], v81 offset:3072
    s_waitcnt lgkmcnt(9)
    v_mfma_f32_32x32x16_bf16 v[96:111], v[156:159], a[244:247], v[96:111]
    ds_read_b64_tr_b16 a[244:245], v82 offset:1024
    ds_read_b64_tr_b16 a[246:247], v82 offset:1536
    buffer_load_dwordx4 v[212:215], v3, s[4:7], s89 offen offset:1024 sc1
    s_waitcnt vmcnt(11)
    v_max3_u32 v7, v160, v164, v168
    s_waitcnt vmcnt(10)
    v_max_u32 v7, v7, v172
    v_cmp_eq_u32 vcc, -1, v7
    s_cbranch_vccnz Lre65
Lok65:
    s_waitcnt lgkmcnt(9)
    v_mfma_f32_32x32x16_bf16 v[224:239], a[224:227], v[160:163], 0
    ds_read_b64_tr_b16 a[224:225], v80 offset:4112
    ds_read_b64_tr_b16 a[226:227], v80 offset:5136
    s_waitcnt lgkmcnt(9)
    v_mfma_f32_32x32x16_bf16 v[240:255], a[228:231], v[160:163], 0
    ds_read_b64_tr_b16 a[228:229], v81 offset:4112
    ds_read_b64_tr_b16 a[230:231], v81 offset:5136
    ds_write_b128 v84, v[32:35] offset:0
    ds_write_b128 v84, v[36:39] offset:1024
    ds_write_b128 v84, v[40:43] offset:2048
    ds_write_b128 v84, v[44:47] offset:3072
    ds_write_b128 v122, v[104:107] offset:4096
    ds_write_b128 v122, v[108:111] offset:5120
    v_mul_f32 v64, v85, v64
    v_mul_f32 v65, v85, v65
    v_mul_f32 v66, v85, v66
    v_mul_f32 v67, v85, v67
    v_mul_f32 v68, v85, v68
    v_mul_f32 v69, v85, v69
    v_mul_f32 v70, v85, v70
    v_mul_f32 v71, v85, v71
    buffer_load_dwordx4 v[216:219], v3, s[4:7], s89 offen offset:2048 sc1
    s_waitcnt lgkmcnt(15)
    v_mfma_f32_32x32x16_bf16 v[128:143], v[160:163], a[232:235], 0
    ds_read_b64_tr_b16 a[232:233], v82 offset:2048
    ds_read_b64_tr_b16 a[234:235], v82 offset:2560
    v_mul_f32 v72, v85, v72
    v_mul_f32 v73, v85, v73
    v_mul_f32 v74, v85, v74
    v_mul_f32 v75, v85, v75
    v_mul_f32 v76, v85, v76
    v_mul_f32 v77, v85, v77
    v_mul_f32 v78, v85, v78
    v_mul_f32 v79, v85, v79
    s_waitcnt lgkmcnt(2)
    s_barrier
    ds_read_b128 v[32:35], v120 offset:0
    ds_read_b128 v[36:39], v120 offset:1024
    ds_read_b128 v[40:43], v120 offset:2048
    ds_read_b128 v[44:47], v120 offset:3072
    ds_read_b128 v[104:107], v120 offset:4096
    v_mfma_f32_32x32x16_bf16 v[224:239], a[236:239], v[164:167], v[224:239]
    ds_read_b64_tr_b16 a[236:237], v80 offset:6160
    ds_read_b64_tr_b16 a[238:239], v80 offset:7184
    ds_read_b128 v[108:111], v120 offset:5120
    v_mul_f32 v96, v16, v96
    v_mul_f32 v97, v17, v97
    v_mul_f32 v98, v18, v98
    v_mul_f32 v99, v19, v99
    v_mul_f32 v100, v20, v100
    v_mul_f32 v101, v21, v101
    v_mul_f32 v102, v22, v102
    v_mul_f32 v103, v23, v103
    s_waitcnt lgkmcnt(7)
    v_fmac_f32 v64, v85, v32
    v_fmac_f32 v65, v85, v33
    v_fmac_f32 v66, v85, v34
    v_fmac_f32 v67, v85, v35
    s_waitcnt lgkmcnt(6)
    v_fmac_f32 v68, v85, v36
    v_fmac_f32 v69, v85, v37
    v_fmac_f32 v70, v85, v38
    buffer_load_dwordx4 v[220:223], v3, s[4:7], s89 offen offset:3072 sc1
    v_mfma_f32_32x32x16_bf16 v[240:255], a[240:243], v[164:167], v[240:255]
    ds_read_b64_tr_b16 a[240:241], v81 offset:6160
    ds_read_b64_tr_b16 a[242:243], v81 offset:7184
    v_fmac_f32 v71, v85, v39
    v_cvt_pk_bf16_f32 v64, v64, v65
    v_cvt_pk_bf16_f32 v65, v66, v67
    v_cvt_pk_bf16_f32 v66, v68, v69
    v_cvt_pk_bf16_f32 v67, v70, v71
    s_add_u32 s83, s26, 0x1b00000
    buffer_store_dwordx4 v[64:67], v3, s[4:7], s83 offen sc1
    s_waitcnt lgkmcnt(7)
    v_fmac_f32 v72, v85, v40
    v_fmac_f32 v73, v85, v41
    v_fmac_f32 v74, v85, v42
    v_fmac_f32 v75, v85, v43
    s_waitcnt lgkmcnt(6)
    v_fmac_f32 v76, v85, v44
    v_fmac_f32 v77, v85, v45
    v_fmac_f32 v78, v85, v46
    v_fmac_f32 v79, v85, v47
    v_mfma_f32_32x32x16_bf16 v[128:143], v[164:167], a[244:247], v[128:143]
    ds_read_b64_tr_b16 a[244:245], v82 offset:3072
    ds_read_b64_tr_b16 a[246:247], v82 offset:3584
    v_cvt_pk_bf16_f32 v72, v72, v73
    v_cvt_pk_bf16_f32 v73, v74, v75
    v_cvt_pk_bf16_f32 v74, v76, v77
    v_cvt_pk_bf16_f32 v75, v78, v79
    s_add_u32 s91, s26, 0x1b20000
    buffer_store_dwordx4 v[72:75], v3, s[4:7], s91 offen sc1
    s_waitcnt lgkmcnt(7)
    v_fmac_f32 v96, v16, v104
    v_fmac_f32 v97, v17, v105
    v_fmac_f32 v98, v18, v106
    v_fmac_f32 v99, v19, v107
    s_waitcnt lgkmcnt(4)
    v_fmac_f32 v100, v20, v108
    v_fmac_f32 v101, v21, v109
    v_fmac_f32 v102, v22, v110
    v_fmac_f32 v103, v23, v111
    v_cvt_pk_bf16_f32 v96, v96, v97
    v_mfma_f32_32x32x16_bf16 v[224:239], a[224:227], v[168:171], v[224:239]
    ds_read_b64_tr_b16 a[224:225], v80 offset:8224
    ds_read_b64_tr_b16 a[226:227], v80 offset:9248
    v_cvt_pk_bf16_f32 v97, v98, v99
    v_cvt_pk_bf16_f32 v98, v100, v101
    v_cvt_pk_bf16_f32 v99, v102, v103
    s_add_u32 s84, s27, 0x1b00000
    buffer_store_dwordx4 v[96:99], v5, s[4:7], s84 offen sc1
    s_barrier
    buffer_load_dwordx4 v[160:163], v83, s[4:7], s90 offen offset:2048 sc1
    v_mfma_f32_32x32x16_bf16 v[240:255], a[228:231], v[168:171], v[240:255]
    ds_read_b64_tr_b16 a[228:229], v81 offset:8224
    ds_read_b64_tr_b16 a[230:231], v81 offset:9248
    v_mfma_f32_32x32x16_bf16 v[128:143], v[168:171], a[232:235], v[128:143]
    ds_read_b64_tr_b16 a[232:233], v82 offset:4112
    ds_read_b64_tr_b16 a[234:235], v82 offset:4624
    buffer_load_dwordx4 v[164:167], v83, s[4:7], s90 offen offset:2560 sc1
    v_mfma_f32_32x32x16_bf16 v[224:239], a[236:239], v[172:175], v[224:239]
    ds_read_b64_tr_b16 a[236:237], v80 offset:10272
    ds_read_b64_tr_b16 a[238:239], v80 offset:11296
    s_waitcnt lgkmcnt(9)
    v_mfma_f32_32x32x16_bf16 v[240:255], a[240:243], v[172:175], v[240:255]
    ds_read_b64_tr_b16 a[240:241], v81 offset:10272
    ds_read_b64_tr_b16 a[242:243], v81 offset:11296
    s_waitcnt lgkmcnt(9)
    v_mfma_f32_32x32x16_bf16 v[128:143], v[172:175], a[244:247], v[128:143]
    ds_read_b64_tr_b16 a[244:245], v82 offset:5136
    ds_read_b64_tr_b16 a[246:247], v82 offset:5648
    s_waitcnt vmcnt(14)
    v_max3_u32 v7, v176, v180, v184
    s_waitcnt vmcnt(13)
    v_max_u32 v7, v7, v188
    v_cmp_eq_u32 vcc, -1, v7
    s_cbranch_vccnz Lre66
Lok66:
    s_waitcnt lgkmcnt(9)
    v_mfma_f32_32x32x16_bf16 v[224:239], a[224:227], v[176:179], v[224:239]
    ds_read_b64_tr_b16 a[224:225], v80 offset:12336
    ds_read_b64_tr_b16 a[226:227], v80 offset:13360
    s_waitcnt lgkmcnt(9)
    v_mfma_f32_32x32x16_bf16 v[240:255], a[228:231], v[176:179], v[240:255]
    ds_read_b64_tr_b16 a[228:229], v81 offset:12336
    ds_read_b64_tr_b16 a[230:231], v81 offset:13360
    s_waitcnt lgkmcnt(9)
    v_mfma_f32_32x32x16_bf16 v[128:143], v[176:179], a[232:235], v[128:143]
    ds_read_b64_tr_b16 a[232:233], v82 offset:6160
    ds_read_b64_tr_b16 a[234:235], v82 offset:6672
    s_waitcnt lgkmcnt(9)
    v_mfma_f32_32x32x16_bf16 v[224:239], a[236:239], v[180:183], v[224:239]
    ds_read_b64_tr_b16 a[236:237], v80 offset:14384
    ds_read_b64_tr_b16 a[238:239], v80 offset:15408
    s_waitcnt lgkmcnt(9)
    v_mfma_f32_32x32x16_bf16 v[240:255], a[240:243], v[180:183], v[240:255]
    ds_read_b64_tr_b16 a[240:241], v81 offset:14384
    ds_read_b64_tr_b16 a[242:243], v81 offset:15408
    s_waitcnt lgkmcnt(9)
    v_mfma_f32_32x32x16_bf16 v[128:143], v[180:183], a[244:247], v[128:143]
    ds_read_b64_tr_b16 a[244:245], v82 offset:7184
    ds_read_b64_tr_b16 a[246:247], v82 offset:7696
    s_waitcnt lgkmcnt(9)
    v_mfma_f32_32x32x16_bf16 v[224:239], a[224:227], v[184:187], v[224:239]
    ds_read_b64_tr_b16 a[224:225], v80 offset:16448
    ds_read_b64_tr_b16 a[226:227], v80 offset:17472
    s_waitcnt lgkmcnt(9)
    v_mfma_f32_32x32x16_bf16 v[240:255], a[228:231], v[184:187], v[240:255]
    ds_read_b64_tr_b16 a[228:229], v81 offset:16448
    ds_read_b64_tr_b16 a[230:231], v81 offset:17472
    s_waitcnt lgkmcnt(9)
    v_mfma_f32_32x32x16_bf16 v[128:143], v[184:187], a[232:235], v[128:143]
    ds_read_b64_tr_b16 a[232:233], v82 offset:8224
    ds_read_b64_tr_b16 a[234:235], v82 offset:8736
    s_waitcnt lgkmcnt(9)
    v_mfma_f32_32x32x16_bf16 v[224:239], a[236:239], v[188:191], v[224:239]
    ds_read_b64_tr_b16 a[236:237], v80 offset:18496
    ds_read_b64_tr_b16 a[238:239], v80 offset:19520
    s_waitcnt lgkmcnt(9)
    v_mfma_f32_32x32x16_bf16 v[240:255], a[240:243], v[188:191], v[240:255]
    ds_read_b64_tr_b16 a[240:241], v81 offset:18496
    ds_read_b64_tr_b16 a[242:243], v81 offset:19520
    s_waitcnt lgkmcnt(9)
    v_mfma_f32_32x32x16_bf16 v[128:143], v[188:191], a[244:247], v[128:143]
    ds_read_b64_tr_b16 a[244:245], v82 offset:9248
    ds_read_b64_tr_b16 a[246:247], v82 offset:9760
    s_waitcnt vmcnt(10)
    v_max3_u32 v7, v192, v196, v200
    s_waitcnt vmcnt(9)
    v_max_u32 v7, v7, v204
    v_cmp_eq_u32 vcc, -1, v7
    s_cbranch_vccnz Lre67
Lok67:
    s_waitcnt lgkmcnt(9)
    v_mfma_f32_32x32x16_bf16 v[224:239], a[224:227], v[192:195], v[224:239]
    ds_read_b64_tr_b16 a[224:225], v80 offset:20560
    ds_read_b64_tr_b16 a[226:227], v80 offset:21584
    s_waitcnt lgkmcnt(9)
    v_mfma_f32_32x32x16_bf16 v[240:255], a[228:231], v[192:195], v[240:255]
    ds_read_b64_tr_b16 a[228:229], v81 offset:20560
    ds_read_b64_tr_b16 a[230:231], v81 offset:21584
    s_waitcnt lgkmcnt(9)
    v_mfma_f32_32x32x16_bf16 v[128:143], v[192:195], a[232:235], v[128:143]
    ds_read_b64_tr_b16 a[232:233], v82 offset:10272
    ds_read_b64_tr_b16 a[234:235], v82 offset:10784
    s_waitcnt lgkmcnt(9)
    v_mfma_f32_32x32x16_bf16 v[224:239], a[236:239], v[196:199], v[224:239]
    ds_read_b64_tr_b16 a[236:237], v80 offset:22608
    ds_read_b64_tr_b16 a[238:239], v80 offset:23632
    s_waitcnt lgkmcnt(9)
    v_mfma_f32_32x32x16_bf16 v[240:255], a[240:243], v[196:199], v[240:255]
    ds_read_b64_tr_b16 a[240:241], v81 offset:22608
    ds_read_b64_tr_b16 a[242:243], v81 offset:23632
    s_waitcnt lgkmcnt(9)
    v_mfma_f32_32x32x16_bf16 v[128:143], v[196:199], a[244:247], v[128:143]
    ds_read_b64_tr_b16 a[244:245], v82 offset:11296
    ds_read_b64_tr_b16 a[246:247], v82 offset:11808
    s_waitcnt vmcnt(1)
    v_max3_u32 v7, v160, v161, v162
    s_waitcnt vmcnt(0)
    v_max3_u32 v7, v7, v163, v164
    v_max3_u32 v7, v7, v165, v166
    v_max_u32 v7, v7, v167
    v_cmp_eq_u32 vcc, -1, v7
    s_cbranch_vccnz Lre68
Lok68:
    s_waitcnt lgkmcnt(9)
    v_mfma_f32_32x32x16_bf16 v[224:239], a[224:227], v[200:203], v[224:239]
    ds_read_b64_tr_b16 a[224:225], v80 offset:24672
    ds_read_b64_tr_b16 a[226:227], v80 offset:25696
    v_add_f32 v160, v160, v164
    v_add_f32 v161, v161, v165
    s_waitcnt lgkmcnt(9)
    v_mfma_f32_32x32x16_bf16 v[240:255], a[228:231], v[200:203], v[240:255]
    ds_read_b64_tr_b16 a[228:229], v81 offset:24672
    ds_read_b64_tr_b16 a[230:231], v81 offset:25696
    v_add_f32 v162, v162, v166
    v_add_f32 v163, v163, v167
    v_add_f32 v160, v160, v162
    v_add_f32 v161, v161, v163
    s_waitcnt lgkmcnt(9)
    v_mfma_f32_32x32x16_bf16 v[128:143], v[200:203], a[232:235], v[128:143]
    ds_read_b64_tr_b16 a[232:233], v82 offset:12336
    ds_read_b64_tr_b16 a[234:235], v82 offset:12848
    v_mov_b32 v162, v160
    v_mov_b32 v163, v161
    s_nop 0
    v_permlane32_swap_b32 v160, v162
    s_waitcnt lgkmcnt(9)
    v_mfma_f32_32x32x16_bf16 v[224:239], a[236:239], v[204:207], v[224:239]
    ds_read_b64_tr_b16 a[236:237], v80 offset:26720
    ds_read_b64_tr_b16 a[238:239], v80 offset:27744
    v_permlane32_swap_b32 v161, v163
    v_add_f32 v160, v160, v162
    s_waitcnt lgkmcnt(9)
    v_mfma_f32_32x32x16_bf16 v[240:255], a[240:243], v[204:207], v[240:255]
    ds_read_b64_tr_b16 a[240:241], v81 offset:26720
    ds_read_b64_tr_b16 a[242:243], v81 offset:27744
    v_add_f32 v161, v161, v163
    v_mul_f32 v160, 0xbb000000, v160
    v_mul_f32 v161, 0x3b000000, v161
    v_fma_f32 v161, -v160, v160, v161
    s_waitcnt lgkmcnt(9)
    v_mfma_f32_32x32x16_bf16 v[128:143], v[204:207], a[244:247], v[128:143]
    ds_read_b64_tr_b16 a[244:245], v82 offset:13360
    ds_read_b64_tr_b16 a[246:247], v82 offset:13872
    v_max_f32 v161, 0, v161
    v_add_f32 v164, 0x3727c5ac, v161
    v_rsq_f32 v162, v164
    v_max3_u32 v7, v208, v212, v216
    v_max_u32 v7, v7, v220
    v_cmp_eq_u32 vcc, -1, v7
    s_cbranch_vccnz Lre69
Lok69:
    s_waitcnt lgkmcnt(9)
    v_mfma_f32_32x32x16_bf16 v[224:239], a[224:227], v[208:211], v[224:239]
    ds_read_b64_tr_b16 a[224:225], v80 offset:28784
    ds_read_b64_tr_b16 a[226:227], v80 offset:29808
    v_cvt_pk_bf16_f32 v168, v160, v160
    v_lshlrev_b32 v165, 16, v168
    v_rcp_f32 v163, v162
    s_waitcnt lgkmcnt(9)
    v_mfma_f32_32x32x16_bf16 v[240:255], a[228:231], v[208:211], v[240:255]
    ds_read_b64_tr_b16 a[228:229], v81 offset:28784
    ds_read_b64_tr_b16 a[230:231], v81 offset:29808
    v_sub_f32 v165, v160, v165
    v_cvt_pk_bf16_f32 v166, v162, v162
    v_cvt_pk_bf16_f32 v169, v165, v163
    s_mov_b32 m0, s22
    s_add_u32 s81, s29, 0x1b00000
    buffer_load_dwordx4 v1, s[4:7], s81 offen sc1 lds
    s_waitcnt lgkmcnt(9)
    v_mfma_f32_32x32x16_bf16 v[128:143], v[208:211], a[232:235], v[128:143]
    ds_read_b64_tr_b16 a[232:233], v82 offset:14384
    ds_read_b64_tr_b16 a[234:235], v82 offset:14896
    v_lshlrev_b32 v166, 16, v166
    v_and_b32 v165, 0xffff0000, v169
    v_sub_f32 v166, v162, v166
    v_sub_f32 v165, v163, v165
    s_waitcnt lgkmcnt(9)
    v_mfma_f32_32x32x16_bf16 v[224:239], a[236:239], v[212:215], v[224:239]
    ds_read_b64_tr_b16 a[236:237], v80 offset:30832
    ds_read_b64_tr_b16 a[238:239], v80 offset:31856
    v_cvt_pk_bf16_f32 v171, v162, v166
    v_cvt_pk_bf16_f32 v170, v165, 0
    v_mul_f32 v86, s43, v162
    buffer_load_dwordx4 v1, s[4:7], s81 offen offset:1024 sc1 lds
    s_waitcnt lgkmcnt(9)
    v_mfma_f32_32x32x16_bf16 v[240:255], a[240:243], v[212:215], v[240:255]
    ds_read_b64_tr_b16 a[240:241], v81 offset:30832
    ds_read_b64_tr_b16 a[242:243], v81 offset:31856
    v_mfma_f32_32x32x16_bf16 v[224:239], a[248:251], v[168:171], v[224:239]
    buffer_load_dwordx4 v1, s[4:7], s81 offen offset:2048 sc1 lds
    v_mfma_f32_32x32x16_bf16 v[144:159], v[168:171], v[48:51], 0
    s_waitcnt lgkmcnt(9)
    v_mfma_f32_32x32x16_bf16 v[128:143], v[212:215], a[244:247], v[128:143]
    ds_read_b64_tr_b16 a[244:245], v82 offset:15408
    ds_read_b64_tr_b16 a[246:247], v82 offset:15920
    buffer_load_dwordx4 v1, s[4:7], s81 offen offset:3072 sc1 lds
    s_waitcnt lgkmcnt(9)
    v_mfma_f32_32x32x16_bf16 v[224:239], a[224:227], v[216:219], v[224:239]
    v_mfma_f32_32x32x16_bf16 v[128:143], v[168:171], a[252:255], v[128:143]
    s_add_u32 s86, s28, 0x1b00000
    buffer_load_dwordx4 v[96:99], v1, s[4:7], s86 offen sc1
PAD13:
    s_cbranch_execz WARM2_4
    s_waitcnt lgkmcnt(7)
    v_mfma_f32_32x32x16_bf16 v[240:255], a[228:231], v[216:219], v[240:255]
    s_waitcnt lgkmcnt(5)
    v_mfma_f32_32x32x16_bf16 v[128:143], v[216:219], a[232:235], v[128:143]
    s_add_u32 m0, s22, 0x4040
    s_add_u32 s82, s29, 0x1b04000
    buffer_load_dwordx4 v1, s[4:7], s82 offen sc1 lds
    s_waitcnt lgkmcnt(4)
    v_mfma_f32_32x32x16_bf16 v[224:239], a[236:239], v[220:223], v[224:239]
    s_waitcnt lgkmcnt(2)
    v_mfma_f32_32x32x16_bf16 v[240:255], a[240:243], v[220:223], v[240:255]
    buffer_load_dwordx4 v1, s[4:7], s82 offen offset:1024 sc1 lds
    s_waitcnt lgkmcnt(0)
    v_mfma_f32_32x32x16_bf16 v[128:143], v[220:223], a[244:247], v[128:143]
    s_nop 8
    ds_write_b128 v84, v[240:243] offset:0
    buffer_load_dwordx4 v1, s[4:7], s82 offen offset:2048 sc1 lds
    ds_write_b128 v84, v[244:247] offset:1024
    ds_write_b128 v84, v[248:251] offset:2048
    ds_write_b128 v84, v[252:255] offset:3072
    ds_write_b128 v122, v[136:139] offset:4096
    buffer_load_dwordx4 v1, s[4:7], s82 offen offset:3072 sc1 lds
    ds_write_b128 v122, v[140:143] offset:5120
    v_mul_f32 v224, v86, v224
    v_mul_f32 v225, v86, v225
    v_mul_f32 v226, v86, v226
    v_mul_f32 v227, v86, v227
    v_mul_f32 v228, v86, v228
    v_mul_f32 v229, v86, v229
    v_mul_f32 v230, v86, v230
    v_mul_f32 v231, v86, v231
    v_mul_f32 v232, v86, v232
    v_mul_f32 v233, v86, v233
    v_mul_f32 v234, v86, v234
    v_mul_f32 v235, v86, v235
    v_mul_f32 v236, v86, v236
    v_mul_f32 v237, v86, v237
    v_mul_f32 v238, v86, v238
    v_mul_f32 v239, v86, v239
    s_waitcnt lgkmcnt(0)
    s_barrier
    ds_read_b128 v[240:243], v120 offset:0
    ds_read_b128 v[244:247], v120 offset:1024
    s_add_u32 m0, s22, 0x8080
    s_add_u32 s88, s29, 0x1b08000
    buffer_load_dwordx4 v1, s[4:7], s88 offen sc1 lds
    ds_read_b128 v[248:251], v120 offset:2048
    ds_read_b128 v[252:255], v120 offset:3072
    ds_read_b128 v[136:139], v120 offset:4096
    ds_read_b128 v[140:143], v120 offset:5120
    buffer_load_dwordx4 v1, s[4:7], s88 offen offset:1024 sc1 lds
    v_mul_f32 v128, v144, v128
    v_mul_f32 v129, v145, v129
    v_mul_f32 v130, v146, v130
    v_mul_f32 v131, v147, v131
    buffer_load_dwordx4 v1, s[4:7], s88 offen offset:2048 sc1 lds
    v_mul_f32 v132, v148, v132
    v_mul_f32 v133, v149, v133
    v_mul_f32 v134, v150, v134
    v_mul_f32 v135, v151, v135
    buffer_load_dwordx4 v1, s[4:7], s88 offen offset:3072 sc1 lds
    s_waitcnt lgkmcnt(5)
    v_fmac_f32 v224, v86, v240
    v_fmac_f32 v225, v86, v241
    v_fmac_f32 v226, v86, v242
    v_fmac_f32 v227, v86, v243
    s_add_u32 m0, s22, 0xc0c0
    s_add_u32 s80, s29, 0x1b0c000
    buffer_load_dwordx4 v1, s[4:7], s80 offen sc1 lds
    s_waitcnt lgkmcnt(4)
    v_fmac_f32 v228, v86, v244
    v_fmac_f32 v229, v86, v245
    v_fmac_f32 v230, v86, v246
    v_fmac_f32 v231, v86, v247
    buffer_load_dwordx4 v1, s[4:7], s80 offen offset:1024 sc1 lds
    v_cvt_pk_bf16_f32 v224, v224, v225
    v_cvt_pk_bf16_f32 v225, v226, v227
    v_cvt_pk_bf16_f32 v226, v228, v229
    v_cvt_pk_bf16_f32 v227, v230, v231
    buffer_load_dwordx4 v1, s[4:7], s80 offen offset:2048 sc1 lds
    s_add_u32 s85, s26, 0x1b10000
    buffer_store_dwordx4 v[224:227], v3, s[4:7], s85 offen sc1
    s_waitcnt lgkmcnt(3)
    v_fmac_f32 v232, v86, v248
    v_fmac_f32 v233, v86, v249
    v_fmac_f32 v234, v86, v250
    buffer_load_dwordx4 v1, s[4:7], s80 offen offset:3072 sc1 lds
    v_fmac_f32 v235, v86, v251
    s_waitcnt lgkmcnt(2)
    v_fmac_f32 v236, v86, v252
    v_fmac_f32 v237, v86, v253
    v_fmac_f32 v238, v86, v254
    v_fmac_f32 v239, v86, v255
    v_cvt_pk_bf16_f32 v232, v232, v233
    v_cvt_pk_bf16_f32 v233, v234, v235
    v_cvt_pk_bf16_f32 v234, v236, v237
    v_cvt_pk_bf16_f32 v235, v238, v239
    s_add_u32 s87, s26, 0x1b30000
    buffer_store_dwordx4 v[232:235], v3, s[4:7], s87 offen sc1
    s_waitcnt lgkmcnt(1)
    v_fmac_f32 v128, v144, v136
    v_fmac_f32 v129, v145, v137
    v_fmac_f32 v130, v146, v138
    v_fmac_f32 v131, v147, v139
    s_waitcnt lgkmcnt(0)
    v_fmac_f32 v132, v148, v140
    v_fmac_f32 v133, v149, v141
    v_fmac_f32 v134, v150, v142
    v_fmac_f32 v135, v151, v143
    v_cvt_pk_bf16_f32 v128, v128, v129
    v_cvt_pk_bf16_f32 v129, v130, v131
    v_cvt_pk_bf16_f32 v130, v132, v133
    v_cvt_pk_bf16_f32 v131, v134, v135
    s_add_u32 s89, s27, 0x1b10000
    buffer_store_dwordx4 v[128:131], v5, s[4:7], s89 offen sc1
    s_mov_b64 exec, 0
    s_cmp_eq_u32 s3, 0
    s_cbranch_scc1 PAD14
    s_cmp_eq_u32 s3, 1
    s_cbranch_scc1 PAD15
    s_cmp_eq_u32 s3, 2
    s_cbranch_scc1 PAD16
    s_cmp_eq_u32 s3, 3
    s_cbranch_scc1 PAD17
WARM1_8:
    s_mov_b64 exec, -1
    v_add_u32 v36, 0x0, v6
    s_waitcnt vmcnt(16)
    ds_read2st64_b32 v[32:33], v36 offset0:0 offset1:4
    ds_read2st64_b32 v[34:35], v36 offset0:8 offset1:12
    v_add_u32 v44, 0x4040, v6
    s_waitcnt vmcnt(11)
    ds_read2st64_b32 v[40:41], v44 offset0:0 offset1:4
    ds_read2st64_b32 v[42:43], v44 offset0:8 offset1:12
    s_waitcnt lgkmcnt(2)
    v_max3_u32 v7, v32, v33, v34
    v_max_u32 v7, v7, v35
    v_cmp_eq_u32 vcc, -1, v7
    s_cbranch_vccnz Lre70
Lok70:
    s_waitcnt lgkmcnt(0)
    v_max3_u32 v7, v40, v41, v42
    v_max_u32 v7, v7, v43
    v_cmp_eq_u32 vcc, -1, v7
    s_cbranch_vccnz Lre71
Lok71:
    v_cmp_eq_u32 vcc, -1, v96
    s_cbranch_vccnz Lre72
Lok72:
    s_barrier
    ds_read_b128 a[232:235], v1 offset:0
    ds_read_b128 a[236:239], v1 offset:2048
    ds_read_b128 a[240:243], v88 offset:0
    ds_read_b128 a[248:251], v89 offset:0
    ds_read_b128 a[244:247], v90 offset:0
    s_waitcnt lgkmcnt(4)
    v_mfma_f32_32x32x16_bf16 v[16:31], a[232:235], v[96:99], 0
    ds_read_b128 a[232:235], v1 offset:4112
    ds_read_b128 a[252:255], v91 offset:0
    s_waitcnt lgkmcnt(4)
    v_mfma_f32_32x32x16_bf16 v[32:47], a[236:239], v[96:99], 0
    ds_read_b128 a[236:239], v1 offset:6160
    s_nop 6
    v_exp_f32 v16, v16
    v_exp_f32 v17, v17
    v_exp_f32 v18, v18
    v_exp_f32 v19, v19
    v_exp_f32 v20, v20
    v_exp_f32 v21, v21
    v_exp_f32 v22, v22
    v_exp_f32 v23, v23
    v_cvt_pk_bf16_f32 v80, v16, v17
    v_cvt_pk_bf16_f32 v81, v18, v19
    v_cvt_pk_bf16_f32 v82, v20, v21
    v_cvt_pk_bf16_f32 v83, v22, v23
    v_exp_f32 v24, v24
    v_exp_f32 v25, v25
    v_mfma_f32_32x32x16_bf16 v[48:63], a[240:243], v[80:83], 0
    ds_read_b128 a[240:243], v88 offset:4112
    v_exp_f32 v26, v26
    v_exp_f32 v27, v27
    v_exp_f32 v28, v28
    v_exp_f32 v29, v29
    v_exp_f32 v30, v30
    v_exp_f32 v31, v31
    v_cvt_pk_bf16_f32 v84, v24, v25
    v_cvt_pk_bf16_f32 v85, v26, v27
    v_cvt_pk_bf16_f32 v86, v28, v29
    v_cvt_pk_bf16_f32 v87, v30, v31
    s_waitcnt lgkmcnt(3)
    v_mfma_f32_32x32x16_bf16 v[16:31], a[232:235], v[96:99], 0
    ds_read_b128 a[232:235], v1 offset:8224
    v_exp_f32 v32, v32
    v_exp_f32 v33, v33
    v_exp_f32 v34, v34
    v_exp_f32 v35, v35
    v_mfma_f32_32x32x16_bf16 v[48:63], a[248:251], v[84:87], v[48:63]
    ds_read_b128 a[248:251], v89 offset:4112
    v_accvgpr_write_b32 a224, -1
    v_accvgpr_write_b32 a225, -1
    v_accvgpr_write_b32 a226, -1
    v_accvgpr_write_b32 a227, -1
    v_exp_f32 v36, v36
    v_exp_f32 v37, v37
    v_exp_f32 v38, v38
    v_exp_f32 v39, v39
    v_cvt_pk_bf16_f32 v80, v32, v33
    v_cvt_pk_bf16_f32 v81, v34, v35
    v_cvt_pk_bf16_f32 v82, v36, v37
    v_cvt_pk_bf16_f32 v83, v38, v39
    v_exp_f32 v40, v40
    v_exp_f32 v41, v41
    v_mfma_f32_32x32x16_bf16 v[48:63], a[244:247], v[80:83], v[48:63]
    ds_read_b128 a[244:247], v90 offset:4112
    v_exp_f32 v42, v42
    v_exp_f32 v43, v43
    v_exp_f32 v44, v44
    v_exp_f32 v45, v45
    v_exp_f32 v46, v46
    v_exp_f32 v47, v47
    v_cvt_pk_bf16_f32 v84, v40, v41
    v_cvt_pk_bf16_f32 v85, v42, v43
    v_cvt_pk_bf16_f32 v86, v44, v45
    v_cvt_pk_bf16_f32 v87, v46, v47
    s_waitcnt lgkmcnt(3)
    v_mfma_f32_32x32x16_bf16 v[32:47], a[236:239], v[96:99], 0
    ds_read_b128 a[236:239], v1 offset:10272
    v_exp_f32 v16, v16
    v_exp_f32 v17, v17
    v_exp_f32 v18, v18
    v_exp_f32 v19, v19
    v_mfma_f32_32x32x16_bf16 v[48:63], a[252:255], v[84:87], v[48:63]
    ds_read_b128 a[252:255], v91 offset:4112
    v_exp_f32 v20, v20
    v_exp_f32 v21, v21
    v_exp_f32 v22, v22
    v_exp_f32 v23, v23
    v_cvt_pk_bf16_f32 v80, v16, v17
    v_cvt_pk_bf16_f32 v81, v18, v19
    v_cvt_pk_bf16_f32 v82, v20, v21
    v_cvt_pk_bf16_f32 v83, v22, v23
    v_exp_f32 v24, v24
    v_exp_f32 v25, v25
    v_mfma_f32_32x32x16_bf16 v[48:63], a[240:243], v[80:83], v[48:63]
    ds_read_b128 a[240:243], v88 offset:8224
    v_exp_f32 v26, v26
    v_exp_f32 v27, v27
    v_exp_f32 v28, v28
    v_exp_f32 v29, v29
    v_exp_f32 v30, v30
    v_exp_f32 v31, v31
    v_cvt_pk_bf16_f32 v84, v24, v25
    v_cvt_pk_bf16_f32 v85, v26, v27
    v_cvt_pk_bf16_f32 v86, v28, v29
    v_cvt_pk_bf16_f32 v87, v30, v31
    s_waitcnt lgkmcnt(3)
    v_mfma_f32_32x32x16_bf16 v[16:31], a[232:235], v[96:99], 0
    ds_read_b128 a[232:235], v1 offset:12336
    v_exp_f32 v32, v32
    v_exp_f32 v33, v33
    v_exp_f32 v34, v34
    v_exp_f32 v35, v35
    v_mfma_f32_32x32x16_bf16 v[48:63], a[248:251], v[84:87], v[48:63]
    ds_read_b128 a[248:251], v89 offset:8224
    v_exp_f32 v36, v36
    v_exp_f32 v37, v37
    v_exp_f32 v38, v38
    v_exp_f32 v39, v39
    v_cvt_pk_bf16_f32 v80, v32, v33
    v_cvt_pk_bf16_f32 v81, v34, v35
    v_cvt_pk_bf16_f32 v82, v36, v37
    v_cvt_pk_bf16_f32 v83, v38, v39
    v_exp_f32 v40, v40
    v_exp_f32 v41, v41
    v_mfma_f32_32x32x16_bf16 v[48:63], a[244:247], v[80:83], v[48:63]
    ds_read_b128 a[244:247], v90 offset:8224
    v_exp_f32 v42, v42
    v_exp_f32 v43, v43
    v_exp_f32 v44, v44
    v_exp_f32 v45, v45
    v_exp_f32 v46, v46
    v_exp_f32 v47, v47
    v_cvt_pk_bf16_f32 v84, v40, v41
    v_cvt_pk_bf16_f32 v85, v42, v43
    v_cvt_pk_bf16_f32 v86, v44, v45
    v_cvt_pk_bf16_f32 v87, v46, v47
    s_waitcnt lgkmcnt(3)
    v_mfma_f32_32x32x16_bf16 v[32:47], a[236:239], v[96:99], 0
    ds_read_b128 a[236:239], v1 offset:14384
    v_exp_f32 v16, v16
    v_exp_f32 v17, v17
    v_exp_f32 v18, v18
    v_exp_f32 v19, v19
    v_mfma_f32_32x32x16_bf16 v[48:63], a[252:255], v[84:87], v[48:63]
    ds_read_b128 a[252:255], v91 offset:8224
    v_exp_f32 v20, v20
    v_exp_f32 v21, v21
    v_exp_f32 v22, v22
    v_exp_f32 v23, v23
    v_cvt_pk_bf16_f32 v80, v16, v17
    v_cvt_pk_bf16_f32 v81, v18, v19
    v_cvt_pk_bf16_f32 v82, v20, v21
    v_cvt_pk_bf16_f32 v83, v22, v23
    v_exp_f32 v24, v24
    v_exp_f32 v25, v25
    v_mfma_f32_32x32x16_bf16 v[48:63], a[240:243], v[80:83], v[48:63]
    ds_read_b128 a[240:243], v88 offset:12336
    v_exp_f32 v26, v26
    v_exp_f32 v27, v27
    v_exp_f32 v28, v28
    v_exp_f32 v29, v29
    v_exp_f32 v30, v30
    v_exp_f32 v31, v31
    v_cvt_pk_bf16_f32 v84, v24, v25
    v_cvt_pk_bf16_f32 v85, v26, v27
    v_cvt_pk_bf16_f32 v86, v28, v29
    v_cvt_pk_bf16_f32 v87, v30, v31
    s_waitcnt lgkmcnt(3)
    v_mfma_f32_32x32x16_bf16 v[16:31], a[232:235], v[96:99], 0
    ds_read_b128 a[232:235], v1 offset:16448
    v_exp_f32 v32, v32
    v_exp_f32 v33, v33
    v_exp_f32 v34, v34
    v_exp_f32 v35, v35
    v_mfma_f32_32x32x16_bf16 v[48:63], a[248:251], v[84:87], v[48:63]
    ds_read_b128 a[248:251], v89 offset:12336
    v_exp_f32 v36, v36
    v_exp_f32 v37, v37
    v_exp_f32 v38, v38
    v_exp_f32 v39, v39
    v_cvt_pk_bf16_f32 v80, v32, v33
    v_cvt_pk_bf16_f32 v81, v34, v35
    v_cvt_pk_bf16_f32 v82, v36, v37
    v_cvt_pk_bf16_f32 v83, v38, v39
    v_exp_f32 v40, v40
    v_exp_f32 v41, v41
    v_mfma_f32_32x32x16_bf16 v[48:63], a[244:247], v[80:83], v[48:63]
    ds_read_b128 a[244:247], v90 offset:12336
    v_exp_f32 v42, v42
    v_exp_f32 v43, v43
    v_exp_f32 v44, v44
    v_exp_f32 v45, v45
    v_exp_f32 v46, v46
    v_exp_f32 v47, v47
    v_cvt_pk_bf16_f32 v84, v40, v41
    v_cvt_pk_bf16_f32 v85, v42, v43
    v_cvt_pk_bf16_f32 v86, v44, v45
    v_cvt_pk_bf16_f32 v87, v46, v47
    s_waitcnt lgkmcnt(3)
    v_mfma_f32_32x32x16_bf16 v[32:47], a[236:239], v[96:99], 0
    ds_read_b128 a[236:239], v1 offset:18496
    v_exp_f32 v16, v16
    v_exp_f32 v17, v17
    v_exp_f32 v18, v18
    v_exp_f32 v19, v19
    v_mfma_f32_32x32x16_bf16 v[48:63], a[252:255], v[84:87], v[48:63]
    ds_read_b128 a[252:255], v91 offset:12336
    v_exp_f32 v20, v20
    v_exp_f32 v21, v21
    v_exp_f32 v22, v22
    v_exp_f32 v23, v23
    v_cvt_pk_bf16_f32 v80, v16, v17
    v_cvt_pk_bf16_f32 v81, v18, v19
    v_cvt_pk_bf16_f32 v82, v20, v21
    v_cvt_pk_bf16_f32 v83, v22, v23
    v_exp_f32 v24, v24
    v_exp_f32 v25, v25
    v_mfma_f32_32x32x16_bf16 v[48:63], a[240:243], v[80:83], v[48:63]
    ds_read_b128 a[240:243], v88 offset:16448
    v_exp_f32 v26, v26
    v_exp_f32 v27, v27
    v_exp_f32 v28, v28
    v_exp_f32 v29, v29
    v_exp_f32 v30, v30
    v_exp_f32 v31, v31
    v_cvt_pk_bf16_f32 v84, v24, v25
    v_cvt_pk_bf16_f32 v85, v26, v27
    v_cvt_pk_bf16_f32 v86, v28, v29
    v_cvt_pk_bf16_f32 v87, v30, v31
    s_waitcnt lgkmcnt(3)
    v_mfma_f32_32x32x16_bf16 v[16:31], a[232:235], v[96:99], 0
    ds_read_b128 a[232:235], v1 offset:20560
    v_exp_f32 v32, v32
    v_exp_f32 v33, v33
    v_exp_f32 v34, v34
    v_exp_f32 v35, v35
    v_mfma_f32_32x32x16_bf16 v[48:63], a[248:251], v[84:87], v[48:63]
    ds_read_b128 a[248:251], v89 offset:16448
    v_exp_f32 v36, v36
    v_exp_f32 v37, v37
    v_exp_f32 v38, v38
    v_exp_f32 v39, v39
    v_cvt_pk_bf16_f32 v80, v32, v33
    v_cvt_pk_bf16_f32 v81, v34, v35
    v_cvt_pk_bf16_f32 v82, v36, v37
    v_cvt_pk_bf16_f32 v83, v38, v39
    v_exp_f32 v40, v40
    v_exp_f32 v41, v41
    v_mfma_f32_32x32x16_bf16 v[48:63], a[244:247], v[80:83], v[48:63]
    ds_read_b128 a[244:247], v90 offset:16448
    v_exp_f32 v42, v42
    v_exp_f32 v43, v43
    v_exp_f32 v44, v44
    v_exp_f32 v45, v45
    v_exp_f32 v46, v46
    v_exp_f32 v47, v47
    v_cvt_pk_bf16_f32 v84, v40, v41
    v_cvt_pk_bf16_f32 v85, v42, v43
    v_cvt_pk_bf16_f32 v86, v44, v45
    v_cvt_pk_bf16_f32 v87, v46, v47
    s_waitcnt lgkmcnt(3)
    v_mfma_f32_32x32x16_bf16 v[32:47], a[236:239], v[96:99], 0
    ds_read_b128 a[236:239], v1 offset:22608
    v_exp_f32 v16, v16
    v_exp_f32 v17, v17
    v_exp_f32 v18, v18
    v_exp_f32 v19, v19
    v_mfma_f32_32x32x16_bf16 v[48:63], a[252:255], v[84:87], v[48:63]
    ds_read_b128 a[252:255], v91 offset:16448
    v_lshrrev_b32 v7, 2, v1
    v_and_b32 v7, 64, v7
    v_xor_b32 v7, v7, v1
    v_and_b32 v7, 0x70, v7
    v_lshrrev_b32 v111, 7, v1
    v_mul_u32_u24 v111, 1024, v111
    v_add_u32 v111, v111, v7
    v_exp_f32 v20, v20
    v_exp_f32 v21, v21
    v_exp_f32 v22, v22
    v_exp_f32 v23, v23
    v_cvt_pk_bf16_f32 v80, v16, v17
    v_cvt_pk_bf16_f32 v81, v18, v19
    v_cvt_pk_bf16_f32 v82, v20, v21
    v_cvt_pk_bf16_f32 v83, v22, v23
    v_exp_f32 v24, v24
    v_exp_f32 v25, v25
    v_mfma_f32_32x32x16_bf16 v[48:63], a[240:243], v[80:83], v[48:63]
    ds_read_b128 a[240:243], v88 offset:20560
    v_exp_f32 v26, v26
    v_exp_f32 v27, v27
    v_exp_f32 v28, v28
    v_exp_f32 v29, v29
    v_exp_f32 v30, v30
    v_exp_f32 v31, v31
    v_cvt_pk_bf16_f32 v84, v24, v25
    v_cvt_pk_bf16_f32 v85, v26, v27
    v_cvt_pk_bf16_f32 v86, v28, v29
    v_cvt_pk_bf16_f32 v87, v30, v31
    s_waitcnt lgkmcnt(3)
    v_mfma_f32_32x32x16_bf16 v[16:31], a[232:235], v[96:99], 0
    ds_read_b128 a[232:235], v1 offset:24672
    v_exp_f32 v32, v32
    v_exp_f32 v33, v33
    v_exp_f32 v34, v34
    v_exp_f32 v35, v35
    v_mfma_f32_32x32x16_bf16 v[48:63], a[248:251], v[84:87], v[48:63]
    ds_read_b128 a[248:251], v89 offset:20560
    v_add_u32 v108, 0x8080, v6
    s_waitcnt vmcnt(4)
    ds_read2st64_b32 v[104:105], v108 offset0:0 offset1:4
    ds_read2st64_b32 v[106:107], v108 offset0:8 offset1:12
    v_lshrrev_b32 v110, 6, v1
    v_mul_u32_u24 v110, 3584, v110
    v_and_or_b32 v110, v1, 48, v110
    s_add_u32 s56, s22, 0x14140
    v_lshrrev_b32 v109, 1, v1
    v_lshrrev_b32 v7, 3, v1
    v_and_b32 v109, 0x118, v109
    v_and_or_b32 v109, v7, 32, v109
    v_and_b32 v7, 0xc0, v1
    v_add3_u32 v109, v109, v7, s56
    v_exp_f32 v36, v36
    v_exp_f32 v37, v37
    v_exp_f32 v38, v38
    v_exp_f32 v39, v39
    v_cvt_pk_bf16_f32 v80, v32, v33
    v_cvt_pk_bf16_f32 v81, v34, v35
    v_cvt_pk_bf16_f32 v82, v36, v37
    v_cvt_pk_bf16_f32 v83, v38, v39
    v_exp_f32 v40, v40
    v_exp_f32 v41, v41
    v_mfma_f32_32x32x16_bf16 v[48:63], a[244:247], v[80:83], v[48:63]
    ds_read_b128 a[244:247], v90 offset:20560
    s_add_u32 s83, s28, 0x1b10000
    buffer_load_dwordx4 v[100:103], v1, s[4:7], s83 offen sc1
    v_exp_f32 v42, v42
    v_exp_f32 v43, v43
    v_exp_f32 v44, v44
    v_exp_f32 v45, v45
    v_exp_f32 v46, v46
    v_exp_f32 v47, v47
    v_cvt_pk_bf16_f32 v84, v40, v41
    v_cvt_pk_bf16_f32 v85, v42, v43
    v_cvt_pk_bf16_f32 v86, v44, v45
    v_cvt_pk_bf16_f32 v87, v46, v47
    s_waitcnt lgkmcnt(5)
    v_mfma_f32_32x32x16_bf16 v[32:47], a[236:239], v[96:99], 0
    ds_read_b128 a[236:239], v1 offset:26720
    s_add_u32 m0, s22, 0x14140
    s_mov_b32 s91, s31
    buffer_load_dwordx4 v110, s[72:75], s91 offen lds
    v_exp_f32 v16, v16
    v_exp_f32 v17, v17
    v_exp_f32 v18, v18
    v_exp_f32 v19, v19
    v_mfma_f32_32x32x16_bf16 v[48:63], a[252:255], v[84:87], v[48:63]
    ds_read_b128 a[252:255], v91 offset:20560
    s_waitcnt lgkmcnt(3)
    v_max3_u32 v7, v104, v105, v106
    v_max_u32 v7, v7, v107
    v_cmp_eq_u32 vcc, -1, v7
    s_cbranch_vccnz Lre73
Lok73:
    v_exp_f32 v20, v20
    v_exp_f32 v21, v21
    v_exp_f32 v22, v22
    v_exp_f32 v23, v23
    v_cvt_pk_bf16_f32 v80, v16, v17
    v_cvt_pk_bf16_f32 v81, v18, v19
    v_cvt_pk_bf16_f32 v82, v20, v21
    v_cvt_pk_bf16_f32 v83, v22, v23
    v_exp_f32 v24, v24
    v_exp_f32 v25, v25
    v_mfma_f32_32x32x16_bf16 v[48:63], a[240:243], v[80:83], v[48:63]
    ds_read_b128 a[240:243], v88 offset:24672
    s_add_u32 s84, s30, 0x1b00000
    buffer_store_dwordx4 a[224:227], v1, s[4:7], s84 offen sc1
    v_exp_f32 v26, v26
    v_exp_f32 v27, v27
    v_exp_f32 v28, v28
    v_exp_f32 v29, v29
    v_exp_f32 v30, v30
    v_exp_f32 v31, v31
    v_cvt_pk_bf16_f32 v84, v24, v25
    v_cvt_pk_bf16_f32 v85, v26, v27
    v_cvt_pk_bf16_f32 v86, v28, v29
    v_cvt_pk_bf16_f32 v87, v30, v31
    s_waitcnt lgkmcnt(3)
    v_mfma_f32_32x32x16_bf16 v[16:31], a[232:235], v[96:99], 0
    ds_read_b128 a[232:235], v1 offset:28784
    v_exp_f32 v32, v32
    v_exp_f32 v33, v33
    v_exp_f32 v34, v34
    v_exp_f32 v35, v35
    v_mfma_f32_32x32x16_bf16 v[48:63], a[248:251], v[84:87], v[48:63]
    ds_read_b128 a[248:251], v89 offset:24672
    v_add_u32 v108, 0xc0c0, v6
    s_waitcnt vmcnt(3)
    ds_read2st64_b32 v[104:105], v108 offset0:0 offset1:4
    ds_read2st64_b32 v[106:107], v108 offset0:8 offset1:12
    v_exp_f32 v36, v36
    v_exp_f32 v37, v37
    v_exp_f32 v38, v38
    v_exp_f32 v39, v39
    v_cvt_pk_bf16_f32 v80, v32, v33
    v_cvt_pk_bf16_f32 v81, v34, v35
    v_cvt_pk_bf16_f32 v82, v36, v37
    v_cvt_pk_bf16_f32 v83, v38, v39
    v_exp_f32 v40, v40
    v_exp_f32 v41, v41
    v_mfma_f32_32x32x16_bf16 v[48:63], a[244:247], v[80:83], v[48:63]
    ds_read_b128 a[244:247], v90 offset:24672
    s_add_u32 s90, s31, 0xdc00
    buffer_load_dwordx4 v110, s[72:75], s90 offen offset:1024 lds
    v_exp_f32 v42, v42
    v_exp_f32 v43, v43
    v_exp_f32 v44, v44
    v_exp_f32 v45, v45
    v_exp_f32 v46, v46
    v_exp_f32 v47, v47
    v_cvt_pk_bf16_f32 v84, v40, v41
    v_cvt_pk_bf16_f32 v85, v42, v43
    v_cvt_pk_bf16_f32 v86, v44, v45
    v_cvt_pk_bf16_f32 v87, v46, v47
    s_waitcnt lgkmcnt(5)
    v_mfma_f32_32x32x16_bf16 v[32:47], a[236:239], v[96:99], 0
    ds_read_b128 a[236:239], v1 offset:30832
    v_exp_f32 v16, v16
    v_exp_f32 v17, v17
    v_exp_f32 v18, v18
    v_exp_f32 v19, v19
    v_mfma_f32_32x32x16_bf16 v[48:63], a[252:255], v[84:87], v[48:63]
    ds_read_b128 a[252:255], v91 offset:24672
    s_waitcnt lgkmcnt(3)
    v_max3_u32 v7, v104, v105, v106
    v_max_u32 v7, v7, v107
    v_cmp_eq_u32 vcc, -1, v7
    s_cbranch_vccnz Lre74
Lok74:
    s_barrier
    v_exp_f32 v20, v20
    v_exp_f32 v21, v21
    v_exp_f32 v22, v22
    v_exp_f32 v23, v23
    v_cvt_pk_bf16_f32 v80, v16, v17
    v_cvt_pk_bf16_f32 v81, v18, v19
    v_cvt_pk_bf16_f32 v82, v20, v21
    v_cvt_pk_bf16_f32 v83, v22, v23
    v_exp_f32 v24, v24
    v_exp_f32 v25, v25
    v_mfma_f32_32x32x16_bf16 v[48:63], a[240:243], v[80:83], v[48:63]
    ds_read_b128 a[240:243], v88 offset:28784
    v_exp_f32 v26, v26
    v_exp_f32 v27, v27
    v_exp_f32 v28, v28
    v_exp_f32 v29, v29
    v_exp_f32 v30, v30
    v_exp_f32 v31, v31
    v_cvt_pk_bf16_f32 v84, v24, v25
    v_cvt_pk_bf16_f32 v85, v26, v27
    v_cvt_pk_bf16_f32 v86, v28, v29
    v_cvt_pk_bf16_f32 v87, v30, v31
    s_waitcnt lgkmcnt(3)
    v_mfma_f32_32x32x16_bf16 v[16:31], a[232:235], v[96:99], 0
    ds_read_b128 a[232:235], v1 offset:32896
    v_exp_f32 v32, v32
    v_exp_f32 v33, v33
    v_exp_f32 v34, v34
    v_exp_f32 v35, v35
    v_mfma_f32_32x32x16_bf16 v[48:63], a[248:251], v[84:87], v[48:63]
    ds_read_b128 a[248:251], v89 offset:28784
    v_exp_f32 v36, v36
    v_exp_f32 v37, v37
    v_exp_f32 v38, v38
    v_exp_f32 v39, v39
    v_cvt_pk_bf16_f32 v80, v32, v33
    v_cvt_pk_bf16_f32 v81, v34, v35
    v_cvt_pk_bf16_f32 v82, v36, v37
    v_cvt_pk_bf16_f32 v83, v38, v39
    v_exp_f32 v40, v40
    v_exp_f32 v41, v41
    v_mfma_f32_32x32x16_bf16 v[48:63], a[244:247], v[80:83], v[48:63]
    ds_read_b128 a[244:247], v90 offset:28784
    s_add_u32 s81, s31, 0x1b800
    buffer_load_dwordx4 v110, s[72:75], s81 offen offset:2048 lds
    v_exp_f32 v42, v42
    v_exp_f32 v43, v43
    v_exp_f32 v44, v44
    v_exp_f32 v45, v45
    v_exp_f32 v46, v46
    v_exp_f32 v47, v47
    v_cvt_pk_bf16_f32 v84, v40, v41
    v_cvt_pk_bf16_f32 v85, v42, v43
    v_cvt_pk_bf16_f32 v86, v44, v45
    v_cvt_pk_bf16_f32 v87, v46, v47
    s_waitcnt lgkmcnt(3)
    v_mfma_f32_32x32x16_bf16 v[32:47], a[236:239], v[96:99], 0
    ds_read_b128 a[236:239], v1 offset:34944
    v_exp_f32 v16, v16
    v_exp_f32 v17, v17
    v_exp_f32 v18, v18
    v_exp_f32 v19, v19
    v_mfma_f32_32x32x16_bf16 v[48:63], a[252:255], v[84:87], v[48:63]
    ds_read_b128 a[252:255], v91 offset:28784
    v_exp_f32 v20, v20
    v_exp_f32 v21, v21
    v_exp_f32 v22, v22
    v_exp_f32 v23, v23
    v_cvt_pk_bf16_f32 v80, v16, v17
    v_cvt_pk_bf16_f32 v81, v18, v19
    v_cvt_pk_bf16_f32 v82, v20, v21
    v_cvt_pk_bf16_f32 v83, v22, v23
    v_exp_f32 v24, v24
    v_exp_f32 v25, v25
    v_mfma_f32_32x32x16_bf16 v[48:63], a[240:243], v[80:83], v[48:63]
    ds_read_b128 a[240:243], v88 offset:32896
    s_add_u32 s86, s31, 0x29400
    buffer_load_dwordx4 v110, s[72:75], s86 offen offset:3072 lds
    v_exp_f32 v26, v26
    v_exp_f32 v27, v27
    v_exp_f32 v28, v28
    v_exp_f32 v29, v29
    v_exp_f32 v30, v30
    v_exp_f32 v31, v31
    v_cvt_pk_bf16_f32 v84, v24, v25
    v_cvt_pk_bf16_f32 v85, v26, v27
    v_cvt_pk_bf16_f32 v86, v28, v29
    v_cvt_pk_bf16_f32 v87, v30, v31
    s_waitcnt lgkmcnt(3)
    v_mfma_f32_32x32x16_bf16 v[16:31], a[232:235], v[96:99], 0
    s_add_u32 s82, s30, 0x1b08000
    buffer_store_dwordx4 a[224:227], v1, s[4:7], s82 offen sc1
    v_exp_f32 v32, v32
    v_exp_f32 v33, v33
    v_exp_f32 v34, v34
    v_exp_f32 v35, v35
    v_mfma_f32_32x32x16_bf16 v[48:63], a[248:251], v[84:87], v[48:63]
    ds_read_b128 a[248:251], v89 offset:32896
    s_waitcnt vmcnt(6)
    v_cmp_eq_u32 vcc, -1, v100
    s_cbranch_vccnz Lre75
Lok75:
    v_accvgpr_write_b32 a228, v100
    v_accvgpr_write_b32 a229, v101
    v_accvgpr_write_b32 a230, v102
    v_accvgpr_write_b32 a231, v103
    v_exp_f32 v36, v36
    v_exp_f32 v37, v37
    v_exp_f32 v38, v38
    v_exp_f32 v39, v39
    v_cvt_pk_bf16_f32 v80, v32, v33
    v_cvt_pk_bf16_f32 v81, v34, v35
    v_cvt_pk_bf16_f32 v82, v36, v37
    v_cvt_pk_bf16_f32 v83, v38, v39
    v_exp_f32 v40, v40
    v_exp_f32 v41, v41
    v_mfma_f32_32x32x16_bf16 v[48:63], a[244:247], v[80:83], v[48:63]
PAD14:
    s_cbranch_execz PAD18
    ds_read_b128 a[244:247], v90 offset:32896
    v_exp_f32 v42, v42
    v_exp_f32 v43, v43
    v_exp_f32 v44, v44
    v_exp_f32 v45, v45
    v_exp_f32 v46, v46
    v_exp_f32 v47, v47
    v_cvt_pk_bf16_f32 v84, v40, v41
    v_cvt_pk_bf16_f32 v85, v42, v43
    v_cvt_pk_bf16_f32 v86, v44, v45
    v_cvt_pk_bf16_f32 v87, v46, v47
    s_waitcnt lgkmcnt(1)
    v_mfma_f32_32x32x16_bf16 v[32:47], a[232:235], a[228:231], 0
    ds_read_b128 a[232:235], v1 offset:37008
    v_exp_f32 v16, v16
    v_exp_f32 v17, v17
    v_exp_f32 v18, v18
    v_exp_f32 v19, v19
    v_mfma_f32_32x32x16_bf16 v[48:63], a[252:255], v[84:87], v[48:63]
    ds_read_b128 a[252:255], v91 offset:32896
    v_exp_f32 v20, v20
    v_exp_f32 v21, v21
    v_exp_f32 v22, v22
    v_exp_f32 v23, v23
    v_cvt_pk_bf16_f32 v80, v16, v17
    v_cvt_pk_bf16_f32 v81, v18, v19
    v_cvt_pk_bf16_f32 v82, v20, v21
    v_cvt_pk_bf16_f32 v83, v22, v23
    v_exp_f32 v24, v24
    v_exp_f32 v25, v25
    v_mfma_f32_32x32x16_bf16 v[48:63], a[240:243], v[80:83], v[48:63]
    s_add_u32 m0, s22, 0x18180
    s_add_u32 s88, s31, 0x38000
    buffer_load_dwordx4 v110, s[72:75], s88 offen lds
    v_exp_f32 v26, v26
    v_exp_f32 v27, v27
    v_exp_f32 v28, v28
    v_exp_f32 v29, v29
    v_exp_f32 v30, v30
    v_exp_f32 v31, v31
    v_cvt_pk_bf16_f32 v84, v24, v25
    v_cvt_pk_bf16_f32 v85, v26, v27
    v_cvt_pk_bf16_f32 v86, v28, v29
    v_cvt_pk_bf16_f32 v87, v30, v31
    v_mfma_f32_32x32x16_bf16 v[16:31], a[236:239], v[96:99], 0
    s_add_u32 s85, s31, 0x45c00
    buffer_load_dwordx4 v110, s[72:75], s85 offen offset:1024 lds
    v_exp_f32 v32, v32
    v_exp_f32 v33, v33
    v_exp_f32 v34, v34
    v_exp_f32 v35, v35
    v_mfma_f32_32x32x16_bf16 v[48:63], a[248:251], v[84:87], v[48:63]
    v_exp_f32 v36, v36
    v_exp_f32 v37, v37
    v_exp_f32 v38, v38
    v_exp_f32 v39, v39
    v_cvt_pk_bf16_f32 v80, v32, v33
    v_cvt_pk_bf16_f32 v81, v34, v35
    v_cvt_pk_bf16_f32 v82, v36, v37
    v_cvt_pk_bf16_f32 v83, v38, v39
    v_exp_f32 v40, v40
    v_exp_f32 v41, v41
    v_mfma_f32_32x32x16_bf16 v[64:79], a[240:243], v[80:83], 0
    ds_read_b128 a[240:243], v88 offset:37008
    v_exp_f32 v42, v42
    v_exp_f32 v43, v43
    v_exp_f32 v44, v44
    v_exp_f32 v45, v45
    v_exp_f32 v46, v46
    v_exp_f32 v47, v47
    v_cvt_pk_bf16_f32 v84, v40, v41
    v_cvt_pk_bf16_f32 v85, v42, v43
    v_cvt_pk_bf16_f32 v86, v44, v45
    v_cvt_pk_bf16_f32 v87, v46, v47
    s_waitcnt lgkmcnt(1)
    v_mfma_f32_32x32x16_bf16 v[32:47], a[236:239], a[228:231], 0
    ds_read_b128 a[236:239], v1 offset:39056
    v_exp_f32 v16, v16
    v_exp_f32 v17, v17
    v_exp_f32 v18, v18
    v_exp_f32 v19, v19
    v_mfma_f32_32x32x16_bf16 v[64:79], a[248:251], v[84:87], v[64:79]
    ds_read_b128 a[248:251], v89 offset:37008
    v_exp_f32 v20, v20
    v_exp_f32 v21, v21
    v_exp_f32 v22, v22
    v_exp_f32 v23, v23
    v_cvt_pk_bf16_f32 v80, v16, v17
    v_cvt_pk_bf16_f32 v81, v18, v19
    v_cvt_pk_bf16_f32 v82, v20, v21
    v_cvt_pk_bf16_f32 v83, v22, v23
    v_exp_f32 v24, v24
    v_exp_f32 v25, v25
    v_mfma_f32_32x32x16_bf16 v[48:63], a[244:247], v[80:83], v[48:63]
    v_exp_f32 v26, v26
    v_exp_f32 v27, v27
    v_exp_f32 v28, v28
    v_exp_f32 v29, v29
    v_exp_f32 v30, v30
    v_exp_f32 v31, v31
    v_cvt_pk_bf16_f32 v84, v24, v25
    v_cvt_pk_bf16_f32 v85, v26, v27
    v_cvt_pk_bf16_f32 v86, v28, v29
    v_cvt_pk_bf16_f32 v87, v30, v31
    v_mfma_f32_32x32x16_bf16 v[16:31], a[232:235], v[96:99], 0
    s_add_u32 s80, s31, 0x53800
    buffer_load_dwordx4 v110, s[72:75], s80 offen offset:2048 lds
    v_exp_f32 v32, v32
    v_exp_f32 v33, v33
    v_exp_f32 v34, v34
    v_exp_f32 v35, v35
    v_mfma_f32_32x32x16_bf16 v[48:63], a[252:255], v[84:87], v[48:63]
    v_exp_f32 v36, v36
    v_exp_f32 v37, v37
    v_exp_f32 v38, v38
    v_exp_f32 v39, v39
    v_cvt_pk_bf16_f32 v80, v32, v33
    v_cvt_pk_bf16_f32 v81, v34, v35
    v_cvt_pk_bf16_f32 v82, v36, v37
    v_cvt_pk_bf16_f32 v83, v38, v39
    v_exp_f32 v40, v40
    v_exp_f32 v41, v41
    v_mfma_f32_32x32x16_bf16 v[64:79], a[244:247], v[80:83], v[64:79]
    ds_read_b128 a[244:247], v90 offset:37008
    v_exp_f32 v42, v42
    v_exp_f32 v43, v43
    v_exp_f32 v44, v44
    v_exp_f32 v45, v45
    v_exp_f32 v46, v46
    v_exp_f32 v47, v47
    v_cvt_pk_bf16_f32 v84, v40, v41
    v_cvt_pk_bf16_f32 v85, v42, v43
    v_cvt_pk_bf16_f32 v86, v44, v45
    v_cvt_pk_bf16_f32 v87, v46, v47
    s_waitcnt lgkmcnt(1)
    v_mfma_f32_32x32x16_bf16 v[32:47], a[232:235], a[228:231], 0
    ds_read_b128 a[232:235], v1 offset:41120
    s_add_u32 s87, s31, 0x61400
    buffer_load_dwordx4 v110, s[72:75], s87 offen offset:3072 lds
    v_exp_f32 v16, v16
    v_exp_f32 v17, v17
    v_exp_f32 v18, v18
    v_exp_f32 v19, v19
    v_mfma_f32_32x32x16_bf16 v[64:79], a[252:255], v[84:87], v[64:79]
    ds_read_b128 a[252:255], v91 offset:37008
    s_waitcnt vmcnt(9)
    ds_read_b64_tr_b16 v[128:129], v109 offset:0
    ds_read_b64_tr_b16 v[130:131], v109 offset:512
    v_exp_f32 v20, v20
    v_exp_f32 v21, v21
    v_exp_f32 v22, v22
    v_exp_f32 v23, v23
    v_cvt_pk_bf16_f32 v80, v16, v17
    v_cvt_pk_bf16_f32 v81, v18, v19
    v_cvt_pk_bf16_f32 v82, v20, v21
    v_cvt_pk_bf16_f32 v83, v22, v23
    v_exp_f32 v24, v24
    v_exp_f32 v25, v25
    v_mfma_f32_32x32x16_bf16 v[48:63], a[240:243], v[80:83], v[48:63]
    s_add_u32 s89, s41, 0x2500000
    buffer_store_dwordx4 a[224:227], v1, s[4:7], s89 offen sc1
    v_exp_f32 v26, v26
    v_exp_f32 v27, v27
    v_exp_f32 v28, v28
    v_exp_f32 v29, v29
    v_exp_f32 v30, v30
    v_exp_f32 v31, v31
    v_cvt_pk_bf16_f32 v84, v24, v25
    v_cvt_pk_bf16_f32 v85, v26, v27
    v_cvt_pk_bf16_f32 v86, v28, v29
    v_cvt_pk_bf16_f32 v87, v30, v31
    v_mfma_f32_32x32x16_bf16 v[16:31], a[236:239], v[96:99], 0
    v_exp_f32 v32, v32
    v_exp_f32 v33, v33
    v_exp_f32 v34, v34
    v_exp_f32 v35, v35
    v_mfma_f32_32x32x16_bf16 v[48:63], a[248:251], v[84:87], v[48:63]
    s_waitcnt vmcnt(8)
    ds_read_b64_tr_b16 v[132:133], v109 offset:1024
    ds_read_b64_tr_b16 v[134:135], v109 offset:1536
    v_exp_f32 v36, v36
    v_exp_f32 v37, v37
    v_exp_f32 v38, v38
    v_exp_f32 v39, v39
    v_cvt_pk_bf16_f32 v80, v32, v33
    v_cvt_pk_bf16_f32 v81, v34, v35
    v_cvt_pk_bf16_f32 v82, v36, v37
    v_cvt_pk_bf16_f32 v83, v38, v39
    v_exp_f32 v40, v40
    v_exp_f32 v41, v41
    v_mfma_f32_32x32x16_bf16 v[64:79], a[240:243], v[80:83], v[64:79]
    ds_read_b128 a[240:243], v88 offset:41120
    v_exp_f32 v42, v42
    v_exp_f32 v43, v43
    v_exp_f32 v44, v44
    v_exp_f32 v45, v45
    v_exp_f32 v46, v46
    v_exp_f32 v47, v47
    v_cvt_pk_bf16_f32 v84, v40, v41
    v_cvt_pk_bf16_f32 v85, v42, v43
    v_cvt_pk_bf16_f32 v86, v44, v45
    v_cvt_pk_bf16_f32 v87, v46, v47
    s_waitcnt lgkmcnt(5)
    v_mfma_f32_32x32x16_bf16 v[32:47], a[236:239], a[228:231], 0
    ds_read_b128 a[236:239], v1 offset:43168
    v_exp_f32 v16, v16
    v_exp_f32 v17, v17
    v_exp_f32 v18, v18
    v_exp_f32 v19, v19
    v_mfma_f32_32x32x16_bf16 v[64:79], a[248:251], v[84:87], v[64:79]
    ds_read_b128 a[248:251], v89 offset:41120
    v_exp_f32 v20, v20
    v_exp_f32 v21, v21
    v_exp_f32 v22, v22
    v_exp_f32 v23, v23
    v_cvt_pk_bf16_f32 v80, v16, v17
    v_cvt_pk_bf16_f32 v81, v18, v19
    v_cvt_pk_bf16_f32 v82, v20, v21
    v_cvt_pk_bf16_f32 v83, v22, v23
    v_exp_f32 v24, v24
    v_exp_f32 v25, v25
    v_mfma_f32_32x32x16_bf16 v[48:63], a[244:247], v[80:83], v[48:63]
    s_waitcnt lgkmcnt(5)
    s_add_u32 m0, s22, 0x14140
    s_add_u32 s83, s31, 0x70000
    buffer_load_dwordx4 v110, s[72:75], s83 offen lds
    v_exp_f32 v26, v26
    v_exp_f32 v27, v27
    v_exp_f32 v28, v28
    v_exp_f32 v29, v29
    v_exp_f32 v30, v30
    v_exp_f32 v31, v31
    v_cvt_pk_bf16_f32 v84, v24, v25
    v_cvt_pk_bf16_f32 v85, v26, v27
    v_cvt_pk_bf16_f32 v86, v28, v29
    v_cvt_pk_bf16_f32 v87, v30, v31
    v_mfma_f32_32x32x16_bf16 v[16:31], a[232:235], v[96:99], 0
    v_exp_f32 v32, v32
    v_exp_f32 v33, v33
    v_exp_f32 v34, v34
    v_exp_f32 v35, v35
    v_mfma_f32_32x32x16_bf16 v[48:63], a[252:255], v[84:87], v[48:63]
    s_waitcnt vmcnt(8)
    ds_read_b64_tr_b16 v[136:137], v109 offset:2048
    ds_read_b64_tr_b16 v[138:139], v109 offset:2560
    v_exp_f32 v36, v36
    v_exp_f32 v37, v37
    v_exp_f32 v38, v38
    v_exp_f32 v39, v39
    v_cvt_pk_bf16_f32 v80, v32, v33
    v_cvt_pk_bf16_f32 v81, v34, v35
    v_cvt_pk_bf16_f32 v82, v36, v37
    v_cvt_pk_bf16_f32 v83, v38, v39
    v_exp_f32 v40, v40
    v_exp_f32 v41, v41
    v_mfma_f32_32x32x16_bf16 v[64:79], a[244:247], v[80:83], v[64:79]
    ds_read_b128 a[244:247], v90 offset:41120
    v_exp_f32 v42, v42
    v_exp_f32 v43, v43
    v_exp_f32 v44, v44
    v_exp_f32 v45, v45
    v_exp_f32 v46, v46
    v_exp_f32 v47, v47
    v_cvt_pk_bf16_f32 v84, v40, v41
    v_cvt_pk_bf16_f32 v85, v42, v43
    v_cvt_pk_bf16_f32 v86, v44, v45
    v_cvt_pk_bf16_f32 v87, v46, v47
    s_waitcnt lgkmcnt(3)
    v_mfma_f32_32x32x16_bf16 v[32:47], a[232:235], a[228:231], 0
    ds_read_b128 a[232:235], v1 offset:45232
    v_exp_f32 v16, v16
    v_exp_f32 v17, v17
    v_exp_f32 v18, v18
    v_exp_f32 v19, v19
    v_mfma_f32_32x32x16_bf16 v[64:79], a[252:255], v[84:87], v[64:79]
    ds_read_b128 a[252:255], v91 offset:41120
    s_waitcnt vmcnt(7)
    ds_read_b64_tr_b16 v[140:141], v109 offset:3072
    ds_read_b64_tr_b16 v[142:143], v109 offset:3584
    v_exp_f32 v20, v20
    v_exp_f32 v21, v21
    v_exp_f32 v22, v22
    v_exp_f32 v23, v23
    v_cvt_pk_bf16_f32 v80, v16, v17
    v_cvt_pk_bf16_f32 v81, v18, v19
    v_cvt_pk_bf16_f32 v82, v20, v21
    v_cvt_pk_bf16_f32 v83, v22, v23
    v_exp_f32 v24, v24
    v_exp_f32 v25, v25
    v_mfma_f32_32x32x16_bf16 v[48:63], a[240:243], v[80:83], v[48:63]
    s_add_u32 s91, s31, 0x7dc00
    buffer_load_dwordx4 v110, s[72:75], s91 offen offset:1024 lds
    v_exp_f32 v26, v26
    v_exp_f32 v27, v27
    v_exp_f32 v28, v28
    v_exp_f32 v29, v29
    v_exp_f32 v30, v30
    v_exp_f32 v31, v31
    v_cvt_pk_bf16_f32 v84, v24, v25
    v_cvt_pk_bf16_f32 v85, v26, v27
    v_cvt_pk_bf16_f32 v86, v28, v29
    v_cvt_pk_bf16_f32 v87, v30, v31
    v_mfma_f32_32x32x16_bf16 v[16:31], a[236:239], v[96:99], 0
    s_waitcnt lgkmcnt(5)
    s_add_u32 s84, s31, 0x8b800
    buffer_load_dwordx4 v110, s[72:75], s84 offen offset:2048 lds
    v_exp_f32 v32, v32
    v_exp_f32 v33, v33
    v_exp_f32 v34, v34
    v_exp_f32 v35, v35
    v_mfma_f32_32x32x16_bf16 v[48:63], a[248:251], v[84:87], v[48:63]
    v_exp_f32 v36, v36
    v_exp_f32 v37, v37
    v_exp_f32 v38, v38
    v_exp_f32 v39, v39
    v_cvt_pk_bf16_f32 v80, v32, v33
    v_cvt_pk_bf16_f32 v81, v34, v35
    v_cvt_pk_bf16_f32 v82, v36, v37
    v_cvt_pk_bf16_f32 v83, v38, v39
    v_exp_f32 v40, v40
    v_exp_f32 v41, v41
    v_mfma_f32_32x32x16_bf16 v[64:79], a[240:243], v[80:83], v[64:79]
    ds_read_b128 a[240:243], v88 offset:45232
    s_add_u32 s90, s41, 0x2600000
    buffer_store_dwordx4 a[224:227], v1, s[4:7], s90 offen sc1
    v_exp_f32 v42, v42
    v_exp_f32 v43, v43
    v_exp_f32 v44, v44
    v_exp_f32 v45, v45
    v_exp_f32 v46, v46
    v_exp_f32 v47, v47
    v_cvt_pk_bf16_f32 v84, v40, v41
    v_cvt_pk_bf16_f32 v85, v42, v43
    v_cvt_pk_bf16_f32 v86, v44, v45
    v_cvt_pk_bf16_f32 v87, v46, v47
    s_waitcnt lgkmcnt(3)
    v_mfma_f32_32x32x16_bf16 v[32:47], a[236:239], a[228:231], 0
    ds_read_b128 a[236:239], v1 offset:47280
    v_exp_f32 v16, v16
    v_exp_f32 v17, v17
    v_exp_f32 v18, v18
    v_exp_f32 v19, v19
    v_mfma_f32_32x32x16_bf16 v[64:79], a[248:251], v[84:87], v[64:79]
    ds_read_b128 a[248:251], v89 offset:45232
    s_waitcnt vmcnt(8)
    ds_read_b64_tr_b16 v[144:145], v109 offset:16448
    ds_read_b64_tr_b16 v[146:147], v109 offset:16960
    v_exp_f32 v20, v20
    v_exp_f32 v21, v21
    v_exp_f32 v22, v22
    v_exp_f32 v23, v23
    v_cvt_pk_bf16_f32 v80, v16, v17
    v_cvt_pk_bf16_f32 v81, v18, v19
    v_cvt_pk_bf16_f32 v82, v20, v21
    v_cvt_pk_bf16_f32 v83, v22, v23
    v_exp_f32 v24, v24
    v_exp_f32 v25, v25
    v_mfma_f32_32x32x16_bf16 v[48:63], a[244:247], v[80:83], v[48:63]
    v_exp_f32 v26, v26
    v_exp_f32 v27, v27
    v_exp_f32 v28, v28
    v_exp_f32 v29, v29
    v_exp_f32 v30, v30
    v_exp_f32 v31, v31
    v_cvt_pk_bf16_f32 v84, v24, v25
    v_cvt_pk_bf16_f32 v85, v26, v27
    v_cvt_pk_bf16_f32 v86, v28, v29
    v_cvt_pk_bf16_f32 v87, v30, v31
    v_mfma_f32_32x32x16_bf16 v[16:31], a[232:235], v[96:99], 0
    s_add_u32 m0, s22, 0x10100
    s_add_u32 s81, s29, 0x1b10000
    buffer_load_dwordx4 v1, s[4:7], s81 offen sc1 lds
    v_exp_f32 v32, v32
    v_exp_f32 v33, v33
    v_exp_f32 v34, v34
    v_exp_f32 v35, v35
    v_mfma_f32_32x32x16_bf16 v[48:63], a[252:255], v[84:87], v[48:63]
    s_waitcnt vmcnt(8)
    ds_read_b64_tr_b16 v[148:149], v109 offset:17472
    ds_read_b64_tr_b16 v[150:151], v109 offset:17984
    v_exp_f32 v36, v36
    v_exp_f32 v37, v37
    v_exp_f32 v38, v38
    v_exp_f32 v39, v39
    v_cvt_pk_bf16_f32 v80, v32, v33
    v_cvt_pk_bf16_f32 v81, v34, v35
    v_cvt_pk_bf16_f32 v82, v36, v37
    v_cvt_pk_bf16_f32 v83, v38, v39
    v_exp_f32 v40, v40
    v_exp_f32 v41, v41
    v_mfma_f32_32x32x16_bf16 v[64:79], a[244:247], v[80:83], v[64:79]
    ds_read_b128 a[244:247], v90 offset:45232
    buffer_load_dwordx4 v1, s[4:7], s81 offen offset:1024 sc1 lds
    v_exp_f32 v42, v42
    v_exp_f32 v43, v43
    v_exp_f32 v44, v44
    v_exp_f32 v45, v45
    v_exp_f32 v46, v46
    v_exp_f32 v47, v47
    v_cvt_pk_bf16_f32 v84, v40, v41
    v_cvt_pk_bf16_f32 v85, v42, v43
    v_cvt_pk_bf16_f32 v86, v44, v45
    v_cvt_pk_bf16_f32 v87, v46, v47
    s_waitcnt lgkmcnt(5)
    v_mfma_f32_32x32x16_bf16 v[32:47], a[232:235], a[228:231], 0
    ds_read_b128 a[232:235], v1 offset:49344
    buffer_load_dwordx4 v1, s[4:7], s81 offen offset:2048 sc1 lds
    v_exp_f32 v16, v16
    v_exp_f32 v17, v17
    v_exp_f32 v18, v18
    v_exp_f32 v19, v19
    v_mfma_f32_32x32x16_bf16 v[64:79], a[252:255], v[84:87], v[64:79]
    ds_read_b128 a[252:255], v91 offset:45232
    v_exp_f32 v20, v20
    v_exp_f32 v21, v21
    v_exp_f32 v22, v22
    v_exp_f32 v23, v23
    v_cvt_pk_bf16_f32 v80, v16, v17
    v_cvt_pk_bf16_f32 v81, v18, v19
    v_cvt_pk_bf16_f32 v82, v20, v21
    v_cvt_pk_bf16_f32 v83, v22, v23
    v_exp_f32 v24, v24
    v_exp_f32 v25, v25
    v_mfma_f32_32x32x16_bf16 v[48:63], a[240:243], v[80:83], v[48:63]
    buffer_load_dwordx4 v1, s[4:7], s81 offen offset:3072 sc1 lds
    v_exp_f32 v26, v26
    v_exp_f32 v27, v27
    v_exp_f32 v28, v28
    v_exp_f32 v29, v29
    v_exp_f32 v30, v30
    v_exp_f32 v31, v31
    v_cvt_pk_bf16_f32 v84, v24, v25
    v_cvt_pk_bf16_f32 v85, v26, v27
    v_cvt_pk_bf16_f32 v86, v28, v29
    v_cvt_pk_bf16_f32 v87, v30, v31
    v_mfma_f32_32x32x16_bf16 v[16:31], a[236:239], v[96:99], 0
    s_add_u32 m0, s22, 0x14d40
    s_add_u32 s86, s31, 0x9a000
    buffer_load_dwordx4 v110, s[72:75], s86 offen lds
    v_exp_f32 v32, v32
    v_exp_f32 v33, v33
    v_exp_f32 v34, v34
    v_exp_f32 v35, v35
    v_mfma_f32_32x32x16_bf16 v[48:63], a[248:251], v[84:87], v[48:63]
    s_waitcnt vmcnt(11)
    ds_read_b64_tr_b16 v[152:153], v109 offset:18496
    ds_read_b64_tr_b16 v[154:155], v109 offset:19008
    v_exp_f32 v36, v36
    v_exp_f32 v37, v37
    v_exp_f32 v38, v38
    v_exp_f32 v39, v39
    v_cvt_pk_bf16_f32 v80, v32, v33
    v_cvt_pk_bf16_f32 v81, v34, v35
    v_cvt_pk_bf16_f32 v82, v36, v37
    v_cvt_pk_bf16_f32 v83, v38, v39
    v_exp_f32 v40, v40
    v_exp_f32 v41, v41
    v_mfma_f32_32x32x16_bf16 v[64:79], a[240:243], v[80:83], v[64:79]
    ds_read_b128 a[240:243], v88 offset:49344
    s_waitcnt lgkmcnt(8)
    s_add_u32 m0, s22, 0x18180
    s_add_u32 s82, s31, 0xa8000
    buffer_load_dwordx4 v110, s[72:75], s82 offen lds
    v_exp_f32 v42, v42
    v_exp_f32 v43, v43
    v_exp_f32 v44, v44
    v_exp_f32 v45, v45
    v_exp_f32 v46, v46
    v_exp_f32 v47, v47
    v_cvt_pk_bf16_f32 v84, v40, v41
    v_cvt_pk_bf16_f32 v85, v42, v43
    v_cvt_pk_bf16_f32 v86, v44, v45
    v_cvt_pk_bf16_f32 v87, v46, v47
    s_waitcnt lgkmcnt(3)
    v_mfma_f32_32x32x16_bf16 v[32:47], a[236:239], a[228:231], 0
    ds_read_b128 a[236:239], v1 offset:51392
    v_exp_f32 v16, v16
    v_exp_f32 v17, v17
    v_exp_f32 v18, v18
    v_exp_f32 v19, v19
    v_mfma_f32_32x32x16_bf16 v[64:79], a[248:251], v[84:87], v[64:79]
    ds_read_b128 a[248:251], v89 offset:49344
    s_waitcnt vmcnt(11)
    ds_read_b64_tr_b16 v[156:157], v109 offset:19520
    ds_read_b64_tr_b16 v[158:159], v109 offset:20032
    v_exp_f32 v20, v20
    v_exp_f32 v21, v21
    v_exp_f32 v22, v22
    v_exp_f32 v23, v23
    v_cvt_pk_bf16_f32 v80, v16, v17
    v_cvt_pk_bf16_f32 v81, v18, v19
    v_cvt_pk_bf16_f32 v82, v20, v21
    v_cvt_pk_bf16_f32 v83, v22, v23
    v_exp_f32 v24, v24
    v_exp_f32 v25, v25
    v_mfma_f32_32x32x16_bf16 v[48:63], a[244:247], v[80:83], v[48:63]
    s_add_u32 s88, s31, 0xb5c00
    buffer_load_dwordx4 v110, s[72:75], s88 offen offset:1024 lds
    v_exp_f32 v26, v26
    v_exp_f32 v27, v27
    v_exp_f32 v28, v28
    v_exp_f32 v29, v29
    v_exp_f32 v30, v30
    v_exp_f32 v31, v31
    v_cvt_pk_bf16_f32 v84, v24, v25
    v_cvt_pk_bf16_f32 v85, v26, v27
    v_cvt_pk_bf16_f32 v86, v28, v29
    v_cvt_pk_bf16_f32 v87, v30, v31
    v_mfma_f32_32x32x16_bf16 v[16:31], a[232:235], v[96:99], 0
    s_waitcnt lgkmcnt(5)
    s_add_u32 s85, s31, 0xc3800
    buffer_load_dwordx4 v110, s[72:75], s85 offen offset:2048 lds
    v_exp_f32 v32, v32
    v_exp_f32 v33, v33
    v_exp_f32 v34, v34
    v_exp_f32 v35, v35
    v_mfma_f32_32x32x16_bf16 v[48:63], a[252:255], v[84:87], v[48:63]
    v_exp_f32 v36, v36
    v_exp_f32 v37, v37
    v_exp_f32 v38, v38
    v_exp_f32 v39, v39
    v_cvt_pk_bf16_f32 v80, v32, v33
    v_cvt_pk_bf16_f32 v81, v34, v35
    v_cvt_pk_bf16_f32 v82, v36, v37
    v_cvt_pk_bf16_f32 v83, v38, v39
    v_exp_f32 v40, v40
    v_exp_f32 v41, v41
    v_mfma_f32_32x32x16_bf16 v[64:79], a[244:247], v[80:83], v[64:79]
    ds_read_b128 a[244:247], v90 offset:49344
    s_add_u32 s80, s41, 0x2700000
    buffer_store_dwordx4 a[224:227], v1, s[4:7], s80 offen sc1
    v_exp_f32 v42, v42
    v_exp_f32 v43, v43
    v_exp_f32 v44, v44
    v_exp_f32 v45, v45
    v_exp_f32 v46, v46
    v_exp_f32 v47, v47
    v_cvt_pk_bf16_f32 v84, v40, v41
    v_cvt_pk_bf16_f32 v85, v42, v43
    v_cvt_pk_bf16_f32 v86, v44, v45
    v_cvt_pk_bf16_f32 v87, v46, v47
    s_waitcnt lgkmcnt(3)
    v_mfma_f32_32x32x16_bf16 v[32:47], a[232:235], a[228:231], 0
    ds_read_b128 a[232:235], v1 offset:53456
    v_exp_f32 v16, v16
    v_exp_f32 v17, v17
    v_exp_f32 v18, v18
    v_exp_f32 v19, v19
    v_mfma_f32_32x32x16_bf16 v[64:79], a[252:255], v[84:87], v[64:79]
    ds_read_b128 a[252:255], v91 offset:49344
    s_waitcnt vmcnt(12)
    ds_read_b64_tr_b16 v[160:161], v109 offset:0
    ds_read_b64_tr_b16 v[162:163], v109 offset:512
    v_exp_f32 v20, v20
    v_exp_f32 v21, v21
    v_exp_f32 v22, v22
    v_exp_f32 v23, v23
    v_cvt_pk_bf16_f32 v80, v16, v17
    v_cvt_pk_bf16_f32 v81, v18, v19
    v_cvt_pk_bf16_f32 v82, v20, v21
    v_cvt_pk_bf16_f32 v83, v22, v23
    v_exp_f32 v24, v24
    v_exp_f32 v25, v25
    v_mfma_f32_32x32x16_bf16 v[48:63], a[240:243], v[80:83], v[48:63]
    v_exp_f32 v26, v26
    v_exp_f32 v27, v27
    v_exp_f32 v28, v28
    v_exp_f32 v29, v29
    v_exp_f32 v30, v30
    v_exp_f32 v31, v31
    v_cvt_pk_bf16_f32 v84, v24, v25
    v_cvt_pk_bf16_f32 v85, v26, v27
    v_cvt_pk_bf16_f32 v86, v28, v29
    v_cvt_pk_bf16_f32 v87, v30, v31
    v_mfma_f32_32x32x16_bf16 v[16:31], a[236:239], v[96:99], 0
    s_waitcnt lgkmcnt(5)
    s_add_u32 s87, s31, 0xd1400
    buffer_load_dwordx4 v110, s[72:75], s87 offen offset:3072 lds
    v_exp_f32 v32, v32
    v_exp_f32 v33, v33
    v_exp_f32 v34, v34
    v_exp_f32 v35, v35
    v_mfma_f32_32x32x16_bf16 v[48:63], a[248:251], v[84:87], v[48:63]
    v_exp_f32 v36, v36
    v_exp_f32 v37, v37
    v_exp_f32 v38, v38
    v_exp_f32 v39, v39
    v_cvt_pk_bf16_f32 v80, v32, v33
    v_cvt_pk_bf16_f32 v81, v34, v35
    v_cvt_pk_bf16_f32 v82, v36, v37
    v_cvt_pk_bf16_f32 v83, v38, v39
    v_exp_f32 v40, v40
    v_exp_f32 v41, v41
    v_mfma_f32_32x32x16_bf16 v[64:79], a[240:243], v[80:83], v[64:79]
    ds_read_b128 a[240:243], v88 offset:53456
    v_exp_f32 v42, v42
    v_exp_f32 v43, v43
    v_exp_f32 v44, v44
    v_exp_f32 v45, v45
    v_exp_f32 v46, v46
    v_exp_f32 v47, v47
    v_cvt_pk_bf16_f32 v84, v40, v41
    v_cvt_pk_bf16_f32 v85, v42, v43
    v_cvt_pk_bf16_f32 v86, v44, v45
    v_cvt_pk_bf16_f32 v87, v46, v47
    s_waitcnt lgkmcnt(3)
    v_mfma_f32_32x32x16_bf16 v[32:47], a[236:239], a[228:231], 0
    ds_read_b128 a[236:239], v1 offset:55504
    v_exp_f32 v16, v16
    v_exp_f32 v17, v17
    v_exp_f32 v18, v18
    v_exp_f32 v19, v19
    v_mfma_f32_32x32x16_bf16 v[64:79], a[248:251], v[84:87], v[64:79]
    ds_read_b128 a[248:251], v89 offset:53456
    s_waitcnt vmcnt(12)
    ds_read_b64_tr_b16 v[164:165], v109 offset:1024
    ds_read_b64_tr_b16 v[166:167], v109 offset:1536
    v_exp_f32 v20, v20
    v_exp_f32 v21, v21
    v_exp_f32 v22, v22
    v_exp_f32 v23, v23
    v_cvt_pk_bf16_f32 v80, v16, v17
    v_cvt_pk_bf16_f32 v81, v18, v19
    v_cvt_pk_bf16_f32 v82, v20, v21
    v_cvt_pk_bf16_f32 v83, v22, v23
    v_exp_f32 v24, v24
    v_exp_f32 v25, v25
    v_mfma_f32_32x32x16_bf16 v[48:63], a[244:247], v[80:83], v[48:63]
    v_exp_f32 v26, v26
    v_exp_f32 v27, v27
    v_exp_f32 v28, v28
    v_exp_f32 v29, v29
    v_exp_f32 v30, v30
    v_exp_f32 v31, v31
    v_cvt_pk_bf16_f32 v84, v24, v25
    v_cvt_pk_bf16_f32 v85, v26, v27
    v_cvt_pk_bf16_f32 v86, v28, v29
    v_cvt_pk_bf16_f32 v87, v30, v31
    v_mfma_f32_32x32x16_bf16 v[16:31], a[232:235], v[96:99], 0
    s_add_u32 m0, s22, 0x1c1c0
    s_add_u32 s89, s31, 0xe0000
    buffer_load_dwordx4 v110, s[72:75], s89 offen lds
    v_exp_f32 v32, v32
    v_exp_f32 v33, v33
    v_exp_f32 v34, v34
    v_exp_f32 v35, v35
    v_mfma_f32_32x32x16_bf16 v[48:63], a[252:255], v[84:87], v[48:63]
    s_waitcnt vmcnt(12)
    ds_read_b64_tr_b16 v[168:169], v109 offset:2048
    ds_read_b64_tr_b16 v[170:171], v109 offset:2560
    v_exp_f32 v36, v36
    v_exp_f32 v37, v37
    v_exp_f32 v38, v38
    v_exp_f32 v39, v39
    v_cvt_pk_bf16_f32 v80, v32, v33
    v_cvt_pk_bf16_f32 v81, v34, v35
    v_cvt_pk_bf16_f32 v82, v36, v37
    v_cvt_pk_bf16_f32 v83, v38, v39
    v_exp_f32 v40, v40
    v_exp_f32 v41, v41
    v_mfma_f32_32x32x16_bf16 v[64:79], a[244:247], v[80:83], v[64:79]
    ds_read_b128 a[244:247], v90 offset:53456
    v_exp_f32 v42, v42
    v_exp_f32 v43, v43
    v_exp_f32 v44, v44
    v_exp_f32 v45, v45
    v_exp_f32 v46, v46
    v_exp_f32 v47, v47
    v_cvt_pk_bf16_f32 v84, v40, v41
    v_cvt_pk_bf16_f32 v85, v42, v43
    v_cvt_pk_bf16_f32 v86, v44, v45
    v_cvt_pk_bf16_f32 v87, v46, v47
    s_waitcnt lgkmcnt(5)
    v_mfma_f32_32x32x16_bf16 v[32:47], a[232:235], a[228:231], 0
    ds_read_b128 a[232:235], v1 offset:57568
    s_add_u32 s83, s31, 0xedc00
    buffer_load_dwordx4 v110, s[72:75], s83 offen offset:1024 lds
    v_exp_f32 v16, v16
    v_exp_f32 v17, v17
    v_exp_f32 v18, v18
    v_exp_f32 v19, v19
    v_mfma_f32_32x32x16_bf16 v[64:79], a[252:255], v[84:87], v[64:79]
    ds_read_b128 a[252:255], v91 offset:53456
    v_exp_f32 v20, v20
    v_exp_f32 v21, v21
    v_exp_f32 v22, v22
    v_exp_f32 v23, v23
    v_cvt_pk_bf16_f32 v80, v16, v17
    v_cvt_pk_bf16_f32 v81, v18, v19
    v_cvt_pk_bf16_f32 v82, v20, v21
    v_cvt_pk_bf16_f32 v83, v22, v23
    v_exp_f32 v24, v24
    v_exp_f32 v25, v25
PAD15:
    s_cbranch_execz PAD19
    v_mfma_f32_32x32x16_bf16 v[48:63], a[240:243], v[80:83], v[48:63]
    s_add_u32 s91, s41, 0x2800000
    buffer_store_dwordx4 a[224:227], v1, s[4:7], s91 offen sc1
    v_exp_f32 v26, v26
    v_exp_f32 v27, v27
    v_exp_f32 v28, v28
    v_exp_f32 v29, v29
    v_exp_f32 v30, v30
    v_exp_f32 v31, v31
    v_cvt_pk_bf16_f32 v84, v24, v25
    v_cvt_pk_bf16_f32 v85, v26, v27
    v_cvt_pk_bf16_f32 v86, v28, v29
    v_cvt_pk_bf16_f32 v87, v30, v31
    v_mfma_f32_32x32x16_bf16 v[16:31], a[236:239], v[96:99], 0
    v_exp_f32 v32, v32
    v_exp_f32 v33, v33
    v_exp_f32 v34, v34
    v_exp_f32 v35, v35
    v_mfma_f32_32x32x16_bf16 v[48:63], a[248:251], v[84:87], v[48:63]
    v_exp_f32 v36, v36
    v_exp_f32 v37, v37
    v_exp_f32 v38, v38
    v_exp_f32 v39, v39
    v_cvt_pk_bf16_f32 v80, v32, v33
    v_cvt_pk_bf16_f32 v81, v34, v35
    v_cvt_pk_bf16_f32 v82, v36, v37
    v_cvt_pk_bf16_f32 v83, v38, v39
    v_exp_f32 v40, v40
    v_exp_f32 v41, v41
    v_mfma_f32_32x32x16_bf16 v[64:79], a[240:243], v[80:83], v[64:79]
    ds_read_b128 a[240:243], v88 offset:57568
    v_exp_f32 v42, v42
    v_exp_f32 v43, v43
    v_exp_f32 v44, v44
    v_exp_f32 v45, v45
    v_exp_f32 v46, v46
    v_exp_f32 v47, v47
    v_cvt_pk_bf16_f32 v84, v40, v41
    v_cvt_pk_bf16_f32 v85, v42, v43
    v_cvt_pk_bf16_f32 v86, v44, v45
    v_cvt_pk_bf16_f32 v87, v46, v47
    s_waitcnt lgkmcnt(1)
    v_mfma_f32_32x32x16_bf16 v[32:47], a[236:239], a[228:231], 0
    ds_read_b128 a[236:239], v1 offset:59616
    v_exp_f32 v16, v16
    v_exp_f32 v17, v17
    v_exp_f32 v18, v18
    v_exp_f32 v19, v19
    v_mfma_f32_32x32x16_bf16 v[64:79], a[248:251], v[84:87], v[64:79]
    ds_read_b128 a[248:251], v89 offset:57568
    v_exp_f32 v20, v20
    v_exp_f32 v21, v21
    v_exp_f32 v22, v22
    v_exp_f32 v23, v23
    v_cvt_pk_bf16_f32 v80, v16, v17
    v_cvt_pk_bf16_f32 v81, v18, v19
    v_cvt_pk_bf16_f32 v82, v20, v21
    v_cvt_pk_bf16_f32 v83, v22, v23
    v_exp_f32 v24, v24
    v_exp_f32 v25, v25
    v_mfma_f32_32x32x16_bf16 v[48:63], a[244:247], v[80:83], v[48:63]
    s_add_u32 s84, s31, 0xfb800
    buffer_load_dwordx4 v110, s[72:75], s84 offen offset:2048 lds
    v_exp_f32 v26, v26
    v_exp_f32 v27, v27
    v_exp_f32 v28, v28
    v_exp_f32 v29, v29
    v_exp_f32 v30, v30
    v_exp_f32 v31, v31
    v_cvt_pk_bf16_f32 v84, v24, v25
    v_cvt_pk_bf16_f32 v85, v26, v27
    v_cvt_pk_bf16_f32 v86, v28, v29
    v_cvt_pk_bf16_f32 v87, v30, v31
    v_mfma_f32_32x32x16_bf16 v[16:31], a[232:235], v[96:99], 0
    s_add_u32 s90, s31, 0x109400
    buffer_load_dwordx4 v110, s[72:75], s90 offen offset:3072 lds
    v_exp_f32 v32, v32
    v_exp_f32 v33, v33
    v_exp_f32 v34, v34
    v_exp_f32 v35, v35
    v_mfma_f32_32x32x16_bf16 v[48:63], a[252:255], v[84:87], v[48:63]
    s_waitcnt vmcnt(10)
    ds_read_b64_tr_b16 v[172:173], v109 offset:3072
    ds_read_b64_tr_b16 v[174:175], v109 offset:3584
    s_waitcnt vmcnt(9)
    ds_read_b64_tr_b16 v[176:177], v109 offset:16448
    ds_read_b64_tr_b16 v[178:179], v109 offset:16960
    v_exp_f32 v36, v36
    v_exp_f32 v37, v37
    v_exp_f32 v38, v38
    v_exp_f32 v39, v39
    v_cvt_pk_bf16_f32 v80, v32, v33
    v_cvt_pk_bf16_f32 v81, v34, v35
    v_cvt_pk_bf16_f32 v82, v36, v37
    v_cvt_pk_bf16_f32 v83, v38, v39
    v_exp_f32 v40, v40
    v_exp_f32 v41, v41
    v_mfma_f32_32x32x16_bf16 v[64:79], a[244:247], v[80:83], v[64:79]
    ds_read_b128 a[244:247], v90 offset:57568
    v_exp_f32 v42, v42
    v_exp_f32 v43, v43
    v_exp_f32 v44, v44
    v_exp_f32 v45, v45
    v_exp_f32 v46, v46
    v_exp_f32 v47, v47
    v_cvt_pk_bf16_f32 v84, v40, v41
    v_cvt_pk_bf16_f32 v85, v42, v43
    v_cvt_pk_bf16_f32 v86, v44, v45
    v_cvt_pk_bf16_f32 v87, v46, v47
    s_waitcnt lgkmcnt(5)
    v_mfma_f32_32x32x16_bf16 v[32:47], a[232:235], a[228:231], 0
    ds_read_b128 a[232:235], v1 offset:61680
    v_exp_f32 v16, v16
    v_exp_f32 v17, v17
    v_exp_f32 v18, v18
    v_exp_f32 v19, v19
    v_mfma_f32_32x32x16_bf16 v[64:79], a[252:255], v[84:87], v[64:79]
    ds_read_b128 a[252:255], v91 offset:57568
    s_waitcnt vmcnt(8)
    ds_read_b64_tr_b16 v[180:181], v109 offset:17472
    ds_read_b64_tr_b16 v[182:183], v109 offset:17984
    v_exp_f32 v20, v20
    v_exp_f32 v21, v21
    v_exp_f32 v22, v22
    v_exp_f32 v23, v23
    v_cvt_pk_bf16_f32 v80, v16, v17
    v_cvt_pk_bf16_f32 v81, v18, v19
    v_cvt_pk_bf16_f32 v82, v20, v21
    v_cvt_pk_bf16_f32 v83, v22, v23
    v_exp_f32 v24, v24
    v_exp_f32 v25, v25
    v_mfma_f32_32x32x16_bf16 v[48:63], a[240:243], v[80:83], v[48:63]
    v_exp_f32 v26, v26
    v_exp_f32 v27, v27
    v_exp_f32 v28, v28
    v_exp_f32 v29, v29
    v_exp_f32 v30, v30
    v_exp_f32 v31, v31
    v_cvt_pk_bf16_f32 v84, v24, v25
    v_cvt_pk_bf16_f32 v85, v26, v27
    v_cvt_pk_bf16_f32 v86, v28, v29
    v_cvt_pk_bf16_f32 v87, v30, v31
    v_mfma_f32_32x32x16_bf16 v[16:31], a[236:239], v[96:99], 0
    s_waitcnt lgkmcnt(5)
    s_add_u32 m0, s22, 0x18180
    s_add_u32 s81, s31, 0x118000
    buffer_load_dwordx4 v110, s[72:75], s81 offen lds
    v_exp_f32 v32, v32
    v_exp_f32 v33, v33
    v_exp_f32 v34, v34
    v_exp_f32 v35, v35
    v_mfma_f32_32x32x16_bf16 v[48:63], a[248:251], v[84:87], v[48:63]
    v_add_u32 v108, 0x10100, v6
    ds_read2st64_b32 v[104:105], v108 offset0:0 offset1:4
    ds_read2st64_b32 v[106:107], v108 offset0:8 offset1:12
    s_waitcnt vmcnt(8)
    ds_read_b64_tr_b16 v[184:185], v109 offset:18496
    ds_read_b64_tr_b16 v[186:187], v109 offset:19008
    v_exp_f32 v36, v36
    v_exp_f32 v37, v37
    v_exp_f32 v38, v38
    v_exp_f32 v39, v39
    v_cvt_pk_bf16_f32 v80, v32, v33
    v_cvt_pk_bf16_f32 v81, v34, v35
    v_cvt_pk_bf16_f32 v82, v36, v37
    v_cvt_pk_bf16_f32 v83, v38, v39
    v_exp_f32 v40, v40
    v_exp_f32 v41, v41
    v_mfma_f32_32x32x16_bf16 v[64:79], a[240:243], v[80:83], v[64:79]
    ds_read_b128 a[240:243], v88 offset:61680
    s_add_u32 s86, s41, 0x2900000
    buffer_store_dwordx4 a[224:227], v1, s[4:7], s86 offen sc1
    v_exp_f32 v42, v42
    v_exp_f32 v43, v43
    v_exp_f32 v44, v44
    v_exp_f32 v45, v45
    v_exp_f32 v46, v46
    v_exp_f32 v47, v47
    v_cvt_pk_bf16_f32 v84, v40, v41
    v_cvt_pk_bf16_f32 v85, v42, v43
    v_cvt_pk_bf16_f32 v86, v44, v45
    v_cvt_pk_bf16_f32 v87, v46, v47
    s_waitcnt lgkmcnt(7)
    v_mfma_f32_32x32x16_bf16 v[32:47], a[236:239], a[228:231], 0
    ds_read_b128 a[236:239], v1 offset:63728
    v_exp_f32 v16, v16
    v_exp_f32 v17, v17
    v_exp_f32 v18, v18
    v_exp_f32 v19, v19
    v_mfma_f32_32x32x16_bf16 v[64:79], a[248:251], v[84:87], v[64:79]
    ds_read_b128 a[248:251], v89 offset:61680
    s_waitcnt lgkmcnt(5)
    v_max3_u32 v7, v104, v105, v106
    v_max_u32 v7, v7, v107
    v_cmp_eq_u32 vcc, -1, v7
    s_cbranch_vccnz Lre76
Lok76:
    v_exp_f32 v20, v20
    v_exp_f32 v21, v21
    v_exp_f32 v22, v22
    v_exp_f32 v23, v23
    v_cvt_pk_bf16_f32 v80, v16, v17
    v_cvt_pk_bf16_f32 v81, v18, v19
    v_cvt_pk_bf16_f32 v82, v20, v21
    v_cvt_pk_bf16_f32 v83, v22, v23
    v_exp_f32 v24, v24
    v_exp_f32 v25, v25
    v_mfma_f32_32x32x16_bf16 v[48:63], a[244:247], v[80:83], v[48:63]
    s_add_u32 s82, s31, 0x125c00
    buffer_load_dwordx4 v110, s[72:75], s82 offen offset:1024 lds
    v_exp_f32 v26, v26
    v_exp_f32 v27, v27
    v_exp_f32 v28, v28
    v_exp_f32 v29, v29
    v_exp_f32 v30, v30
    v_exp_f32 v31, v31
    v_cvt_pk_bf16_f32 v84, v24, v25
    v_cvt_pk_bf16_f32 v85, v26, v27
    v_cvt_pk_bf16_f32 v86, v28, v29
    v_cvt_pk_bf16_f32 v87, v30, v31
    v_mfma_f32_32x32x16_bf16 v[16:31], a[232:235], v[96:99], 0
    s_add_u32 m0, s22, 0x14140
    s_add_u32 s88, s29, 0x1b14000
    buffer_load_dwordx4 v1, s[4:7], s88 offen sc1 lds
    v_exp_f32 v32, v32
    v_exp_f32 v33, v33
    v_exp_f32 v34, v34
    v_exp_f32 v35, v35
    v_mfma_f32_32x32x16_bf16 v[48:63], a[252:255], v[84:87], v[48:63]
    s_barrier
    s_waitcnt vmcnt(9)
    ds_read_b64_tr_b16 v[188:189], v109 offset:19520
    ds_read_b64_tr_b16 v[190:191], v109 offset:20032
    v_exp_f32 v36, v36
    v_exp_f32 v37, v37
    v_exp_f32 v38, v38
    v_exp_f32 v39, v39
    v_cvt_pk_bf16_f32 v80, v32, v33
    v_cvt_pk_bf16_f32 v81, v34, v35
    v_cvt_pk_bf16_f32 v82, v36, v37
    v_cvt_pk_bf16_f32 v83, v38, v39
    v_exp_f32 v40, v40
    v_exp_f32 v41, v41
    v_mfma_f32_32x32x16_bf16 v[64:79], a[244:247], v[80:83], v[64:79]
    ds_read_b128 a[244:247], v90 offset:61680
    buffer_load_dwordx4 v1, s[4:7], s88 offen offset:1024 sc1 lds
    v_exp_f32 v42, v42
    v_exp_f32 v43, v43
    v_exp_f32 v44, v44
    v_exp_f32 v45, v45
    v_exp_f32 v46, v46
    v_exp_f32 v47, v47
    v_cvt_pk_bf16_f32 v84, v40, v41
    v_cvt_pk_bf16_f32 v85, v42, v43
    v_cvt_pk_bf16_f32 v86, v44, v45
    v_cvt_pk_bf16_f32 v87, v46, v47
    s_waitcnt lgkmcnt(3)
    v_mfma_f32_32x32x16_bf16 v[32:47], a[232:235], a[228:231], 0
    ds_read_b128 a[232:235], v2 offset:256
    buffer_load_dwordx4 v1, s[4:7], s88 offen offset:2048 sc1 lds
    v_exp_f32 v16, v16
    v_exp_f32 v17, v17
    v_exp_f32 v18, v18
    v_exp_f32 v19, v19
    v_mfma_f32_32x32x16_bf16 v[64:79], a[252:255], v[84:87], v[64:79]
    ds_read_b128 a[252:255], v91 offset:61680
    v_exp_f32 v20, v20
    v_exp_f32 v21, v21
    v_exp_f32 v22, v22
    v_exp_f32 v23, v23
    v_cvt_pk_bf16_f32 v80, v16, v17
    v_cvt_pk_bf16_f32 v81, v18, v19
    v_cvt_pk_bf16_f32 v82, v20, v21
    v_cvt_pk_bf16_f32 v83, v22, v23
    v_exp_f32 v24, v24
    v_exp_f32 v25, v25
    v_mfma_f32_32x32x16_bf16 v[48:63], a[240:243], v[80:83], v[48:63]
    buffer_load_dwordx4 v1, s[4:7], s88 offen offset:3072 sc1 lds
    v_exp_f32 v26, v26
    v_exp_f32 v27, v27
    v_exp_f32 v28, v28
    v_exp_f32 v29, v29
    v_exp_f32 v30, v30
    v_exp_f32 v31, v31
    v_cvt_pk_bf16_f32 v84, v24, v25
    v_cvt_pk_bf16_f32 v85, v26, v27
    v_cvt_pk_bf16_f32 v86, v28, v29
    v_cvt_pk_bf16_f32 v87, v30, v31
    v_mfma_f32_32x32x16_bf16 v[16:31], a[236:239], v[96:99], 0
    s_add_u32 m0, s22, 0x18980
    s_add_u32 s85, s31, 0x134000
    buffer_load_dwordx4 v110, s[72:75], s85 offen lds
    v_exp_f32 v32, v32
    v_exp_f32 v33, v33
    v_exp_f32 v34, v34
    v_exp_f32 v35, v35
    v_mfma_f32_32x32x16_bf16 v[48:63], a[248:251], v[84:87], v[48:63]
    s_waitcnt vmcnt(12)
    ds_read_b64_tr_b16 v[192:193], v109 offset:32896
    ds_read_b64_tr_b16 v[194:195], v109 offset:33408
    v_exp_f32 v36, v36
    v_exp_f32 v37, v37
    v_exp_f32 v38, v38
    v_exp_f32 v39, v39
    v_cvt_pk_bf16_f32 v80, v32, v33
    v_cvt_pk_bf16_f32 v81, v34, v35
    v_cvt_pk_bf16_f32 v82, v36, v37
    v_cvt_pk_bf16_f32 v83, v38, v39
    v_exp_f32 v40, v40
    v_exp_f32 v41, v41
    v_mfma_f32_32x32x16_bf16 v[64:79], a[240:243], v[80:83], v[64:79]
    ds_read_b128 a[240:243], v92 offset:0
    s_waitcnt lgkmcnt(6)
    s_add_u32 s80, s31, 0x141c00
    buffer_load_dwordx4 v110, s[72:75], s80 offen offset:1024 lds
    v_exp_f32 v42, v42
    v_exp_f32 v43, v43
    v_exp_f32 v44, v44
    v_exp_f32 v45, v45
    v_exp_f32 v46, v46
    v_exp_f32 v47, v47
    v_cvt_pk_bf16_f32 v84, v40, v41
    v_cvt_pk_bf16_f32 v85, v42, v43
    v_cvt_pk_bf16_f32 v86, v44, v45
    v_cvt_pk_bf16_f32 v87, v46, v47
    s_waitcnt lgkmcnt(3)
    v_mfma_f32_32x32x16_bf16 v[32:47], a[236:239], a[228:231], 0
    ds_read_b128 a[236:239], v2 offset:2304
    v_exp_f32 v16, v16
    v_exp_f32 v17, v17
    v_exp_f32 v18, v18
    v_exp_f32 v19, v19
    v_mfma_f32_32x32x16_bf16 v[64:79], a[248:251], v[84:87], v[64:79]
    ds_read_b128 a[248:251], v93 offset:0
    s_waitcnt vmcnt(12)
    ds_read_b64_tr_b16 v[196:197], v109 offset:33920
    ds_read_b64_tr_b16 v[198:199], v109 offset:34432
    v_exp_f32 v20, v20
    v_exp_f32 v21, v21
    v_exp_f32 v22, v22
    v_exp_f32 v23, v23
    v_cvt_pk_bf16_f32 v80, v16, v17
    v_cvt_pk_bf16_f32 v81, v18, v19
    v_cvt_pk_bf16_f32 v82, v20, v21
    v_cvt_pk_bf16_f32 v83, v22, v23
    v_exp_f32 v24, v24
    v_exp_f32 v25, v25
    v_mfma_f32_32x32x16_bf16 v[48:63], a[244:247], v[80:83], v[48:63]
    s_add_u32 s87, s41, 0x2a00000
    buffer_store_dwordx4 a[224:227], v1, s[4:7], s87 offen sc1
    v_exp_f32 v26, v26
    v_exp_f32 v27, v27
    v_exp_f32 v28, v28
    v_exp_f32 v29, v29
    v_exp_f32 v30, v30
    v_exp_f32 v31, v31
    v_cvt_pk_bf16_f32 v84, v24, v25
    v_cvt_pk_bf16_f32 v85, v26, v27
    v_cvt_pk_bf16_f32 v86, v28, v29
    v_cvt_pk_bf16_f32 v87, v30, v31
    v_mfma_f32_32x32x16_bf16 v[16:31], a[232:235], v[96:99], 0
    s_waitcnt lgkmcnt(5)
    s_add_u32 m0, s22, 0x1c1c0
    s_add_u32 s89, s31, 0x150000
    buffer_load_dwordx4 v110, s[72:75], s89 offen lds
    v_exp_f32 v32, v32
    v_exp_f32 v33, v33
    v_exp_f32 v34, v34
    v_exp_f32 v35, v35
    v_mfma_f32_32x32x16_bf16 v[48:63], a[252:255], v[84:87], v[48:63]
    v_exp_f32 v36, v36
    v_exp_f32 v37, v37
    v_exp_f32 v38, v38
    v_exp_f32 v39, v39
    v_cvt_pk_bf16_f32 v80, v32, v33
    v_cvt_pk_bf16_f32 v81, v34, v35
    v_cvt_pk_bf16_f32 v82, v36, v37
    v_cvt_pk_bf16_f32 v83, v38, v39
    v_exp_f32 v40, v40
    v_exp_f32 v41, v41
    v_mfma_f32_32x32x16_bf16 v[64:79], a[244:247], v[80:83], v[64:79]
    ds_read_b128 a[244:247], v94 offset:0
    v_exp_f32 v42, v42
    v_exp_f32 v43, v43
    v_exp_f32 v44, v44
    v_exp_f32 v45, v45
    v_exp_f32 v46, v46
    v_exp_f32 v47, v47
    v_cvt_pk_bf16_f32 v84, v40, v41
    v_cvt_pk_bf16_f32 v85, v42, v43
    v_cvt_pk_bf16_f32 v86, v44, v45
    v_cvt_pk_bf16_f32 v87, v46, v47
    s_waitcnt lgkmcnt(3)
    v_mfma_f32_32x32x16_bf16 v[32:47], a[232:235], a[228:231], 0
    ds_read_b128 a[232:235], v2 offset:4368
    v_exp_f32 v16, v16
    v_exp_f32 v17, v17
    v_exp_f32 v18, v18
    v_exp_f32 v19, v19
    v_mfma_f32_32x32x16_bf16 v[64:79], a[252:255], v[84:87], v[64:79]
    ds_read_b128 a[252:255], v95 offset:0
    s_waitcnt vmcnt(12)
    ds_read_b64_tr_b16 v[200:201], v109 offset:34944
    ds_read_b64_tr_b16 v[202:203], v109 offset:35456
    v_exp_f32 v20, v20
    v_exp_f32 v21, v21
    v_exp_f32 v22, v22
    v_exp_f32 v23, v23
    v_cvt_pk_bf16_f32 v80, v16, v17
    v_cvt_pk_bf16_f32 v81, v18, v19
    v_cvt_pk_bf16_f32 v82, v20, v21
    v_cvt_pk_bf16_f32 v83, v22, v23
    v_exp_f32 v24, v24
    v_exp_f32 v25, v25
    v_mfma_f32_32x32x16_bf16 v[48:63], a[240:243], v[80:83], v[48:63]
    v_exp_f32 v26, v26
    v_exp_f32 v27, v27
    v_exp_f32 v28, v28
    v_exp_f32 v29, v29
    v_exp_f32 v30, v30
    v_exp_f32 v31, v31
    v_cvt_pk_bf16_f32 v84, v24, v25
    v_cvt_pk_bf16_f32 v85, v26, v27
    v_cvt_pk_bf16_f32 v86, v28, v29
    v_cvt_pk_bf16_f32 v87, v30, v31
    v_mfma_f32_32x32x16_bf16 v[16:31], a[236:239], v[96:99], 0
    s_waitcnt lgkmcnt(5)
    s_add_u32 s83, s31, 0x15dc00
    buffer_load_dwordx4 v110, s[72:75], s83 offen offset:1024 lds
    v_exp_f32 v32, v32
    v_exp_f32 v33, v33
    v_exp_f32 v34, v34
    v_exp_f32 v35, v35
    v_mfma_f32_32x32x16_bf16 v[48:63], a[248:251], v[84:87], v[48:63]
    s_waitcnt vmcnt(12)
    ds_read_b64_tr_b16 v[204:205], v109 offset:35968
    ds_read_b64_tr_b16 v[206:207], v109 offset:36480
    v_exp_f32 v36, v36
    v_exp_f32 v37, v37
    v_exp_f32 v38, v38
    v_exp_f32 v39, v39
    v_cvt_pk_bf16_f32 v80, v32, v33
    v_cvt_pk_bf16_f32 v81, v34, v35
    v_cvt_pk_bf16_f32 v82, v36, v37
    v_cvt_pk_bf16_f32 v83, v38, v39
    v_exp_f32 v40, v40
    v_exp_f32 v41, v41
    v_mfma_f32_32x32x16_bf16 v[64:79], a[240:243], v[80:83], v[64:79]
    ds_read_b128 a[240:243], v92 offset:4112
    v_exp_f32 v42, v42
    v_exp_f32 v43, v43
    v_exp_f32 v44, v44
    v_exp_f32 v45, v45
    v_exp_f32 v46, v46
    v_exp_f32 v47, v47
    v_cvt_pk_bf16_f32 v84, v40, v41
    v_cvt_pk_bf16_f32 v85, v42, v43
    v_cvt_pk_bf16_f32 v86, v44, v45
    v_cvt_pk_bf16_f32 v87, v46, v47
    s_waitcnt lgkmcnt(5)
    v_mfma_f32_32x32x16_bf16 v[32:47], a[236:239], a[228:231], 0
    ds_read_b128 a[236:239], v2 offset:6416
    v_exp_f32 v16, v16
    v_exp_f32 v17, v17
    v_exp_f32 v18, v18
    v_exp_f32 v19, v19
    v_mfma_f32_32x32x16_bf16 v[64:79], a[248:251], v[84:87], v[64:79]
    ds_read_b128 a[248:251], v93 offset:4112
    v_exp_f32 v20, v20
    v_exp_f32 v21, v21
    v_exp_f32 v22, v22
    v_exp_f32 v23, v23
    v_cvt_pk_bf16_f32 v80, v16, v17
    v_cvt_pk_bf16_f32 v81, v18, v19
    v_cvt_pk_bf16_f32 v82, v20, v21
    v_cvt_pk_bf16_f32 v83, v22, v23
    v_exp_f32 v24, v24
    v_exp_f32 v25, v25
    v_mfma_f32_32x32x16_bf16 v[48:63], a[244:247], v[80:83], v[48:63]
    s_waitcnt lgkmcnt(5)
    s_add_u32 s91, s31, 0x16b800
    buffer_load_dwordx4 v110, s[72:75], s91 offen offset:2048 lds
    v_exp_f32 v26, v26
    v_exp_f32 v27, v27
    v_exp_f32 v28, v28
    v_exp_f32 v29, v29
    v_exp_f32 v30, v30
    v_exp_f32 v31, v31
    v_cvt_pk_bf16_f32 v84, v24, v25
    v_cvt_pk_bf16_f32 v85, v26, v27
    v_cvt_pk_bf16_f32 v86, v28, v29
    v_cvt_pk_bf16_f32 v87, v30, v31
    v_mfma_f32_32x32x16_bf16 v[16:31], a[232:235], v[96:99], 0
    v_exp_f32 v32, v32
    v_exp_f32 v33, v33
    v_exp_f32 v34, v34
    v_exp_f32 v35, v35
    v_mfma_f32_32x32x16_bf16 v[48:63], a[252:255], v[84:87], v[48:63]
    s_waitcnt vmcnt(12)
    ds_read_b64_tr_b16 v[208:209], v109 offset:16448
    ds_read_b64_tr_b16 v[210:211], v109 offset:16960
    v_exp_f32 v36, v36
    v_exp_f32 v37, v37
    v_exp_f32 v38, v38
    v_exp_f32 v39, v39
    v_cvt_pk_bf16_f32 v80, v32, v33
    v_cvt_pk_bf16_f32 v81, v34, v35
    v_cvt_pk_bf16_f32 v82, v36, v37
    v_cvt_pk_bf16_f32 v83, v38, v39
    v_exp_f32 v40, v40
    v_exp_f32 v41, v41
    v_mfma_f32_32x32x16_bf16 v[64:79], a[244:247], v[80:83], v[64:79]
    ds_read_b128 a[244:247], v94 offset:4112
    v_exp_f32 v42, v42
    v_exp_f32 v43, v43
    v_exp_f32 v44, v44
    v_exp_f32 v45, v45
    v_exp_f32 v46, v46
    v_exp_f32 v47, v47
    v_cvt_pk_bf16_f32 v84, v40, v41
    v_cvt_pk_bf16_f32 v85, v42, v43
    v_cvt_pk_bf16_f32 v86, v44, v45
    v_cvt_pk_bf16_f32 v87, v46, v47
    s_waitcnt lgkmcnt(3)
    v_mfma_f32_32x32x16_bf16 v[32:47], a[232:235], a[228:231], 0
    ds_read_b128 a[232:235], v2 offset:8480
    s_add_u32 s84, s31, 0x179400
    buffer_load_dwordx4 v110, s[72:75], s84 offen offset:3072 lds
    v_exp_f32 v16, v16
    v_exp_f32 v17, v17
    v_exp_f32 v18, v18
    v_exp_f32 v19, v19
    v_mfma_f32_32x32x16_bf16 v[64:79], a[252:255], v[84:87], v[64:79]
    ds_read_b128 a[252:255], v95 offset:4112
    s_waitcnt vmcnt(11)
    ds_read_b64_tr_b16 v[212:213], v109 offset:17472
    ds_read_b64_tr_b16 v[214:215], v109 offset:17984
    v_exp_f32 v20, v20
    v_exp_f32 v21, v21
    v_exp_f32 v22, v22
    v_exp_f32 v23, v23
    v_cvt_pk_bf16_f32 v80, v16, v17
    v_cvt_pk_bf16_f32 v81, v18, v19
    v_cvt_pk_bf16_f32 v82, v20, v21
    v_cvt_pk_bf16_f32 v83, v22, v23
    v_exp_f32 v24, v24
    v_exp_f32 v25, v25
    v_mfma_f32_32x32x16_bf16 v[48:63], a[240:243], v[80:83], v[48:63]
    s_add_u32 s90, s41, 0x2b00000
    buffer_store_dwordx4 a[224:227], v1, s[4:7], s90 offen sc1
    v_exp_f32 v26, v26
    v_exp_f32 v27, v27
    v_exp_f32 v28, v28
    v_exp_f32 v29, v29
    v_exp_f32 v30, v30
    v_exp_f32 v31, v31
    v_cvt_pk_bf16_f32 v84, v24, v25
    v_cvt_pk_bf16_f32 v85, v26, v27
    v_cvt_pk_bf16_f32 v86, v28, v29
    v_cvt_pk_bf16_f32 v87, v30, v31
    v_mfma_f32_32x32x16_bf16 v[16:31], a[236:239], v[96:99], 0
    s_add_u32 m0, s22, 0x20200
    s_add_u32 s81, s31, 0x188000
    buffer_load_dwordx4 v110, s[72:75], s81 offen lds
    v_exp_f32 v32, v32
    v_exp_f32 v33, v33
    v_exp_f32 v34, v34
    v_exp_f32 v35, v35
    v_mfma_f32_32x32x16_bf16 v[48:63], a[248:251], v[84:87], v[48:63]
    v_exp_f32 v36, v36
    v_exp_f32 v37, v37
    v_exp_f32 v38, v38
    v_exp_f32 v39, v39
    v_cvt_pk_bf16_f32 v80, v32, v33
    v_cvt_pk_bf16_f32 v81, v34, v35
    v_cvt_pk_bf16_f32 v82, v36, v37
    v_cvt_pk_bf16_f32 v83, v38, v39
    v_exp_f32 v40, v40
    v_exp_f32 v41, v41
    v_mfma_f32_32x32x16_bf16 v[64:79], a[240:243], v[80:83], v[64:79]
    ds_read_b128 a[240:243], v92 offset:8224
    v_exp_f32 v42, v42
    v_exp_f32 v43, v43
    v_exp_f32 v44, v44
    v_exp_f32 v45, v45
    v_exp_f32 v46, v46
    v_exp_f32 v47, v47
    v_cvt_pk_bf16_f32 v84, v40, v41
    v_cvt_pk_bf16_f32 v85, v42, v43
    v_cvt_pk_bf16_f32 v86, v44, v45
    v_cvt_pk_bf16_f32 v87, v46, v47
    s_waitcnt lgkmcnt(3)
    v_mfma_f32_32x32x16_bf16 v[32:47], a[236:239], a[228:231], 0
    ds_read_b128 a[236:239], v2 offset:10528
    v_exp_f32 v16, v16
    v_exp_f32 v17, v17
    v_exp_f32 v18, v18
    v_exp_f32 v19, v19
    v_mfma_f32_32x32x16_bf16 v[64:79], a[248:251], v[84:87], v[64:79]
    ds_read_b128 a[248:251], v93 offset:8224
    v_exp_f32 v20, v20
    v_exp_f32 v21, v21
    v_exp_f32 v22, v22
    v_exp_f32 v23, v23
    v_cvt_pk_bf16_f32 v80, v16, v17
    v_cvt_pk_bf16_f32 v81, v18, v19
    v_cvt_pk_bf16_f32 v82, v20, v21
    v_cvt_pk_bf16_f32 v83, v22, v23
    v_exp_f32 v24, v24
    v_exp_f32 v25, v25
    v_mfma_f32_32x32x16_bf16 v[48:63], a[244:247], v[80:83], v[48:63]
    v_exp_f32 v26, v26
    v_exp_f32 v27, v27
    v_exp_f32 v28, v28
    v_exp_f32 v29, v29
    v_exp_f32 v30, v30
    v_exp_f32 v31, v31
    v_cvt_pk_bf16_f32 v84, v24, v25
    v_cvt_pk_bf16_f32 v85, v26, v27
    v_cvt_pk_bf16_f32 v86, v28, v29
    v_cvt_pk_bf16_f32 v87, v30, v31
    v_mfma_f32_32x32x16_bf16 v[16:31], a[232:235], v[96:99], 0
    s_add_u32 s86, s31, 0x195c00
    buffer_load_dwordx4 v110, s[72:75], s86 offen offset:1024 lds
    v_exp_f32 v32, v32
    v_exp_f32 v33, v33
    v_exp_f32 v34, v34
    v_exp_f32 v35, v35
    v_mfma_f32_32x32x16_bf16 v[48:63], a[252:255], v[84:87], v[48:63]
    s_waitcnt vmcnt(9)
    ds_read_b64_tr_b16 v[216:217], v109 offset:18496
    ds_read_b64_tr_b16 v[218:219], v109 offset:19008
    s_waitcnt vmcnt(8)
    ds_read_b64_tr_b16 v[220:221], v109 offset:19520
    ds_read_b64_tr_b16 v[222:223], v109 offset:20032
    v_exp_f32 v36, v36
    v_exp_f32 v37, v37
    v_exp_f32 v38, v38
    v_exp_f32 v39, v39
    v_cvt_pk_bf16_f32 v80, v32, v33
    v_cvt_pk_bf16_f32 v81, v34, v35
    v_cvt_pk_bf16_f32 v82, v36, v37
    v_cvt_pk_bf16_f32 v83, v38, v39
    v_exp_f32 v40, v40
    v_exp_f32 v41, v41
    v_mfma_f32_32x32x16_bf16 v[64:79], a[244:247], v[80:83], v[64:79]
    ds_read_b128 a[244:247], v94 offset:8224
    v_exp_f32 v42, v42
    v_exp_f32 v43, v43
    v_exp_f32 v44, v44
    v_exp_f32 v45, v45
    v_exp_f32 v46, v46
    v_exp_f32 v47, v47
    v_cvt_pk_bf16_f32 v84, v40, v41
    v_cvt_pk_bf16_f32 v85, v42, v43
    v_cvt_pk_bf16_f32 v86, v44, v45
    v_cvt_pk_bf16_f32 v87, v46, v47
    s_waitcnt lgkmcnt(5)
    v_mfma_f32_32x32x16_bf16 v[32:47], a[232:235], a[228:231], 0
    ds_read_b128 a[232:235], v2 offset:12592
    v_exp_f32 v16, v16
    v_exp_f32 v17, v17
    v_exp_f32 v18, v18
    v_exp_f32 v19, v19
    v_mfma_f32_32x32x16_bf16 v[64:79], a[252:255], v[84:87], v[64:79]
    ds_read_b128 a[252:255], v95 offset:8224
    v_exp_f32 v20, v20
    v_exp_f32 v21, v21
    v_exp_f32 v22, v22
    v_exp_f32 v23, v23
    v_cvt_pk_bf16_f32 v80, v16, v17
    v_cvt_pk_bf16_f32 v81, v18, v19
    v_cvt_pk_bf16_f32 v82, v20, v21
    v_cvt_pk_bf16_f32 v83, v22, v23
    v_exp_f32 v24, v24
    v_exp_f32 v25, v25
    v_mfma_f32_32x32x16_bf16 v[48:63], a[240:243], v[80:83], v[48:63]
    s_add_u32 s82, s31, 0x1a3800
    buffer_load_dwordx4 v110, s[72:75], s82 offen offset:2048 lds
    v_exp_f32 v26, v26
    v_exp_f32 v27, v27
    v_exp_f32 v28, v28
    v_exp_f32 v29, v29
    v_exp_f32 v30, v30
    v_exp_f32 v31, v31
    v_cvt_pk_bf16_f32 v84, v24, v25
    v_cvt_pk_bf16_f32 v85, v26, v27
    v_cvt_pk_bf16_f32 v86, v28, v29
    v_cvt_pk_bf16_f32 v87, v30, v31
    v_mfma_f32_32x32x16_bf16 v[16:31], a[236:239], v[96:99], 0
    s_add_u32 s88, s41, 0x2c00000
    buffer_store_dwordx4 a[224:227], v1, s[4:7], s88 offen sc1
PAD16:
    s_cbranch_execz PAD20
    v_exp_f32 v32, v32
    v_exp_f32 v33, v33
    v_exp_f32 v34, v34
    v_exp_f32 v35, v35
    v_mfma_f32_32x32x16_bf16 v[48:63], a[248:251], v[84:87], v[48:63]
    v_add_u32 v108, 0x14140, v6
    ds_read2st64_b32 v[104:105], v108 offset0:0 offset1:4
    ds_read2st64_b32 v[106:107], v108 offset0:8 offset1:12
    s_waitcnt vmcnt(8)
    ds_read_b64_tr_b16 v[224:225], v109 offset:32896
    ds_read_b64_tr_b16 v[226:227], v109 offset:33408
    v_exp_f32 v36, v36
    v_exp_f32 v37, v37
    v_exp_f32 v38, v38
    v_exp_f32 v39, v39
    v_cvt_pk_bf16_f32 v80, v32, v33
    v_cvt_pk_bf16_f32 v81, v34, v35
    v_cvt_pk_bf16_f32 v82, v36, v37
    v_cvt_pk_bf16_f32 v83, v38, v39
    v_exp_f32 v40, v40
    v_exp_f32 v41, v41
    v_mfma_f32_32x32x16_bf16 v[64:79], a[240:243], v[80:83], v[64:79]
    ds_read_b128 a[240:243], v92 offset:12336
    v_exp_f32 v42, v42
    v_exp_f32 v43, v43
    v_exp_f32 v44, v44
    v_exp_f32 v45, v45
    v_exp_f32 v46, v46
    v_exp_f32 v47, v47
    v_cvt_pk_bf16_f32 v84, v40, v41
    v_cvt_pk_bf16_f32 v85, v42, v43
    v_cvt_pk_bf16_f32 v86, v44, v45
    v_cvt_pk_bf16_f32 v87, v46, v47
    s_waitcnt lgkmcnt(5)
    v_mfma_f32_32x32x16_bf16 v[32:47], a[236:239], a[228:231], 0
    ds_read_b128 a[236:239], v2 offset:14640
    v_exp_f32 v16, v16
    v_exp_f32 v17, v17
    v_exp_f32 v18, v18
    v_exp_f32 v19, v19
    v_mfma_f32_32x32x16_bf16 v[64:79], a[248:251], v[84:87], v[64:79]
    ds_read_b128 a[248:251], v93 offset:12336
    s_waitcnt lgkmcnt(5)
    v_max3_u32 v7, v104, v105, v106
    v_max_u32 v7, v7, v107
    v_cmp_eq_u32 vcc, -1, v7
    s_cbranch_vccnz Lre77
Lok77:
    v_exp_f32 v20, v20
    v_exp_f32 v21, v21
    v_exp_f32 v22, v22
    v_exp_f32 v23, v23
    v_cvt_pk_bf16_f32 v80, v16, v17
    v_cvt_pk_bf16_f32 v81, v18, v19
    v_cvt_pk_bf16_f32 v82, v20, v21
    v_cvt_pk_bf16_f32 v83, v22, v23
    v_exp_f32 v24, v24
    v_exp_f32 v25, v25
    v_mfma_f32_32x32x16_bf16 v[48:63], a[244:247], v[80:83], v[48:63]
    s_add_u32 s85, s31, 0x1b1400
    buffer_load_dwordx4 v110, s[72:75], s85 offen offset:3072 lds
    v_exp_f32 v26, v26
    v_exp_f32 v27, v27
    v_exp_f32 v28, v28
    v_exp_f32 v29, v29
    v_exp_f32 v30, v30
    v_exp_f32 v31, v31
    v_cvt_pk_bf16_f32 v84, v24, v25
    v_cvt_pk_bf16_f32 v85, v26, v27
    v_cvt_pk_bf16_f32 v86, v28, v29
    v_cvt_pk_bf16_f32 v87, v30, v31
    v_mfma_f32_32x32x16_bf16 v[16:31], a[232:235], v[96:99], 0
    s_add_u32 m0, s22, 0x18180
    s_add_u32 s80, s29, 0x1b18000
    buffer_load_dwordx4 v1, s[4:7], s80 offen sc1 lds
    v_exp_f32 v32, v32
    v_exp_f32 v33, v33
    v_exp_f32 v34, v34
    v_exp_f32 v35, v35
    v_mfma_f32_32x32x16_bf16 v[48:63], a[252:255], v[84:87], v[48:63]
    s_barrier
    s_waitcnt vmcnt(9)
    ds_read_b64_tr_b16 v[228:229], v109 offset:33920
    ds_read_b64_tr_b16 v[230:231], v109 offset:34432
    v_exp_f32 v36, v36
    v_exp_f32 v37, v37
    v_exp_f32 v38, v38
    v_exp_f32 v39, v39
    v_cvt_pk_bf16_f32 v80, v32, v33
    v_cvt_pk_bf16_f32 v81, v34, v35
    v_cvt_pk_bf16_f32 v82, v36, v37
    v_cvt_pk_bf16_f32 v83, v38, v39
    v_exp_f32 v40, v40
    v_exp_f32 v41, v41
    v_mfma_f32_32x32x16_bf16 v[64:79], a[244:247], v[80:83], v[64:79]
    ds_read_b128 a[244:247], v94 offset:12336
    buffer_load_dwordx4 v1, s[4:7], s80 offen offset:1024 sc1 lds
    v_exp_f32 v42, v42
    v_exp_f32 v43, v43
    v_exp_f32 v44, v44
    v_exp_f32 v45, v45
    v_exp_f32 v46, v46
    v_exp_f32 v47, v47
    v_cvt_pk_bf16_f32 v84, v40, v41
    v_cvt_pk_bf16_f32 v85, v42, v43
    v_cvt_pk_bf16_f32 v86, v44, v45
    v_cvt_pk_bf16_f32 v87, v46, v47
    s_waitcnt lgkmcnt(3)
    v_mfma_f32_32x32x16_bf16 v[32:47], a[232:235], a[228:231], 0
    ds_read_b128 a[232:235], v2 offset:16704
    buffer_load_dwordx4 v1, s[4:7], s80 offen offset:2048 sc1 lds
    v_exp_f32 v16, v16
    v_exp_f32 v17, v17
    v_exp_f32 v18, v18
    v_exp_f32 v19, v19
    v_mfma_f32_32x32x16_bf16 v[64:79], a[252:255], v[84:87], v[64:79]
    ds_read_b128 a[252:255], v95 offset:12336
    s_waitcnt vmcnt(10)
    ds_read_b64_tr_b16 v[232:233], v109 offset:34944
    ds_read_b64_tr_b16 v[234:235], v109 offset:35456
    v_exp_f32 v20, v20
    v_exp_f32 v21, v21
    v_exp_f32 v22, v22
    v_exp_f32 v23, v23
    v_cvt_pk_bf16_f32 v80, v16, v17
    v_cvt_pk_bf16_f32 v81, v18, v19
    v_cvt_pk_bf16_f32 v82, v20, v21
    v_cvt_pk_bf16_f32 v83, v22, v23
    v_exp_f32 v24, v24
    v_exp_f32 v25, v25
    v_mfma_f32_32x32x16_bf16 v[48:63], a[240:243], v[80:83], v[48:63]
    buffer_load_dwordx4 v1, s[4:7], s80 offen offset:3072 sc1 lds
    v_exp_f32 v26, v26
    v_exp_f32 v27, v27
    v_exp_f32 v28, v28
    v_exp_f32 v29, v29
    v_exp_f32 v30, v30
    v_exp_f32 v31, v31
    v_cvt_pk_bf16_f32 v84, v24, v25
    v_cvt_pk_bf16_f32 v85, v26, v27
    v_cvt_pk_bf16_f32 v86, v28, v29
    v_cvt_pk_bf16_f32 v87, v30, v31
    v_mfma_f32_32x32x16_bf16 v[16:31], a[236:239], v[96:99], 0
    v_exp_f32 v32, v32
    v_exp_f32 v33, v33
    v_exp_f32 v34, v34
    v_exp_f32 v35, v35
    v_mfma_f32_32x32x16_bf16 v[48:63], a[248:251], v[84:87], v[48:63]
    v_exp_f32 v36, v36
    v_exp_f32 v37, v37
    v_exp_f32 v38, v38
    v_exp_f32 v39, v39
    v_cvt_pk_bf16_f32 v80, v32, v33
    v_cvt_pk_bf16_f32 v81, v34, v35
    v_cvt_pk_bf16_f32 v82, v36, v37
    v_cvt_pk_bf16_f32 v83, v38, v39
    v_exp_f32 v40, v40
    v_exp_f32 v41, v41
    v_mfma_f32_32x32x16_bf16 v[64:79], a[240:243], v[80:83], v[64:79]
    ds_read_b128 a[240:243], v92 offset:16448
    v_exp_f32 v42, v42
    v_exp_f32 v43, v43
    v_exp_f32 v44, v44
    v_exp_f32 v45, v45
    v_exp_f32 v46, v46
    v_exp_f32 v47, v47
    v_cvt_pk_bf16_f32 v84, v40, v41
    v_cvt_pk_bf16_f32 v85, v42, v43
    v_cvt_pk_bf16_f32 v86, v44, v45
    v_cvt_pk_bf16_f32 v87, v46, v47
    s_waitcnt lgkmcnt(3)
    v_mfma_f32_32x32x16_bf16 v[32:47], a[236:239], a[228:231], 0
    ds_read_b128 a[236:239], v2 offset:18752
    v_exp_f32 v16, v16
    v_exp_f32 v17, v17
    v_exp_f32 v18, v18
    v_exp_f32 v19, v19
    v_mfma_f32_32x32x16_bf16 v[64:79], a[248:251], v[84:87], v[64:79]
    ds_read_b128 a[248:251], v93 offset:16448
    s_waitcnt vmcnt(10)
    ds_read_b64_tr_b16 v[236:237], v109 offset:35968
    ds_read_b64_tr_b16 v[238:239], v109 offset:36480
    v_exp_f32 v20, v20
    v_exp_f32 v21, v21
    v_exp_f32 v22, v22
    v_exp_f32 v23, v23
    v_cvt_pk_bf16_f32 v80, v16, v17
    v_cvt_pk_bf16_f32 v81, v18, v19
    v_cvt_pk_bf16_f32 v82, v20, v21
    v_cvt_pk_bf16_f32 v83, v22, v23
    v_exp_f32 v24, v24
    v_exp_f32 v25, v25
    v_mfma_f32_32x32x16_bf16 v[48:63], a[244:247], v[80:83], v[48:63]
    s_add_u32 s87, s41, 0x2d00000
    buffer_store_dwordx4 a[224:227], v1, s[4:7], s87 offen sc1
    v_exp_f32 v26, v26
    v_exp_f32 v27, v27
    v_exp_f32 v28, v28
    v_exp_f32 v29, v29
    v_exp_f32 v30, v30
    v_exp_f32 v31, v31
    v_cvt_pk_bf16_f32 v84, v24, v25
    v_cvt_pk_bf16_f32 v85, v26, v27
    v_cvt_pk_bf16_f32 v86, v28, v29
    v_cvt_pk_bf16_f32 v87, v30, v31
    v_mfma_f32_32x32x16_bf16 v[16:31], a[232:235], v[96:99], 0
    v_exp_f32 v32, v32
    v_exp_f32 v33, v33
    v_exp_f32 v34, v34
    v_exp_f32 v35, v35
    v_mfma_f32_32x32x16_bf16 v[48:63], a[252:255], v[84:87], v[48:63]
    s_waitcnt vmcnt(9)
    ds_read_b64_tr_b16 v[240:241], v109 offset:49344
    ds_read_b64_tr_b16 v[242:243], v109 offset:49856
    v_exp_f32 v36, v36
    v_exp_f32 v37, v37
    v_exp_f32 v38, v38
    v_exp_f32 v39, v39
    v_cvt_pk_bf16_f32 v80, v32, v33
    v_cvt_pk_bf16_f32 v81, v34, v35
    v_cvt_pk_bf16_f32 v82, v36, v37
    v_cvt_pk_bf16_f32 v83, v38, v39
    v_exp_f32 v40, v40
    v_exp_f32 v41, v41
    v_mfma_f32_32x32x16_bf16 v[64:79], a[244:247], v[80:83], v[64:79]
    ds_read_b128 a[244:247], v94 offset:16448
    v_exp_f32 v42, v42
    v_exp_f32 v43, v43
    v_exp_f32 v44, v44
    v_exp_f32 v45, v45
    v_exp_f32 v46, v46
    v_exp_f32 v47, v47
    v_cvt_pk_bf16_f32 v84, v40, v41
    v_cvt_pk_bf16_f32 v85, v42, v43
    v_cvt_pk_bf16_f32 v86, v44, v45
    v_cvt_pk_bf16_f32 v87, v46, v47
    s_waitcnt lgkmcnt(5)
    v_mfma_f32_32x32x16_bf16 v[32:47], a[232:235], a[228:231], 0
    ds_read_b128 a[232:235], v2 offset:20816
    v_exp_f32 v16, v16
    v_exp_f32 v17, v17
    v_exp_f32 v18, v18
    v_exp_f32 v19, v19
    v_mfma_f32_32x32x16_bf16 v[64:79], a[252:255], v[84:87], v[64:79]
    ds_read_b128 a[252:255], v95 offset:16448
    v_exp_f32 v20, v20
    v_exp_f32 v21, v21
    v_exp_f32 v22, v22
    v_exp_f32 v23, v23
    v_cvt_pk_bf16_f32 v80, v16, v17
    v_cvt_pk_bf16_f32 v81, v18, v19
    v_cvt_pk_bf16_f32 v82, v20, v21
    v_cvt_pk_bf16_f32 v83, v22, v23
    v_exp_f32 v24, v24
    v_exp_f32 v25, v25
    v_mfma_f32_32x32x16_bf16 v[48:63], a[240:243], v[80:83], v[48:63]
    v_exp_f32 v26, v26
    v_exp_f32 v27, v27
    v_exp_f32 v28, v28
    v_exp_f32 v29, v29
    v_exp_f32 v30, v30
    v_exp_f32 v31, v31
    v_cvt_pk_bf16_f32 v84, v24, v25
    v_cvt_pk_bf16_f32 v85, v26, v27
    v_cvt_pk_bf16_f32 v86, v28, v29
    v_cvt_pk_bf16_f32 v87, v30, v31
    v_mfma_f32_32x32x16_bf16 v[16:31], a[236:239], v[96:99], 0
    v_exp_f32 v32, v32
    v_exp_f32 v33, v33
    v_exp_f32 v34, v34
    v_exp_f32 v35, v35
    v_mfma_f32_32x32x16_bf16 v[48:63], a[248:251], v[84:87], v[48:63]
    s_waitcnt vmcnt(8)
    ds_read_b64_tr_b16 v[244:245], v109 offset:50368
    ds_read_b64_tr_b16 v[246:247], v109 offset:50880
    v_exp_f32 v36, v36
    v_exp_f32 v37, v37
    v_exp_f32 v38, v38
    v_exp_f32 v39, v39
    v_cvt_pk_bf16_f32 v80, v32, v33
    v_cvt_pk_bf16_f32 v81, v34, v35
    v_cvt_pk_bf16_f32 v82, v36, v37
    v_cvt_pk_bf16_f32 v83, v38, v39
    v_exp_f32 v40, v40
    v_exp_f32 v41, v41
    v_mfma_f32_32x32x16_bf16 v[64:79], a[240:243], v[80:83], v[64:79]
    ds_read_b128 a[240:243], v92 offset:20560
    v_exp_f32 v42, v42
    v_exp_f32 v43, v43
    v_exp_f32 v44, v44
    v_exp_f32 v45, v45
    v_exp_f32 v46, v46
    v_exp_f32 v47, v47
    v_cvt_pk_bf16_f32 v84, v40, v41
    v_cvt_pk_bf16_f32 v85, v42, v43
    v_cvt_pk_bf16_f32 v86, v44, v45
    v_cvt_pk_bf16_f32 v87, v46, v47
    s_waitcnt lgkmcnt(3)
    v_mfma_f32_32x32x16_bf16 v[32:47], a[236:239], a[228:231], 0
    ds_read_b128 a[236:239], v2 offset:22864
    v_exp_f32 v16, v16
    v_exp_f32 v17, v17
    v_exp_f32 v18, v18
    v_exp_f32 v19, v19
    v_mfma_f32_32x32x16_bf16 v[64:79], a[248:251], v[84:87], v[64:79]
    ds_read_b128 a[248:251], v93 offset:20560
    s_waitcnt vmcnt(7)
    ds_read_b64_tr_b16 v[248:249], v109 offset:51392
    ds_read_b64_tr_b16 v[250:251], v109 offset:51904
    v_exp_f32 v20, v20
    v_exp_f32 v21, v21
    v_exp_f32 v22, v22
    v_exp_f32 v23, v23
    v_cvt_pk_bf16_f32 v80, v16, v17
    v_cvt_pk_bf16_f32 v81, v18, v19
    v_cvt_pk_bf16_f32 v82, v20, v21
    v_cvt_pk_bf16_f32 v83, v22, v23
    v_exp_f32 v24, v24
    v_exp_f32 v25, v25
    v_mfma_f32_32x32x16_bf16 v[48:63], a[244:247], v[80:83], v[48:63]
    v_exp_f32 v26, v26
    v_exp_f32 v27, v27
    v_exp_f32 v28, v28
    v_exp_f32 v29, v29
    v_exp_f32 v30, v30
    v_exp_f32 v31, v31
    v_cvt_pk_bf16_f32 v84, v24, v25
    v_cvt_pk_bf16_f32 v85, v26, v27
    v_cvt_pk_bf16_f32 v86, v28, v29
    v_cvt_pk_bf16_f32 v87, v30, v31
    v_mfma_f32_32x32x16_bf16 v[16:31], a[232:235], v[96:99], 0
    v_exp_f32 v32, v32
    v_exp_f32 v33, v33
    v_exp_f32 v34, v34
    v_exp_f32 v35, v35
    v_mfma_f32_32x32x16_bf16 v[48:63], a[252:255], v[84:87], v[48:63]
    v_exp_f32 v36, v36
    v_exp_f32 v37, v37
    v_exp_f32 v38, v38
    v_exp_f32 v39, v39
    v_cvt_pk_bf16_f32 v80, v32, v33
    v_cvt_pk_bf16_f32 v81, v34, v35
    v_cvt_pk_bf16_f32 v82, v36, v37
    v_cvt_pk_bf16_f32 v83, v38, v39
    v_exp_f32 v40, v40
    v_exp_f32 v41, v41
    v_mfma_f32_32x32x16_bf16 v[64:79], a[244:247], v[80:83], v[64:79]
    ds_read_b128 a[244:247], v94 offset:20560
    v_exp_f32 v42, v42
    v_exp_f32 v43, v43
    v_exp_f32 v44, v44
    v_exp_f32 v45, v45
    v_exp_f32 v46, v46
    v_exp_f32 v47, v47
    v_cvt_pk_bf16_f32 v84, v40, v41
    v_cvt_pk_bf16_f32 v85, v42, v43
    v_cvt_pk_bf16_f32 v86, v44, v45
    v_cvt_pk_bf16_f32 v87, v46, v47
    s_waitcnt lgkmcnt(3)
    v_mfma_f32_32x32x16_bf16 v[32:47], a[232:235], a[228:231], 0
    ds_read_b128 a[232:235], v2 offset:24928
    v_exp_f32 v16, v16
    v_exp_f32 v17, v17
    v_exp_f32 v18, v18
    v_exp_f32 v19, v19
    v_mfma_f32_32x32x16_bf16 v[64:79], a[252:255], v[84:87], v[64:79]
    ds_read_b128 a[252:255], v95 offset:20560
    s_waitcnt vmcnt(5)
    ds_read_b64_tr_b16 v[252:253], v109 offset:52416
    ds_read_b64_tr_b16 v[254:255], v109 offset:52928
    v_exp_f32 v20, v20
    v_exp_f32 v21, v21
    v_exp_f32 v22, v22
    v_exp_f32 v23, v23
    v_cvt_pk_bf16_f32 v80, v16, v17
    v_cvt_pk_bf16_f32 v81, v18, v19
    v_cvt_pk_bf16_f32 v82, v20, v21
    v_cvt_pk_bf16_f32 v83, v22, v23
    v_exp_f32 v24, v24
    v_exp_f32 v25, v25
    v_mfma_f32_32x32x16_bf16 v[48:63], a[240:243], v[80:83], v[48:63]
    v_exp_f32 v26, v26
    v_exp_f32 v27, v27
    v_exp_f32 v28, v28
    v_exp_f32 v29, v29
    v_exp_f32 v30, v30
    v_exp_f32 v31, v31
    v_cvt_pk_bf16_f32 v84, v24, v25
    v_cvt_pk_bf16_f32 v85, v26, v27
    v_cvt_pk_bf16_f32 v86, v28, v29
    v_cvt_pk_bf16_f32 v87, v30, v31
    v_mfma_f32_32x32x16_bf16 v[16:31], a[236:239], v[96:99], 0
    v_exp_f32 v32, v32
    v_exp_f32 v33, v33
    v_exp_f32 v34, v34
    v_exp_f32 v35, v35
    v_mfma_f32_32x32x16_bf16 v[48:63], a[248:251], v[84:87], v[48:63]
    v_exp_f32 v36, v36
    v_exp_f32 v37, v37
    v_exp_f32 v38, v38
    v_exp_f32 v39, v39
    v_cvt_pk_bf16_f32 v80, v32, v33
    v_cvt_pk_bf16_f32 v81, v34, v35
    v_cvt_pk_bf16_f32 v82, v36, v37
    v_cvt_pk_bf16_f32 v83, v38, v39
    v_exp_f32 v40, v40
    v_exp_f32 v41, v41
    v_mfma_f32_32x32x16_bf16 v[64:79], a[240:243], v[80:83], v[64:79]
    ds_read_b128 a[240:243], v92 offset:24672
    v_exp_f32 v42, v42
    v_exp_f32 v43, v43
    v_exp_f32 v44, v44
    v_exp_f32 v45, v45
    v_exp_f32 v46, v46
    v_exp_f32 v47, v47
    v_cvt_pk_bf16_f32 v84, v40, v41
    v_cvt_pk_bf16_f32 v85, v42, v43
    v_cvt_pk_bf16_f32 v86, v44, v45
    v_cvt_pk_bf16_f32 v87, v46, v47
    s_waitcnt lgkmcnt(3)
    v_mfma_f32_32x32x16_bf16 v[32:47], a[236:239], a[228:231], 0
    ds_read_b128 a[236:239], v2 offset:26976
    v_exp_f32 v16, v16
    v_exp_f32 v17, v17
    v_exp_f32 v18, v18
    v_exp_f32 v19, v19
    v_mfma_f32_32x32x16_bf16 v[64:79], a[248:251], v[84:87], v[64:79]
    ds_read_b128 a[248:251], v93 offset:24672
    v_exp_f32 v20, v20
    v_exp_f32 v21, v21
    v_exp_f32 v22, v22
    v_exp_f32 v23, v23
    v_cvt_pk_bf16_f32 v80, v16, v17
    v_cvt_pk_bf16_f32 v81, v18, v19
    v_cvt_pk_bf16_f32 v82, v20, v21
    v_cvt_pk_bf16_f32 v83, v22, v23
    v_exp_f32 v24, v24
    v_exp_f32 v25, v25
    v_mfma_f32_32x32x16_bf16 v[48:63], a[244:247], v[80:83], v[48:63]
    v_exp_f32 v26, v26
    v_exp_f32 v27, v27
    v_exp_f32 v28, v28
    v_exp_f32 v29, v29
    v_exp_f32 v30, v30
    v_exp_f32 v31, v31
    v_cvt_pk_bf16_f32 v84, v24, v25
    v_cvt_pk_bf16_f32 v85, v26, v27
    v_cvt_pk_bf16_f32 v86, v28, v29
    v_cvt_pk_bf16_f32 v87, v30, v31
    v_mfma_f32_32x32x16_bf16 v[16:31], a[232:235], v[96:99], 0
    v_exp_f32 v32, v32
    v_exp_f32 v33, v33
    v_exp_f32 v34, v34
    v_exp_f32 v35, v35
    v_mfma_f32_32x32x16_bf16 v[48:63], a[252:255], v[84:87], v[48:63]
    v_exp_f32 v36, v36
    v_exp_f32 v37, v37
    v_exp_f32 v38, v38
    v_exp_f32 v39, v39
    v_cvt_pk_bf16_f32 v80, v32, v33
    v_cvt_pk_bf16_f32 v81, v34, v35
    v_cvt_pk_bf16_f32 v82, v36, v37
    v_cvt_pk_bf16_f32 v83, v38, v39
    v_exp_f32 v40, v40
    v_exp_f32 v41, v41
    v_mfma_f32_32x32x16_bf16 v[64:79], a[244:247], v[80:83], v[64:79]
    ds_read_b128 a[244:247], v94 offset:24672
    v_exp_f32 v42, v42
    v_exp_f32 v43, v43
    v_exp_f32 v44, v44
    v_exp_f32 v45, v45
    v_exp_f32 v46, v46
    v_exp_f32 v47, v47
    v_cvt_pk_bf16_f32 v84, v40, v41
    v_cvt_pk_bf16_f32 v85, v42, v43
    v_cvt_pk_bf16_f32 v86, v44, v45
    v_cvt_pk_bf16_f32 v87, v46, v47
    s_waitcnt lgkmcnt(1)
    v_mfma_f32_32x32x16_bf16 v[32:47], a[232:235], a[228:231], 0
    ds_read_b128 a[232:235], v2 offset:29040
    v_exp_f32 v16, v16
    v_exp_f32 v17, v17
    v_exp_f32 v18, v18
    v_exp_f32 v19, v19
    v_mfma_f32_32x32x16_bf16 v[64:79], a[252:255], v[84:87], v[64:79]
    ds_read_b128 a[252:255], v95 offset:24672
    v_exp_f32 v20, v20
    v_exp_f32 v21, v21
    v_exp_f32 v22, v22
    v_exp_f32 v23, v23
    v_cvt_pk_bf16_f32 v80, v16, v17
    v_cvt_pk_bf16_f32 v81, v18, v19
    v_cvt_pk_bf16_f32 v82, v20, v21
    v_cvt_pk_bf16_f32 v83, v22, v23
    v_exp_f32 v24, v24
    v_exp_f32 v25, v25
    v_mfma_f32_32x32x16_bf16 v[48:63], a[240:243], v[80:83], v[48:63]
    v_exp_f32 v26, v26
    v_exp_f32 v27, v27
    v_exp_f32 v28, v28
    v_exp_f32 v29, v29
    v_exp_f32 v30, v30
    v_exp_f32 v31, v31
    v_cvt_pk_bf16_f32 v84, v24, v25
    v_cvt_pk_bf16_f32 v85, v26, v27
    v_cvt_pk_bf16_f32 v86, v28, v29
    v_cvt_pk_bf16_f32 v87, v30, v31
    v_mfma_f32_32x32x16_bf16 v[16:31], a[236:239], v[96:99], 0
    v_exp_f32 v32, v32
    v_exp_f32 v33, v33
    v_exp_f32 v34, v34
    v_exp_f32 v35, v35
    v_mfma_f32_32x32x16_bf16 v[48:63], a[248:251], v[84:87], v[48:63]
    v_add_u32 v108, 0x18180, v6
    s_waitcnt vmcnt(1)
    ds_read2st64_b32 v[104:105], v108 offset0:0 offset1:4
    ds_read2st64_b32 v[106:107], v108 offset0:8 offset1:12
    v_exp_f32 v36, v36
    v_exp_f32 v37, v37
    v_exp_f32 v38, v38
    v_exp_f32 v39, v39
    v_cvt_pk_bf16_f32 v80, v32, v33
    v_cvt_pk_bf16_f32 v81, v34, v35
    v_cvt_pk_bf16_f32 v82, v36, v37
    v_cvt_pk_bf16_f32 v83, v38, v39
    v_exp_f32 v40, v40
    v_exp_f32 v41, v41
    v_mfma_f32_32x32x16_bf16 v[64:79], a[240:243], v[80:83], v[64:79]
    ds_read_b128 a[240:243], v92 offset:28784
    v_exp_f32 v42, v42
    v_exp_f32 v43, v43
    v_exp_f32 v44, v44
    v_exp_f32 v45, v45
    v_exp_f32 v46, v46
    v_exp_f32 v47, v47
    v_cvt_pk_bf16_f32 v84, v40, v41
    v_cvt_pk_bf16_f32 v85, v42, v43
    v_cvt_pk_bf16_f32 v86, v44, v45
    v_cvt_pk_bf16_f32 v87, v46, v47
    s_waitcnt lgkmcnt(3)
    v_mfma_f32_32x32x16_bf16 v[32:47], a[236:239], a[228:231], 0
    ds_read_b128 a[236:239], v2 offset:31088
    v_exp_f32 v16, v16
    v_exp_f32 v17, v17
    v_exp_f32 v18, v18
    v_exp_f32 v19, v19
    v_mfma_f32_32x32x16_bf16 v[64:79], a[248:251], v[84:87], v[64:79]
    ds_read_b128 a[248:251], v93 offset:28784
    s_waitcnt lgkmcnt(3)
    v_max3_u32 v7, v104, v105, v106
    v_max_u32 v7, v7, v107
    v_cmp_eq_u32 vcc, -1, v7
    s_cbranch_vccnz Lre78
Lok78:
    v_exp_f32 v20, v20
    v_exp_f32 v21, v21
    v_exp_f32 v22, v22
    v_exp_f32 v23, v23
    v_cvt_pk_bf16_f32 v80, v16, v17
    v_cvt_pk_bf16_f32 v81, v18, v19
    v_cvt_pk_bf16_f32 v82, v20, v21
    v_cvt_pk_bf16_f32 v83, v22, v23
    v_exp_f32 v24, v24
    v_exp_f32 v25, v25
    v_mfma_f32_32x32x16_bf16 v[48:63], a[244:247], v[80:83], v[48:63]
    v_exp_f32 v26, v26
    v_exp_f32 v27, v27
    v_exp_f32 v28, v28
    v_exp_f32 v29, v29
    v_exp_f32 v30, v30
    v_exp_f32 v31, v31
    v_cvt_pk_bf16_f32 v84, v24, v25
    v_cvt_pk_bf16_f32 v85, v26, v27
    v_cvt_pk_bf16_f32 v86, v28, v29
    v_cvt_pk_bf16_f32 v87, v30, v31
    v_mfma_f32_32x32x16_bf16 v[16:31], a[232:235], v[96:99], 0
    s_add_u32 m0, s22, 0x1c1c0
    s_add_u32 s89, s29, 0x1b1c000
    buffer_load_dwordx4 v1, s[4:7], s89 offen sc1 lds
    v_exp_f32 v32, v32
    v_exp_f32 v33, v33
    v_exp_f32 v34, v34
    v_exp_f32 v35, v35
    v_mfma_f32_32x32x16_bf16 v[48:63], a[252:255], v[84:87], v[48:63]
    s_barrier
    v_exp_f32 v36, v36
    v_exp_f32 v37, v37
    v_exp_f32 v38, v38
    v_exp_f32 v39, v39
    v_cvt_pk_bf16_f32 v80, v32, v33
    v_cvt_pk_bf16_f32 v81, v34, v35
    v_cvt_pk_bf16_f32 v82, v36, v37
    v_cvt_pk_bf16_f32 v83, v38, v39
    v_exp_f32 v40, v40
    v_exp_f32 v41, v41
    v_mfma_f32_32x32x16_bf16 v[64:79], a[244:247], v[80:83], v[64:79]
    ds_read_b128 a[244:247], v94 offset:28784
    buffer_load_dwordx4 v1, s[4:7], s89 offen offset:1024 sc1 lds
    v_exp_f32 v42, v42
    v_exp_f32 v43, v43
    v_exp_f32 v44, v44
    v_exp_f32 v45, v45
    v_exp_f32 v46, v46
    v_exp_f32 v47, v47
    v_cvt_pk_bf16_f32 v84, v40, v41
    v_cvt_pk_bf16_f32 v85, v42, v43
    v_cvt_pk_bf16_f32 v86, v44, v45
    v_cvt_pk_bf16_f32 v87, v46, v47
    s_waitcnt lgkmcnt(1)
    v_mfma_f32_32x32x16_bf16 v[32:47], a[232:235], a[228:231], 0
    ds_read_b128 a[232:235], v2 offset:33152
    buffer_load_dwordx4 v1, s[4:7], s89 offen offset:2048 sc1 lds
    v_exp_f32 v16, v16
    v_exp_f32 v17, v17
    v_exp_f32 v18, v18
    v_exp_f32 v19, v19
    v_mfma_f32_32x32x16_bf16 v[64:79], a[252:255], v[84:87], v[64:79]
    ds_read_b128 a[252:255], v95 offset:28784
    v_exp_f32 v20, v20
    v_exp_f32 v21, v21
    v_exp_f32 v22, v22
    v_exp_f32 v23, v23
    v_cvt_pk_bf16_f32 v80, v16, v17
    v_cvt_pk_bf16_f32 v81, v18, v19
    v_cvt_pk_bf16_f32 v82, v20, v21
    v_cvt_pk_bf16_f32 v83, v22, v23
    v_exp_f32 v24, v24
    v_exp_f32 v25, v25
    v_mfma_f32_32x32x16_bf16 v[48:63], a[240:243], v[80:83], v[48:63]
    buffer_load_dwordx4 v1, s[4:7], s89 offen offset:3072 sc1 lds
    v_exp_f32 v26, v26
    v_exp_f32 v27, v27
    v_exp_f32 v28, v28
    v_exp_f32 v29, v29
    v_exp_f32 v30, v30
    v_exp_f32 v31, v31
    v_cvt_pk_bf16_f32 v84, v24, v25
    v_cvt_pk_bf16_f32 v85, v26, v27
    v_cvt_pk_bf16_f32 v86, v28, v29
    v_cvt_pk_bf16_f32 v87, v30, v31
    v_mfma_f32_32x32x16_bf16 v[16:31], a[236:239], v[96:99], 0
    v_exp_f32 v32, v32
    v_exp_f32 v33, v33
    v_exp_f32 v34, v34
    v_exp_f32 v35, v35
    v_mfma_f32_32x32x16_bf16 v[48:63], a[248:251], v[84:87], v[48:63]
    v_exp_f32 v36, v36
    v_exp_f32 v37, v37
    v_exp_f32 v38, v38
    v_exp_f32 v39, v39
    v_cvt_pk_bf16_f32 v80, v32, v33
    v_cvt_pk_bf16_f32 v81, v34, v35
    v_cvt_pk_bf16_f32 v82, v36, v37
    v_cvt_pk_bf16_f32 v83, v38, v39
    v_exp_f32 v40, v40
    v_exp_f32 v41, v41
    v_mfma_f32_32x32x16_bf16 v[64:79], a[240:243], v[80:83], v[64:79]
    ds_read_b128 a[240:243], v92 offset:32896
    v_exp_f32 v42, v42
    v_exp_f32 v43, v43
    v_exp_f32 v44, v44
    v_exp_f32 v45, v45
    v_exp_f32 v46, v46
    v_exp_f32 v47, v47
    v_cvt_pk_bf16_f32 v84, v40, v41
    v_cvt_pk_bf16_f32 v85, v42, v43
    v_cvt_pk_bf16_f32 v86, v44, v45
    v_cvt_pk_bf16_f32 v87, v46, v47
    s_waitcnt lgkmcnt(1)
    v_mfma_f32_32x32x16_bf16 v[32:47], a[236:239], a[228:231], 0
    ds_read_b128 a[236:239], v2 offset:35200
    v_exp_f32 v16, v16
    v_exp_f32 v17, v17
    v_exp_f32 v18, v18
    v_exp_f32 v19, v19
    v_mfma_f32_32x32x16_bf16 v[64:79], a[248:251], v[84:87], v[64:79]
    ds_read_b128 a[248:251], v93 offset:32896
    s_waitcnt vmcnt(4)
    v_mov_b32 v104, 1
    s_mov_b64 exec, 1
    s_add_u32 s83, s42, 0x5f4000
    buffer_atomic_add v104, off, s[4:7], s83 sc1
    s_mov_b64 exec, -1
    v_exp_f32 v20, v20
    v_exp_f32 v21, v21
    v_exp_f32 v22, v22
    v_exp_f32 v23, v23
    v_cvt_pk_bf16_f32 v80, v16, v17
    v_cvt_pk_bf16_f32 v81, v18, v19
    v_cvt_pk_bf16_f32 v82, v20, v21
    v_cvt_pk_bf16_f32 v83, v22, v23
    v_exp_f32 v24, v24
    v_exp_f32 v25, v25
    v_mfma_f32_32x32x16_bf16 v[48:63], a[244:247], v[80:83], v[48:63]
    v_exp_f32 v26, v26
    v_exp_f32 v27, v27
    v_exp_f32 v28, v28
    v_exp_f32 v29, v29
    v_exp_f32 v30, v30
    v_exp_f32 v31, v31
    v_cvt_pk_bf16_f32 v84, v24, v25
    v_cvt_pk_bf16_f32 v85, v26, v27
    v_cvt_pk_bf16_f32 v86, v28, v29
    v_cvt_pk_bf16_f32 v87, v30, v31
    v_mfma_f32_32x32x16_bf16 v[16:31], a[232:235], v[96:99], 0
    v_exp_f32 v32, v32
    v_exp_f32 v33, v33
    v_exp_f32 v34, v34
PAD17:
    s_cbranch_execz PAD21
    v_exp_f32 v35, v35
    v_mfma_f32_32x32x16_bf16 v[48:63], a[252:255], v[84:87], v[48:63]
    v_exp_f32 v36, v36
    v_exp_f32 v37, v37
    v_exp_f32 v38, v38
    v_exp_f32 v39, v39
    v_cvt_pk_bf16_f32 v80, v32, v33
    v_cvt_pk_bf16_f32 v81, v34, v35
    v_cvt_pk_bf16_f32 v82, v36, v37
    v_cvt_pk_bf16_f32 v83, v38, v39
    v_exp_f32 v40, v40
    v_exp_f32 v41, v41
    v_mfma_f32_32x32x16_bf16 v[64:79], a[244:247], v[80:83], v[64:79]
    ds_read_b128 a[244:247], v94 offset:32896
    v_exp_f32 v42, v42
    v_exp_f32 v43, v43
    v_exp_f32 v44, v44
    v_exp_f32 v45, v45
    v_exp_f32 v46, v46
    v_exp_f32 v47, v47
    v_cvt_pk_bf16_f32 v84, v40, v41
    v_cvt_pk_bf16_f32 v85, v42, v43
    v_cvt_pk_bf16_f32 v86, v44, v45
    v_cvt_pk_bf16_f32 v87, v46, v47
    s_waitcnt lgkmcnt(1)
    v_mfma_f32_32x32x16_bf16 v[32:47], a[232:235], a[228:231], 0
    ds_read_b128 a[232:235], v2 offset:37264
    v_exp_f32 v16, v16
    v_exp_f32 v17, v17
    v_exp_f32 v18, v18
    v_exp_f32 v19, v19
    v_mfma_f32_32x32x16_bf16 v[64:79], a[252:255], v[84:87], v[64:79]
    ds_read_b128 a[252:255], v95 offset:32896
    v_exp_f32 v20, v20
    v_exp_f32 v21, v21
    v_exp_f32 v22, v22
    v_exp_f32 v23, v23
    v_cvt_pk_bf16_f32 v80, v16, v17
    v_cvt_pk_bf16_f32 v81, v18, v19
    v_cvt_pk_bf16_f32 v82, v20, v21
    v_cvt_pk_bf16_f32 v83, v22, v23
    v_exp_f32 v24, v24
    v_exp_f32 v25, v25
    v_mfma_f32_32x32x16_bf16 v[48:63], a[240:243], v[80:83], v[48:63]
    v_exp_f32 v26, v26
    v_exp_f32 v27, v27
    v_exp_f32 v28, v28
    v_exp_f32 v29, v29
    v_exp_f32 v30, v30
    v_exp_f32 v31, v31
    v_cvt_pk_bf16_f32 v84, v24, v25
    v_cvt_pk_bf16_f32 v85, v26, v27
    v_cvt_pk_bf16_f32 v86, v28, v29
    v_cvt_pk_bf16_f32 v87, v30, v31
    v_mfma_f32_32x32x16_bf16 v[16:31], a[236:239], v[96:99], 0
    v_exp_f32 v32, v32
    v_exp_f32 v33, v33
    v_exp_f32 v34, v34
    v_exp_f32 v35, v35
    v_mfma_f32_32x32x16_bf16 v[48:63], a[248:251], v[84:87], v[48:63]
    v_exp_f32 v36, v36
    v_exp_f32 v37, v37
    v_exp_f32 v38, v38
    v_exp_f32 v39, v39
    v_cvt_pk_bf16_f32 v80, v32, v33
    v_cvt_pk_bf16_f32 v81, v34, v35
    v_cvt_pk_bf16_f32 v82, v36, v37
    v_cvt_pk_bf16_f32 v83, v38, v39
    v_exp_f32 v40, v40
    v_exp_f32 v41, v41
    v_mfma_f32_32x32x16_bf16 v[64:79], a[240:243], v[80:83], v[64:79]
    ds_read_b128 a[240:243], v92 offset:37008
    v_exp_f32 v42, v42
    v_exp_f32 v43, v43
    v_exp_f32 v44, v44
    v_exp_f32 v45, v45
    v_exp_f32 v46, v46
    v_exp_f32 v47, v47
    v_cvt_pk_bf16_f32 v84, v40, v41
    v_cvt_pk_bf16_f32 v85, v42, v43
    v_cvt_pk_bf16_f32 v86, v44, v45
    v_cvt_pk_bf16_f32 v87, v46, v47
    s_waitcnt lgkmcnt(1)
    v_mfma_f32_32x32x16_bf16 v[32:47], a[236:239], a[228:231], 0
    ds_read_b128 a[236:239], v2 offset:39312
    v_exp_f32 v16, v16
    v_exp_f32 v17, v17
    v_exp_f32 v18, v18
    v_exp_f32 v19, v19
    v_mfma_f32_32x32x16_bf16 v[64:79], a[248:251], v[84:87], v[64:79]
    ds_read_b128 a[248:251], v93 offset:37008
    v_exp_f32 v20, v20
    v_exp_f32 v21, v21
    v_exp_f32 v22, v22
    v_exp_f32 v23, v23
    v_cvt_pk_bf16_f32 v80, v16, v17
    v_cvt_pk_bf16_f32 v81, v18, v19
    v_cvt_pk_bf16_f32 v82, v20, v21
    v_cvt_pk_bf16_f32 v83, v22, v23
    v_exp_f32 v24, v24
    v_exp_f32 v25, v25
    v_mfma_f32_32x32x16_bf16 v[48:63], a[244:247], v[80:83], v[48:63]
    v_exp_f32 v26, v26
    v_exp_f32 v27, v27
    v_exp_f32 v28, v28
    v_exp_f32 v29, v29
    v_exp_f32 v30, v30
    v_exp_f32 v31, v31
    v_cvt_pk_bf16_f32 v84, v24, v25
    v_cvt_pk_bf16_f32 v85, v26, v27
    v_cvt_pk_bf16_f32 v86, v28, v29
    v_cvt_pk_bf16_f32 v87, v30, v31
    v_mfma_f32_32x32x16_bf16 v[16:31], a[232:235], v[96:99], 0
    v_exp_f32 v32, v32
    v_exp_f32 v33, v33
    v_exp_f32 v34, v34
    v_exp_f32 v35, v35
    v_mfma_f32_32x32x16_bf16 v[48:63], a[252:255], v[84:87], v[48:63]
    v_exp_f32 v36, v36
    v_exp_f32 v37, v37
    v_exp_f32 v38, v38
    v_exp_f32 v39, v39
    v_cvt_pk_bf16_f32 v80, v32, v33
    v_cvt_pk_bf16_f32 v81, v34, v35
    v_cvt_pk_bf16_f32 v82, v36, v37
    v_cvt_pk_bf16_f32 v83, v38, v39
    v_exp_f32 v40, v40
    v_exp_f32 v41, v41
    v_mfma_f32_32x32x16_bf16 v[64:79], a[244:247], v[80:83], v[64:79]
    ds_read_b128 a[244:247], v94 offset:37008
    v_exp_f32 v42, v42
    v_exp_f32 v43, v43
    v_exp_f32 v44, v44
    v_exp_f32 v45, v45
    v_exp_f32 v46, v46
    v_exp_f32 v47, v47
    v_cvt_pk_bf16_f32 v84, v40, v41
    v_cvt_pk_bf16_f32 v85, v42, v43
    v_cvt_pk_bf16_f32 v86, v44, v45
    v_cvt_pk_bf16_f32 v87, v46, v47
    s_waitcnt lgkmcnt(1)
    v_mfma_f32_32x32x16_bf16 v[32:47], a[232:235], a[228:231], 0
    ds_read_b128 a[232:235], v2 offset:41376
    v_exp_f32 v16, v16
    v_exp_f32 v17, v17
    v_exp_f32 v18, v18
    v_exp_f32 v19, v19
    v_mfma_f32_32x32x16_bf16 v[64:79], a[252:255], v[84:87], v[64:79]
    ds_read_b128 a[252:255], v95 offset:37008
    v_exp_f32 v20, v20
    v_exp_f32 v21, v21
    v_exp_f32 v22, v22
    v_exp_f32 v23, v23
    v_cvt_pk_bf16_f32 v80, v16, v17
    v_cvt_pk_bf16_f32 v81, v18, v19
    v_cvt_pk_bf16_f32 v82, v20, v21
    v_cvt_pk_bf16_f32 v83, v22, v23
    v_exp_f32 v24, v24
    v_exp_f32 v25, v25
    v_mfma_f32_32x32x16_bf16 v[48:63], a[240:243], v[80:83], v[48:63]
    v_exp_f32 v26, v26
    v_exp_f32 v27, v27
    v_exp_f32 v28, v28
    v_exp_f32 v29, v29
    v_exp_f32 v30, v30
    v_exp_f32 v31, v31
    v_cvt_pk_bf16_f32 v84, v24, v25
    v_cvt_pk_bf16_f32 v85, v26, v27
    v_cvt_pk_bf16_f32 v86, v28, v29
    v_cvt_pk_bf16_f32 v87, v30, v31
    v_mfma_f32_32x32x16_bf16 v[16:31], a[236:239], v[96:99], 0
    v_exp_f32 v32, v32
    v_exp_f32 v33, v33
    v_exp_f32 v34, v34
    v_exp_f32 v35, v35
    v_mfma_f32_32x32x16_bf16 v[48:63], a[248:251], v[84:87], v[48:63]
    v_exp_f32 v36, v36
    v_exp_f32 v37, v37
    v_exp_f32 v38, v38
    v_exp_f32 v39, v39
    v_cvt_pk_bf16_f32 v80, v32, v33
    v_cvt_pk_bf16_f32 v81, v34, v35
    v_cvt_pk_bf16_f32 v82, v36, v37
    v_cvt_pk_bf16_f32 v83, v38, v39
    v_exp_f32 v40, v40
    v_exp_f32 v41, v41
    v_mfma_f32_32x32x16_bf16 v[64:79], a[240:243], v[80:83], v[64:79]
    ds_read_b128 a[240:243], v92 offset:41120
    v_exp_f32 v42, v42
    v_exp_f32 v43, v43
    v_exp_f32 v44, v44
    v_exp_f32 v45, v45
    v_exp_f32 v46, v46
    v_exp_f32 v47, v47
    v_cvt_pk_bf16_f32 v84, v40, v41
    v_cvt_pk_bf16_f32 v85, v42, v43
    v_cvt_pk_bf16_f32 v86, v44, v45
    v_cvt_pk_bf16_f32 v87, v46, v47
    s_waitcnt lgkmcnt(1)
    v_mfma_f32_32x32x16_bf16 v[32:47], a[236:239], a[228:231], 0
    ds_read_b128 a[236:239], v2 offset:43424
    v_exp_f32 v16, v16
    v_exp_f32 v17, v17
    v_exp_f32 v18, v18
    v_exp_f32 v19, v19
    v_mfma_f32_32x32x16_bf16 v[64:79], a[248:251], v[84:87], v[64:79]
    ds_read_b128 a[248:251], v93 offset:41120
    v_exp_f32 v20, v20
    v_exp_f32 v21, v21
    v_exp_f32 v22, v22
    v_exp_f32 v23, v23
    v_cvt_pk_bf16_f32 v80, v16, v17
    v_cvt_pk_bf16_f32 v81, v18, v19
    v_cvt_pk_bf16_f32 v82, v20, v21
    v_cvt_pk_bf16_f32 v83, v22, v23
    v_exp_f32 v24, v24
    v_exp_f32 v25, v25
    v_mfma_f32_32x32x16_bf16 v[48:63], a[244:247], v[80:83], v[48:63]
    v_exp_f32 v26, v26
    v_exp_f32 v27, v27
    v_exp_f32 v28, v28
    v_exp_f32 v29, v29
    v_exp_f32 v30, v30
    v_exp_f32 v31, v31
    v_cvt_pk_bf16_f32 v84, v24, v25
    v_cvt_pk_bf16_f32 v85, v26, v27
    v_cvt_pk_bf16_f32 v86, v28, v29
    v_cvt_pk_bf16_f32 v87, v30, v31
    v_mfma_f32_32x32x16_bf16 v[16:31], a[232:235], v[96:99], 0
    v_exp_f32 v32, v32
    v_exp_f32 v33, v33
    v_exp_f32 v34, v34
    v_exp_f32 v35, v35
    v_mfma_f32_32x32x16_bf16 v[48:63], a[252:255], v[84:87], v[48:63]
    v_exp_f32 v36, v36
    v_exp_f32 v37, v37
    v_exp_f32 v38, v38
    v_exp_f32 v39, v39
    v_cvt_pk_bf16_f32 v80, v32, v33
    v_cvt_pk_bf16_f32 v81, v34, v35
    v_cvt_pk_bf16_f32 v82, v36, v37
    v_cvt_pk_bf16_f32 v83, v38, v39
    v_exp_f32 v40, v40
    v_exp_f32 v41, v41
    v_mfma_f32_32x32x16_bf16 v[64:79], a[244:247], v[80:83], v[64:79]
    ds_read_b128 a[244:247], v94 offset:41120
    v_exp_f32 v42, v42
    v_exp_f32 v43, v43
    v_exp_f32 v44, v44
    v_exp_f32 v45, v45
    v_exp_f32 v46, v46
    v_exp_f32 v47, v47
    v_cvt_pk_bf16_f32 v84, v40, v41
    v_cvt_pk_bf16_f32 v85, v42, v43
    v_cvt_pk_bf16_f32 v86, v44, v45
    v_cvt_pk_bf16_f32 v87, v46, v47
    s_waitcnt lgkmcnt(1)
    v_mfma_f32_32x32x16_bf16 v[32:47], a[232:235], a[228:231], 0
    ds_read_b128 a[232:235], v2 offset:45488
    v_exp_f32 v16, v16
    v_exp_f32 v17, v17
    v_exp_f32 v18, v18
    v_exp_f32 v19, v19
    v_mfma_f32_32x32x16_bf16 v[64:79], a[252:255], v[84:87], v[64:79]
    ds_read_b128 a[252:255], v95 offset:41120
    v_exp_f32 v20, v20
    v_exp_f32 v21, v21
    v_exp_f32 v22, v22
    v_exp_f32 v23, v23
    v_cvt_pk_bf16_f32 v80, v16, v17
    v_cvt_pk_bf16_f32 v81, v18, v19
    v_cvt_pk_bf16_f32 v82, v20, v21
    v_cvt_pk_bf16_f32 v83, v22, v23
    v_exp_f32 v24, v24
    v_exp_f32 v25, v25
    v_mfma_f32_32x32x16_bf16 v[48:63], a[240:243], v[80:83], v[48:63]
    v_exp_f32 v26, v26
    v_exp_f32 v27, v27
    v_exp_f32 v28, v28
    v_exp_f32 v29, v29
    v_exp_f32 v30, v30
    v_exp_f32 v31, v31
    v_cvt_pk_bf16_f32 v84, v24, v25
    v_cvt_pk_bf16_f32 v85, v26, v27
    v_cvt_pk_bf16_f32 v86, v28, v29
    v_cvt_pk_bf16_f32 v87, v30, v31
    v_mfma_f32_32x32x16_bf16 v[16:31], a[236:239], v[96:99], 0
    v_exp_f32 v32, v32
    v_exp_f32 v33, v33
    v_exp_f32 v34, v34
    v_exp_f32 v35, v35
    v_mfma_f32_32x32x16_bf16 v[48:63], a[248:251], v[84:87], v[48:63]
    v_add_u32 v108, 0x1c1c0, v6
    s_waitcnt vmcnt(1)
    ds_read2st64_b32 v[104:105], v108 offset0:0 offset1:4
    ds_read2st64_b32 v[106:107], v108 offset0:8 offset1:12
    v_exp_f32 v36, v36
    v_exp_f32 v37, v37
    v_exp_f32 v38, v38
    v_exp_f32 v39, v39
    v_cvt_pk_bf16_f32 v80, v32, v33
    v_cvt_pk_bf16_f32 v81, v34, v35
    v_cvt_pk_bf16_f32 v82, v36, v37
    v_cvt_pk_bf16_f32 v83, v38, v39
    v_exp_f32 v40, v40
    v_exp_f32 v41, v41
    v_mfma_f32_32x32x16_bf16 v[64:79], a[240:243], v[80:83], v[64:79]
    ds_read_b128 a[240:243], v92 offset:45232
    v_exp_f32 v42, v42
    v_exp_f32 v43, v43
    v_exp_f32 v44, v44
    v_exp_f32 v45, v45
    v_exp_f32 v46, v46
    v_exp_f32 v47, v47
    v_cvt_pk_bf16_f32 v84, v40, v41
    v_cvt_pk_bf16_f32 v85, v42, v43
    v_cvt_pk_bf16_f32 v86, v44, v45
    v_cvt_pk_bf16_f32 v87, v46, v47
    s_waitcnt lgkmcnt(3)
    v_mfma_f32_32x32x16_bf16 v[32:47], a[236:239], a[228:231], 0
    ds_read_b128 a[236:239], v2 offset:47536
    v_exp_f32 v16, v16
    v_exp_f32 v17, v17
    v_exp_f32 v18, v18
    v_exp_f32 v19, v19
    v_mfma_f32_32x32x16_bf16 v[64:79], a[248:251], v[84:87], v[64:79]
    ds_read_b128 a[248:251], v93 offset:45232
    s_waitcnt lgkmcnt(3)
    v_max3_u32 v7, v104, v105, v106
    v_max_u32 v7, v7, v107
    v_cmp_eq_u32 vcc, -1, v7
    s_cbranch_vccnz Lre79
Lok79:
    v_exp_f32 v20, v20
    v_exp_f32 v21, v21
    v_exp_f32 v22, v22
    v_exp_f32 v23, v23
    v_cvt_pk_bf16_f32 v80, v16, v17
    v_cvt_pk_bf16_f32 v81, v18, v19
    v_cvt_pk_bf16_f32 v82, v20, v21
    v_cvt_pk_bf16_f32 v83, v22, v23
    v_exp_f32 v24, v24
    v_exp_f32 v25, v25
    v_mfma_f32_32x32x16_bf16 v[48:63], a[244:247], v[80:83], v[48:63]
    v_exp_f32 v26, v26
    v_exp_f32 v27, v27
    v_exp_f32 v28, v28
    v_exp_f32 v29, v29
    v_exp_f32 v30, v30
    v_exp_f32 v31, v31
    v_cvt_pk_bf16_f32 v84, v24, v25
    v_cvt_pk_bf16_f32 v85, v26, v27
    v_cvt_pk_bf16_f32 v86, v28, v29
    v_cvt_pk_bf16_f32 v87, v30, v31
    v_mfma_f32_32x32x16_bf16 v[16:31], a[232:235], v[96:99], 0
    v_exp_f32 v32, v32
    v_exp_f32 v33, v33
    v_exp_f32 v34, v34
    v_exp_f32 v35, v35
    v_mfma_f32_32x32x16_bf16 v[48:63], a[252:255], v[84:87], v[48:63]
    s_barrier
    v_exp_f32 v36, v36
    v_exp_f32 v37, v37
    v_exp_f32 v38, v38
    v_exp_f32 v39, v39
    v_cvt_pk_bf16_f32 v80, v32, v33
    v_cvt_pk_bf16_f32 v81, v34, v35
    v_cvt_pk_bf16_f32 v82, v36, v37
    v_cvt_pk_bf16_f32 v83, v38, v39
    v_exp_f32 v40, v40
    v_exp_f32 v41, v41
    v_mfma_f32_32x32x16_bf16 v[64:79], a[244:247], v[80:83], v[64:79]
    ds_read_b128 a[244:247], v94 offset:45232
    v_exp_f32 v42, v42
    v_exp_f32 v43, v43
    v_exp_f32 v44, v44
    v_exp_f32 v45, v45
    v_exp_f32 v46, v46
    v_exp_f32 v47, v47
    v_cvt_pk_bf16_f32 v84, v40, v41
    v_cvt_pk_bf16_f32 v85, v42, v43
    v_cvt_pk_bf16_f32 v86, v44, v45
    v_cvt_pk_bf16_f32 v87, v46, v47
    s_waitcnt lgkmcnt(1)
    v_mfma_f32_32x32x16_bf16 v[32:47], a[232:235], a[228:231], 0
    ds_read_b128 a[232:235], v2 offset:49600
    s_add_u32 m0, s22, 0x14140
    s_add_u32 s91, s34, 0x18000
    buffer_load_dwordx4 v111, s[68:71], s91 offen lds
    v_exp_f32 v16, v16
    v_exp_f32 v17, v17
    v_exp_f32 v18, v18
    v_exp_f32 v19, v19
    v_mfma_f32_32x32x16_bf16 v[64:79], a[252:255], v[84:87], v[64:79]
    ds_read_b128 a[252:255], v95 offset:45232
    v_exp_f32 v20, v20
    v_exp_f32 v21, v21
    v_exp_f32 v22, v22
    v_exp_f32 v23, v23
    v_cvt_pk_bf16_f32 v80, v16, v17
    v_cvt_pk_bf16_f32 v81, v18, v19
    v_cvt_pk_bf16_f32 v82, v20, v21
    v_cvt_pk_bf16_f32 v83, v22, v23
    v_exp_f32 v24, v24
    v_exp_f32 v25, v25
    v_mfma_f32_32x32x16_bf16 v[48:63], a[240:243], v[80:83], v[48:63]
    s_add_u32 s84, s34, 0x19c00
    buffer_load_dwordx4 v111, s[68:71], s84 offen offset:1024 lds
    v_exp_f32 v26, v26
    v_exp_f32 v27, v27
    v_exp_f32 v28, v28
    v_exp_f32 v29, v29
    v_exp_f32 v30, v30
    v_exp_f32 v31, v31
    v_cvt_pk_bf16_f32 v84, v24, v25
    v_cvt_pk_bf16_f32 v85, v26, v27
    v_cvt_pk_bf16_f32 v86, v28, v29
    v_cvt_pk_bf16_f32 v87, v30, v31
    v_mfma_f32_32x32x16_bf16 v[16:31], a[236:239], v[96:99], 0
    s_add_u32 s90, s34, 0x1b800
    buffer_load_dwordx4 v111, s[68:71], s90 offen offset:2048 lds
    v_exp_f32 v32, v32
    v_exp_f32 v33, v33
    v_exp_f32 v34, v34
    v_exp_f32 v35, v35
    v_mfma_f32_32x32x16_bf16 v[48:63], a[248:251], v[84:87], v[48:63]
    v_exp_f32 v36, v36
    v_exp_f32 v37, v37
    v_exp_f32 v38, v38
    v_exp_f32 v39, v39
    v_cvt_pk_bf16_f32 v80, v32, v33
    v_cvt_pk_bf16_f32 v81, v34, v35
    v_cvt_pk_bf16_f32 v82, v36, v37
    v_cvt_pk_bf16_f32 v83, v38, v39
    v_exp_f32 v40, v40
    v_exp_f32 v41, v41
    v_mfma_f32_32x32x16_bf16 v[64:79], a[240:243], v[80:83], v[64:79]
    ds_read_b128 a[240:243], v92 offset:49344
    s_add_u32 s81, s34, 0x1d400
    buffer_load_dwordx4 v111, s[68:71], s81 offen offset:3072 lds
    v_exp_f32 v42, v42
    v_exp_f32 v43, v43
    v_exp_f32 v44, v44
    v_exp_f32 v45, v45
    v_exp_f32 v46, v46
    v_exp_f32 v47, v47
    v_cvt_pk_bf16_f32 v84, v40, v41
    v_cvt_pk_bf16_f32 v85, v42, v43
    v_cvt_pk_bf16_f32 v86, v44, v45
    v_cvt_pk_bf16_f32 v87, v46, v47
    s_waitcnt lgkmcnt(1)
    v_mfma_f32_32x32x16_bf16 v[32:47], a[236:239], a[228:231], 0
    ds_read_b128 a[236:239], v2 offset:51648
    s_add_u32 m0, s22, 0x8080
    s_mov_b32 s86, s34
    buffer_load_dwordx4 v111, s[68:71], s86 offen lds
    v_exp_f32 v16, v16
    v_exp_f32 v17, v17
    v_exp_f32 v18, v18
    v_exp_f32 v19, v19
    v_mfma_f32_32x32x16_bf16 v[64:79], a[248:251], v[84:87], v[64:79]
    ds_read_b128 a[248:251], v93 offset:49344
    v_exp_f32 v20, v20
    v_exp_f32 v21, v21
    v_exp_f32 v22, v22
    v_exp_f32 v23, v23
    v_cvt_pk_bf16_f32 v80, v16, v17
    v_cvt_pk_bf16_f32 v81, v18, v19
    v_cvt_pk_bf16_f32 v82, v20, v21
    v_cvt_pk_bf16_f32 v83, v22, v23
    v_exp_f32 v24, v24
    v_exp_f32 v25, v25
    v_mfma_f32_32x32x16_bf16 v[48:63], a[244:247], v[80:83], v[48:63]
    s_add_u32 s82, s34, 0x1c00
    buffer_load_dwordx4 v111, s[68:71], s82 offen offset:1024 lds
    v_exp_f32 v26, v26
    v_exp_f32 v27, v27
    v_exp_f32 v28, v28
    v_exp_f32 v29, v29
    v_exp_f32 v30, v30
    v_exp_f32 v31, v31
    v_cvt_pk_bf16_f32 v84, v24, v25
    v_cvt_pk_bf16_f32 v85, v26, v27
    v_cvt_pk_bf16_f32 v86, v28, v29
    v_cvt_pk_bf16_f32 v87, v30, v31
    v_mfma_f32_32x32x16_bf16 v[16:31], a[232:235], v[96:99], 0
    s_add_u32 s88, s34, 0x3800
    buffer_load_dwordx4 v111, s[68:71], s88 offen offset:2048 lds
    v_exp_f32 v32, v32
    v_exp_f32 v33, v33
    v_exp_f32 v34, v34
    v_exp_f32 v35, v35
    v_mfma_f32_32x32x16_bf16 v[48:63], a[252:255], v[84:87], v[48:63]
    v_exp_f32 v36, v36
    v_exp_f32 v37, v37
    v_exp_f32 v38, v38
    v_exp_f32 v39, v39
    v_cvt_pk_bf16_f32 v80, v32, v33
    v_cvt_pk_bf16_f32 v81, v34, v35
    v_cvt_pk_bf16_f32 v82, v36, v37
    v_cvt_pk_bf16_f32 v83, v38, v39
    v_exp_f32 v40, v40
    v_exp_f32 v41, v41
    v_mfma_f32_32x32x16_bf16 v[64:79], a[244:247], v[80:83], v[64:79]
    ds_read_b128 a[244:247], v94 offset:49344
    s_add_u32 s85, s34, 0x5400
    buffer_load_dwordx4 v111, s[68:71], s85 offen offset:3072 lds
    v_exp_f32 v42, v42
    v_exp_f32 v43, v43
    v_exp_f32 v44, v44
    v_exp_f32 v45, v45
    v_exp_f32 v46, v46
    v_exp_f32 v47, v47
    v_cvt_pk_bf16_f32 v84, v40, v41
    v_cvt_pk_bf16_f32 v85, v42, v43
    v_cvt_pk_bf16_f32 v86, v44, v45
    v_cvt_pk_bf16_f32 v87, v46, v47
    s_waitcnt lgkmcnt(1)
    v_mfma_f32_32x32x16_bf16 v[32:47], a[232:235], a[228:231], 0
    ds_read_b128 a[232:235], v2 offset:53712
    s_add_u32 m0, s22, 0xc0c0
    s_add_u32 s80, s34, 0x8000
    buffer_load_dwordx4 v111, s[68:71], s80 offen lds
    v_exp_f32 v16, v16
    v_exp_f32 v17, v17
    v_exp_f32 v18, v18
    v_exp_f32 v19, v19
    v_mfma_f32_32x32x16_bf16 v[64:79], a[252:255], v[84:87], v[64:79]
    ds_read_b128 a[252:255], v95 offset:49344
    v_exp_f32 v20, v20
    v_exp_f32 v21, v21
    v_exp_f32 v22, v22
    v_exp_f32 v23, v23
    v_cvt_pk_bf16_f32 v80, v16, v17
    v_cvt_pk_bf16_f32 v81, v18, v19
    v_cvt_pk_bf16_f32 v82, v20, v21
    v_cvt_pk_bf16_f32 v83, v22, v23
    v_exp_f32 v24, v24
    v_exp_f32 v25, v25
    v_mfma_f32_32x32x16_bf16 v[48:63], a[240:243], v[80:83], v[48:63]
    s_add_u32 s87, s34, 0x9c00
    buffer_load_dwordx4 v111, s[68:71], s87 offen offset:1024 lds
    v_exp_f32 v26, v26
    v_exp_f32 v27, v27
    v_exp_f32 v28, v28
    v_exp_f32 v29, v29
    v_exp_f32 v30, v30
    v_exp_f32 v31, v31
    v_cvt_pk_bf16_f32 v84, v24, v25
    v_cvt_pk_bf16_f32 v85, v26, v27
    v_cvt_pk_bf16_f32 v86, v28, v29
    v_cvt_pk_bf16_f32 v87, v30, v31
    v_mfma_f32_32x32x16_bf16 v[16:31], a[236:239], v[96:99], 0
    s_add_u32 s89, s34, 0xb800
    buffer_load_dwordx4 v111, s[68:71], s89 offen offset:2048 lds
    v_exp_f32 v32, v32
    v_exp_f32 v33, v33
    v_exp_f32 v34, v34
    v_exp_f32 v35, v35
    v_mfma_f32_32x32x16_bf16 v[48:63], a[248:251], v[84:87], v[48:63]
    v_exp_f32 v36, v36
    v_exp_f32 v37, v37
    v_exp_f32 v38, v38
    v_exp_f32 v39, v39
    v_cvt_pk_bf16_f32 v80, v32, v33
    v_cvt_pk_bf16_f32 v81, v34, v35
    v_cvt_pk_bf16_f32 v82, v36, v37
    v_cvt_pk_bf16_f32 v83, v38, v39
    v_exp_f32 v40, v40
    v_exp_f32 v41, v41
    v_mfma_f32_32x32x16_bf16 v[64:79], a[240:243], v[80:83], v[64:79]
    ds_read_b128 a[240:243], v92 offset:53456
    s_add_u32 s83, s34, 0xd400
    buffer_load_dwordx4 v111, s[68:71], s83 offen offset:3072 lds
    v_exp_f32 v42, v42
    v_exp_f32 v43, v43
    v_exp_f32 v44, v44
    v_exp_f32 v45, v45
    v_exp_f32 v46, v46
    v_exp_f32 v47, v47
    v_cvt_pk_bf16_f32 v84, v40, v41
    v_cvt_pk_bf16_f32 v85, v42, v43
    v_cvt_pk_bf16_f32 v86, v44, v45
    v_cvt_pk_bf16_f32 v87, v46, v47
    s_waitcnt lgkmcnt(1)
    v_mfma_f32_32x32x16_bf16 v[32:47], a[236:239], a[228:231], 0
    ds_read_b128 a[236:239], v2 offset:55760
    s_add_u32 m0, s22, 0x10100
    s_add_u32 s91, s34, 0x10000
    buffer_load_dwordx4 v111, s[68:71], s91 offen lds
    v_exp_f32 v16, v16
    v_exp_f32 v17, v17
    v_exp_f32 v18, v18
    v_exp_f32 v19, v19
    v_mfma_f32_32x32x16_bf16 v[64:79], a[248:251], v[84:87], v[64:79]
    ds_read_b128 a[248:251], v93 offset:53456
    v_exp_f32 v20, v20
    v_exp_f32 v21, v21
    v_exp_f32 v22, v22
    v_exp_f32 v23, v23
    v_cvt_pk_bf16_f32 v80, v16, v17
    v_cvt_pk_bf16_f32 v81, v18, v19
    v_cvt_pk_bf16_f32 v82, v20, v21
    v_cvt_pk_bf16_f32 v83, v22, v23
    v_exp_f32 v24, v24
    v_exp_f32 v25, v25
    v_mfma_f32_32x32x16_bf16 v[48:63], a[244:247], v[80:83], v[48:63]
    s_add_u32 s84, s34, 0x11c00
    buffer_load_dwordx4 v111, s[68:71], s84 offen offset:1024 lds
    v_exp_f32 v26, v26
    v_exp_f32 v27, v27
    v_exp_f32 v28, v28
    v_exp_f32 v29, v29
    v_exp_f32 v30, v30
    v_exp_f32 v31, v31
    v_cvt_pk_bf16_f32 v84, v24, v25
    v_cvt_pk_bf16_f32 v85, v26, v27
    v_cvt_pk_bf16_f32 v86, v28, v29
    v_cvt_pk_bf16_f32 v87, v30, v31
    v_mfma_f32_32x32x16_bf16 v[16:31], a[232:235], v[96:99], 0
    s_add_u32 s90, s34, 0x13800
    buffer_load_dwordx4 v111, s[68:71], s90 offen offset:2048 lds
    v_exp_f32 v32, v32
    v_exp_f32 v33, v33
    v_exp_f32 v34, v34
    v_exp_f32 v35, v35
    v_mfma_f32_32x32x16_bf16 v[48:63], a[252:255], v[84:87], v[48:63]
    v_exp_f32 v36, v36
    v_exp_f32 v37, v37
    v_exp_f32 v38, v38
    v_exp_f32 v39, v39
    v_cvt_pk_bf16_f32 v80, v32, v33
    v_cvt_pk_bf16_f32 v81, v34, v35
    v_cvt_pk_bf16_f32 v82, v36, v37
    v_cvt_pk_bf16_f32 v83, v38, v39
    v_exp_f32 v40, v40
    v_exp_f32 v41, v41
    v_mfma_f32_32x32x16_bf16 v[64:79], a[244:247], v[80:83], v[64:79]
    ds_read_b128 a[244:247], v94 offset:53456
    s_add_u32 s81, s34, 0x15400
    buffer_load_dwordx4 v111, s[68:71], s81 offen offset:3072 lds
    v_exp_f32 v42, v42
    v_exp_f32 v43, v43
    v_exp_f32 v44, v44
    v_exp_f32 v45, v45
    v_exp_f32 v46, v46
    v_exp_f32 v47, v47
    v_cvt_pk_bf16_f32 v84, v40, v41
    v_cvt_pk_bf16_f32 v85, v42, v43
    v_cvt_pk_bf16_f32 v86, v44, v45
    v_cvt_pk_bf16_f32 v87, v46, v47
    s_waitcnt lgkmcnt(1)
    v_mfma_f32_32x32x16_bf16 v[32:47], a[232:235], a[228:231], 0
    ds_read_b128 a[232:235], v2 offset:57824
    v_exp_f32 v16, v16
    v_exp_f32 v17, v17
    v_exp_f32 v18, v18
    v_exp_f32 v19, v19
    v_mfma_f32_32x32x16_bf16 v[64:79], a[252:255], v[84:87], v[64:79]
    ds_read_b128 a[252:255], v95 offset:53456
    v_exp_f32 v20, v20
    v_exp_f32 v21, v21
    v_exp_f32 v22, v22
    v_exp_f32 v23, v23
    v_cvt_pk_bf16_f32 v80, v16, v17
    v_cvt_pk_bf16_f32 v81, v18, v19
    v_cvt_pk_bf16_f32 v82, v20, v21
    v_cvt_pk_bf16_f32 v83, v22, v23
    v_exp_f32 v24, v24
    v_exp_f32 v25, v25
    v_mfma_f32_32x32x16_bf16 v[48:63], a[240:243], v[80:83], v[48:63]
    v_exp_f32 v26, v26
    v_exp_f32 v27, v27
    v_exp_f32 v28, v28
    v_exp_f32 v29, v29
    v_exp_f32 v30, v30
    v_exp_f32 v31, v31
    v_cvt_pk_bf16_f32 v84, v24, v25
    v_cvt_pk_bf16_f32 v85, v26, v27
    v_cvt_pk_bf16_f32 v86, v28, v29
    v_cvt_pk_bf16_f32 v87, v30, v31
    v_mfma_f32_32x32x16_bf16 v[16:31], a[236:239], v[96:99], 0
    v_exp_f32 v32, v32
    v_exp_f32 v33, v33
    v_exp_f32 v34, v34
    v_exp_f32 v35, v35
    v_mfma_f32_32x32x16_bf16 v[48:63], a[248:251], v[84:87], v[48:63]
    v_exp_f32 v36, v36
    v_exp_f32 v37, v37
    v_exp_f32 v38, v38
    v_exp_f32 v39, v39
    v_cvt_pk_bf16_f32 v80, v32, v33
    v_cvt_pk_bf16_f32 v81, v34, v35
    v_cvt_pk_bf16_f32 v82, v36, v37
    v_cvt_pk_bf16_f32 v83, v38, v39
    v_exp_f32 v40, v40
    v_exp_f32 v41, v41
    v_mfma_f32_32x32x16_bf16 v[64:79], a[240:243], v[80:83], v[64:79]
    ds_read_b128 a[240:243], v92 offset:57568
    v_exp_f32 v42, v42
    v_exp_f32 v43, v43
    v_exp_f32 v44, v44
    v_exp_f32 v45, v45
PAD18:
    s_cbranch_execz WARM1_8
    v_exp_f32 v46, v46
    v_exp_f32 v47, v47
    v_cvt_pk_bf16_f32 v84, v40, v41
    v_cvt_pk_bf16_f32 v85, v42, v43
    v_cvt_pk_bf16_f32 v86, v44, v45
    v_cvt_pk_bf16_f32 v87, v46, v47
    s_waitcnt lgkmcnt(1)
    v_mfma_f32_32x32x16_bf16 v[32:47], a[236:239], a[228:231], 0
    ds_read_b128 a[236:239], v2 offset:59872
    v_exp_f32 v16, v16
    v_exp_f32 v17, v17
    v_exp_f32 v18, v18
    v_exp_f32 v19, v19
    v_mfma_f32_32x32x16_bf16 v[64:79], a[248:251], v[84:87], v[64:79]
    ds_read_b128 a[248:251], v93 offset:57568
    v_exp_f32 v20, v20
    v_exp_f32 v21, v21
    v_exp_f32 v22, v22
    v_exp_f32 v23, v23
    v_cvt_pk_bf16_f32 v80, v16, v17
    v_cvt_pk_bf16_f32 v81, v18, v19
    v_cvt_pk_bf16_f32 v82, v20, v21
    v_cvt_pk_bf16_f32 v83, v22, v23
    v_exp_f32 v24, v24
    v_exp_f32 v25, v25
    v_mfma_f32_32x32x16_bf16 v[48:63], a[244:247], v[80:83], v[48:63]
    v_exp_f32 v26, v26
    v_exp_f32 v27, v27
    v_exp_f32 v28, v28
    v_exp_f32 v29, v29
    v_exp_f32 v30, v30
    v_exp_f32 v31, v31
    v_cvt_pk_bf16_f32 v84, v24, v25
    v_cvt_pk_bf16_f32 v85, v26, v27
    v_cvt_pk_bf16_f32 v86, v28, v29
    v_cvt_pk_bf16_f32 v87, v30, v31
    v_mfma_f32_32x32x16_bf16 v[16:31], a[232:235], v[96:99], 0
    v_exp_f32 v32, v32
    v_exp_f32 v33, v33
    v_exp_f32 v34, v34
    v_exp_f32 v35, v35
    v_mfma_f32_32x32x16_bf16 v[48:63], a[252:255], v[84:87], v[48:63]
    v_exp_f32 v36, v36
    v_exp_f32 v37, v37
    v_exp_f32 v38, v38
    v_exp_f32 v39, v39
    v_cvt_pk_bf16_f32 v80, v32, v33
    v_cvt_pk_bf16_f32 v81, v34, v35
    v_cvt_pk_bf16_f32 v82, v36, v37
    v_cvt_pk_bf16_f32 v83, v38, v39
    v_exp_f32 v40, v40
    v_exp_f32 v41, v41
    v_mfma_f32_32x32x16_bf16 v[64:79], a[244:247], v[80:83], v[64:79]
    ds_read_b128 a[244:247], v94 offset:57568
    v_exp_f32 v42, v42
    v_exp_f32 v43, v43
    v_exp_f32 v44, v44
    v_exp_f32 v45, v45
    v_exp_f32 v46, v46
    v_exp_f32 v47, v47
    v_cvt_pk_bf16_f32 v84, v40, v41
    v_cvt_pk_bf16_f32 v85, v42, v43
    v_cvt_pk_bf16_f32 v86, v44, v45
    v_cvt_pk_bf16_f32 v87, v46, v47
    s_waitcnt lgkmcnt(1)
    v_mfma_f32_32x32x16_bf16 v[32:47], a[232:235], a[228:231], 0
    ds_read_b128 a[232:235], v2 offset:61936
    v_exp_f32 v16, v16
    v_exp_f32 v17, v17
    v_exp_f32 v18, v18
    v_exp_f32 v19, v19
    v_mfma_f32_32x32x16_bf16 v[64:79], a[252:255], v[84:87], v[64:79]
    ds_read_b128 a[252:255], v95 offset:57568
    v_exp_f32 v20, v20
    v_exp_f32 v21, v21
    v_exp_f32 v22, v22
    v_exp_f32 v23, v23
    v_cvt_pk_bf16_f32 v80, v16, v17
    v_cvt_pk_bf16_f32 v81, v18, v19
    v_cvt_pk_bf16_f32 v82, v20, v21
    v_cvt_pk_bf16_f32 v83, v22, v23
    v_exp_f32 v24, v24
    v_exp_f32 v25, v25
    v_mfma_f32_32x32x16_bf16 v[48:63], a[240:243], v[80:83], v[48:63]
    v_exp_f32 v26, v26
    v_exp_f32 v27, v27
    v_exp_f32 v28, v28
    v_exp_f32 v29, v29
    v_exp_f32 v30, v30
    v_exp_f32 v31, v31
    v_cvt_pk_bf16_f32 v84, v24, v25
    v_cvt_pk_bf16_f32 v85, v26, v27
    v_cvt_pk_bf16_f32 v86, v28, v29
    v_cvt_pk_bf16_f32 v87, v30, v31
    v_mfma_f32_32x32x16_bf16 v[16:31], a[236:239], v[96:99], 0
    v_exp_f32 v32, v32
    v_exp_f32 v33, v33
    v_exp_f32 v34, v34
    v_exp_f32 v35, v35
    v_mfma_f32_32x32x16_bf16 v[48:63], a[248:251], v[84:87], v[48:63]
    v_exp_f32 v36, v36
    v_exp_f32 v37, v37
    v_exp_f32 v38, v38
    v_exp_f32 v39, v39
    v_cvt_pk_bf16_f32 v80, v32, v33
    v_cvt_pk_bf16_f32 v81, v34, v35
    v_cvt_pk_bf16_f32 v82, v36, v37
    v_cvt_pk_bf16_f32 v83, v38, v39
    v_exp_f32 v40, v40
    v_exp_f32 v41, v41
    v_mfma_f32_32x32x16_bf16 v[64:79], a[240:243], v[80:83], v[64:79]
    ds_read_b128 a[240:243], v92 offset:61680
    v_exp_f32 v42, v42
    v_exp_f32 v43, v43
    v_exp_f32 v44, v44
    v_exp_f32 v45, v45
    v_exp_f32 v46, v46
    v_exp_f32 v47, v47
    v_cvt_pk_bf16_f32 v84, v40, v41
    v_cvt_pk_bf16_f32 v85, v42, v43
    v_cvt_pk_bf16_f32 v86, v44, v45
    v_cvt_pk_bf16_f32 v87, v46, v47
    s_waitcnt lgkmcnt(1)
    v_mfma_f32_32x32x16_bf16 v[32:47], a[236:239], a[228:231], 0
    ds_read_b128 a[236:239], v2 offset:63984
    v_exp_f32 v16, v16
    v_exp_f32 v17, v17
    v_exp_f32 v18, v18
    v_exp_f32 v19, v19
    v_mfma_f32_32x32x16_bf16 v[64:79], a[248:251], v[84:87], v[64:79]
    ds_read_b128 a[248:251], v93 offset:61680
    v_exp_f32 v20, v20
    v_exp_f32 v21, v21
    v_exp_f32 v22, v22
    v_exp_f32 v23, v23
    v_cvt_pk_bf16_f32 v80, v16, v17
    v_cvt_pk_bf16_f32 v81, v18, v19
    v_cvt_pk_bf16_f32 v82, v20, v21
    v_cvt_pk_bf16_f32 v83, v22, v23
    v_exp_f32 v24, v24
    v_exp_f32 v25, v25
    v_mfma_f32_32x32x16_bf16 v[48:63], a[244:247], v[80:83], v[48:63]
    v_exp_f32 v26, v26
    v_exp_f32 v27, v27
    v_exp_f32 v28, v28
    v_exp_f32 v29, v29
    v_exp_f32 v30, v30
    v_exp_f32 v31, v31
    v_cvt_pk_bf16_f32 v84, v24, v25
    v_cvt_pk_bf16_f32 v85, v26, v27
    v_cvt_pk_bf16_f32 v86, v28, v29
    v_cvt_pk_bf16_f32 v87, v30, v31
    v_mfma_f32_32x32x16_bf16 v[16:31], a[232:235], v[96:99], 0
    v_exp_f32 v32, v32
    v_exp_f32 v33, v33
    v_exp_f32 v34, v34
    v_exp_f32 v35, v35
    v_mfma_f32_32x32x16_bf16 v[48:63], a[252:255], v[84:87], v[48:63]
    v_exp_f32 v36, v36
    v_exp_f32 v37, v37
    v_exp_f32 v38, v38
    v_exp_f32 v39, v39
    v_cvt_pk_bf16_f32 v80, v32, v33
    v_cvt_pk_bf16_f32 v81, v34, v35
    v_cvt_pk_bf16_f32 v82, v36, v37
    v_cvt_pk_bf16_f32 v83, v38, v39
    v_exp_f32 v40, v40
    v_exp_f32 v41, v41
    v_mfma_f32_32x32x16_bf16 v[64:79], a[244:247], v[80:83], v[64:79]
    ds_read_b128 a[244:247], v94 offset:61680
    v_exp_f32 v42, v42
    v_exp_f32 v43, v43
    v_exp_f32 v44, v44
    v_exp_f32 v45, v45
    v_exp_f32 v46, v46
    v_exp_f32 v47, v47
    v_cvt_pk_bf16_f32 v84, v40, v41
    v_cvt_pk_bf16_f32 v85, v42, v43
    v_cvt_pk_bf16_f32 v86, v44, v45
    v_cvt_pk_bf16_f32 v87, v46, v47
    s_waitcnt lgkmcnt(1)
    v_mfma_f32_32x32x16_bf16 v[32:47], a[232:235], a[228:231], 0
    ds_read_b128 a[232:235], v1 offset:0
    v_exp_f32 v16, v16
    v_exp_f32 v17, v17
    v_exp_f32 v18, v18
    v_exp_f32 v19, v19
    v_mfma_f32_32x32x16_bf16 v[64:79], a[252:255], v[84:87], v[64:79]
    ds_read_b128 a[252:255], v95 offset:61680
    v_exp_f32 v20, v20
    v_exp_f32 v21, v21
    v_exp_f32 v22, v22
    v_exp_f32 v23, v23
    v_cvt_pk_bf16_f32 v80, v16, v17
    v_cvt_pk_bf16_f32 v81, v18, v19
    v_cvt_pk_bf16_f32 v82, v20, v21
    v_cvt_pk_bf16_f32 v83, v22, v23
    v_exp_f32 v24, v24
    v_exp_f32 v25, v25
    v_mfma_f32_32x32x16_bf16 v[48:63], a[240:243], v[80:83], v[48:63]
    v_exp_f32 v26, v26
    v_exp_f32 v27, v27
    v_exp_f32 v28, v28
    v_exp_f32 v29, v29
    v_exp_f32 v30, v30
    v_exp_f32 v31, v31
    v_cvt_pk_bf16_f32 v84, v24, v25
    v_cvt_pk_bf16_f32 v85, v26, v27
    v_cvt_pk_bf16_f32 v86, v28, v29
    v_cvt_pk_bf16_f32 v87, v30, v31
    v_mfma_f32_32x32x16_bf16 v[16:31], a[236:239], v[96:99], 0
    v_exp_f32 v32, v32
    v_exp_f32 v33, v33
    v_exp_f32 v34, v34
    v_exp_f32 v35, v35
    v_mfma_f32_32x32x16_bf16 v[48:63], a[248:251], v[84:87], v[48:63]
    v_exp_f32 v36, v36
    v_exp_f32 v37, v37
    v_exp_f32 v38, v38
    v_exp_f32 v39, v39
    v_cvt_pk_bf16_f32 v80, v32, v33
    v_cvt_pk_bf16_f32 v81, v34, v35
    v_cvt_pk_bf16_f32 v82, v36, v37
    v_cvt_pk_bf16_f32 v83, v38, v39
    v_exp_f32 v40, v40
    v_exp_f32 v41, v41
    v_mfma_f32_32x32x16_bf16 v[64:79], a[240:243], v[80:83], v[64:79]
    ds_read_b128 a[240:243], v88 offset:0
    v_exp_f32 v42, v42
    v_exp_f32 v43, v43
    v_exp_f32 v44, v44
    v_exp_f32 v45, v45
    v_exp_f32 v46, v46
    v_exp_f32 v47, v47
    v_cvt_pk_bf16_f32 v84, v40, v41
    v_cvt_pk_bf16_f32 v85, v42, v43
    v_cvt_pk_bf16_f32 v86, v44, v45
    v_cvt_pk_bf16_f32 v87, v46, v47
    s_waitcnt lgkmcnt(1)
    v_mfma_f32_32x32x16_bf16 v[32:47], a[236:239], a[228:231], 0
    ds_read_b128 a[236:239], v1 offset:2048
    v_exp_f32 v16, v16
    v_exp_f32 v17, v17
    v_exp_f32 v18, v18
    v_exp_f32 v19, v19
    v_mfma_f32_32x32x16_bf16 v[64:79], a[248:251], v[84:87], v[64:79]
    ds_read_b128 a[248:251], v89 offset:0
    v_exp_f32 v20, v20
    v_exp_f32 v21, v21
    v_exp_f32 v22, v22
    v_exp_f32 v23, v23
    v_cvt_pk_bf16_f32 v80, v16, v17
    v_cvt_pk_bf16_f32 v81, v18, v19
    v_cvt_pk_bf16_f32 v82, v20, v21
    v_cvt_pk_bf16_f32 v83, v22, v23
    v_exp_f32 v24, v24
    v_exp_f32 v25, v25
    v_mfma_f32_32x32x16_bf16 v[48:63], a[244:247], v[80:83], v[48:63]
    v_exp_f32 v26, v26
    v_exp_f32 v27, v27
    v_exp_f32 v28, v28
    v_exp_f32 v29, v29
    v_exp_f32 v30, v30
    v_exp_f32 v31, v31
    v_cvt_pk_bf16_f32 v84, v24, v25
    v_cvt_pk_bf16_f32 v85, v26, v27
    v_cvt_pk_bf16_f32 v86, v28, v29
    v_cvt_pk_bf16_f32 v87, v30, v31
    v_mfma_f32_32x32x16_bf16 v[16:31], a[232:235], a[228:231], 0
    ds_read_b128 a[232:235], v1 offset:4112
    v_exp_f32 v32, v32
    v_exp_f32 v33, v33
    v_exp_f32 v34, v34
    v_exp_f32 v35, v35
    v_mfma_f32_32x32x16_bf16 v[48:63], a[252:255], v[84:87], v[48:63]
    v_exp_f32 v36, v36
    v_exp_f32 v37, v37
    v_exp_f32 v38, v38
    v_exp_f32 v39, v39
    v_cvt_pk_bf16_f32 v80, v32, v33
    v_cvt_pk_bf16_f32 v81, v34, v35
    v_cvt_pk_bf16_f32 v82, v36, v37
    v_cvt_pk_bf16_f32 v83, v38, v39
    v_exp_f32 v40, v40
    v_exp_f32 v41, v41
    v_mfma_f32_32x32x16_bf16 v[64:79], a[244:247], v[80:83], v[64:79]
    ds_read_b128 a[244:247], v90 offset:0
    v_exp_f32 v42, v42
    v_exp_f32 v43, v43
    v_exp_f32 v44, v44
    v_exp_f32 v45, v45
    v_exp_f32 v46, v46
    v_exp_f32 v47, v47
    v_cvt_pk_bf16_f32 v84, v40, v41
    v_cvt_pk_bf16_f32 v85, v42, v43
    v_cvt_pk_bf16_f32 v86, v44, v45
    v_cvt_pk_bf16_f32 v87, v46, v47
    s_waitcnt lgkmcnt(3)
    v_mfma_f32_32x32x16_bf16 v[32:47], a[236:239], a[228:231], 0
    ds_read_b128 a[236:239], v1 offset:6160
    v_exp_f32 v16, v16
    v_exp_f32 v17, v17
    v_exp_f32 v18, v18
    v_exp_f32 v19, v19
    v_mfma_f32_32x32x16_bf16 v[64:79], a[252:255], v[84:87], v[64:79]
    ds_read_b128 a[252:255], v91 offset:0
    v_subrev_u32 v7, 0x21800000, v56
    v_cmp_lt_u32 vcc, 0x32000000, v7
    s_mov_b64 s[54:55], vcc
    v_rcp_f32 v57, v56
    s_nop 0
    v_mul_f32 v48, v48, v57
    v_mul_f32 v49, v49, v57
    v_mul_f32 v50, v50, v57
    v_mul_f32 v51, v51, v57
    v_mul_f32 v52, v52, v57
    v_mul_f32 v53, v53, v57
    v_mul_f32 v54, v54, v57
    v_mul_f32 v55, v55, v57
    v_cvt_pk_bf16_f32 v48, v48, v49
    v_cvt_pk_bf16_f32 v49, v50, v51
    v_cvt_pk_bf16_f32 v50, v52, v53
    v_cvt_pk_bf16_f32 v51, v54, v55
    s_not_b64 exec, s[54:55]
    s_add_u32 s86, s30, 0x1b00000
    buffer_store_dwordx4 v[48:51], v1, s[4:7], s86 offen sc1
    s_mov_b64 exec, -1
    v_exp_f32 v20, v20
    v_exp_f32 v21, v21
    v_exp_f32 v22, v22
    v_exp_f32 v23, v23
    v_cvt_pk_bf16_f32 v80, v16, v17
    v_cvt_pk_bf16_f32 v81, v18, v19
    v_cvt_pk_bf16_f32 v82, v20, v21
    v_cvt_pk_bf16_f32 v83, v22, v23
    v_exp_f32 v24, v24
    v_exp_f32 v25, v25
    v_mfma_f32_32x32x16_bf16 v[64:79], a[240:243], v[80:83], v[64:79]
    ds_read_b128 a[240:243], v88 offset:4112
    v_exp_f32 v26, v26
    v_exp_f32 v27, v27
    v_exp_f32 v28, v28
    v_exp_f32 v29, v29
    v_exp_f32 v30, v30
    v_exp_f32 v31, v31
    v_cvt_pk_bf16_f32 v84, v24, v25
    v_cvt_pk_bf16_f32 v85, v26, v27
    v_cvt_pk_bf16_f32 v86, v28, v29
    v_cvt_pk_bf16_f32 v87, v30, v31
    s_waitcnt lgkmcnt(3)
    v_mfma_f32_32x32x16_bf16 v[16:31], a[232:235], a[228:231], 0
    ds_read_b128 a[232:235], v1 offset:8224
    v_exp_f32 v32, v32
    v_exp_f32 v33, v33
    v_exp_f32 v34, v34
    v_exp_f32 v35, v35
    v_mfma_f32_32x32x16_bf16 v[64:79], a[248:251], v[84:87], v[64:79]
    ds_read_b128 a[248:251], v89 offset:4112
    v_lshlrev_b32 v104, 4, v1
    s_mov_b32 s82, 0x5f4000
    buffer_load_dword v105, v104, s[4:7], s82 offen sc1
    v_exp_f32 v36, v36
    v_exp_f32 v37, v37
    v_exp_f32 v38, v38
    v_exp_f32 v39, v39
    v_cvt_pk_bf16_f32 v80, v32, v33
    v_cvt_pk_bf16_f32 v81, v34, v35
    v_cvt_pk_bf16_f32 v82, v36, v37
    v_cvt_pk_bf16_f32 v83, v38, v39
    v_exp_f32 v40, v40
    v_exp_f32 v41, v41
    v_mfma_f32_32x32x16_bf16 v[64:79], a[244:247], v[80:83], v[64:79]
    ds_read_b128 a[244:247], v90 offset:4112
    v_exp_f32 v42, v42
    v_exp_f32 v43, v43
    v_exp_f32 v44, v44
    v_exp_f32 v45, v45
    v_exp_f32 v46, v46
    v_exp_f32 v47, v47
    v_cvt_pk_bf16_f32 v84, v40, v41
    v_cvt_pk_bf16_f32 v85, v42, v43
    v_cvt_pk_bf16_f32 v86, v44, v45
    v_cvt_pk_bf16_f32 v87, v46, v47
    s_waitcnt lgkmcnt(3)
    v_mfma_f32_32x32x16_bf16 v[32:47], a[236:239], a[228:231], 0
    ds_read_b128 a[236:239], v1 offset:10272
    v_exp_f32 v16, v16
    v_exp_f32 v17, v17
    v_exp_f32 v18, v18
    v_exp_f32 v19, v19
    v_mfma_f32_32x32x16_bf16 v[64:79], a[252:255], v[84:87], v[64:79]
    ds_read_b128 a[252:255], v91 offset:4112
    v_exp_f32 v20, v20
    v_exp_f32 v21, v21
    v_exp_f32 v22, v22
    v_exp_f32 v23, v23
    v_cvt_pk_bf16_f32 v80, v16, v17
    v_cvt_pk_bf16_f32 v81, v18, v19
    v_cvt_pk_bf16_f32 v82, v20, v21
    v_cvt_pk_bf16_f32 v83, v22, v23
    v_exp_f32 v24, v24
    v_exp_f32 v25, v25
    v_mfma_f32_32x32x16_bf16 v[64:79], a[240:243], v[80:83], v[64:79]
    ds_read_b128 a[240:243], v88 offset:8224
    v_exp_f32 v26, v26
    v_exp_f32 v27, v27
    v_exp_f32 v28, v28
    v_exp_f32 v29, v29
    v_exp_f32 v30, v30
    v_exp_f32 v31, v31
    v_cvt_pk_bf16_f32 v84, v24, v25
    v_cvt_pk_bf16_f32 v85, v26, v27
    v_cvt_pk_bf16_f32 v86, v28, v29
    v_cvt_pk_bf16_f32 v87, v30, v31
    s_waitcnt lgkmcnt(3)
    v_mfma_f32_32x32x16_bf16 v[16:31], a[232:235], a[228:231], 0
    ds_read_b128 a[232:235], v1 offset:12336
    v_exp_f32 v32, v32
    v_exp_f32 v33, v33
    v_exp_f32 v34, v34
    v_exp_f32 v35, v35
    v_mfma_f32_32x32x16_bf16 v[64:79], a[248:251], v[84:87], v[64:79]
    ds_read_b128 a[248:251], v89 offset:8224
    v_exp_f32 v36, v36
    v_exp_f32 v37, v37
    v_exp_f32 v38, v38
    v_exp_f32 v39, v39
    v_cvt_pk_bf16_f32 v80, v32, v33
    v_cvt_pk_bf16_f32 v81, v34, v35
    v_cvt_pk_bf16_f32 v82, v36, v37
    v_cvt_pk_bf16_f32 v83, v38, v39
    v_exp_f32 v40, v40
    v_exp_f32 v41, v41
    v_mfma_f32_32x32x16_bf16 v[64:79], a[244:247], v[80:83], v[64:79]
    ds_read_b128 a[244:247], v90 offset:8224
    v_exp_f32 v42, v42
    v_exp_f32 v43, v43
    v_exp_f32 v44, v44
    v_exp_f32 v45, v45
    v_exp_f32 v46, v46
    v_exp_f32 v47, v47
    v_cvt_pk_bf16_f32 v84, v40, v41
    v_cvt_pk_bf16_f32 v85, v42, v43
    v_cvt_pk_bf16_f32 v86, v44, v45
    v_cvt_pk_bf16_f32 v87, v46, v47
    s_waitcnt lgkmcnt(3)
    v_mfma_f32_32x32x16_bf16 v[32:47], a[236:239], a[228:231], 0
    ds_read_b128 a[236:239], v1 offset:14384
    v_exp_f32 v16, v16
    v_exp_f32 v17, v17
    v_exp_f32 v18, v18
    v_exp_f32 v19, v19
    v_mfma_f32_32x32x16_bf16 v[64:79], a[252:255], v[84:87], v[64:79]
    ds_read_b128 a[252:255], v91 offset:8224
    v_exp_f32 v20, v20
    v_exp_f32 v21, v21
    v_exp_f32 v22, v22
    v_exp_f32 v23, v23
    v_cvt_pk_bf16_f32 v80, v16, v17
    v_cvt_pk_bf16_f32 v81, v18, v19
    v_cvt_pk_bf16_f32 v82, v20, v21
    v_cvt_pk_bf16_f32 v83, v22, v23
    v_exp_f32 v24, v24
    v_exp_f32 v25, v25
    v_mfma_f32_32x32x16_bf16 v[64:79], a[240:243], v[80:83], v[64:79]
    ds_read_b128 a[240:243], v88 offset:12336
    v_exp_f32 v26, v26
    v_exp_f32 v27, v27
    v_exp_f32 v28, v28
    v_exp_f32 v29, v29
    v_exp_f32 v30, v30
    v_exp_f32 v31, v31
    v_cvt_pk_bf16_f32 v84, v24, v25
    v_cvt_pk_bf16_f32 v85, v26, v27
    v_cvt_pk_bf16_f32 v86, v28, v29
    v_cvt_pk_bf16_f32 v87, v30, v31
    s_waitcnt lgkmcnt(3)
    v_mfma_f32_32x32x16_bf16 v[16:31], a[232:235], a[228:231], 0
    ds_read_b128 a[232:235], v1 offset:16448
    v_exp_f32 v32, v32
    v_exp_f32 v33, v33
    v_exp_f32 v34, v34
    v_exp_f32 v35, v35
    v_mfma_f32_32x32x16_bf16 v[64:79], a[248:251], v[84:87], v[64:79]
    ds_read_b128 a[248:251], v89 offset:12336
    v_exp_f32 v36, v36
    v_exp_f32 v37, v37
    v_exp_f32 v38, v38
    v_exp_f32 v39, v39
    v_cvt_pk_bf16_f32 v80, v32, v33
    v_cvt_pk_bf16_f32 v81, v34, v35
    v_cvt_pk_bf16_f32 v82, v36, v37
    v_cvt_pk_bf16_f32 v83, v38, v39
    v_exp_f32 v40, v40
    v_exp_f32 v41, v41
    v_mfma_f32_32x32x16_bf16 v[64:79], a[244:247], v[80:83], v[64:79]
    ds_read_b128 a[244:247], v90 offset:12336
    v_exp_f32 v42, v42
    v_exp_f32 v43, v43
    v_exp_f32 v44, v44
    v_exp_f32 v45, v45
    v_exp_f32 v46, v46
    v_exp_f32 v47, v47
    v_cvt_pk_bf16_f32 v84, v40, v41
    v_cvt_pk_bf16_f32 v85, v42, v43
    v_cvt_pk_bf16_f32 v86, v44, v45
    v_cvt_pk_bf16_f32 v87, v46, v47
    s_waitcnt lgkmcnt(3)
    v_mfma_f32_32x32x16_bf16 v[32:47], a[236:239], a[228:231], 0
    ds_read_b128 a[236:239], v1 offset:18496
    v_exp_f32 v16, v16
    v_exp_f32 v17, v17
    v_exp_f32 v18, v18
    v_exp_f32 v19, v19
    v_mfma_f32_32x32x16_bf16 v[64:79], a[252:255], v[84:87], v[64:79]
    ds_read_b128 a[252:255], v91 offset:12336
    v_exp_f32 v20, v20
    v_exp_f32 v21, v21
    v_exp_f32 v22, v22
    v_exp_f32 v23, v23
    v_cvt_pk_bf16_f32 v80, v16, v17
    v_cvt_pk_bf16_f32 v81, v18, v19
    v_cvt_pk_bf16_f32 v82, v20, v21
    v_cvt_pk_bf16_f32 v83, v22, v23
    v_exp_f32 v24, v24
    v_exp_f32 v25, v25
    v_mfma_f32_32x32x16_bf16 v[64:79], a[240:243], v[80:83], v[64:79]
    ds_read_b128 a[240:243], v88 offset:16448
    v_exp_f32 v26, v26
    v_exp_f32 v27, v27
    v_exp_f32 v28, v28
    v_exp_f32 v29, v29
    v_exp_f32 v30, v30
    v_exp_f32 v31, v31
    v_cvt_pk_bf16_f32 v84, v24, v25
    v_cvt_pk_bf16_f32 v85, v26, v27
    v_cvt_pk_bf16_f32 v86, v28, v29
    v_cvt_pk_bf16_f32 v87, v30, v31
    s_waitcnt lgkmcnt(3)
    v_mfma_f32_32x32x16_bf16 v[16:31], a[232:235], a[228:231], 0
    ds_read_b128 a[232:235], v1 offset:20560
    v_exp_f32 v32, v32
    v_exp_f32 v33, v33
    v_exp_f32 v34, v34
    v_exp_f32 v35, v35
    v_mfma_f32_32x32x16_bf16 v[64:79], a[248:251], v[84:87], v[64:79]
    ds_read_b128 a[248:251], v89 offset:16448
    v_exp_f32 v36, v36
    v_exp_f32 v37, v37
    v_exp_f32 v38, v38
    v_exp_f32 v39, v39
    v_cvt_pk_bf16_f32 v80, v32, v33
    v_cvt_pk_bf16_f32 v81, v34, v35
    v_cvt_pk_bf16_f32 v82, v36, v37
    v_cvt_pk_bf16_f32 v83, v38, v39
    v_exp_f32 v40, v40
    v_exp_f32 v41, v41
    v_mfma_f32_32x32x16_bf16 v[64:79], a[244:247], v[80:83], v[64:79]
    ds_read_b128 a[244:247], v90 offset:16448
    v_exp_f32 v42, v42
    v_exp_f32 v43, v43
    v_exp_f32 v44, v44
    v_exp_f32 v45, v45
    v_exp_f32 v46, v46
    v_exp_f32 v47, v47
    v_cvt_pk_bf16_f32 v84, v40, v41
    v_cvt_pk_bf16_f32 v85, v42, v43
    v_cvt_pk_bf16_f32 v86, v44, v45
    v_cvt_pk_bf16_f32 v87, v46, v47
    s_waitcnt lgkmcnt(3)
    v_mfma_f32_32x32x16_bf16 v[32:47], a[236:239], a[228:231], 0
    ds_read_b128 a[236:239], v1 offset:22608
    v_exp_f32 v16, v16
    v_exp_f32 v17, v17
    v_exp_f32 v18, v18
    v_exp_f32 v19, v19
    v_mfma_f32_32x32x16_bf16 v[64:79], a[252:255], v[84:87], v[64:79]
    ds_read_b128 a[252:255], v91 offset:16448
    s_waitcnt vmcnt(0)
    v_cmp_ne_u32 vcc, 16, v105
    s_cbranch_vccnz Lre80
Lok80:
    ds_read_b64_tr_b16 a[224:225], v4 offset:0
    ds_read_b64_tr_b16 a[226:227], v4 offset:1024
    v_exp_f32 v20, v20
    v_exp_f32 v21, v21
    v_exp_f32 v22, v22
    v_exp_f32 v23, v23
    v_cvt_pk_bf16_f32 v80, v16, v17
    v_cvt_pk_bf16_f32 v81, v18, v19
    v_cvt_pk_bf16_f32 v82, v20, v21
    v_cvt_pk_bf16_f32 v83, v22, v23
    v_exp_f32 v24, v24
    v_exp_f32 v25, v25
    v_mfma_f32_32x32x16_bf16 v[64:79], a[240:243], v[80:83], v[64:79]
    ds_read_b128 a[240:243], v88 offset:20560
    v_exp_f32 v26, v26
    v_exp_f32 v27, v27
    v_exp_f32 v28, v28
    v_exp_f32 v29, v29
    v_exp_f32 v30, v30
    v_exp_f32 v31, v31
    v_cvt_pk_bf16_f32 v84, v24, v25
    v_cvt_pk_bf16_f32 v85, v26, v27
    v_cvt_pk_bf16_f32 v86, v28, v29
    v_cvt_pk_bf16_f32 v87, v30, v31
    s_waitcnt lgkmcnt(5)
    v_mfma_f32_32x32x16_bf16 v[16:31], a[232:235], a[228:231], 0
    ds_read_b128 a[232:235], v1 offset:24672
    s_add_u32 s88, s17, 0x2300000
    buffer_load_dwordx4 v[48:51], v1, s[4:7], s88 offen sc1
    v_exp_f32 v32, v32
    v_exp_f32 v33, v33
    v_exp_f32 v34, v34
    v_exp_f32 v35, v35
    v_mfma_f32_32x32x16_bf16 v[64:79], a[248:251], v[84:87], v[64:79]
    ds_read_b128 a[248:251], v89 offset:20560
    v_exp_f32 v36, v36
    v_exp_f32 v37, v37
    v_exp_f32 v38, v38
    v_exp_f32 v39, v39
    v_cvt_pk_bf16_f32 v80, v32, v33
    v_cvt_pk_bf16_f32 v81, v34, v35
    v_cvt_pk_bf16_f32 v82, v36, v37
    v_cvt_pk_bf16_f32 v83, v38, v39
    v_exp_f32 v40, v40
    v_exp_f32 v41, v41
    v_mfma_f32_32x32x16_bf16 v[64:79], a[244:247], v[80:83], v[64:79]
    ds_read_b128 a[244:247], v90 offset:20560
    buffer_load_dwordx4 v[52:55], v1, s[4:7], s88 offen offset:1024 sc1
    v_exp_f32 v42, v42
    v_exp_f32 v43, v43
    v_exp_f32 v44, v44
    v_exp_f32 v45, v45
    v_exp_f32 v46, v46
    v_exp_f32 v47, v47
    v_cvt_pk_bf16_f32 v84, v40, v41
    v_cvt_pk_bf16_f32 v85, v42, v43
    v_cvt_pk_bf16_f32 v86, v44, v45
    v_cvt_pk_bf16_f32 v87, v46, v47
    s_waitcnt lgkmcnt(3)
    v_mfma_f32_32x32x16_bf16 v[32:47], a[236:239], a[228:231], 0
    ds_read_b128 a[236:239], v1 offset:26720
    buffer_load_dwordx4 v[56:59], v1, s[4:7], s88 offen offset:2048 sc1
    v_exp_f32 v16, v16
    v_exp_f32 v17, v17
    v_exp_f32 v18, v18
    v_exp_f32 v19, v19
    v_mfma_f32_32x32x16_bf16 v[64:79], a[252:255], v[84:87], v[64:79]
    ds_read_b128 a[252:255], v91 offset:20560
    v_exp_f32 v20, v20
    v_exp_f32 v21, v21
    v_exp_f32 v22, v22
    v_exp_f32 v23, v23
    v_cvt_pk_bf16_f32 v80, v16, v17
    v_cvt_pk_bf16_f32 v81, v18, v19
    v_cvt_pk_bf16_f32 v82, v20, v21
    v_cvt_pk_bf16_f32 v83, v22, v23
    v_exp_f32 v24, v24
    v_exp_f32 v25, v25
    v_mfma_f32_32x32x16_bf16 v[64:79], a[240:243], v[80:83], v[64:79]
    ds_read_b128 a[240:243], v88 offset:24672
    buffer_load_dwordx4 v[60:63], v1, s[4:7], s88 offen offset:3072 sc1
    v_exp_f32 v26, v26
    v_exp_f32 v27, v27
    v_exp_f32 v28, v28
    v_exp_f32 v29, v29
    v_exp_f32 v30, v30
    v_exp_f32 v31, v31
    v_cvt_pk_bf16_f32 v84, v24, v25
    v_cvt_pk_bf16_f32 v85, v26, v27
    v_cvt_pk_bf16_f32 v86, v28, v29
    v_cvt_pk_bf16_f32 v87, v30, v31
    s_waitcnt lgkmcnt(3)
    v_mfma_f32_32x32x16_bf16 v[16:31], a[232:235], a[228:231], 0
    ds_read_b128 a[232:235], v1 offset:28784
    s_add_u32 s85, s17, 0x2301000
    buffer_load_dwordx4 v[96:99], v1, s[4:7], s85 offen sc1
    v_exp_f32 v32, v32
    v_exp_f32 v33, v33
    v_exp_f32 v34, v34
    v_exp_f32 v35, v35
    v_mfma_f32_32x32x16_bf16 v[64:79], a[248:251], v[84:87], v[64:79]
    ds_read_b128 a[248:251], v89 offset:24672
    v_exp_f32 v36, v36
    v_exp_f32 v37, v37
    v_exp_f32 v38, v38
    v_exp_f32 v39, v39
    v_cvt_pk_bf16_f32 v80, v32, v33
    v_cvt_pk_bf16_f32 v81, v34, v35
    v_cvt_pk_bf16_f32 v82, v36, v37
    v_cvt_pk_bf16_f32 v83, v38, v39
    v_exp_f32 v40, v40
    v_exp_f32 v41, v41
    v_mfma_f32_32x32x16_bf16 v[64:79], a[244:247], v[80:83], v[64:79]
    ds_read_b128 a[244:247], v90 offset:24672
    buffer_load_dwordx4 v[100:103], v1, s[4:7], s85 offen offset:1024 sc1
    v_exp_f32 v42, v42
    v_exp_f32 v43, v43
    v_exp_f32 v44, v44
    v_exp_f32 v45, v45
    v_exp_f32 v46, v46
    v_exp_f32 v47, v47
    v_cvt_pk_bf16_f32 v84, v40, v41
    v_cvt_pk_bf16_f32 v85, v42, v43
    v_cvt_pk_bf16_f32 v86, v44, v45
    v_cvt_pk_bf16_f32 v87, v46, v47
PAD19:
    s_cbranch_execz WARM1_8
    s_waitcnt lgkmcnt(3)
    v_mfma_f32_32x32x16_bf16 v[32:47], a[236:239], a[228:231], 0
    ds_read_b128 a[236:239], v1 offset:30832
    buffer_load_dwordx4 v[104:107], v1, s[4:7], s85 offen offset:2048 sc1
    v_exp_f32 v16, v16
    v_exp_f32 v17, v17
    v_exp_f32 v18, v18
    v_exp_f32 v19, v19
    v_mfma_f32_32x32x16_bf16 v[64:79], a[252:255], v[84:87], v[64:79]
    ds_read_b128 a[252:255], v91 offset:24672
    v_exp_f32 v20, v20
    v_exp_f32 v21, v21
    v_exp_f32 v22, v22
    v_exp_f32 v23, v23
    v_cvt_pk_bf16_f32 v80, v16, v17
    v_cvt_pk_bf16_f32 v81, v18, v19
    v_cvt_pk_bf16_f32 v82, v20, v21
    v_cvt_pk_bf16_f32 v83, v22, v23
    v_exp_f32 v24, v24
    v_exp_f32 v25, v25
    v_mfma_f32_32x32x16_bf16 v[64:79], a[240:243], v[80:83], v[64:79]
    ds_read_b128 a[240:243], v88 offset:28784
    buffer_load_dwordx4 v[108:111], v1, s[4:7], s85 offen offset:3072 sc1
    v_exp_f32 v26, v26
    v_exp_f32 v27, v27
    v_exp_f32 v28, v28
    v_exp_f32 v29, v29
    v_exp_f32 v30, v30
    v_exp_f32 v31, v31
    v_cvt_pk_bf16_f32 v84, v24, v25
    v_cvt_pk_bf16_f32 v85, v26, v27
    v_cvt_pk_bf16_f32 v86, v28, v29
    v_cvt_pk_bf16_f32 v87, v30, v31
    s_waitcnt lgkmcnt(3)
    v_mfma_f32_32x32x16_bf16 v[16:31], a[232:235], a[228:231], 0
    ds_read_b64_tr_b16 a[232:233], v124 offset:0
    ds_read_b64_tr_b16 a[234:235], v124 offset:1024
    v_exp_f32 v32, v32
    v_exp_f32 v33, v33
    v_exp_f32 v34, v34
    v_exp_f32 v35, v35
    v_mfma_f32_32x32x16_bf16 v[64:79], a[248:251], v[84:87], v[64:79]
    ds_read_b128 a[248:251], v89 offset:28784
    v_exp_f32 v36, v36
    v_exp_f32 v37, v37
    v_exp_f32 v38, v38
    v_exp_f32 v39, v39
    v_cvt_pk_bf16_f32 v80, v32, v33
    v_cvt_pk_bf16_f32 v81, v34, v35
    v_cvt_pk_bf16_f32 v82, v36, v37
    v_cvt_pk_bf16_f32 v83, v38, v39
    v_exp_f32 v40, v40
    v_exp_f32 v41, v41
    v_mfma_f32_32x32x16_bf16 v[64:79], a[244:247], v[80:83], v[64:79]
    ds_read_b128 a[244:247], v90 offset:28784
    v_exp_f32 v42, v42
    v_exp_f32 v43, v43
    v_exp_f32 v44, v44
    v_exp_f32 v45, v45
    v_exp_f32 v46, v46
    v_exp_f32 v47, v47
    v_cvt_pk_bf16_f32 v84, v40, v41
    v_cvt_pk_bf16_f32 v85, v42, v43
    v_cvt_pk_bf16_f32 v86, v44, v45
    v_cvt_pk_bf16_f32 v87, v46, v47
    s_waitcnt lgkmcnt(4)
    v_mfma_f32_32x32x16_bf16 v[32:47], a[236:239], a[228:231], 0
    ds_read_b64_tr_b16 a[236:237], v4 offset:2048
    ds_read_b64_tr_b16 a[238:239], v4 offset:3072
    ds_read_b64_tr_b16 a[228:229], v124 offset:2048
    ds_read_b64_tr_b16 a[230:231], v124 offset:3072
    v_exp_f32 v16, v16
    v_exp_f32 v17, v17
    v_exp_f32 v18, v18
    v_exp_f32 v19, v19
    v_mfma_f32_32x32x16_bf16 v[64:79], a[252:255], v[84:87], v[64:79]
    ds_read_b128 a[252:255], v91 offset:28784
    v_exp_f32 v20, v20
    v_exp_f32 v21, v21
    v_exp_f32 v22, v22
    v_exp_f32 v23, v23
    v_cvt_pk_bf16_f32 v80, v16, v17
    v_cvt_pk_bf16_f32 v81, v18, v19
    v_cvt_pk_bf16_f32 v82, v20, v21
    v_cvt_pk_bf16_f32 v83, v22, v23
    v_exp_f32 v24, v24
    v_exp_f32 v25, v25
    v_mfma_f32_32x32x16_bf16 v[64:79], a[240:243], v[80:83], v[64:79]
    ds_read_b64_tr_b16 a[240:241], v4 offset:16448
    ds_read_b64_tr_b16 a[242:243], v4 offset:17472
    v_exp_f32 v26, v26
    v_exp_f32 v27, v27
    v_exp_f32 v28, v28
    v_exp_f32 v29, v29
    v_exp_f32 v30, v30
    v_exp_f32 v31, v31
    v_cvt_pk_bf16_f32 v84, v24, v25
    v_cvt_pk_bf16_f32 v85, v26, v27
    v_cvt_pk_bf16_f32 v86, v28, v29
    v_cvt_pk_bf16_f32 v87, v30, v31
    v_exp_f32 v32, v32
    v_exp_f32 v33, v33
    v_exp_f32 v34, v34
    v_exp_f32 v35, v35
    s_waitcnt lgkmcnt(7)
    v_mfma_f32_32x32x16_bf16 v[64:79], a[248:251], v[84:87], v[64:79]
    ds_read_b64_tr_b16 a[248:249], v124 offset:16448
    ds_read_b64_tr_b16 a[250:251], v124 offset:17472
    v_exp_f32 v36, v36
    v_exp_f32 v37, v37
    v_exp_f32 v38, v38
    v_exp_f32 v39, v39
    v_cvt_pk_bf16_f32 v80, v32, v33
    v_cvt_pk_bf16_f32 v81, v34, v35
    v_cvt_pk_bf16_f32 v82, v36, v37
    v_cvt_pk_bf16_f32 v83, v38, v39
    v_exp_f32 v40, v40
    v_exp_f32 v41, v41
    v_mfma_f32_32x32x16_bf16 v[64:79], a[244:247], v[80:83], v[64:79]
    ds_read_b64_tr_b16 a[244:245], v4 offset:18496
    ds_read_b64_tr_b16 a[246:247], v4 offset:19520
    v_exp_f32 v42, v42
    v_exp_f32 v43, v43
    v_exp_f32 v44, v44
    v_exp_f32 v45, v45
    v_exp_f32 v46, v46
    v_exp_f32 v47, v47
    v_cvt_pk_bf16_f32 v84, v40, v41
    v_cvt_pk_bf16_f32 v85, v42, v43
    v_cvt_pk_bf16_f32 v86, v44, v45
    v_cvt_pk_bf16_f32 v87, v46, v47
    s_waitcnt lgkmcnt(5)
    s_nop 0
    v_mfma_f32_32x32x16_bf16 v[64:79], a[252:255], v[84:87], v[64:79]
    ds_read_b64_tr_b16 a[252:253], v124 offset:18496
    ds_read_b64_tr_b16 a[254:255], v124 offset:19520
    s_nop 9
    v_subrev_u32 v7, 0x21800000, v72
    v_cmp_lt_u32 vcc, 0x32000000, v7
    s_or_b64 s[54:55], s[54:55], vcc
    s_cbranch_scc1 att_slow1
att_back1:
    v_rcp_f32 v73, v72
    s_nop 0
    v_mul_f32 v64, v64, v73
    v_mul_f32 v65, v65, v73
    v_mul_f32 v66, v66, v73
    v_mul_f32 v67, v67, v73
    v_mul_f32 v68, v68, v73
    v_mul_f32 v69, v69, v73
    v_mul_f32 v70, v70, v73
    v_mul_f32 v71, v71, v73
    v_cvt_pk_bf16_f32 v64, v64, v65
    v_cvt_pk_bf16_f32 v65, v66, v67
    v_cvt_pk_bf16_f32 v66, v68, v69
    v_cvt_pk_bf16_f32 v67, v70, v71
    s_add_u32 s80, s30, 0x1b08000
    buffer_store_dwordx4 v[64:67], v1, s[4:7], s80 offen sc1
    s_waitcnt vmcnt(6)
    v_max3_u32 v7, v48, v52, v56
    s_waitcnt vmcnt(5)
    v_max_u32 v7, v7, v60
    v_cmp_eq_u32 vcc, -1, v7
    s_cbranch_vccnz Lre81
Lok81:
    v_mfma_f32_32x32x16_bf16 v[32:47], a[224:227], v[48:51], 0
    ds_read_b64_tr_b16 a[224:225], v4 offset:32896
    ds_read_b64_tr_b16 a[226:227], v4 offset:33920
    v_mfma_f32_32x32x16_bf16 v[16:31], a[232:235], v[48:51], 0
    ds_read_b64_tr_b16 a[232:233], v124 offset:32896
    ds_read_b64_tr_b16 a[234:235], v124 offset:33920
    v_mfma_f32_32x32x16_bf16 v[32:47], a[236:239], v[52:55], v[32:47]
    ds_read_b64_tr_b16 a[236:237], v4 offset:34944
    ds_read_b64_tr_b16 a[238:239], v4 offset:35968
    v_mfma_f32_32x32x16_bf16 v[16:31], a[228:231], v[52:55], v[16:31]
    ds_read_b64_tr_b16 a[228:229], v124 offset:34944
    ds_read_b64_tr_b16 a[230:231], v124 offset:35968
    s_waitcnt lgkmcnt(13)
    v_mfma_f32_32x32x16_bf16 v[32:47], a[240:243], v[56:59], v[32:47]
    ds_read_b64_tr_b16 a[240:241], v4 offset:49344
    ds_read_b64_tr_b16 a[242:243], v4 offset:50368
    s_waitcnt lgkmcnt(13)
    v_mfma_f32_32x32x16_bf16 v[16:31], a[248:251], v[56:59], v[16:31]
    ds_read_b64_tr_b16 a[248:249], v124 offset:49344
    ds_read_b64_tr_b16 a[250:251], v124 offset:50368
    s_waitcnt lgkmcnt(13)
    v_mfma_f32_32x32x16_bf16 v[32:47], a[244:247], v[60:63], v[32:47]
    ds_read_b64_tr_b16 a[244:245], v4 offset:51392
    ds_read_b64_tr_b16 a[246:247], v4 offset:52416
    s_waitcnt lgkmcnt(13)
    v_mfma_f32_32x32x16_bf16 v[16:31], a[252:255], v[60:63], v[16:31]
    ds_read_b64_tr_b16 a[252:253], v124 offset:51392
    ds_read_b64_tr_b16 a[254:255], v124 offset:52416
    s_waitcnt vmcnt(2)
    v_max3_u32 v7, v96, v100, v104
    s_waitcnt vmcnt(1)
    v_max_u32 v7, v7, v108
    v_cmp_eq_u32 vcc, -1, v7
    s_cbranch_vccnz Lre82
Lok82:
    s_waitcnt lgkmcnt(13)
    v_mfma_f32_32x32x16_bf16 v[32:47], a[224:227], v[96:99], v[32:47]
    ds_read_b64_tr_b16 a[224:225], v4 offset:0
    ds_read_b64_tr_b16 a[226:227], v4 offset:1024
    s_waitcnt lgkmcnt(13)
    v_mfma_f32_32x32x16_bf16 v[16:31], a[232:235], v[96:99], v[16:31]
    ds_read_b64_tr_b16 a[232:233], v124 offset:0
    ds_read_b64_tr_b16 a[234:235], v124 offset:1024
    s_waitcnt lgkmcnt(13)
    v_mfma_f32_32x32x16_bf16 v[32:47], a[236:239], v[100:103], v[32:47]
    ds_read_b64_tr_b16 a[236:237], v4 offset:2048
    ds_read_b64_tr_b16 a[238:239], v4 offset:3072
    s_waitcnt lgkmcnt(13)
    v_mfma_f32_32x32x16_bf16 v[16:31], a[228:231], v[100:103], v[16:31]
    ds_read_b64_tr_b16 a[228:229], v124 offset:2048
    ds_read_b64_tr_b16 a[230:231], v124 offset:3072
    s_waitcnt lgkmcnt(13)
    v_mfma_f32_32x32x16_bf16 v[32:47], a[240:243], v[104:107], v[32:47]
    ds_read_b64_tr_b16 a[240:241], v4 offset:16448
    ds_read_b64_tr_b16 a[242:243], v4 offset:17472
    s_waitcnt lgkmcnt(13)
    v_mfma_f32_32x32x16_bf16 v[16:31], a[248:251], v[104:107], v[16:31]
    ds_read_b64_tr_b16 a[248:249], v124 offset:16448
    ds_read_b64_tr_b16 a[250:251], v124 offset:17472
    s_waitcnt lgkmcnt(13)
    v_mfma_f32_32x32x16_bf16 v[32:47], a[244:247], v[108:111], v[32:47]
    ds_read_b64_tr_b16 a[244:245], v4 offset:18496
    ds_read_b64_tr_b16 a[246:247], v4 offset:19520
    s_waitcnt lgkmcnt(13)
    v_mfma_f32_32x32x16_bf16 v[16:31], a[252:255], v[108:111], v[16:31]
    ds_read_b64_tr_b16 a[252:253], v124 offset:18496
    ds_read_b64_tr_b16 a[254:255], v124 offset:19520
    s_nop 5
    ds_write_b128 v122, v[32:35] offset:2048
    ds_write_b128 v122, v[36:39] offset:3072
    ds_write_b128 v123, v[40:43] offset:4096
    ds_write_b128 v123, v[44:47] offset:5120
    ds_write_b128 v121, v[24:27] offset:0
    ds_write_b128 v121, v[28:31] offset:1024
    v_lshlrev_b32 v85, 16, v8
    v_and_b32 v86, 0xffff0000, v8
    v_add_f32 v16, v16, v85
    v_add_f32 v17, v17, v86
    v_lshlrev_b32 v85, 16, v9
    v_and_b32 v86, 0xffff0000, v9
    v_add_f32 v18, v18, v85
    v_add_f32 v19, v19, v86
    v_lshlrev_b32 v85, 16, v10
    v_and_b32 v86, 0xffff0000, v10
    v_add_f32 v20, v20, v85
    v_add_f32 v21, v21, v86
    v_lshlrev_b32 v85, 16, v11
    v_and_b32 v86, 0xffff0000, v11
    v_add_f32 v22, v22, v85
    v_add_f32 v23, v23, v86
    s_waitcnt lgkmcnt(0)
    s_barrier
    ds_read_b128 v[24:27], v120 offset:0
    ds_read_b128 v[32:35], v120 offset:2048
    ds_read_b128 v[40:43], v120 offset:4096
    ds_read_b128 v[28:31], v120 offset:1024
    ds_read_b128 v[36:39], v120 offset:3072
    ds_read_b128 v[44:47], v120 offset:5120
    s_waitcnt lgkmcnt(5)
    v_add_f32 v16, v16, v24
    v_add_f32 v17, v17, v25
    v_add_f32 v18, v18, v26
    v_add_f32 v19, v19, v27
    s_waitcnt lgkmcnt(4)
    v_add_f32 v16, v16, v32
    v_add_f32 v17, v17, v33
    v_add_f32 v18, v18, v34
    v_add_f32 v19, v19, v35
    s_waitcnt lgkmcnt(3)
    v_add_f32 v16, v16, v40
    v_add_f32 v17, v17, v41
    v_add_f32 v18, v18, v42
    s_add_u32 s87, s17, 0x2308000
    buffer_load_dwordx4 v[64:67], v1, s[4:7], s87 offen sc1
    v_add_f32 v19, v19, v43
    v_cvt_pk_bf16_f32 v8, v16, v17
    v_cvt_pk_bf16_f32 v9, v18, v19
    buffer_load_dwordx4 v[68:71], v1, s[4:7], s87 offen offset:1024 sc1
    s_waitcnt lgkmcnt(2)
    v_add_f32 v20, v20, v28
    v_add_f32 v21, v21, v29
    v_add_f32 v22, v22, v30
    buffer_load_dwordx4 v[72:75], v1, s[4:7], s87 offen offset:2048 sc1
    v_add_f32 v23, v23, v31
    s_waitcnt lgkmcnt(1)
    v_add_f32 v20, v20, v36
    v_add_f32 v21, v21, v37
    buffer_load_dwordx4 v[76:79], v1, s[4:7], s87 offen offset:3072 sc1
    v_add_f32 v22, v22, v38
    v_add_f32 v23, v23, v39
    s_waitcnt lgkmcnt(0)
    v_add_f32 v20, v20, v44
    s_add_u32 s89, s17, 0x2309000
    buffer_load_dwordx4 v[48:51], v1, s[4:7], s89 offen sc1
    v_add_f32 v21, v21, v45
    v_add_f32 v22, v22, v46
    v_add_f32 v23, v23, v47
    buffer_load_dwordx4 v[52:55], v1, s[4:7], s89 offen offset:1024 sc1
    v_cvt_pk_bf16_f32 v10, v20, v21
    v_cvt_pk_bf16_f32 v11, v22, v23
    s_add_u32 s83, s16, 0x2500000
    s_bitcmp1_b32 s33, 0
    s_cbranch_scc1 Lre83
    buffer_store_dwordx4 v[8:11], v1, s[4:7], s83 offen
Lok83:
    buffer_load_dwordx4 v[56:59], v1, s[4:7], s89 offen offset:2048 sc1
    v_dot2_f32_bf16 v32, v8, s52, 0
    v_dot2_f32_bf16 v33, v8, v8, 0
    buffer_load_dwordx4 v[60:63], v1, s[4:7], s89 offen offset:3072 sc1
    v_dot2_f32_bf16 v32, v9, s52, v32
    v_dot2_f32_bf16 v33, v9, v9, v33
    v_dot2_f32_bf16 v32, v10, s52, v32
    v_dot2_f32_bf16 v33, v10, v10, v33
    v_dot2_f32_bf16 v32, v11, s52, v32
    v_dot2_f32_bf16 v33, v11, v11, v33
    s_nop 2
    v_permlane32_swap_b32 v32, v33
    v_add_f32 v32, v32, v33
    ds_write_b32 v126, v32 offset:24576
    s_waitcnt lgkmcnt(0)
    s_barrier
    ds_read_b128 v[36:39], v125 offset:24576
    s_waitcnt lgkmcnt(0)
    v_add_f32 v36, v36, v37
    v_add_f32 v38, v38, v39
    v_add_f32 v36, v36, v38
    s_mov_b64 exec, s[50:51]
    s_add_u32 s91, s18, 0x660000
    s_bitcmp1_b32 s33, 0
    s_cbranch_scc1 Lre84
    buffer_store_dword v36, v127, s[4:7], s91 offen
Lok84:
    s_mov_b64 exec, -1
    s_waitcnt vmcnt(7)
    v_max3_u32 v7, v64, v68, v72
    s_waitcnt vmcnt(6)
    v_max_u32 v7, v7, v76
    v_cmp_eq_u32 vcc, -1, v7
    s_cbranch_vccnz Lre85
Lok85:
    v_mfma_f32_32x32x16_bf16 v[32:47], a[224:227], v[64:67], 0
    ds_read_b64_tr_b16 a[224:225], v4 offset:32896
    ds_read_b64_tr_b16 a[226:227], v4 offset:33920
    s_mov_b32 m0, s22
    s_add_u32 s84, s21, 0x2500000
    buffer_load_dwordx4 v1, s[4:7], s84 offen sc1 lds
    v_mfma_f32_32x32x16_bf16 v[96:111], a[232:235], v[64:67], 0
    ds_read_b64_tr_b16 a[232:233], v124 offset:32896
    ds_read_b64_tr_b16 a[234:235], v124 offset:33920
    v_mfma_f32_32x32x16_bf16 v[32:47], a[236:239], v[68:71], v[32:47]
    ds_read_b64_tr_b16 a[236:237], v4 offset:34944
    ds_read_b64_tr_b16 a[238:239], v4 offset:35968
    buffer_load_dwordx4 v1, s[4:7], s84 offen offset:1024 sc1 lds
    v_mfma_f32_32x32x16_bf16 v[96:111], a[228:231], v[68:71], v[96:111]
    ds_read_b64_tr_b16 a[228:229], v124 offset:34944
    ds_read_b64_tr_b16 a[230:231], v124 offset:35968
    v_mfma_f32_32x32x16_bf16 v[32:47], a[240:243], v[72:75], v[32:47]
    ds_read_b64_tr_b16 a[240:241], v4 offset:49344
    ds_read_b64_tr_b16 a[242:243], v4 offset:50368
    buffer_load_dwordx4 v1, s[4:7], s84 offen offset:2048 sc1 lds
    v_mfma_f32_32x32x16_bf16 v[96:111], a[248:251], v[72:75], v[96:111]
    ds_read_b64_tr_b16 a[248:249], v124 offset:49344
    ds_read_b64_tr_b16 a[250:251], v124 offset:50368
    v_mfma_f32_32x32x16_bf16 v[32:47], a[244:247], v[76:79], v[32:47]
    ds_read_b64_tr_b16 a[244:245], v4 offset:51392
    ds_read_b64_tr_b16 a[246:247], v4 offset:52416
    buffer_load_dwordx4 v1, s[4:7], s84 offen offset:3072 sc1 lds
    v_mfma_f32_32x32x16_bf16 v[96:111], a[252:255], v[76:79], v[96:111]
    ds_read_b64_tr_b16 a[252:253], v124 offset:51392
    ds_read_b64_tr_b16 a[254:255], v124 offset:52416
    s_waitcnt vmcnt(6)
    v_max3_u32 v7, v48, v52, v56
    s_waitcnt vmcnt(5)
    v_max_u32 v7, v7, v60
    v_cmp_eq_u32 vcc, -1, v7
    s_cbranch_vccnz Lre86
Lok86:
    s_waitcnt lgkmcnt(13)
    v_mfma_f32_32x32x16_bf16 v[32:47], a[224:227], v[48:51], v[32:47]
    s_add_u32 m0, s22, 0x4040
    s_add_u32 s90, s21, 0x2504000
    buffer_load_dwordx4 v1, s[4:7], s90 offen sc1 lds
    s_waitcnt lgkmcnt(11)
    v_mfma_f32_32x32x16_bf16 v[96:111], a[232:235], v[48:51], v[96:111]
    s_waitcnt lgkmcnt(9)
    v_mfma_f32_32x32x16_bf16 v[32:47], a[236:239], v[52:55], v[32:47]
    buffer_load_dwordx4 v1, s[4:7], s90 offen offset:1024 sc1 lds
    s_waitcnt lgkmcnt(7)
    v_mfma_f32_32x32x16_bf16 v[96:111], a[228:231], v[52:55], v[96:111]
    s_waitcnt lgkmcnt(5)
    v_mfma_f32_32x32x16_bf16 v[32:47], a[240:243], v[56:59], v[32:47]
    buffer_load_dwordx4 v1, s[4:7], s90 offen offset:2048 sc1 lds
    s_waitcnt lgkmcnt(4)
    v_mfma_f32_32x32x16_bf16 v[96:111], a[248:251], v[56:59], v[96:111]
    s_waitcnt lgkmcnt(2)
    v_mfma_f32_32x32x16_bf16 v[32:47], a[244:247], v[60:63], v[32:47]
    buffer_load_dwordx4 v1, s[4:7], s90 offen offset:3072 sc1 lds
    s_waitcnt lgkmcnt(0)
    v_mfma_f32_32x32x16_bf16 v[96:111], a[252:255], v[60:63], v[96:111]
    s_nop 8
    ds_write_b128 v122, v[32:35] offset:2048
    ds_write_b128 v122, v[36:39] offset:3072
    ds_write_b128 v123, v[40:43] offset:4096
    ds_write_b128 v123, v[44:47] offset:5120
    ds_write_b128 v121, v[104:107] offset:0
    ds_write_b128 v121, v[108:111] offset:1024
    s_add_u32 m0, s22, 0x8080
    s_add_u32 s81, s21, 0x2510000
    buffer_load_dwordx4 v1, s[4:7], s81 offen sc1 lds
    v_lshlrev_b32 v85, 16, v12
    v_and_b32 v86, 0xffff0000, v12
    v_add_f32 v96, v96, v85
    buffer_load_dwordx4 v1, s[4:7], s81 offen offset:1024 sc1 lds
    v_add_f32 v97, v97, v86
    v_lshlrev_b32 v85, 16, v13
    v_and_b32 v86, 0xffff0000, v13
    buffer_load_dwordx4 v1, s[4:7], s81 offen offset:2048 sc1 lds
    v_add_f32 v98, v98, v85
    v_add_f32 v99, v99, v86
    v_lshlrev_b32 v85, 16, v14
    buffer_load_dwordx4 v1, s[4:7], s81 offen offset:3072 sc1 lds
    v_and_b32 v86, 0xffff0000, v14
    v_add_f32 v100, v100, v85
    v_add_f32 v101, v101, v86
    s_add_u32 m0, s22, 0xc0c0
    s_add_u32 s86, s21, 0x2514000
    buffer_load_dwordx4 v1, s[4:7], s86 offen sc1 lds
    v_lshlrev_b32 v85, 16, v15
    v_and_b32 v86, 0xffff0000, v15
    v_add_f32 v102, v102, v85
    buffer_load_dwordx4 v1, s[4:7], s86 offen offset:1024 sc1 lds
    v_add_f32 v103, v103, v86
    s_waitcnt lgkmcnt(0)
    s_barrier
    ds_read_b128 v[104:107], v120 offset:0
    buffer_load_dwordx4 v1, s[4:7], s86 offen offset:2048 sc1 lds
    ds_read_b128 v[32:35], v120 offset:2048
    ds_read_b128 v[40:43], v120 offset:4096
    ds_read_b128 v[108:111], v120 offset:1024
    buffer_load_dwordx4 v1, s[4:7], s86 offen offset:3072 sc1 lds
    ds_read_b128 v[36:39], v120 offset:3072
    ds_read_b128 v[44:47], v120 offset:5120
    s_waitcnt lgkmcnt(5)
    v_add_f32 v96, v96, v104
    v_add_f32 v97, v97, v105
    v_add_f32 v98, v98, v106
    v_add_f32 v99, v99, v107
    s_waitcnt lgkmcnt(4)
    v_add_f32 v96, v96, v32
    v_add_f32 v97, v97, v33
    v_add_f32 v98, v98, v34
    v_add_f32 v99, v99, v35
    s_waitcnt lgkmcnt(3)
    v_add_f32 v96, v96, v40
    v_add_f32 v97, v97, v41
    v_add_f32 v98, v98, v42
    v_add_f32 v99, v99, v43
    v_cvt_pk_bf16_f32 v12, v96, v97
    v_cvt_pk_bf16_f32 v13, v98, v99
    s_waitcnt lgkmcnt(2)
    v_add_f32 v100, v100, v108
    v_add_f32 v101, v101, v109
    v_add_f32 v102, v102, v110
    v_add_f32 v103, v103, v111
    s_waitcnt lgkmcnt(1)
    v_add_f32 v100, v100, v36
    v_add_f32 v101, v101, v37
    v_add_f32 v102, v102, v38
    v_add_f32 v103, v103, v39
    s_waitcnt lgkmcnt(0)
    v_add_f32 v100, v100, v44
    v_add_f32 v101, v101, v45
    v_add_f32 v102, v102, v46
    v_add_f32 v103, v103, v47
    v_cvt_pk_bf16_f32 v14, v100, v101
    v_cvt_pk_bf16_f32 v15, v102, v103
    s_add_u32 s82, s16, 0x2508000
    s_bitcmp1_b32 s33, 0
    s_cbranch_scc1 Lre87
    buffer_store_dwordx4 v[12:15], v1, s[4:7], s82 offen
Lok87:
    v_and_b32 v47, 512, v1
    v_mad_u32_u24 v47, v47, 7, v1
    s_add_u32 s88, s19, 0x660000
    buffer_load_dwordx4 v[64:67], v47, s[4:7], s88 offen sc1
    v_dot2_f32_bf16 v32, v12, s52, 0
    v_dot2_f32_bf16 v33, v12, v12, 0
    v_dot2_f32_bf16 v32, v13, s52, v32
    buffer_load_dwordx4 v[68:71], v47, s[4:7], s88 offen offset:512 sc1
    v_dot2_f32_bf16 v33, v13, v13, v33
    v_dot2_f32_bf16 v32, v14, s52, v32
    v_dot2_f32_bf16 v33, v14, v14, v33
    buffer_load_dwordx4 v[72:75], v47, s[4:7], s88 offen offset:1024 sc1
    v_dot2_f32_bf16 v32, v15, s52, v32
    v_dot2_f32_bf16 v33, v15, v15, v33
    s_nop 2
    v_permlane32_swap_b32 v32, v33
    buffer_load_dwordx4 v[76:79], v47, s[4:7], s88 offen offset:1536 sc1
    v_add_f32 v32, v32, v33
    ds_write_b32 v126, v32 offset:25600
    s_waitcnt lgkmcnt(0)
    s_barrier
    ds_read_b128 v[36:39], v125 offset:25600
    s_waitcnt lgkmcnt(0)
    v_add_f32 v36, v36, v37
    v_add_f32 v38, v38, v39
    v_add_f32 v36, v36, v38
    s_mov_b64 exec, s[50:51]
    s_bitcmp1_b32 s33, 0
    s_cbranch_scc1 Lre88
    buffer_store_dword v36, v127, s[4:7], s91 offen offset:2048
Lok88:
    s_mov_b64 exec, -1
    v_xor_b32 v80, 512, v1
    s_mov_b32 s85, s38
    buffer_load_dwordx4 a[248:251], v1, s[4:7], s85 offen
    buffer_load_dwordx4 a[252:255], v80, s[4:7], s85 offen
    v_add_u32 v108, 0x0, v6
    s_waitcnt vmcnt(20)
    ds_read2st64_b32 v[104:105], v108 offset0:0 offset1:4
    ds_read2st64_b32 v[106:107], v108 offset0:8 offset1:12
    v_add_u32 v86, 0x4040, v6
    s_waitcnt vmcnt(16)
    ds_read2st64_b32 v[82:83], v86 offset0:0 offset1:4
    ds_read2st64_b32 v[84:85], v86 offset0:8 offset1:12
    s_waitcnt lgkmcnt(2)
    v_max3_u32 v7, v104, v105, v106
    v_max_u32 v7, v7, v107
    v_cmp_eq_u32 vcc, -1, v7
    s_cbranch_vccnz Lre89
Lok89:
    s_waitcnt lgkmcnt(0)
    v_max3_u32 v7, v82, v83, v84
    v_max_u32 v7, v7, v85
    v_cmp_eq_u32 vcc, -1, v7
    s_cbranch_vccnz Lre90
Lok90:
    s_barrier
    ds_read_b128 a[224:227], v1 offset:0
    ds_read_b128 a[228:231], v1 offset:1024
    ds_read_b128 a[232:235], v1 offset:2048
    ds_read_b128 a[236:239], v1 offset:3072
    ds_read_b128 a[240:243], v1 offset:4112
    ds_read_b128 a[244:247], v1 offset:5136
    s_waitcnt lgkmcnt(4)
    v_mfma_f32_32x32x16_bf16 v[16:31], v[128:131], a[224:227], 0
    ds_read_b128 a[224:227], v1 offset:6160
    v_mfma_f32_32x32x16_bf16 v[16:31], v[132:135], a[228:231], v[16:31]
    ds_read_b128 a[228:231], v1 offset:7184
    s_waitcnt lgkmcnt(4)
    v_mfma_f32_32x32x16_bf16 v[16:31], v[136:139], a[232:235], v[16:31]
    ds_read_b128 a[232:235], v1 offset:8224
    v_mfma_f32_32x32x16_bf16 v[16:31], v[140:143], a[236:239], v[16:31]
    ds_read_b128 a[236:239], v1 offset:9248
    s_waitcnt lgkmcnt(4)
    v_mfma_f32_32x32x16_bf16 v[16:31], v[144:147], a[240:243], v[16:31]
    ds_read_b128 a[240:243], v1 offset:10272
    s_waitcnt vmcnt(6)
    v_max3_u32 v7, v64, v65, v66
    s_waitcnt vmcnt(5)
    v_max3_u32 v7, v7, v67, v68
    v_max3_u32 v7, v7, v69, v70
    s_waitcnt vmcnt(4)
    v_max3_u32 v7, v7, v71, v72
    v_max3_u32 v7, v7, v73, v74
    s_waitcnt vmcnt(3)
    v_max3_u32 v7, v7, v75, v76
    v_max3_u32 v7, v7, v77, v78
    v_max_u32 v7, v7, v79
    v_cmp_eq_u32 vcc, -1, v7
    s_cbranch_vccnz Lre91
Lok91:
    v_mfma_f32_32x32x16_bf16 v[16:31], v[148:151], a[244:247], v[16:31]
    ds_read_b128 a[244:247], v1 offset:11296
    v_add_f32 v64, v64, v72
    v_add_f32 v65, v65, v73
    v_add_f32 v66, v66, v74
    v_add_f32 v67, v67, v75
    s_waitcnt lgkmcnt(4)
    v_mfma_f32_32x32x16_bf16 v[16:31], v[152:155], a[224:227], v[16:31]
    ds_read_b128 a[224:227], v1 offset:12336
    v_add_f32 v68, v68, v76
    v_add_f32 v69, v69, v77
    v_add_f32 v70, v70, v78
    v_add_f32 v71, v71, v79
    v_mfma_f32_32x32x16_bf16 v[16:31], v[156:159], a[228:231], v[16:31]
    ds_read_b128 a[228:231], v1 offset:13360
    v_add_f32 v64, v64, v68
    v_add_f32 v65, v65, v69
    v_add_f32 v66, v66, v70
    v_add_f32 v67, v67, v71
    s_waitcnt lgkmcnt(4)
    v_mfma_f32_32x32x16_bf16 v[16:31], v[160:163], a[232:235], v[16:31]
    ds_read_b128 a[232:235], v1 offset:14384
    v_add_f32 v64, v64, v66
    v_add_f32 v65, v65, v67
    v_mul_f32 v64, 0xbb000000, v64
    v_mul_f32 v65, 0x3b000000, v65
    v_mfma_f32_32x32x16_bf16 v[16:31], v[164:167], a[236:239], v[16:31]
    ds_read_b128 a[236:239], v1 offset:15408
    v_fma_f32 v65, -v64, v64, v65
    v_max_f32 v65, 0, v65
    v_add_f32 v68, 0x3727c5ac, v65
    s_waitcnt lgkmcnt(4)
    v_mfma_f32_32x32x16_bf16 v[16:31], v[168:171], a[240:243], v[16:31]
    ds_read_b128 a[240:243], v1 offset:16448
    v_rsq_f32 v66, v68
    v_cvt_pk_bf16_f32 v32, v64, v64
    v_mul_f32 v68, v66, v66
    v_mfma_f32_32x32x16_bf16 v[16:31], v[172:175], a[244:247], v[16:31]
    ds_read_b128 a[244:247], v1 offset:17472
    v_mul_f32 v68, v68, v65
    v_add_f32 v68, 0x3727c5ac, v68
    v_rsq_f32 v68, v68
    s_waitcnt lgkmcnt(4)
    v_mfma_f32_32x32x16_bf16 v[16:31], v[176:179], a[224:227], v[16:31]
    ds_read_b128 a[224:227], v1 offset:18496
    v_lshlrev_b32 v69, 16, v32
    v_mul_f32 v66, v66, v68
    v_rcp_f32 v67, v66
    v_mfma_f32_32x32x16_bf16 v[16:31], v[180:183], a[228:231], v[16:31]
    ds_read_b128 a[228:231], v1 offset:19520
    v_sub_f32 v69, v64, v69
    v_cvt_pk_bf16_f32 v70, v66, v66
    v_cvt_pk_bf16_f32 v33, v69, v67
    v_lshlrev_b32 v70, 16, v70
    s_waitcnt lgkmcnt(4)
    v_mfma_f32_32x32x16_bf16 v[16:31], v[184:187], a[232:235], v[16:31]
    ds_read_b128 a[232:235], v1 offset:20560
    v_and_b32 v69, 0xffff0000, v33
    v_sub_f32 v70, v66, v70
    v_sub_f32 v69, v67, v69
    v_cvt_pk_bf16_f32 v35, v66, v70
    v_mfma_f32_32x32x16_bf16 v[16:31], v[188:191], a[236:239], v[16:31]
    ds_read_b128 a[236:239], v1 offset:21584
    v_cvt_pk_bf16_f32 v34, v69, 0
    v_mul_f32 v68, v66, v66
    v_mul_f32 v36, 0xc0135761, v66
    v_mul_f32 v39, 0xc0135761, v66
    s_waitcnt lgkmcnt(4)
    v_mfma_f32_32x32x16_bf16 v[16:31], v[192:195], a[240:243], v[16:31]
    ds_read_b128 a[240:243], v1 offset:22608
    v_mul_f32 v68, v68, v66
    v_mov_b32 v38, v67
    v_mov_b32 v41, v67
    v_mul_f32 v37, 0xbdd2d3e8, v68
    v_mfma_f32_32x32x16_bf16 v[16:31], v[196:199], a[244:247], v[16:31]
    ds_read_b128 a[244:247], v1 offset:23632
    v_mul_f32 v40, 0xbdd2d3e8, v68
    v_permlane32_swap_b32 v36, v39
    s_waitcnt lgkmcnt(4)
    v_mfma_f32_32x32x16_bf16 v[16:31], v[200:203], a[224:227], v[16:31]
    ds_read_b128 a[224:227], v1 offset:24672
    v_permlane32_swap_b32 v38, v41
    v_permlane32_swap_b32 v37, v40
    v_mfma_f32_32x32x16_bf16 v[16:31], v[204:207], a[228:231], v[16:31]
    ds_read_b128 a[228:231], v1 offset:25696
    s_waitcnt lgkmcnt(4)
    v_mfma_f32_32x32x16_bf16 v[16:31], v[208:211], a[232:235], v[16:31]
    ds_read_b128 a[232:235], v1 offset:26720
    v_add_u32 v46, 0x8080, v6
    ds_read2st64_b32 v[42:43], v46 offset0:0 offset1:4
    ds_read2st64_b32 v[44:45], v46 offset0:8 offset1:12
    s_add_u32 m0, s22, 0x10100
    s_add_u32 s80, s21, 0x2508000
    buffer_load_dwordx4 v1, s[4:7], s80 offen sc1 lds
    v_mfma_f32_32x32x16_bf16 v[16:31], v[212:215], a[236:239], v[16:31]
    ds_read_b128 a[236:239], v1 offset:27744
    v_add_u32 v110, 0xc0c0, v6
    ds_read2st64_b32 v[106:107], v110 offset0:0 offset1:4
    s_waitcnt lgkmcnt(7)
    v_mfma_f32_32x32x16_bf16 v[16:31], v[216:219], a[240:243], v[16:31]
    ds_read_b128 a[240:243], v1 offset:28784
PAD20:
    s_cbranch_execz WARM1_8
    ds_read2st64_b32 v[108:109], v110 offset0:8 offset1:12
    buffer_load_dwordx4 v1, s[4:7], s80 offen offset:1024 sc1 lds
    v_mfma_f32_32x32x16_bf16 v[16:31], v[220:223], a[244:247], v[16:31]
    ds_read_b128 a[244:247], v1 offset:29808
    s_waitcnt lgkmcnt(8)
    v_mfma_f32_32x32x16_bf16 v[16:31], v[224:227], a[224:227], v[16:31]
    ds_read_b128 a[224:227], v1 offset:30832
    s_waitcnt lgkmcnt(6)
    v_max3_u32 v7, v42, v43, v44
    v_max_u32 v7, v7, v45
    v_cmp_eq_u32 vcc, -1, v7
    s_cbranch_vccnz Lre92
Lok92:
    buffer_load_dwordx4 v1, s[4:7], s80 offen offset:2048 sc1 lds
    v_mfma_f32_32x32x16_bf16 v[16:31], v[228:231], a[228:231], v[16:31]
    ds_read_b128 a[228:231], v1 offset:31856
    s_waitcnt lgkmcnt(3)
    v_max3_u32 v7, v106, v107, v108
    v_max_u32 v7, v7, v109
    v_cmp_eq_u32 vcc, -1, v7
    s_cbranch_vccnz Lre93
Lok93:
    s_barrier
    v_mfma_f32_32x32x16_bf16 v[16:31], v[232:235], a[232:235], v[16:31]
    ds_read_b128 a[232:235], v1 offset:32896
    buffer_load_dwordx4 v1, s[4:7], s80 offen offset:3072 sc1 lds
    v_mfma_f32_32x32x16_bf16 v[16:31], v[236:239], a[236:239], v[16:31]
    ds_read_b128 a[236:239], v1 offset:33920
    v_mfma_f32_32x32x16_bf16 v[16:31], v[240:243], a[240:243], v[16:31]
    ds_read_b128 a[240:243], v1 offset:34944
    s_add_u32 m0, s22, 0x14140
    s_add_u32 s87, s21, 0x250c000
    buffer_load_dwordx4 v1, s[4:7], s87 offen sc1 lds
    s_waitcnt vmcnt(6)
    v_mfma_f32_32x32x16_bf16 v[16:31], a[248:251], v[32:35], v[16:31]
    s_waitcnt lgkmcnt(4)
    v_mfma_f32_32x32x16_bf16 v[16:31], v[244:247], a[244:247], v[16:31]
    ds_read_b128 a[244:247], v1 offset:35968
    buffer_load_dwordx4 v1, s[4:7], s87 offen offset:1024 sc1 lds
    v_mfma_f32_32x32x16_bf16 v[16:31], v[248:251], a[224:227], v[16:31]
    ds_read_b128 a[224:227], v1 offset:37008
    s_waitcnt lgkmcnt(4)
    v_mfma_f32_32x32x16_bf16 v[16:31], v[252:255], a[228:231], v[16:31]
    ds_read_b128 a[228:231], v1 offset:38032
    buffer_load_dwordx4 v1, s[4:7], s87 offen offset:2048 sc1 lds
    v_mfma_f32_32x32x16_bf16 v[48:63], v[128:131], a[232:235], 0
    ds_read_b128 a[232:235], v1 offset:39056
    s_waitcnt lgkmcnt(4)
    v_mfma_f32_32x32x16_bf16 v[48:63], v[132:135], a[236:239], v[48:63]
    ds_read_b128 a[236:239], v1 offset:40080
    s_barrier
    buffer_load_dwordx4 v1, s[4:7], s87 offen offset:3072 sc1 lds
    s_nop 2
    v_mul_f32 v80, v16, v16
    v_mul_f32 v81, v17, v17
    v_mul_f32 v82, v18, v18
    v_mfma_f32_32x32x16_bf16 v[48:63], v[136:139], a[240:243], v[48:63]
    ds_read_b128 a[240:243], v1 offset:41120
    v_mul_f32 v83, v19, v19
    v_mul_f32 v84, v20, v20
    v_mul_f32 v85, v21, v21
    v_mul_f32 v86, v22, v22
    v_mul_f32 v87, v23, v23
    v_fma_f32 v80, v80, v37, v36
    v_fma_f32 v81, v81, v37, v36
    s_waitcnt lgkmcnt(4)
    v_mfma_f32_32x32x16_bf16 v[48:63], v[140:143], a[244:247], v[48:63]
    ds_read_b128 a[244:247], v1 offset:42144
    s_mov_b32 m0, s22
    s_add_u32 s83, s21, 0x2518000
    buffer_load_dwordx4 v1, s[4:7], s83 offen sc1 lds
    v_fma_f32 v82, v82, v37, v36
    v_fma_f32 v83, v83, v37, v36
    v_fma_f32 v84, v84, v37, v36
    v_fma_f32 v85, v85, v37, v36
    v_mfma_f32_32x32x16_bf16 v[48:63], v[144:147], a[224:227], v[48:63]
    ds_read_b128 a[224:227], v1 offset:43168
    v_fma_f32 v86, v86, v37, v36
    v_fma_f32 v87, v87, v37, v36
    v_mul_f32 v80, v80, v16
    v_mul_f32 v81, v81, v17
    v_mul_f32 v82, v82, v18
    v_mul_f32 v83, v83, v19
    v_mul_f32 v84, v84, v20
    s_waitcnt lgkmcnt(4)
    v_mfma_f32_32x32x16_bf16 v[48:63], v[148:151], a[228:231], v[48:63]
    ds_read_b128 a[228:231], v1 offset:44192
    buffer_load_dwordx4 v1, s[4:7], s83 offen offset:1024 sc1 lds
    v_mul_f32 v85, v85, v21
    v_mul_f32 v86, v86, v22
    v_mul_f32 v87, v87, v23
    v_mfma_f32_32x32x16_bf16 v[48:63], v[152:155], a[232:235], v[48:63]
    ds_read_b128 a[232:235], v1 offset:45232
    v_exp_f32 v80, v80
    v_exp_f32 v81, v81
    v_exp_f32 v82, v82
    s_waitcnt lgkmcnt(4)
    v_mfma_f32_32x32x16_bf16 v[48:63], v[156:159], a[236:239], v[48:63]
    ds_read_b128 a[236:239], v1 offset:46256
    buffer_load_dwordx4 v1, s[4:7], s83 offen offset:2048 sc1 lds
    v_exp_f32 v83, v83
    v_exp_f32 v84, v84
    v_mfma_f32_32x32x16_bf16 v[48:63], v[160:163], a[240:243], v[48:63]
    ds_read_b128 a[240:243], v1 offset:47280
    v_exp_f32 v85, v85
    v_exp_f32 v86, v86
    v_exp_f32 v87, v87
    v_fma_f32 v80, v80, v38, v38
    s_waitcnt lgkmcnt(4)
    v_mfma_f32_32x32x16_bf16 v[48:63], v[164:167], a[244:247], v[48:63]
    ds_read_b128 a[244:247], v1 offset:48304
    buffer_load_dwordx4 v1, s[4:7], s83 offen offset:3072 sc1 lds
    v_fma_f32 v81, v81, v38, v38
    v_fma_f32 v82, v82, v38, v38
    v_fma_f32 v83, v83, v38, v38
    v_fma_f32 v84, v84, v38, v38
    v_mfma_f32_32x32x16_bf16 v[48:63], v[168:171], a[224:227], v[48:63]
    ds_read_b128 a[224:227], v1 offset:49344
    v_fma_f32 v85, v85, v38, v38
    v_fma_f32 v86, v86, v38, v38
    v_fma_f32 v87, v87, v38, v38
    v_rcp_f32 v80, v80
    v_rcp_f32 v81, v81
    s_waitcnt lgkmcnt(4)
    v_mfma_f32_32x32x16_bf16 v[48:63], v[172:175], a[228:231], v[48:63]
    ds_read_b128 a[228:231], v1 offset:50368
    s_add_u32 m0, s22, 0x4040
    s_add_u32 s89, s21, 0x251c000
    buffer_load_dwordx4 v1, s[4:7], s89 offen sc1 lds
    v_rcp_f32 v82, v82
    v_rcp_f32 v83, v83
    v_mfma_f32_32x32x16_bf16 v[48:63], v[176:179], a[232:235], v[48:63]
    ds_read_b128 a[232:235], v1 offset:51392
    v_rcp_f32 v84, v84
    v_rcp_f32 v85, v85
    v_rcp_f32 v86, v86
    s_waitcnt lgkmcnt(4)
    v_mfma_f32_32x32x16_bf16 v[48:63], v[180:183], a[236:239], v[48:63]
    ds_read_b128 a[236:239], v1 offset:52416
    buffer_load_dwordx4 v1, s[4:7], s89 offen offset:1024 sc1 lds
    v_rcp_f32 v87, v87
    v_mul_f32 v80, v80, v16
    v_mul_f32 v81, v81, v17
    v_mfma_f32_32x32x16_bf16 v[48:63], v[184:187], a[240:243], v[48:63]
    ds_read_b128 a[240:243], v1 offset:53456
    v_mul_f32 v82, v82, v18
    v_mul_f32 v83, v83, v19
    v_mul_f32 v84, v84, v20
    v_mul_f32 v85, v85, v21
    v_mul_f32 v86, v86, v22
    v_mul_f32 v87, v87, v23
    v_cvt_pk_bf16_f32 v16, v80, v81
    s_waitcnt lgkmcnt(4)
    v_mfma_f32_32x32x16_bf16 v[48:63], v[188:191], a[244:247], v[48:63]
    ds_read_b128 a[244:247], v1 offset:54480
    buffer_load_dwordx4 v1, s[4:7], s89 offen offset:2048 sc1 lds
    v_cvt_pk_bf16_f32 v17, v82, v83
    v_cvt_pk_bf16_f32 v18, v84, v85
    v_cvt_pk_bf16_f32 v19, v86, v87
    v_mfma_f32_32x32x16_bf16 v[48:63], v[192:195], a[224:227], v[48:63]
    ds_read_b128 a[224:227], v1 offset:55504
    s_add_u32 s84, s23, 0x2700000
    s_bitcmp1_b32 s33, 0
    s_cbranch_scc1 Lre94
    buffer_store_dwordx4 v[16:19], v1, s[4:7], s84 offen
Lok94:
    v_mul_f32 v80, v24, v24
    v_mul_f32 v81, v25, v25
    s_waitcnt lgkmcnt(4)
    v_mfma_f32_32x32x16_bf16 v[48:63], v[196:199], a[228:231], v[48:63]
    ds_read_b128 a[228:231], v1 offset:56528
    buffer_load_dwordx4 v1, s[4:7], s89 offen offset:3072 sc1 lds
    v_mul_f32 v82, v26, v26
    v_mul_f32 v83, v27, v27
    v_mul_f32 v84, v28, v28
    v_mul_f32 v85, v29, v29
    v_mfma_f32_32x32x16_bf16 v[48:63], v[200:203], a[232:235], v[48:63]
    ds_read_b128 a[232:235], v1 offset:57568
    v_mul_f32 v86, v30, v30
    v_mul_f32 v87, v31, v31
    v_fma_f32 v80, v80, v37, v36
    v_fma_f32 v81, v81, v37, v36
    v_fma_f32 v82, v82, v37, v36
    v_fma_f32 v83, v83, v37, v36
    v_fma_f32 v84, v84, v37, v36
    s_waitcnt lgkmcnt(4)
    v_mfma_f32_32x32x16_bf16 v[48:63], v[204:207], a[236:239], v[48:63]
    ds_read_b128 a[236:239], v1 offset:58592
    buffer_load_dwordx4 v[64:67], v47, s[4:7], s88 offen offset:2048 sc1
    v_fma_f32 v85, v85, v37, v36
    v_fma_f32 v86, v86, v37, v36
    v_fma_f32 v87, v87, v37, v36
    v_mul_f32 v80, v80, v24
    v_mfma_f32_32x32x16_bf16 v[48:63], v[208:211], a[240:243], v[48:63]
    ds_read_b128 a[240:243], v1 offset:59616
    v_add_u32 v46, 0x10100, v6
    s_waitcnt vmcnt(14)
    ds_read2st64_b32 v[42:43], v46 offset0:0 offset1:4
    ds_read2st64_b32 v[44:45], v46 offset0:8 offset1:12
    v_mul_f32 v81, v81, v25
    v_mul_f32 v82, v82, v26
    v_mul_f32 v83, v83, v27
    s_waitcnt lgkmcnt(6)
    v_mfma_f32_32x32x16_bf16 v[48:63], v[212:215], a[244:247], v[48:63]
    ds_read_b128 a[244:247], v1 offset:60640
    v_add_u32 v110, 0x14140, v6
    s_waitcnt vmcnt(10)
    ds_read2st64_b32 v[106:107], v110 offset0:0 offset1:4
    buffer_load_dwordx4 v[68:71], v47, s[4:7], s88 offen offset:2560 sc1
    v_mul_f32 v84, v84, v28
    v_mfma_f32_32x32x16_bf16 v[48:63], v[216:219], a[224:227], v[48:63]
    ds_read_b128 a[224:227], v1 offset:61680
    ds_read2st64_b32 v[108:109], v110 offset0:8 offset1:12
    v_mul_f32 v85, v85, v29
    v_mul_f32 v86, v86, v30
    v_mul_f32 v87, v87, v31
    v_exp_f32 v80, v80
    s_waitcnt lgkmcnt(8)
    v_mfma_f32_32x32x16_bf16 v[48:63], v[220:223], a[228:231], v[48:63]
    ds_read_b128 a[228:231], v1 offset:62704
    buffer_load_dwordx4 v[72:75], v47, s[4:7], s88 offen offset:3072 sc1
    v_exp_f32 v81, v81
    v_exp_f32 v82, v82
    v_mfma_f32_32x32x16_bf16 v[48:63], v[224:227], a[232:235], v[48:63]
    ds_read_b128 a[232:235], v1 offset:63728
    s_waitcnt lgkmcnt(6)
    v_max3_u32 v7, v42, v43, v44
    v_max_u32 v7, v7, v45
    v_cmp_eq_u32 vcc, -1, v7
    s_cbranch_vccnz Lre95
Lok95:
    v_exp_f32 v83, v83
    v_mfma_f32_32x32x16_bf16 v[48:63], v[228:231], a[236:239], v[48:63]
    ds_read_b128 a[236:239], v1 offset:64752
    s_waitcnt lgkmcnt(3)
    v_max3_u32 v7, v106, v107, v108
    v_max_u32 v7, v7, v109
    v_cmp_eq_u32 vcc, -1, v7
    s_cbranch_vccnz Lre96
Lok96:
    s_barrier
    buffer_load_dwordx4 v[76:79], v47, s[4:7], s88 offen offset:3584 sc1
    v_mfma_f32_32x32x16_bf16 v[48:63], v[232:235], a[240:243], v[48:63]
    ds_read_b128 a[240:243], v2 offset:256
    v_exp_f32 v84, v84
    v_exp_f32 v85, v85
    v_exp_f32 v86, v86
    v_mfma_f32_32x32x16_bf16 v[48:63], v[236:239], a[244:247], v[48:63]
    ds_read_b128 a[244:247], v2 offset:1280
    v_exp_f32 v87, v87
    v_fma_f32 v80, v80, v38, v38
    v_fma_f32 v81, v81, v38, v38
    v_fma_f32 v82, v82, v38, v38
    v_fma_f32 v83, v83, v38, v38
    v_fma_f32 v84, v84, v38, v38
    v_mfma_f32_32x32x16_bf16 v[48:63], v[240:243], a[224:227], v[48:63]
    ds_read_b128 a[224:227], v2 offset:2304
    v_fma_f32 v85, v85, v38, v38
    v_fma_f32 v86, v86, v38, v38
    v_fma_f32 v87, v87, v38, v38
    v_rcp_f32 v80, v80
    v_rcp_f32 v81, v81
    v_mfma_f32_32x32x16_bf16 v[48:63], a[252:255], v[32:35], v[48:63]
    v_rcp_f32 v82, v82
    v_rcp_f32 v83, v83
    v_rcp_f32 v84, v84
    v_rcp_f32 v85, v85
    s_waitcnt lgkmcnt(4)
    v_mfma_f32_32x32x16_bf16 v[48:63], v[244:247], a[228:231], v[48:63]
    ds_read_b128 a[228:231], v2 offset:3328
    v_rcp_f32 v86, v86
    v_rcp_f32 v87, v87
    v_mul_f32 v80, v80, v24
    v_mul_f32 v81, v81, v25
    v_mul_f32 v82, v82, v26
    v_mfma_f32_32x32x16_bf16 v[48:63], v[248:251], a[232:235], v[48:63]
    ds_read_b128 a[232:235], v2 offset:4368
    v_mul_f32 v83, v83, v27
    v_mul_f32 v84, v84, v28
    v_mul_f32 v85, v85, v29
    v_mul_f32 v86, v86, v30
    v_mul_f32 v87, v87, v31
    v_cvt_pk_bf16_f32 v24, v80, v81
    v_cvt_pk_bf16_f32 v25, v82, v83
    s_waitcnt lgkmcnt(4)
    v_mfma_f32_32x32x16_bf16 v[48:63], v[252:255], a[236:239], v[48:63]
    ds_read_b128 a[236:239], v2 offset:5392
    v_cvt_pk_bf16_f32 v26, v84, v85
    v_cvt_pk_bf16_f32 v27, v86, v87
    s_bitcmp1_b32 s33, 0
    s_cbranch_scc1 Lre97
    buffer_store_dwordx4 v[24:27], v1, s[4:7], s84 offen offset:1024
Lok97:
    s_nop 1
    v_mfma_f32_32x32x16_bf16 v[16:31], v[128:131], a[240:243], 0
    ds_read_b128 a[240:243], v2 offset:6416
    s_waitcnt lgkmcnt(4)
    v_mfma_f32_32x32x16_bf16 v[16:31], v[132:135], a[244:247], v[16:31]
    ds_read_b128 a[244:247], v2 offset:7440
    v_mul_f32 v80, v48, v48
    v_mul_f32 v81, v49, v49
    v_mul_f32 v82, v50, v50
    v_mul_f32 v83, v51, v51
    v_mul_f32 v84, v52, v52
    v_mul_f32 v85, v53, v53
    v_mul_f32 v86, v54, v54
    v_mul_f32 v87, v55, v55
    v_mfma_f32_32x32x16_bf16 v[16:31], v[136:139], a[224:227], v[16:31]
    ds_read_b128 a[224:227], v2 offset:8480
    v_fma_f32 v80, v80, v40, v39
    v_fma_f32 v81, v81, v40, v39
    v_fma_f32 v82, v82, v40, v39
    v_fma_f32 v83, v83, v40, v39
    v_fma_f32 v84, v84, v40, v39
    v_fma_f32 v85, v85, v40, v39
    v_fma_f32 v86, v86, v40, v39
    v_fma_f32 v87, v87, v40, v39
    s_waitcnt lgkmcnt(4)
    v_mfma_f32_32x32x16_bf16 v[16:31], v[140:143], a[228:231], v[16:31]
    ds_read_b128 a[228:231], v2 offset:9504
    v_mul_f32 v80, v80, v48
    v_mul_f32 v81, v81, v49
    v_mul_f32 v82, v82, v50
    v_mul_f32 v83, v83, v51
    v_mul_f32 v84, v84, v52
    v_mul_f32 v85, v85, v53
    v_mul_f32 v86, v86, v54
    v_mul_f32 v87, v87, v55
    v_mfma_f32_32x32x16_bf16 v[16:31], v[144:147], a[232:235], v[16:31]
    ds_read_b128 a[232:235], v2 offset:10528
    v_exp_f32 v80, v80
    v_exp_f32 v81, v81
    v_exp_f32 v82, v82
    v_exp_f32 v83, v83
    s_waitcnt lgkmcnt(4)
    v_mfma_f32_32x32x16_bf16 v[16:31], v[148:151], a[236:239], v[16:31]
    ds_read_b128 a[236:239], v2 offset:11552
    v_exp_f32 v84, v84
    v_exp_f32 v85, v85
    v_exp_f32 v86, v86
    v_exp_f32 v87, v87
    v_mfma_f32_32x32x16_bf16 v[16:31], v[152:155], a[240:243], v[16:31]
    ds_read_b128 a[240:243], v2 offset:12592
    v_fma_f32 v80, v80, v41, v41
    v_fma_f32 v81, v81, v41, v41
    v_fma_f32 v82, v82, v41, v41
    v_fma_f32 v83, v83, v41, v41
    v_fma_f32 v84, v84, v41, v41
    v_fma_f32 v85, v85, v41, v41
    v_fma_f32 v86, v86, v41, v41
    v_fma_f32 v87, v87, v41, v41
    s_waitcnt lgkmcnt(4)
    v_mfma_f32_32x32x16_bf16 v[16:31], v[156:159], a[244:247], v[16:31]
    ds_read_b128 a[244:247], v2 offset:13616
    v_rcp_f32 v80, v80
    v_rcp_f32 v81, v81
    v_rcp_f32 v82, v82
    v_rcp_f32 v83, v83
    v_mfma_f32_32x32x16_bf16 v[16:31], v[160:163], a[224:227], v[16:31]
    ds_read_b128 a[224:227], v2 offset:14640
    s_waitcnt vmcnt(4)
    v_max3_u32 v7, v64, v65, v66
    s_waitcnt vmcnt(3)
    v_max3_u32 v7, v7, v67, v68
    v_max3_u32 v7, v7, v69, v70
    s_waitcnt vmcnt(2)
    v_max3_u32 v7, v7, v71, v72
    v_max3_u32 v7, v7, v73, v74
    s_waitcnt vmcnt(1)
    v_max3_u32 v7, v7, v75, v76
    v_max3_u32 v7, v7, v77, v78
    v_max_u32 v7, v7, v79
    v_cmp_eq_u32 vcc, -1, v7
    s_cbranch_vccnz Lre98
Lok98:
    s_waitcnt lgkmcnt(4)
    v_mfma_f32_32x32x16_bf16 v[16:31], v[164:167], a[228:231], v[16:31]
    ds_read_b128 a[228:231], v2 offset:15664
    v_rcp_f32 v84, v84
    v_rcp_f32 v85, v85
    v_rcp_f32 v86, v86
    v_rcp_f32 v87, v87
    v_mfma_f32_32x32x16_bf16 v[16:31], v[168:171], a[232:235], v[16:31]
    ds_read_b128 a[232:235], v2 offset:16704
    v_mul_f32 v80, v80, v48
    v_mul_f32 v81, v81, v49
    v_mul_f32 v82, v82, v50
    v_mul_f32 v83, v83, v51
    v_mul_f32 v84, v84, v52
    v_mul_f32 v85, v85, v53
    v_mul_f32 v86, v86, v54
    v_mul_f32 v87, v87, v55
    s_waitcnt lgkmcnt(4)
    v_mfma_f32_32x32x16_bf16 v[16:31], v[172:175], a[236:239], v[16:31]
    ds_read_b128 a[236:239], v2 offset:17728
    v_add_f32 v64, v64, v72
    v_add_f32 v65, v65, v73
    v_add_f32 v66, v66, v74
    v_cvt_pk_bf16_f32 v48, v80, v81
    v_cvt_pk_bf16_f32 v49, v82, v83
    v_cvt_pk_bf16_f32 v50, v84, v85
    v_cvt_pk_bf16_f32 v51, v86, v87
    v_mfma_f32_32x32x16_bf16 v[16:31], v[176:179], a[240:243], v[16:31]
    ds_read_b128 a[240:243], v2 offset:18752
    v_add_f32 v67, v67, v75
    v_add_f32 v68, v68, v76
    v_add_f32 v69, v69, v77
    s_add_u32 s90, s23, 0x2738000
    s_bitcmp1_b32 s33, 0
    s_cbranch_scc1 Lre99
    buffer_store_dwordx4 v[48:51], v1, s[4:7], s90 offen
Lok99:
    s_waitcnt lgkmcnt(4)
    v_mfma_f32_32x32x16_bf16 v[16:31], v[180:183], a[244:247], v[16:31]
    ds_read_b128 a[244:247], v2 offset:19776
    v_add_f32 v70, v70, v78
    v_add_f32 v71, v71, v79
    v_add_f32 v64, v64, v68
    v_add_f32 v65, v65, v69
    v_mul_f32 v80, v56, v56
    v_mul_f32 v81, v57, v57
    v_mul_f32 v82, v58, v58
    v_mul_f32 v83, v59, v59
    v_mfma_f32_32x32x16_bf16 v[16:31], v[184:187], a[224:227], v[16:31]
    ds_read_b128 a[224:227], v2 offset:20816
    v_add_f32 v66, v66, v70
    v_add_f32 v67, v67, v71
    v_add_f32 v64, v64, v66
    v_mul_f32 v84, v60, v60
    v_mul_f32 v85, v61, v61
    v_mul_f32 v86, v62, v62
    v_mul_f32 v87, v63, v63
    v_fma_f32 v80, v80, v40, v39
    s_waitcnt lgkmcnt(4)
    v_mfma_f32_32x32x16_bf16 v[16:31], v[188:191], a[228:231], v[16:31]
    ds_read_b128 a[228:231], v2 offset:21840
    v_add_f32 v65, v65, v67
    v_mul_f32 v64, 0xbb000000, v64
    v_mul_f32 v65, 0x3b000000, v65
    v_fma_f32 v81, v81, v40, v39
    v_fma_f32 v82, v82, v40, v39
    v_fma_f32 v83, v83, v40, v39
    v_fma_f32 v84, v84, v40, v39
    v_fma_f32 v85, v85, v40, v39
    v_mfma_f32_32x32x16_bf16 v[16:31], v[192:195], a[232:235], v[16:31]
    ds_read_b128 a[232:235], v2 offset:22864
    v_fma_f32 v65, -v64, v64, v65
    v_max_f32 v65, 0, v65
    v_add_f32 v68, 0x3727c5ac, v65
    v_fma_f32 v86, v86, v40, v39
    v_fma_f32 v87, v87, v40, v39
    v_mul_f32 v80, v80, v56
    v_mul_f32 v81, v81, v57
    v_mul_f32 v82, v82, v58
    s_waitcnt lgkmcnt(4)
    v_mfma_f32_32x32x16_bf16 v[16:31], v[196:199], a[236:239], v[16:31]
    ds_read_b128 a[236:239], v2 offset:23888
    v_rsq_f32 v66, v68
    v_cvt_pk_bf16_f32 v96, v64, v64
    v_mul_f32 v83, v83, v59
    v_mul_f32 v84, v84, v60
    v_mul_f32 v85, v85, v61
    v_mul_f32 v86, v86, v62
    v_mul_f32 v87, v87, v63
    v_mfma_f32_32x32x16_bf16 v[16:31], v[200:203], a[240:243], v[16:31]
    ds_read_b128 a[240:243], v2 offset:24928
    v_mul_f32 v68, v66, v66
    v_mul_f32 v68, v68, v65
    v_add_f32 v68, 0x3727c5ac, v68
    v_rsq_f32 v68, v68
    v_exp_f32 v80, v80
    s_waitcnt lgkmcnt(4)
    v_mfma_f32_32x32x16_bf16 v[16:31], v[204:207], a[244:247], v[16:31]
    ds_read_b128 a[244:247], v2 offset:25952
    v_lshlrev_b32 v69, 16, v96
    v_mul_f32 v66, v66, v68
    v_exp_f32 v81, v81
    v_exp_f32 v82, v82
    v_exp_f32 v83, v83
    v_mfma_f32_32x32x16_bf16 v[16:31], v[208:211], a[224:227], v[16:31]
    ds_read_b128 a[224:227], v2 offset:26976
    v_add_u32 v46, 0x0, v6
    ds_read2st64_b32 v[42:43], v46 offset0:0 offset1:4
    ds_read2st64_b32 v[44:45], v46 offset0:8 offset1:12
    v_rcp_f32 v67, v66
    v_sub_f32 v69, v64, v69
    s_waitcnt lgkmcnt(6)
    v_mfma_f32_32x32x16_bf16 v[16:31], v[212:215], a[228:231], v[16:31]
    ds_read_b128 a[228:231], v2 offset:28000
    v_add_u32 v110, 0x4040, v6
    ds_read2st64_b32 v[106:107], v110 offset0:0 offset1:4
    v_cvt_pk_bf16_f32 v70, v66, v66
    v_cvt_pk_bf16_f32 v97, v69, v67
    v_lshlrev_b32 v70, 16, v70
    v_exp_f32 v84, v84
    v_mfma_f32_32x32x16_bf16 v[16:31], v[216:219], a[232:235], v[16:31]
    ds_read_b128 a[232:235], v2 offset:29040
    ds_read2st64_b32 v[108:109], v110 offset0:8 offset1:12
    v_and_b32 v69, 0xffff0000, v97
    v_sub_f32 v70, v66, v70
    v_sub_f32 v69, v67, v69
    v_exp_f32 v85, v85
    s_waitcnt lgkmcnt(8)
    v_mfma_f32_32x32x16_bf16 v[16:31], v[220:223], a[236:239], v[16:31]
    ds_read_b128 a[236:239], v2 offset:30064
    v_cvt_pk_bf16_f32 v99, v66, v70
    v_cvt_pk_bf16_f32 v98, v69, 0
    v_mul_f32 v68, v66, v66
    v_mul_f32 v100, 0xc0135761, v66
    v_exp_f32 v86, v86
    v_exp_f32 v87, v87
    v_mfma_f32_32x32x16_bf16 v[16:31], v[224:227], a[240:243], v[16:31]
    ds_read_b128 a[240:243], v2 offset:31088
    s_waitcnt lgkmcnt(6)
    v_max3_u32 v7, v42, v43, v44
    v_max_u32 v7, v7, v45
    v_cmp_eq_u32 vcc, -1, v7
    s_cbranch_vccnz Lre100
Lok100:
    v_mul_f32 v103, 0xc0135761, v66
    v_mul_f32 v68, v68, v66
    v_mov_b32 v102, v67
    v_fma_f32 v80, v80, v41, v41
    v_mfma_f32_32x32x16_bf16 v[16:31], v[228:231], a[244:247], v[16:31]
    ds_read_b128 a[244:247], v2 offset:32112
    s_waitcnt lgkmcnt(3)
    v_max3_u32 v7, v106, v107, v108
    v_max_u32 v7, v7, v109
    v_cmp_eq_u32 vcc, -1, v7
    s_cbranch_vccnz Lre101
Lok101:
    s_barrier
    v_mov_b32 v105, v67
    v_mul_f32 v101, 0xbdd2d3e8, v68
    v_mul_f32 v104, 0xbdd2d3e8, v68
    v_mfma_f32_32x32x16_bf16 v[16:31], v[232:235], a[224:227], v[16:31]
    ds_read_b128 a[224:227], v1 offset:0
    v_permlane32_swap_b32 v100, v103
    v_permlane32_swap_b32 v102, v105
    v_fma_f32 v81, v81, v41, v41
    v_fma_f32 v82, v82, v41, v41
    v_fma_f32 v83, v83, v41, v41
    v_fma_f32 v84, v84, v41, v41
    v_mfma_f32_32x32x16_bf16 v[16:31], v[236:239], a[228:231], v[16:31]
    ds_read_b128 a[228:231], v1 offset:1024
    v_permlane32_swap_b32 v101, v104
    v_fma_f32 v85, v85, v41, v41
    v_fma_f32 v86, v86, v41, v41
    v_fma_f32 v87, v87, v41, v41
    v_rcp_f32 v80, v80
    v_mfma_f32_32x32x16_bf16 v[16:31], v[240:243], a[232:235], v[16:31]
    ds_read_b128 a[232:235], v1 offset:2048
    v_rcp_f32 v81, v81
    v_rcp_f32 v82, v82
    v_rcp_f32 v83, v83
    v_rcp_f32 v84, v84
    v_mfma_f32_32x32x16_bf16 v[16:31], a[248:251], v[96:99], v[16:31]
    v_rcp_f32 v85, v85
    v_rcp_f32 v86, v86
    v_rcp_f32 v87, v87
    v_mul_f32 v80, v80, v56
    v_mul_f32 v81, v81, v57
    v_mul_f32 v82, v82, v58
    s_waitcnt lgkmcnt(4)
    v_mfma_f32_32x32x16_bf16 v[16:31], v[244:247], a[236:239], v[16:31]
    ds_read_b128 a[236:239], v1 offset:3072
    v_mul_f32 v83, v83, v59
    v_mul_f32 v84, v84, v60
    v_mul_f32 v85, v85, v61
    v_mul_f32 v86, v86, v62
    v_mul_f32 v87, v87, v63
    v_cvt_pk_bf16_f32 v56, v80, v81
    v_cvt_pk_bf16_f32 v57, v82, v83
    v_cvt_pk_bf16_f32 v58, v84, v85
    v_mfma_f32_32x32x16_bf16 v[16:31], v[248:251], a[240:243], v[16:31]
    ds_read_b128 a[240:243], v1 offset:4112
    v_cvt_pk_bf16_f32 v59, v86, v87
    s_bitcmp1_b32 s33, 0
    s_cbranch_scc1 Lre102
    buffer_store_dwordx4 v[56:59], v1, s[4:7], s90 offen offset:1024
Lok102:
    s_waitcnt lgkmcnt(4)
    v_mfma_f32_32x32x16_bf16 v[16:31], v[252:255], a[244:247], v[16:31]
    ds_read_b128 a[244:247], v1 offset:5136
    v_mfma_f32_32x32x16_bf16 v[48:63], v[128:131], a[224:227], 0
    ds_read_b128 a[224:227], v1 offset:6160
    s_waitcnt lgkmcnt(4)
    v_mfma_f32_32x32x16_bf16 v[48:63], v[132:135], a[228:231], v[48:63]
    ds_read_b128 a[228:231], v1 offset:7184
    s_nop 5
    v_mul_f32 v80, v16, v16
    v_mul_f32 v81, v17, v17
    v_mul_f32 v82, v18, v18
    v_mul_f32 v83, v19, v19
    v_mul_f32 v84, v20, v20
    v_mul_f32 v85, v21, v21
    v_mfma_f32_32x32x16_bf16 v[48:63], v[136:139], a[232:235], v[48:63]
    ds_read_b128 a[232:235], v1 offset:8224
    v_mul_f32 v86, v22, v22
    v_mul_f32 v87, v23, v23
    v_fma_f32 v80, v80, v101, v100
    v_fma_f32 v81, v81, v101, v100
    v_fma_f32 v82, v82, v101, v100
    v_fma_f32 v83, v83, v101, v100
    s_waitcnt lgkmcnt(4)
    v_mfma_f32_32x32x16_bf16 v[48:63], v[140:143], a[236:239], v[48:63]
    ds_read_b128 a[236:239], v1 offset:9248
    v_fma_f32 v84, v84, v101, v100
    v_fma_f32 v85, v85, v101, v100
    v_fma_f32 v86, v86, v101, v100
    v_fma_f32 v87, v87, v101, v100
    v_mul_f32 v80, v80, v16
    v_mul_f32 v81, v81, v17
    v_mfma_f32_32x32x16_bf16 v[48:63], v[144:147], a[240:243], v[48:63]
    ds_read_b128 a[240:243], v1 offset:10272
    v_mul_f32 v82, v82, v18
    v_mul_f32 v83, v83, v19
    v_mul_f32 v84, v84, v20
    v_mul_f32 v85, v85, v21
    v_mul_f32 v86, v86, v22
    v_mul_f32 v87, v87, v23
    s_waitcnt lgkmcnt(4)
    v_mfma_f32_32x32x16_bf16 v[48:63], v[148:151], a[244:247], v[48:63]
    ds_read_b128 a[244:247], v1 offset:11296
    v_exp_f32 v80, v80
    v_exp_f32 v81, v81
    v_exp_f32 v82, v82
    v_mfma_f32_32x32x16_bf16 v[48:63], v[152:155], a[224:227], v[48:63]
    ds_read_b128 a[224:227], v1 offset:12336
    v_exp_f32 v83, v83
    v_exp_f32 v84, v84
    v_exp_f32 v85, v85
    s_waitcnt lgkmcnt(4)
    v_mfma_f32_32x32x16_bf16 v[48:63], v[156:159], a[228:231], v[48:63]
    ds_read_b128 a[228:231], v1 offset:13360
    v_exp_f32 v86, v86
    v_exp_f32 v87, v87
    v_fma_f32 v80, v80, v102, v102
    v_fma_f32 v81, v81, v102, v102
    v_mfma_f32_32x32x16_bf16 v[48:63], v[160:163], a[232:235], v[48:63]
    ds_read_b128 a[232:235], v1 offset:14384
    v_fma_f32 v82, v82, v102, v102
    v_fma_f32 v83, v83, v102, v102
    v_fma_f32 v84, v84, v102, v102
    v_fma_f32 v85, v85, v102, v102
    v_fma_f32 v86, v86, v102, v102
    v_fma_f32 v87, v87, v102, v102
    s_waitcnt lgkmcnt(4)
    v_mfma_f32_32x32x16_bf16 v[48:63], v[164:167], a[236:239], v[48:63]
    ds_read_b128 a[236:239], v1 offset:15408
    v_rcp_f32 v80, v80
    v_rcp_f32 v81, v81
    v_rcp_f32 v82, v82
    v_mfma_f32_32x32x16_bf16 v[48:63], v[168:171], a[240:243], v[48:63]
    ds_read_b128 a[240:243], v1 offset:16448
    s_add_u32 s81, s24, 0x2700000
    buffer_load_dwordx4 v[128:131], v1, s[4:7], s81 offen sc1
    v_rcp_f32 v83, v83
    s_waitcnt lgkmcnt(4)
    v_mfma_f32_32x32x16_bf16 v[48:63], v[172:175], a[244:247], v[48:63]
    ds_read_b128 a[244:247], v1 offset:17472
    v_rcp_f32 v84, v84
    v_rcp_f32 v85, v85
    v_rcp_f32 v86, v86
    v_mfma_f32_32x32x16_bf16 v[48:63], v[176:179], a[224:227], v[48:63]
    ds_read_b128 a[224:227], v1 offset:18496
    buffer_load_dwordx4 v[132:135], v1, s[4:7], s81 offen offset:2048 sc1
    v_rcp_f32 v87, v87
    v_mul_f32 v80, v80, v16
    s_waitcnt lgkmcnt(4)
    v_mfma_f32_32x32x16_bf16 v[48:63], v[180:183], a[228:231], v[48:63]
    ds_read_b128 a[228:231], v1 offset:19520
    v_mul_f32 v81, v81, v17
    v_mul_f32 v82, v82, v18
    v_mul_f32 v83, v83, v19
    v_mul_f32 v84, v84, v20
    v_mul_f32 v85, v85, v21
    v_mul_f32 v86, v86, v22
    v_mfma_f32_32x32x16_bf16 v[48:63], v[184:187], a[232:235], v[48:63]
    ds_read_b128 a[232:235], v1 offset:20560
    s_add_u32 s86, s24, 0x2701000
    buffer_load_dwordx4 v[136:139], v1, s[4:7], s86 offen sc1
    v_mul_f32 v87, v87, v23
PAD21:
    s_cbranch_execz WARM1_8
    v_cvt_pk_bf16_f32 v16, v80, v81
    v_cvt_pk_bf16_f32 v17, v82, v83
    s_waitcnt lgkmcnt(4)
    v_mfma_f32_32x32x16_bf16 v[48:63], v[188:191], a[236:239], v[48:63]
    ds_read_b128 a[236:239], v1 offset:21584
    v_cvt_pk_bf16_f32 v18, v84, v85
    v_cvt_pk_bf16_f32 v19, v86, v87
    s_add_u32 s82, s23, 0x271c000
    s_bitcmp1_b32 s33, 0
    s_cbranch_scc1 Lre103
    buffer_store_dwordx4 v[16:19], v1, s[4:7], s82 offen
Lok103:
    v_mfma_f32_32x32x16_bf16 v[48:63], v[192:195], a[240:243], v[48:63]
    ds_read_b128 a[240:243], v1 offset:22608
    buffer_load_dwordx4 v[140:143], v1, s[4:7], s86 offen offset:2048 sc1
    v_mul_f32 v80, v24, v24
    v_mul_f32 v81, v25, v25
    v_mul_f32 v82, v26, v26
    s_waitcnt lgkmcnt(4)
    v_mfma_f32_32x32x16_bf16 v[48:63], v[196:199], a[244:247], v[48:63]
    ds_read_b128 a[244:247], v1 offset:23632
    v_mul_f32 v83, v27, v27
    v_mul_f32 v84, v28, v28
    v_mul_f32 v85, v29, v29
    v_mul_f32 v86, v30, v30
    v_mul_f32 v87, v31, v31
    v_fma_f32 v80, v80, v101, v100
    v_mfma_f32_32x32x16_bf16 v[48:63], v[200:203], a[224:227], v[48:63]
    ds_read_b128 a[224:227], v1 offset:24672
    s_add_u32 s91, s24, 0x2702000
    buffer_load_dwordx4 v[144:147], v1, s[4:7], s91 offen sc1
    v_fma_f32 v81, v81, v101, v100
    v_fma_f32 v82, v82, v101, v100
    v_fma_f32 v83, v83, v101, v100
    s_waitcnt lgkmcnt(4)
    v_mfma_f32_32x32x16_bf16 v[48:63], v[204:207], a[228:231], v[48:63]
    ds_read_b128 a[228:231], v1 offset:25696
    v_fma_f32 v84, v84, v101, v100
    v_fma_f32 v85, v85, v101, v100
    v_fma_f32 v86, v86, v101, v100
    v_fma_f32 v87, v87, v101, v100
    v_mul_f32 v80, v80, v24
    v_mul_f32 v81, v81, v25
    v_mfma_f32_32x32x16_bf16 v[48:63], v[208:211], a[232:235], v[48:63]
    ds_read_b128 a[232:235], v1 offset:26720
    buffer_load_dwordx4 v[148:151], v1, s[4:7], s91 offen offset:2048 sc1
    v_mul_f32 v82, v82, v26
    v_mul_f32 v83, v83, v27
    v_mul_f32 v84, v84, v28
    s_waitcnt lgkmcnt(4)
    v_mfma_f32_32x32x16_bf16 v[48:63], v[212:215], a[236:239], v[48:63]
    ds_read_b128 a[236:239], v1 offset:27744
    v_mul_f32 v85, v85, v29
    v_mul_f32 v86, v86, v30
    v_mul_f32 v87, v87, v31
    v_exp_f32 v80, v80
    v_mfma_f32_32x32x16_bf16 v[48:63], v[216:219], a[240:243], v[48:63]
    ds_read_b128 a[240:243], v1 offset:28784
    s_add_u32 s85, s24, 0x2703000
    buffer_load_dwordx4 v[152:155], v1, s[4:7], s85 offen sc1
    v_exp_f32 v81, v81
    s_waitcnt lgkmcnt(4)
    v_mfma_f32_32x32x16_bf16 v[48:63], v[220:223], a[244:247], v[48:63]
    ds_read_b128 a[244:247], v1 offset:29808
    v_exp_f32 v82, v82
    v_exp_f32 v83, v83
    v_exp_f32 v84, v84
    v_mfma_f32_32x32x16_bf16 v[48:63], v[224:227], a[224:227], v[48:63]
    ds_read_b128 a[224:227], v1 offset:30832
    buffer_load_dwordx4 v[156:159], v1, s[4:7], s85 offen offset:2048 sc1
    v_exp_f32 v85, v85
    s_waitcnt lgkmcnt(4)
    v_mfma_f32_32x32x16_bf16 v[48:63], v[228:231], a[228:231], v[48:63]
    ds_read_b128 a[228:231], v1 offset:31856
    v_exp_f32 v86, v86
    v_exp_f32 v87, v87
    v_fma_f32 v80, v80, v102, v102
    v_fma_f32 v81, v81, v102, v102
    v_mfma_f32_32x32x16_bf16 v[48:63], v[232:235], a[232:235], v[48:63]
    s_add_u32 s80, s24, 0x2704000
    buffer_load_dwordx4 v[160:163], v1, s[4:7], s80 offen sc1
    v_fma_f32 v82, v82, v102, v102
    v_fma_f32 v83, v83, v102, v102
    v_fma_f32 v84, v84, v102, v102
    v_fma_f32 v85, v85, v102, v102
    s_waitcnt lgkmcnt(4)
    v_mfma_f32_32x32x16_bf16 v[48:63], v[236:239], a[236:239], v[48:63]
    v_fma_f32 v86, v86, v102, v102
    v_fma_f32 v87, v87, v102, v102
    v_rcp_f32 v80, v80
    v_rcp_f32 v81, v81
    v_rcp_f32 v82, v82
    s_waitcnt lgkmcnt(3)
    v_mfma_f32_32x32x16_bf16 v[48:63], v[240:243], a[240:243], v[48:63]
    buffer_load_dwordx4 v[164:167], v1, s[4:7], s80 offen offset:2048 sc1
    v_rcp_f32 v83, v83
    v_rcp_f32 v84, v84
    v_mfma_f32_32x32x16_bf16 v[48:63], a[252:255], v[96:99], v[48:63]
    v_rcp_f32 v85, v85
    v_rcp_f32 v86, v86
    v_rcp_f32 v87, v87
    v_mul_f32 v80, v80, v24
    v_mul_f32 v81, v81, v25
    s_waitcnt lgkmcnt(2)
    v_mfma_f32_32x32x16_bf16 v[48:63], v[244:247], a[244:247], v[48:63]
    s_add_u32 s87, s24, 0x2705000
    buffer_load_dwordx4 v[168:171], v1, s[4:7], s87 offen sc1
    v_mul_f32 v82, v82, v26
    v_mul_f32 v83, v83, v27
    v_mul_f32 v84, v84, v28
    v_mul_f32 v85, v85, v29
    s_waitcnt lgkmcnt(1)
    v_mfma_f32_32x32x16_bf16 v[48:63], v[248:251], a[224:227], v[48:63]
    v_mul_f32 v86, v86, v30
    v_mul_f32 v87, v87, v31
    v_cvt_pk_bf16_f32 v24, v80, v81
    v_cvt_pk_bf16_f32 v25, v82, v83
    v_cvt_pk_bf16_f32 v26, v84, v85
    v_cvt_pk_bf16_f32 v27, v86, v87
    s_waitcnt lgkmcnt(0)
    v_mfma_f32_32x32x16_bf16 v[48:63], v[252:255], a[228:231], v[48:63]
    buffer_load_dwordx4 v[172:175], v1, s[4:7], s87 offen offset:2048 sc1
    s_bitcmp1_b32 s33, 0
    s_cbranch_scc1 Lre104
    buffer_store_dwordx4 v[24:27], v1, s[4:7], s82 offen offset:1024
Lok104:
    s_nop 7
    v_mul_f32 v80, v48, v48
    v_mul_f32 v81, v49, v49
    v_mul_f32 v82, v50, v50
    v_mul_f32 v83, v51, v51
    s_add_u32 s83, s24, 0x2706000
    buffer_load_dwordx4 v[176:179], v1, s[4:7], s83 offen sc1
    v_mul_f32 v84, v52, v52
    v_mul_f32 v85, v53, v53
    v_mul_f32 v86, v54, v54
    v_mul_f32 v87, v55, v55
    v_fma_f32 v80, v80, v104, v103
    v_fma_f32 v81, v81, v104, v103
    v_fma_f32 v82, v82, v104, v103
    v_fma_f32 v83, v83, v104, v103
    buffer_load_dwordx4 v[180:183], v1, s[4:7], s83 offen offset:2048 sc1
    v_fma_f32 v84, v84, v104, v103
    v_fma_f32 v85, v85, v104, v103
    v_fma_f32 v86, v86, v104, v103
    v_fma_f32 v87, v87, v104, v103
    v_mul_f32 v80, v80, v48
    v_mul_f32 v81, v81, v49
    v_mul_f32 v82, v82, v50
    v_mul_f32 v83, v83, v51
    buffer_load_dwordx4 v[184:187], v1, s[4:7], s81 offen offset:1024 sc1
    v_mul_f32 v84, v84, v52
    v_mul_f32 v85, v85, v53
    v_mul_f32 v86, v86, v54
    v_mul_f32 v87, v87, v55
    v_exp_f32 v80, v80
    v_exp_f32 v81, v81
    v_exp_f32 v82, v82
    v_exp_f32 v83, v83
    buffer_load_dwordx4 v[188:191], v1, s[4:7], s81 offen offset:3072 sc1
    v_exp_f32 v84, v84
    v_exp_f32 v85, v85
    v_exp_f32 v86, v86
    v_exp_f32 v87, v87
    v_fma_f32 v80, v80, v105, v105
    v_fma_f32 v81, v81, v105, v105
    v_fma_f32 v82, v82, v105, v105
    v_fma_f32 v83, v83, v105, v105
    buffer_load_dwordx4 v[192:195], v1, s[4:7], s86 offen offset:1024 sc1
    v_fma_f32 v84, v84, v105, v105
    v_fma_f32 v85, v85, v105, v105
    v_fma_f32 v86, v86, v105, v105
    v_fma_f32 v87, v87, v105, v105
    v_rcp_f32 v80, v80
    v_rcp_f32 v81, v81
    v_rcp_f32 v82, v82
    v_rcp_f32 v83, v83
    buffer_load_dwordx4 v[196:199], v1, s[4:7], s86 offen offset:3072 sc1
    v_rcp_f32 v84, v84
    v_rcp_f32 v85, v85
    v_rcp_f32 v86, v86
    v_rcp_f32 v87, v87
    v_mul_f32 v80, v80, v48
    v_mul_f32 v81, v81, v49
    v_mul_f32 v82, v82, v50
    v_mul_f32 v83, v83, v51
    v_mul_f32 v84, v84, v52
    v_mul_f32 v85, v85, v53
    v_mul_f32 v86, v86, v54
    v_mul_f32 v87, v87, v55
    v_cvt_pk_bf16_f32 v48, v80, v81
    v_cvt_pk_bf16_f32 v49, v82, v83
    v_cvt_pk_bf16_f32 v50, v84, v85
    v_cvt_pk_bf16_f32 v51, v86, v87
    s_add_u32 s89, s23, 0x2754000
    s_bitcmp1_b32 s33, 0
    s_cbranch_scc1 Lre105
    buffer_store_dwordx4 v[48:51], v1, s[4:7], s89 offen
Lok105:
    s_waitcnt vmcnt(18)
    v_max3_u32 v7, v128, v132, v136
    s_waitcnt vmcnt(16)
    v_max_u32 v7, v7, v140
    v_cmp_eq_u32 vcc, -1, v7
    s_cbranch_vccnz Lre106
Lok106:
    v_mfma_f32_32x32x16_bf16 v[32:47], a[4:7], v[128:131], 0
    buffer_load_dwordx4 v[200:203], v1, s[4:7], s91 offen offset:1024 sc1
    v_mul_f32 v80, v56, v56
    v_mul_f32 v81, v57, v57
    v_mul_f32 v82, v58, v58
    v_mul_f32 v83, v59, v59
    v_mfma_f32_32x32x16_bf16 v[64:79], a[0:3], v[128:131], 0
    v_mul_f32 v84, v60, v60
    v_mul_f32 v85, v61, v61
    v_mul_f32 v86, v62, v62
    v_mul_f32 v87, v63, v63
    v_fma_f32 v80, v80, v104, v103
    v_fma_f32 v81, v81, v104, v103
    v_fma_f32 v82, v82, v104, v103
    v_mfma_f32_32x32x16_bf16 v[32:47], a[20:23], v[132:135], v[32:47]
    buffer_load_dwordx4 v[204:207], v1, s[4:7], s91 offen offset:3072 sc1
    v_fma_f32 v83, v83, v104, v103
    v_fma_f32 v84, v84, v104, v103
    v_fma_f32 v85, v85, v104, v103
    v_fma_f32 v86, v86, v104, v103
    v_mfma_f32_32x32x16_bf16 v[64:79], a[16:19], v[132:135], v[64:79]
    v_fma_f32 v87, v87, v104, v103
    v_mul_f32 v80, v80, v56
    v_mul_f32 v81, v81, v57
    v_mul_f32 v82, v82, v58
    v_mul_f32 v83, v83, v59
    v_mul_f32 v84, v84, v60
    v_mul_f32 v85, v85, v61
    v_mfma_f32_32x32x16_bf16 v[32:47], a[36:39], v[136:139], v[32:47]
    buffer_load_dwordx4 v[208:211], v1, s[4:7], s85 offen offset:1024 sc1
    v_mul_f32 v86, v86, v62
    v_mul_f32 v87, v87, v63
    v_exp_f32 v80, v80
    v_mfma_f32_32x32x16_bf16 v[64:79], a[32:35], v[136:139], v[64:79]
    v_exp_f32 v81, v81
    v_exp_f32 v82, v82
    v_exp_f32 v83, v83
    v_mfma_f32_32x32x16_bf16 v[32:47], a[52:55], v[140:143], v[32:47]
    buffer_load_dwordx4 v[212:215], v1, s[4:7], s85 offen offset:3072 sc1
    v_exp_f32 v84, v84
    v_exp_f32 v85, v85
    v_mfma_f32_32x32x16_bf16 v[64:79], a[48:51], v[140:143], v[64:79]
    v_exp_f32 v86, v86
    s_waitcnt vmcnt(17)
    v_max3_u32 v7, v144, v148, v152
    s_waitcnt vmcnt(16)
    v_max_u32 v7, v7, v156
    v_cmp_eq_u32 vcc, -1, v7
    s_cbranch_vccnz Lre107
Lok107:
    v_mfma_f32_32x32x16_bf16 v[32:47], a[68:71], v[144:147], v[32:47]
    buffer_load_dwordx4 v[216:219], v1, s[4:7], s80 offen offset:1024 sc1
    v_exp_f32 v87, v87
    v_fma_f32 v80, v80, v105, v105
    v_fma_f32 v81, v81, v105, v105
    v_mfma_f32_32x32x16_bf16 v[64:79], a[64:67], v[144:147], v[64:79]
    v_fma_f32 v82, v82, v105, v105
    v_fma_f32 v83, v83, v105, v105
    v_fma_f32 v84, v84, v105, v105
    v_fma_f32 v85, v85, v105, v105
    v_fma_f32 v86, v86, v105, v105
    v_fma_f32 v87, v87, v105, v105
    v_mfma_f32_32x32x16_bf16 v[32:47], a[84:87], v[148:151], v[32:47]
    buffer_load_dwordx4 v[220:223], v1, s[4:7], s80 offen offset:3072 sc1
    v_rcp_f32 v80, v80
    v_rcp_f32 v81, v81
    v_mfma_f32_32x32x16_bf16 v[64:79], a[80:83], v[148:151], v[64:79]
    v_rcp_f32 v82, v82
    v_rcp_f32 v83, v83
    v_rcp_f32 v84, v84
    v_mfma_f32_32x32x16_bf16 v[32:47], a[100:103], v[152:155], v[32:47]
    buffer_load_dwordx4 v[224:227], v1, s[4:7], s87 offen offset:1024 sc1
    v_rcp_f32 v85, v85
    v_rcp_f32 v86, v86
    v_mfma_f32_32x32x16_bf16 v[64:79], a[96:99], v[152:155], v[64:79]
    v_rcp_f32 v87, v87
    v_mul_f32 v80, v80, v56
    v_mul_f32 v81, v81, v57
    v_mul_f32 v82, v82, v58
    v_mul_f32 v83, v83, v59
    v_mul_f32 v84, v84, v60
    v_mfma_f32_32x32x16_bf16 v[32:47], a[116:119], v[156:159], v[32:47]
    buffer_load_dwordx4 v[228:231], v1, s[4:7], s87 offen offset:3072 sc1
    v_mul_f32 v85, v85, v61
    v_mul_f32 v86, v86, v62
    v_mul_f32 v87, v87, v63
    v_cvt_pk_bf16_f32 v56, v80, v81
    v_mfma_f32_32x32x16_bf16 v[64:79], a[112:115], v[156:159], v[64:79]
    v_cvt_pk_bf16_f32 v57, v82, v83
    v_cvt_pk_bf16_f32 v58, v84, v85
    v_cvt_pk_bf16_f32 v59, v86, v87
    s_waitcnt vmcnt(15)
    v_max3_u32 v7, v160, v164, v168
    s_waitcnt vmcnt(14)
    v_max_u32 v7, v7, v172
    v_cmp_eq_u32 vcc, -1, v7
    s_cbranch_vccnz Lre108
Lok108:
    v_mfma_f32_32x32x16_bf16 v[32:47], a[132:135], v[160:163], v[32:47]
    buffer_load_dwordx4 v[232:235], v1, s[4:7], s83 offen offset:1024 sc1
    s_bitcmp1_b32 s33, 0
    s_cbranch_scc1 Lre109
    buffer_store_dwordx4 v[56:59], v1, s[4:7], s89 offen offset:1024
Lok109:
    v_mfma_f32_32x32x16_bf16 v[64:79], a[128:131], v[160:163], v[64:79]
    v_mfma_f32_32x32x16_bf16 v[32:47], a[148:151], v[164:167], v[32:47]
    buffer_load_dwordx4 v[236:239], v1, s[4:7], s83 offen offset:3072 sc1
    v_mfma_f32_32x32x16_bf16 v[64:79], a[144:147], v[164:167], v[64:79]
    v_mfma_f32_32x32x16_bf16 v[32:47], a[164:167], v[168:171], v[32:47]
    v_mfma_f32_32x32x16_bf16 v[64:79], a[160:163], v[168:171], v[64:79]
    v_mfma_f32_32x32x16_bf16 v[32:47], a[180:183], v[172:175], v[32:47]
    v_mfma_f32_32x32x16_bf16 v[64:79], a[176:179], v[172:175], v[64:79]
    s_waitcnt vmcnt(14)
    v_max3_u32 v7, v176, v180, v184
    s_waitcnt vmcnt(13)
    v_max_u32 v7, v7, v188
    v_cmp_eq_u32 vcc, -1, v7
    s_cbranch_vccnz Lre110
Lok110:
    v_mfma_f32_32x32x16_bf16 v[32:47], a[196:199], v[176:179], v[32:47]
    s_add_u32 s88, s24, 0x271c000
    buffer_load_dwordx4 v[240:243], v1, s[4:7], s88 offen sc1
    v_mfma_f32_32x32x16_bf16 v[64:79], a[192:195], v[176:179], v[64:79]
    v_mfma_f32_32x32x16_bf16 v[32:47], a[212:215], v[180:183], v[32:47]
    buffer_load_dwordx4 v[244:247], v1, s[4:7], s88 offen offset:2048 sc1
    v_mfma_f32_32x32x16_bf16 v[64:79], a[208:211], v[180:183], v[64:79]
    v_mfma_f32_32x32x16_bf16 v[32:47], a[12:15], v[184:187], v[32:47]
    s_add_u32 s84, s24, 0x271d000
    buffer_load_dwordx4 v[248:251], v1, s[4:7], s84 offen sc1
    v_mfma_f32_32x32x16_bf16 v[64:79], a[8:11], v[184:187], v[64:79]
    v_mfma_f32_32x32x16_bf16 v[32:47], a[28:31], v[188:191], v[32:47]
    buffer_load_dwordx4 v[252:255], v1, s[4:7], s84 offen offset:2048 sc1
    v_mfma_f32_32x32x16_bf16 v[64:79], a[24:27], v[188:191], v[64:79]
    s_waitcnt vmcnt(14)
    v_max3_u32 v7, v192, v196, v200
    s_waitcnt vmcnt(13)
    v_max_u32 v7, v7, v204
    v_cmp_eq_u32 vcc, -1, v7
    s_cbranch_vccnz Lre111
Lok111:
    v_mfma_f32_32x32x16_bf16 v[32:47], a[44:47], v[192:195], v[32:47]
    s_add_u32 s90, s24, 0x271e000
    buffer_load_dwordx4 v[128:131], v1, s[4:7], s90 offen sc1
    v_mfma_f32_32x32x16_bf16 v[64:79], a[40:43], v[192:195], v[64:79]
    v_mfma_f32_32x32x16_bf16 v[32:47], a[60:63], v[196:199], v[32:47]
    buffer_load_dwordx4 v[132:135], v1, s[4:7], s90 offen offset:2048 sc1
    v_mfma_f32_32x32x16_bf16 v[64:79], a[56:59], v[196:199], v[64:79]
    v_mfma_f32_32x32x16_bf16 v[32:47], a[76:79], v[200:203], v[32:47]
    s_add_u32 s82, s24, 0x271f000
    buffer_load_dwordx4 v[136:139], v1, s[4:7], s82 offen sc1
    v_mfma_f32_32x32x16_bf16 v[64:79], a[72:75], v[200:203], v[64:79]
    v_mfma_f32_32x32x16_bf16 v[32:47], a[92:95], v[204:207], v[32:47]
    buffer_load_dwordx4 v[140:143], v1, s[4:7], s82 offen offset:2048 sc1
    v_mfma_f32_32x32x16_bf16 v[64:79], a[88:91], v[204:207], v[64:79]
    s_waitcnt vmcnt(13)
    v_max3_u32 v7, v208, v212, v216
    s_waitcnt vmcnt(12)
    v_max_u32 v7, v7, v220
    v_cmp_eq_u32 vcc, -1, v7
    s_cbranch_vccnz Lre112
Lok112:
    v_mfma_f32_32x32x16_bf16 v[32:47], a[108:111], v[208:211], v[32:47]
    s_add_u32 s81, s24, 0x2720000
    buffer_load_dwordx4 v[144:147], v1, s[4:7], s81 offen sc1
    v_mfma_f32_32x32x16_bf16 v[64:79], a[104:107], v[208:211], v[64:79]
    v_mfma_f32_32x32x16_bf16 v[32:47], a[124:127], v[212:215], v[32:47]
    buffer_load_dwordx4 v[148:151], v1, s[4:7], s81 offen offset:2048 sc1
    v_mfma_f32_32x32x16_bf16 v[64:79], a[120:123], v[212:215], v[64:79]
    v_mfma_f32_32x32x16_bf16 v[32:47], a[140:143], v[216:219], v[32:47]
    s_add_u32 s86, s24, 0x2721000
    buffer_load_dwordx4 v[152:155], v1, s[4:7], s86 offen sc1
    v_mfma_f32_32x32x16_bf16 v[64:79], a[136:139], v[216:219], v[64:79]
    v_mfma_f32_32x32x16_bf16 v[32:47], a[156:159], v[220:223], v[32:47]
    buffer_load_dwordx4 v[156:159], v1, s[4:7], s86 offen offset:2048 sc1
    v_mfma_f32_32x32x16_bf16 v[64:79], a[152:155], v[220:223], v[64:79]
    s_waitcnt vmcnt(9)
    v_max3_u32 v7, v224, v228, v232
    s_waitcnt vmcnt(8)
    v_max_u32 v7, v7, v236
    v_cmp_eq_u32 vcc, -1, v7
    s_cbranch_vccnz Lre113
Lok113:
    v_mfma_f32_32x32x16_bf16 v[32:47], a[172:175], v[224:227], v[32:47]
    s_add_u32 s91, s24, 0x2722000
    buffer_load_dwordx4 v[160:163], v1, s[4:7], s91 offen sc1
    v_mfma_f32_32x32x16_bf16 v[64:79], a[168:171], v[224:227], v[64:79]
    v_mfma_f32_32x32x16_bf16 v[32:47], a[188:191], v[228:231], v[32:47]
    buffer_load_dwordx4 v[164:167], v1, s[4:7], s91 offen offset:2048 sc1
    v_mfma_f32_32x32x16_bf16 v[64:79], a[184:187], v[228:231], v[64:79]
    v_mfma_f32_32x32x16_bf16 v[32:47], a[204:207], v[232:235], v[32:47]
    buffer_load_dwordx4 v[168:171], v1, s[4:7], s88 offen offset:1024 sc1
    v_mfma_f32_32x32x16_bf16 v[64:79], a[200:203], v[232:235], v[64:79]
    v_mfma_f32_32x32x16_bf16 v[32:47], a[220:223], v[236:239], v[32:47]
    buffer_load_dwordx4 v[172:175], v1, s[4:7], s88 offen offset:3072 sc1
    v_mfma_f32_32x32x16_bf16 v[64:79], a[216:219], v[236:239], v[64:79]
    v_and_b32 v87, 511, v1
    v_lshlrev_b32 v87, 6, v87
    v_lshrrev_b32 v85, 5, v1
    v_and_or_b32 v87, v85, 16, v87
    buffer_load_dwordx4 v[176:179], v1, s[4:7], s84 offen offset:1024 sc1
    v_max3_u32 v7, v240, v244, v248
    v_max_u32 v7, v7, v252
    v_cmp_eq_u32 vcc, -1, v7
    s_cbranch_vccnz Lre114
Lok114:
    v_mfma_f32_32x32x16_bf16 v[48:63], a[4:7], v[240:243], 0
    ds_write_b128 v122, v[32:35] offset:2048
    ds_write_b128 v122, v[36:39] offset:3072
    ds_write_b128 v123, v[40:43] offset:4096
    ds_write_b128 v123, v[44:47] offset:5120
    ds_write_b128 v121, v[72:75] offset:0
    ds_write_b128 v121, v[76:79] offset:1024
    v_lshlrev_b32 v85, 16, v8
    v_mfma_f32_32x32x16_bf16 v[16:31], a[0:3], v[240:243], 0
    buffer_load_dwordx4 v[180:183], v1, s[4:7], s84 offen offset:3072 sc1
    v_and_b32 v86, 0xffff0000, v8
    v_add_f32 v64, v64, v85
    v_add_f32 v65, v65, v86
    v_lshlrev_b32 v85, 16, v9
    v_and_b32 v86, 0xffff0000, v9
    v_add_f32 v66, v66, v85
    v_mfma_f32_32x32x16_bf16 v[48:63], a[20:23], v[244:247], v[48:63]
    v_add_f32 v67, v67, v86
    v_lshlrev_b32 v85, 16, v10
    v_and_b32 v86, 0xffff0000, v10
    v_add_f32 v68, v68, v85
    v_add_f32 v69, v69, v86
    v_lshlrev_b32 v85, 16, v11
    v_and_b32 v86, 0xffff0000, v11
    v_add_f32 v70, v70, v85
    v_add_f32 v71, v71, v86
    s_waitcnt lgkmcnt(0)
    s_barrier
    v_mfma_f32_32x32x16_bf16 v[16:31], a[16:19], v[244:247], v[16:31]
    buffer_load_dwordx4 v[184:187], v1, s[4:7], s90 offen offset:1024 sc1
    ds_read_b128 v[72:75], v120 offset:0
    ds_read_b128 v[32:35], v120 offset:2048
    ds_read_b128 v[40:43], v120 offset:4096
    ds_read_b128 v[76:79], v120 offset:1024
    v_mfma_f32_32x32x16_bf16 v[48:63], a[36:39], v[248:251], v[48:63]
    ds_read_b128 v[36:39], v120 offset:3072
    ds_read_b128 v[44:47], v120 offset:5120
    v_add_f32 v64, v64, v112
    v_add_f32 v65, v65, v113
    v_add_f32 v66, v66, v114
    v_add_f32 v67, v67, v115
    v_add_f32 v68, v68, v116
    v_add_f32 v69, v69, v117
    v_add_f32 v70, v70, v118
    v_mfma_f32_32x32x16_bf16 v[16:31], a[32:35], v[248:251], v[16:31]
    buffer_load_dwordx4 v[188:191], v1, s[4:7], s90 offen offset:3072 sc1
    v_add_f32 v71, v71, v119
    s_waitcnt lgkmcnt(5)
    v_add_f32 v64, v64, v72
    v_add_f32 v65, v65, v73
    v_add_f32 v66, v66, v74
    v_add_f32 v67, v67, v75
    s_waitcnt lgkmcnt(4)
    v_add_f32 v64, v64, v32
    v_mfma_f32_32x32x16_bf16 v[48:63], a[52:55], v[252:255], v[48:63]
    v_add_f32 v65, v65, v33
    v_add_f32 v66, v66, v34
    v_add_f32 v67, v67, v35
    s_waitcnt lgkmcnt(3)
    v_add_f32 v64, v64, v40
    v_add_f32 v65, v65, v41
    v_add_f32 v66, v66, v42
    v_add_f32 v67, v67, v43
    v_cvt_pk_bf16_f32 v8, v64, v65
    v_cvt_pk_bf16_f32 v9, v66, v67
    s_waitcnt lgkmcnt(2)
    v_add_f32 v68, v68, v76
    v_mfma_f32_32x32x16_bf16 v[16:31], a[48:51], v[252:255], v[16:31]
    buffer_load_dwordx4 v[192:195], v1, s[4:7], s82 offen offset:1024 sc1
    v_add_f32 v69, v69, v77
    v_add_f32 v70, v70, v78
    s_waitcnt vmcnt(14)
    v_max3_u32 v7, v128, v132, v136
    s_waitcnt vmcnt(13)
    v_max_u32 v7, v7, v140
    v_cmp_eq_u32 vcc, -1, v7
    s_cbranch_vccnz Lre115
Lok115:
    v_mfma_f32_32x32x16_bf16 v[48:63], a[68:71], v[128:131], v[48:63]
    v_add_f32 v71, v71, v79
    s_waitcnt lgkmcnt(1)
    v_add_f32 v68, v68, v36
    v_add_f32 v69, v69, v37
    v_add_f32 v70, v70, v38
    v_add_f32 v71, v71, v39
    s_waitcnt lgkmcnt(0)
    v_add_f32 v68, v68, v44
    v_add_f32 v69, v69, v45
    v_add_f32 v70, v70, v46
    v_add_f32 v71, v71, v47
    v_cvt_pk_bf16_f32 v10, v68, v69
    v_mfma_f32_32x32x16_bf16 v[16:31], a[64:67], v[128:131], v[16:31]
    buffer_load_dwordx4 v[196:199], v1, s[4:7], s82 offen offset:3072 sc1
    v_cvt_pk_bf16_f32 v11, v70, v71
    v_permlane32_swap_b32 v8, v10
    s_nop 0
    v_permlane32_swap_b32 v9, v11
    v_mfma_f32_32x32x16_bf16 v[48:63], a[84:87], v[132:135], v[48:63]
    s_mov_b32 s85, s48
    buffer_store_dwordx4 v[8:11], v87, s[96:99], s85 offen
    s_barrier
    v_mfma_f32_32x32x16_bf16 v[16:31], a[80:83], v[132:135], v[16:31]
    buffer_load_dwordx4 v[200:203], v1, s[4:7], s81 offen offset:1024 sc1
    v_mfma_f32_32x32x16_bf16 v[48:63], a[100:103], v[136:139], v[48:63]
    v_mfma_f32_32x32x16_bf16 v[16:31], a[96:99], v[136:139], v[16:31]
    buffer_load_dwordx4 v[204:207], v1, s[4:7], s81 offen offset:3072 sc1
    v_mfma_f32_32x32x16_bf16 v[48:63], a[116:119], v[140:143], v[48:63]
    v_mfma_f32_32x32x16_bf16 v[16:31], a[112:115], v[140:143], v[16:31]
    buffer_load_dwordx4 v[208:211], v1, s[4:7], s86 offen offset:1024 sc1
    s_waitcnt vmcnt(15)
    v_max3_u32 v7, v144, v148, v152
    s_waitcnt vmcnt(14)
    v_max_u32 v7, v7, v156
    v_cmp_eq_u32 vcc, -1, v7
    s_cbranch_vccnz Lre116
Lok116:
    v_mfma_f32_32x32x16_bf16 v[48:63], a[132:135], v[144:147], v[48:63]
    v_mfma_f32_32x32x16_bf16 v[16:31], a[128:131], v[144:147], v[16:31]
    buffer_load_dwordx4 v[212:215], v1, s[4:7], s86 offen offset:3072 sc1
    v_mfma_f32_32x32x16_bf16 v[48:63], a[148:151], v[148:151], v[48:63]
    v_mfma_f32_32x32x16_bf16 v[16:31], a[144:147], v[148:151], v[16:31]
    buffer_load_dwordx4 v[216:219], v1, s[4:7], s91 offen offset:1024 sc1
    v_mfma_f32_32x32x16_bf16 v[48:63], a[164:167], v[152:155], v[48:63]
    v_mfma_f32_32x32x16_bf16 v[16:31], a[160:163], v[152:155], v[16:31]
    buffer_load_dwordx4 v[220:223], v1, s[4:7], s91 offen offset:3072 sc1
    v_mfma_f32_32x32x16_bf16 v[48:63], a[180:183], v[156:159], v[48:63]
    v_mfma_f32_32x32x16_bf16 v[16:31], a[176:179], v[156:159], v[16:31]
    s_waitcnt vmcnt(14)
    v_max3_u32 v7, v160, v164, v168
    s_waitcnt vmcnt(13)
    v_max_u32 v7, v7, v172
    v_cmp_eq_u32 vcc, -1, v7
    s_cbranch_vccnz Lre117
Lok117:
    v_mfma_f32_32x32x16_bf16 v[48:63], a[196:199], v[160:163], v[48:63]
    v_mfma_f32_32x32x16_bf16 v[16:31], a[192:195], v[160:163], v[16:31]
    v_mfma_f32_32x32x16_bf16 v[48:63], a[212:215], v[164:167], v[48:63]
    v_mfma_f32_32x32x16_bf16 v[16:31], a[208:211], v[164:167], v[16:31]
    v_mfma_f32_32x32x16_bf16 v[48:63], a[12:15], v[168:171], v[48:63]
    v_mfma_f32_32x32x16_bf16 v[16:31], a[8:11], v[168:171], v[16:31]
    v_mfma_f32_32x32x16_bf16 v[48:63], a[28:31], v[172:175], v[48:63]
    v_mfma_f32_32x32x16_bf16 v[16:31], a[24:27], v[172:175], v[16:31]
    s_waitcnt vmcnt(9)
    v_max3_u32 v7, v176, v180, v184
    s_waitcnt vmcnt(8)
    v_max_u32 v7, v7, v188
    v_cmp_eq_u32 vcc, -1, v7
    s_cbranch_vccnz Lre118
Lok118:
    v_mfma_f32_32x32x16_bf16 v[48:63], a[44:47], v[176:179], v[48:63]
    v_mfma_f32_32x32x16_bf16 v[16:31], a[40:43], v[176:179], v[16:31]
    v_mfma_f32_32x32x16_bf16 v[48:63], a[60:63], v[180:183], v[48:63]
    v_mfma_f32_32x32x16_bf16 v[16:31], a[56:59], v[180:183], v[16:31]
    v_mfma_f32_32x32x16_bf16 v[48:63], a[76:79], v[184:187], v[48:63]
    v_mfma_f32_32x32x16_bf16 v[16:31], a[72:75], v[184:187], v[16:31]
    v_mfma_f32_32x32x16_bf16 v[48:63], a[92:95], v[188:191], v[48:63]
    v_mfma_f32_32x32x16_bf16 v[16:31], a[88:91], v[188:191], v[16:31]
    s_waitcnt vmcnt(5)
    v_max3_u32 v7, v192, v196, v200
    s_waitcnt vmcnt(4)
    v_max_u32 v7, v7, v204
    v_cmp_eq_u32 vcc, -1, v7
    s_cbranch_vccnz Lre119
Lok119:
    v_mfma_f32_32x32x16_bf16 v[48:63], a[108:111], v[192:195], v[48:63]
    v_mfma_f32_32x32x16_bf16 v[16:31], a[104:107], v[192:195], v[16:31]
    v_mfma_f32_32x32x16_bf16 v[48:63], a[124:127], v[196:199], v[48:63]
    v_mfma_f32_32x32x16_bf16 v[16:31], a[120:123], v[196:199], v[16:31]
    v_mfma_f32_32x32x16_bf16 v[48:63], a[140:143], v[200:203], v[48:63]
    v_mfma_f32_32x32x16_bf16 v[16:31], a[136:139], v[200:203], v[16:31]
    v_mfma_f32_32x32x16_bf16 v[48:63], a[156:159], v[204:207], v[48:63]
    v_mfma_f32_32x32x16_bf16 v[16:31], a[152:155], v[204:207], v[16:31]
    s_waitcnt vmcnt(1)
    v_max3_u32 v7, v208, v212, v216
    s_waitcnt vmcnt(0)
    v_max_u32 v7, v7, v220
    v_cmp_eq_u32 vcc, -1, v7
    s_cbranch_vccnz Lre120
Lok120:
    v_mfma_f32_32x32x16_bf16 v[48:63], a[172:175], v[208:211], v[48:63]
    v_mfma_f32_32x32x16_bf16 v[16:31], a[168:171], v[208:211], v[16:31]
    v_mfma_f32_32x32x16_bf16 v[48:63], a[188:191], v[212:215], v[48:63]
    v_mfma_f32_32x32x16_bf16 v[16:31], a[184:187], v[212:215], v[16:31]
    v_mfma_f32_32x32x16_bf16 v[48:63], a[204:207], v[216:219], v[48:63]
    v_mfma_f32_32x32x16_bf16 v[16:31], a[200:203], v[216:219], v[16:31]
    v_mfma_f32_32x32x16_bf16 v[48:63], a[220:223], v[220:223], v[48:63]
    v_mfma_f32_32x32x16_bf16 v[16:31], a[216:219], v[220:223], v[16:31]
    s_nop 10
    ds_write_b128 v122, v[48:51] offset:2048
    ds_write_b128 v122, v[52:55] offset:3072
    ds_write_b128 v123, v[56:59] offset:4096
    ds_write_b128 v123, v[60:63] offset:5120
    ds_write_b128 v121, v[24:27] offset:0
    ds_write_b128 v121, v[28:31] offset:1024
    v_lshlrev_b32 v85, 16, v12
    v_and_b32 v86, 0xffff0000, v12
    v_add_f32 v16, v16, v85
    v_add_f32 v17, v17, v86
    v_lshlrev_b32 v85, 16, v13
    v_and_b32 v86, 0xffff0000, v13
    v_add_f32 v18, v18, v85
    v_add_f32 v19, v19, v86
    v_lshlrev_b32 v85, 16, v14
    v_and_b32 v86, 0xffff0000, v14
    v_add_f32 v20, v20, v85
    v_add_f32 v21, v21, v86
    v_lshlrev_b32 v85, 16, v15
    v_and_b32 v86, 0xffff0000, v15
    v_add_f32 v22, v22, v85
    v_add_f32 v23, v23, v86
    s_waitcnt lgkmcnt(0)
    s_barrier
    ds_read_b128 v[24:27], v120 offset:0
    ds_read_b128 v[48:51], v120 offset:2048
    ds_read_b128 v[56:59], v120 offset:4096
    ds_read_b128 v[28:31], v120 offset:1024
    ds_read_b128 v[52:55], v120 offset:3072
    ds_read_b128 v[60:63], v120 offset:5120
    v_add_f32 v16, v16, v112
    v_add_f32 v17, v17, v113
    v_add_f32 v18, v18, v114
    v_add_f32 v19, v19, v115
    v_add_f32 v20, v20, v116
    v_add_f32 v21, v21, v117
    v_add_f32 v22, v22, v118
    v_add_f32 v23, v23, v119
    s_waitcnt lgkmcnt(5)
    v_add_f32 v16, v16, v24
    v_add_f32 v17, v17, v25
    v_add_f32 v18, v18, v26
    v_add_f32 v19, v19, v27
    s_waitcnt lgkmcnt(4)
    v_add_f32 v16, v16, v48
    v_add_f32 v17, v17, v49
    v_add_f32 v18, v18, v50
    v_add_f32 v19, v19, v51
    s_waitcnt lgkmcnt(3)
    v_add_f32 v16, v16, v56
    v_add_f32 v17, v17, v57
    v_add_f32 v18, v18, v58
    v_add_f32 v19, v19, v59
    v_cvt_pk_bf16_f32 v12, v16, v17
    v_cvt_pk_bf16_f32 v13, v18, v19
    s_waitcnt lgkmcnt(2)
    v_add_f32 v20, v20, v28
    v_add_f32 v21, v21, v29
    v_add_f32 v22, v22, v30
    v_add_f32 v23, v23, v31
    s_waitcnt lgkmcnt(1)
    v_add_f32 v20, v20, v52
    v_add_f32 v21, v21, v53
    v_add_f32 v22, v22, v54
    v_add_f32 v23, v23, v55
    s_waitcnt lgkmcnt(0)
    v_add_f32 v20, v20, v60
    v_add_f32 v21, v21, v61
    v_add_f32 v22, v22, v62
    v_add_f32 v23, v23, v63
    v_cvt_pk_bf16_f32 v14, v20, v21
    v_cvt_pk_bf16_f32 v15, v22, v23
    s_nop 0
    v_permlane32_swap_b32 v12, v14
    v_permlane32_swap_b32 v13, v15
    s_add_u32 s80, s48, 0x8000
    buffer_store_dwordx4 v[12:15], v87, s[96:99], s80 offen
main_end:
    s_endpgm
att_slow0:
    s_mov_b32 s56, 0x0000ffff
    s_mov_b32 s57, 0x0000ffff
    s_lshl_b32 s60, s3, 12
    s_sub_u32 s60, s29, s60
    s_add_u32 s60, s60, 0x800000
    v_mov_b32 v36, s52
    v_mov_b32 v37, s52
    v_mov_b32 v38, s52
    v_mov_b32 v39, s52
    v_mov_b32 v40, s52
    v_mov_b32 v41, s52
    v_mov_b32 v42, s52
    v_mov_b32 v43, s52
    s_add_u32 s58, s28, 0x800000
    buffer_load_dwordx4 v[44:47], v1, s[4:7], s58 offen sc1
    v_mov_b32 v7, 0xff800000
    s_mov_b32 s58, s60
    s_mov_b32 s59, 0
Lmx00:
    buffer_load_dwordx4 v[32:35], v1, s[4:7], s58 offen sc1
    s_add_u32 s58, s58, 2048
    s_add_u32 s59, s59, 1
    s_waitcnt vmcnt(0)
    v_mfma_f32_32x32x16_bf16 v[16:31], v[32:35], v[44:47], 0
    s_cmp_lt_u32 s59, 64
    s_nop 10
    v_max3_f32 v7, v7, v16, v17
    v_max3_f32 v7, v7, v18, v19
    v_max3_f32 v7, v7, v20, v21
    v_max3_f32 v7, v7, v22, v23
    v_max3_f32 v7, v7, v24, v25
    v_max3_f32 v7, v7, v26, v27
    v_max3_f32 v7, v7, v28, v29
    v_max3_f32 v7, v7, v30, v31
    s_cbranch_scc1 Lmx00
    v_mov_b32 v80, v7
    s_nop 1
    v_permlane32_swap_b32 v7, v80
    v_max_f32 v7, v7, v80
    v_mov_b32 v64, 0
    v_mov_b32 v65, 0
    v_mov_b32 v66, 0
    v_mov_b32 v67, 0
    v_mov_b32 v68, 0
    v_mov_b32 v69, 0
    v_mov_b32 v70, 0
    v_mov_b32 v71, 0
    v_mov_b32 v72, 0
    v_mov_b32 v73, 0
    v_mov_b32 v74, 0
    v_mov_b32 v75, 0
    v_mov_b32 v76, 0
    v_mov_b32 v77, 0
    v_mov_b32 v78, 0
    v_mov_b32 v79, 0
    s_mov_b32 s58, s60
    s_mov_b32 s59, 0
Lpv00:
    buffer_load_dwordx4 v[32:35], v1, s[4:7], s58 offen sc1
    s_mov_b64 exec, s[56:57]
    buffer_load_dwordx4 v[36:39], v88, s[4:7], s58 offen sc1
    buffer_load_dwordx4 v[40:43], v89, s[4:7], s58 offen sc1
    s_mov_b64 exec, -1
    s_add_u32 s58, s58, 2048
    s_add_u32 s59, s59, 1
    s_waitcnt vmcnt(0)
    v_mfma_f32_32x32x16_bf16 v[16:31], v[32:35], v[44:47], 0
    s_cmp_lt_u32 s59, 64
    s_nop 10
    v_sub_f32 v16, v16, v7
    v_sub_f32 v17, v17, v7
    v_sub_f32 v18, v18, v7
    v_sub_f32 v19, v19, v7
    v_sub_f32 v20, v20, v7
    v_sub_f32 v21, v21, v7
    v_sub_f32 v22, v22, v7
    v_sub_f32 v23, v23, v7
    v_sub_f32 v24, v24, v7
    v_sub_f32 v25, v25, v7
    v_sub_f32 v26, v26, v7
    v_sub_f32 v27, v27, v7
    v_sub_f32 v28, v28, v7
    v_sub_f32 v29, v29, v7
    v_sub_f32 v30, v30, v7
    v_sub_f32 v31, v31, v7
    v_exp_f32 v16, v16
    v_exp_f32 v17, v17
    v_exp_f32 v18, v18
    v_exp_f32 v19, v19
    v_exp_f32 v20, v20
    v_exp_f32 v21, v21
    v_exp_f32 v22, v22
    v_exp_f32 v23, v23
    v_exp_f32 v24, v24
    v_exp_f32 v25, v25
    v_exp_f32 v26, v26
    v_exp_f32 v27, v27
    v_exp_f32 v28, v28
    v_exp_f32 v29, v29
    v_exp_f32 v30, v30
    v_exp_f32 v31, v31
    v_cvt_pk_bf16_f32 v80, v16, v17
    v_cvt_pk_bf16_f32 v81, v18, v19
    v_cvt_pk_bf16_f32 v82, v20, v21
    v_cvt_pk_bf16_f32 v83, v22, v23
    v_cvt_pk_bf16_f32 v84, v24, v25
    v_cvt_pk_bf16_f32 v85, v26, v27
    v_cvt_pk_bf16_f32 v86, v28, v29
    v_cvt_pk_bf16_f32 v87, v30, v31
    v_mfma_f32_32x32x16_bf16 v[64:79], v[36:39], v[80:83], v[64:79]
    s_nop 0
    v_mfma_f32_32x32x16_bf16 v[64:79], v[40:43], v[84:87], v[64:79]
    s_cbranch_scc1 Lpv00
    s_nop 10
    v_rcp_f32 v73, v72
    s_nop 0
    v_mul_f32 v64, v64, v73
    v_mul_f32 v65, v65, v73
    v_mul_f32 v66, v66, v73
    v_mul_f32 v67, v67, v73
    v_mul_f32 v68, v68, v73
    v_mul_f32 v69, v69, v73
    v_mul_f32 v70, v70, v73
    v_mul_f32 v71, v71, v73
    v_cvt_pk_bf16_f32 v64, v64, v65
    v_cvt_pk_bf16_f32 v65, v66, v67
    v_cvt_pk_bf16_f32 v66, v68, v69
    v_cvt_pk_bf16_f32 v67, v70, v71
    s_add_u32 s58, s30, 0x800000
    buffer_store_dwordx4 v[64:67], v1, s[4:7], s58 offen sc1
    s_add_u32 s58, s28, 0x810000
    buffer_load_dwordx4 v[44:47], v1, s[4:7], s58 offen sc1
    v_mov_b32 v7, 0xff800000
    s_mov_b32 s58, s60
    s_mov_b32 s59, 0
Lmx01:
    buffer_load_dwordx4 v[32:35], v1, s[4:7], s58 offen sc1
    s_add_u32 s58, s58, 2048
    s_add_u32 s59, s59, 1
    s_waitcnt vmcnt(0)
    v_mfma_f32_32x32x16_bf16 v[16:31], v[32:35], v[44:47], 0
    s_cmp_lt_u32 s59, 64
    s_nop 10
    v_max3_f32 v7, v7, v16, v17
    v_max3_f32 v7, v7, v18, v19
    v_max3_f32 v7, v7, v20, v21
    v_max3_f32 v7, v7, v22, v23
    v_max3_f32 v7, v7, v24, v25
    v_max3_f32 v7, v7, v26, v27
    v_max3_f32 v7, v7, v28, v29
    v_max3_f32 v7, v7, v30, v31
    s_cbranch_scc1 Lmx01
    v_mov_b32 v80, v7
    s_nop 1
    v_permlane32_swap_b32 v7, v80
    v_max_f32 v7, v7, v80
    v_mov_b32 v64, 0
    v_mov_b32 v65, 0
    v_mov_b32 v66, 0
    v_mov_b32 v67, 0
    v_mov_b32 v68, 0
    v_mov_b32 v69, 0
    v_mov_b32 v70, 0
    v_mov_b32 v71, 0
    v_mov_b32 v72, 0
    v_mov_b32 v73, 0
    v_mov_b32 v74, 0
    v_mov_b32 v75, 0
    v_mov_b32 v76, 0
    v_mov_b32 v77, 0
    v_mov_b32 v78, 0
    v_mov_b32 v79, 0
    s_mov_b32 s58, s60
    s_mov_b32 s59, 0
Lpv01:
    buffer_load_dwordx4 v[32:35], v1, s[4:7], s58 offen sc1
    s_mov_b64 exec, s[56:57]
    buffer_load_dwordx4 v[36:39], v88, s[4:7], s58 offen sc1
    buffer_load_dwordx4 v[40:43], v89, s[4:7], s58 offen sc1
    s_mov_b64 exec, -1
    s_add_u32 s58, s58, 2048
    s_add_u32 s59, s59, 1
    s_waitcnt vmcnt(0)
    v_mfma_f32_32x32x16_bf16 v[16:31], v[32:35], v[44:47], 0
    s_cmp_lt_u32 s59, 64
    s_nop 10
    v_sub_f32 v16, v16, v7
    v_sub_f32 v17, v17, v7
    v_sub_f32 v18, v18, v7
    v_sub_f32 v19, v19, v7
    v_sub_f32 v20, v20, v7
    v_sub_f32 v21, v21, v7
    v_sub_f32 v22, v22, v7
    v_sub_f32 v23, v23, v7
    v_sub_f32 v24, v24, v7
    v_sub_f32 v25, v25, v7
    v_sub_f32 v26, v26, v7
    v_sub_f32 v27, v27, v7
    v_sub_f32 v28, v28, v7
    v_sub_f32 v29, v29, v7
    v_sub_f32 v30, v30, v7
    v_sub_f32 v31, v31, v7
    v_exp_f32 v16, v16
    v_exp_f32 v17, v17
    v_exp_f32 v18, v18
    v_exp_f32 v19, v19
    v_exp_f32 v20, v20
    v_exp_f32 v21, v21
    v_exp_f32 v22, v22
    v_exp_f32 v23, v23
    v_exp_f32 v24, v24
    v_exp_f32 v25, v25
    v_exp_f32 v26, v26
    v_exp_f32 v27, v27
    v_exp_f32 v28, v28
    v_exp_f32 v29, v29
    v_exp_f32 v30, v30
    v_exp_f32 v31, v31
    v_cvt_pk_bf16_f32 v80, v16, v17
    v_cvt_pk_bf16_f32 v81, v18, v19
    v_cvt_pk_bf16_f32 v82, v20, v21
    v_cvt_pk_bf16_f32 v83, v22, v23
    v_cvt_pk_bf16_f32 v84, v24, v25
    v_cvt_pk_bf16_f32 v85, v26, v27
    v_cvt_pk_bf16_f32 v86, v28, v29
    v_cvt_pk_bf16_f32 v87, v30, v31
    v_mfma_f32_32x32x16_bf16 v[64:79], v[36:39], v[80:83], v[64:79]
    s_nop 0
    v_mfma_f32_32x32x16_bf16 v[64:79], v[40:43], v[84:87], v[64:79]
    s_cbranch_scc1 Lpv01
    s_nop 9
    s_branch att_back0
att_slow1:
    s_mov_b32 s56, 0x0000ffff
    s_mov_b32 s57, 0x0000ffff
    s_lshl_b32 s60, s3, 12
    s_sub_u32 s60, s29, s60
    s_add_u32 s60, s60, 0x1b00000
    v_mov_b32 v36, s52
    v_mov_b32 v37, s52
    v_mov_b32 v38, s52
    v_mov_b32 v39, s52
    v_mov_b32 v40, s52
    v_mov_b32 v41, s52
    v_mov_b32 v42, s52
    v_mov_b32 v43, s52
    s_add_u32 s58, s28, 0x1b00000
    buffer_load_dwordx4 v[44:47], v1, s[4:7], s58 offen sc1
    v_mov_b32 v7, 0xff800000
    s_mov_b32 s58, s60
    s_mov_b32 s59, 0
Lmx10:
    buffer_load_dwordx4 v[32:35], v1, s[4:7], s58 offen sc1
    s_add_u32 s58, s58, 2048
    s_add_u32 s59, s59, 1
    s_waitcnt vmcnt(0)
    v_mfma_f32_32x32x16_bf16 v[16:31], v[32:35], v[44:47], 0
    s_cmp_lt_u32 s59, 64
    s_nop 10
    v_max3_f32 v7, v7, v16, v17
    v_max3_f32 v7, v7, v18, v19
    v_max3_f32 v7, v7, v20, v21
    v_max3_f32 v7, v7, v22, v23
    v_max3_f32 v7, v7, v24, v25
    v_max3_f32 v7, v7, v26, v27
    v_max3_f32 v7, v7, v28, v29
    v_max3_f32 v7, v7, v30, v31
    s_cbranch_scc1 Lmx10
    v_mov_b32 v80, v7
    s_nop 1
    v_permlane32_swap_b32 v7, v80
    v_max_f32 v7, v7, v80
    v_mov_b32 v64, 0
    v_mov_b32 v65, 0
    v_mov_b32 v66, 0
    v_mov_b32 v67, 0
    v_mov_b32 v68, 0
    v_mov_b32 v69, 0
    v_mov_b32 v70, 0
    v_mov_b32 v71, 0
    v_mov_b32 v72, 0
    v_mov_b32 v73, 0
    v_mov_b32 v74, 0
    v_mov_b32 v75, 0
    v_mov_b32 v76, 0
    v_mov_b32 v77, 0
    v_mov_b32 v78, 0
    v_mov_b32 v79, 0
    s_mov_b32 s58, s60
    s_mov_b32 s59, 0
Lpv10:
    buffer_load_dwordx4 v[32:35], v1, s[4:7], s58 offen sc1
    s_mov_b64 exec, s[56:57]
    buffer_load_dwordx4 v[36:39], v88, s[4:7], s58 offen sc1
    buffer_load_dwordx4 v[40:43], v89, s[4:7], s58 offen sc1
    s_mov_b64 exec, -1
    s_add_u32 s58, s58, 2048
    s_add_u32 s59, s59, 1
    s_waitcnt vmcnt(0)
    v_mfma_f32_32x32x16_bf16 v[16:31], v[32:35], v[44:47], 0
    s_cmp_lt_u32 s59, 64
    s_nop 10
    v_sub_f32 v16, v16, v7
    v_sub_f32 v17, v17, v7
    v_sub_f32 v18, v18, v7
    v_sub_f32 v19, v19, v7
    v_sub_f32 v20, v20, v7
    v_sub_f32 v21, v21, v7
    v_sub_f32 v22, v22, v7
    v_sub_f32 v23, v23, v7
    v_sub_f32 v24, v24, v7
    v_sub_f32 v25, v25, v7
    v_sub_f32 v26, v26, v7
    v_sub_f32 v27, v27, v7
    v_sub_f32 v28, v28, v7
    v_sub_f32 v29, v29, v7
    v_sub_f32 v30, v30, v7
    v_sub_f32 v31, v31, v7
    v_exp_f32 v16, v16
    v_exp_f32 v17, v17
    v_exp_f32 v18, v18
    v_exp_f32 v19, v19
    v_exp_f32 v20, v20
    v_exp_f32 v21, v21
    v_exp_f32 v22, v22
    v_exp_f32 v23, v23
    v_exp_f32 v24, v24
    v_exp_f32 v25, v25
    v_exp_f32 v26, v26
    v_exp_f32 v27, v27
    v_exp_f32 v28, v28
    v_exp_f32 v29, v29
    v_exp_f32 v30, v30
    v_exp_f32 v31, v31
    v_cvt_pk_bf16_f32 v80, v16, v17
    v_cvt_pk_bf16_f32 v81, v18, v19
    v_cvt_pk_bf16_f32 v82, v20, v21
    v_cvt_pk_bf16_f32 v83, v22, v23
    v_cvt_pk_bf16_f32 v84, v24, v25
    v_cvt_pk_bf16_f32 v85, v26, v27
    v_cvt_pk_bf16_f32 v86, v28, v29
    v_cvt_pk_bf16_f32 v87, v30, v31
    v_mfma_f32_32x32x16_bf16 v[64:79], v[36:39], v[80:83], v[64:79]
    s_nop 0
    v_mfma_f32_32x32x16_bf16 v[64:79], v[40:43], v[84:87], v[64:79]
    s_cbranch_scc1 Lpv10
    s_nop 10
    v_rcp_f32 v73, v72
    s_nop 0
    v_mul_f32 v64, v64, v73
    v_mul_f32 v65, v65, v73
    v_mul_f32 v66, v66, v73
    v_mul_f32 v67, v67, v73
    v_mul_f32 v68, v68, v73
    v_mul_f32 v69, v69, v73
    v_mul_f32 v70, v70, v73
    v_mul_f32 v71, v71, v73
    v_cvt_pk_bf16_f32 v64, v64, v65
    v_cvt_pk_bf16_f32 v65, v66, v67
    v_cvt_pk_bf16_f32 v66, v68, v69
    v_cvt_pk_bf16_f32 v67, v70, v71
    s_add_u32 s58, s30, 0x1b00000
    buffer_store_dwordx4 v[64:67], v1, s[4:7], s58 offen sc1
    s_add_u32 s58, s28, 0x1b10000
    buffer_load_dwordx4 v[44:47], v1, s[4:7], s58 offen sc1
    v_mov_b32 v7, 0xff800000
    s_mov_b32 s58, s60
    s_mov_b32 s59, 0
Lmx11:
    buffer_load_dwordx4 v[32:35], v1, s[4:7], s58 offen sc1
    s_add_u32 s58, s58, 2048
    s_add_u32 s59, s59, 1
    s_waitcnt vmcnt(0)
    v_mfma_f32_32x32x16_bf16 v[16:31], v[32:35], v[44:47], 0
    s_cmp_lt_u32 s59, 64
    s_nop 10
    v_max3_f32 v7, v7, v16, v17
    v_max3_f32 v7, v7, v18, v19
    v_max3_f32 v7, v7, v20, v21
    v_max3_f32 v7, v7, v22, v23
    v_max3_f32 v7, v7, v24, v25
    v_max3_f32 v7, v7, v26, v27
    v_max3_f32 v7, v7, v28, v29
    v_max3_f32 v7, v7, v30, v31
    s_cbranch_scc1 Lmx11
    v_mov_b32 v80, v7
    s_nop 1
    v_permlane32_swap_b32 v7, v80
    v_max_f32 v7, v7, v80
    v_mov_b32 v64, 0
    v_mov_b32 v65, 0
    v_mov_b32 v66, 0
    v_mov_b32 v67, 0
    v_mov_b32 v68, 0
    v_mov_b32 v69, 0
    v_mov_b32 v70, 0
    v_mov_b32 v71, 0
    v_mov_b32 v72, 0
    v_mov_b32 v73, 0
    v_mov_b32 v74, 0
    v_mov_b32 v75, 0
    v_mov_b32 v76, 0
    v_mov_b32 v77, 0
    v_mov_b32 v78, 0
    v_mov_b32 v79, 0
    s_mov_b32 s58, s60
    s_mov_b32 s59, 0
Lpv11:
    buffer_load_dwordx4 v[32:35], v1, s[4:7], s58 offen sc1
    s_mov_b64 exec, s[56:57]
    buffer_load_dwordx4 v[36:39], v88, s[4:7], s58 offen sc1
    buffer_load_dwordx4 v[40:43], v89, s[4:7], s58 offen sc1
    s_mov_b64 exec, -1
    s_add_u32 s58, s58, 2048
    s_add_u32 s59, s59, 1
    s_waitcnt vmcnt(0)
    v_mfma_f32_32x32x16_bf16 v[16:31], v[32:35], v[44:47], 0
    s_cmp_lt_u32 s59, 64
    s_nop 10
    v_sub_f32 v16, v16, v7
    v_sub_f32 v17, v17, v7
    v_sub_f32 v18, v18, v7
    v_sub_f32 v19, v19, v7
    v_sub_f32 v20, v20, v7
    v_sub_f32 v21, v21, v7
    v_sub_f32 v22, v22, v7
    v_sub_f32 v23, v23, v7
    v_sub_f32 v24, v24, v7
    v_sub_f32 v25, v25, v7
    v_sub_f32 v26, v26, v7
    v_sub_f32 v27, v27, v7
    v_sub_f32 v28, v28, v7
    v_sub_f32 v29, v29, v7
    v_sub_f32 v30, v30, v7
    v_sub_f32 v31, v31, v7
    v_exp_f32 v16, v16
    v_exp_f32 v17, v17
    v_exp_f32 v18, v18
    v_exp_f32 v19, v19
    v_exp_f32 v20, v20
    v_exp_f32 v21, v21
    v_exp_f32 v22, v22
    v_exp_f32 v23, v23
    v_exp_f32 v24, v24
    v_exp_f32 v25, v25
    v_exp_f32 v26, v26
    v_exp_f32 v27, v27
    v_exp_f32 v28, v28
    v_exp_f32 v29, v29
    v_exp_f32 v30, v30
    v_exp_f32 v31, v31
    v_cvt_pk_bf16_f32 v80, v16, v17
    v_cvt_pk_bf16_f32 v81, v18, v19
    v_cvt_pk_bf16_f32 v82, v20, v21
    v_cvt_pk_bf16_f32 v83, v22, v23
    v_cvt_pk_bf16_f32 v84, v24, v25
    v_cvt_pk_bf16_f32 v85, v26, v27
    v_cvt_pk_bf16_f32 v86, v28, v29
    v_cvt_pk_bf16_f32 v87, v30, v31
    v_mfma_f32_32x32x16_bf16 v[64:79], v[36:39], v[80:83], v[64:79]
    s_nop 0
    v_mfma_f32_32x32x16_bf16 v[64:79], v[40:43], v[84:87], v[64:79]
    s_cbranch_scc1 Lpv11
    s_nop 9
    s_branch att_back1
Lre1:
    s_cmp_eq_u32 s94, 0
    s_cbranch_scc1 Lok1
    s_sub_u32 s94, s94, 1
    s_waitcnt lgkmcnt(0)
    s_mov_b32 s92, 0x740000
    buffer_load_dword v11, v9, s[4:7], s92 offen sc1
    s_waitcnt vmcnt(0)
    v_cmp_ne_u32 vcc, 1, v11
    s_cbranch_vccnz Lre1
    s_branch Lok1
Lre2:
    s_cmp_eq_u32 s94, 0
    s_cbranch_scc1 Lok2
    s_sub_u32 s94, s94, 1
    s_mov_b32 s93, m0
    s_waitcnt lgkmcnt(0)
    s_mov_b32 m0, s22
    s_add_u32 s92, s29, 0x800000
    buffer_load_dwordx4 v1, s[4:7], s92 offen sc1 lds
    s_add_u32 m0, s22, 0x400
    s_add_u32 s92, s29, 0x800400
    buffer_load_dwordx4 v1, s[4:7], s92 offen sc1 lds
    s_add_u32 m0, s22, 0x800
    s_add_u32 s92, s29, 0x800800
    buffer_load_dwordx4 v1, s[4:7], s92 offen sc1 lds
    s_add_u32 m0, s22, 0xc00
    s_add_u32 s92, s29, 0x800c00
    buffer_load_dwordx4 v1, s[4:7], s92 offen sc1 lds
    s_add_u32 m0, s22, 0x4040
    s_add_u32 s92, s29, 0x804000
    buffer_load_dwordx4 v1, s[4:7], s92 offen sc1 lds
    s_add_u32 m0, s22, 0x4440
    s_add_u32 s92, s29, 0x804400
    buffer_load_dwordx4 v1, s[4:7], s92 offen sc1 lds
    s_add_u32 m0, s22, 0x4840
    s_add_u32 s92, s29, 0x804800
    buffer_load_dwordx4 v1, s[4:7], s92 offen sc1 lds
    s_add_u32 m0, s22, 0x4c40
    s_add_u32 s92, s29, 0x804c00
    buffer_load_dwordx4 v1, s[4:7], s92 offen sc1 lds
    s_waitcnt vmcnt(0)
    ds_read2st64_b32 v[32:33], v36 offset0:0 offset1:4
    ds_read2st64_b32 v[34:35], v36 offset0:8 offset1:12
    ds_read2st64_b32 v[40:41], v44 offset0:0 offset1:4
    ds_read2st64_b32 v[42:43], v44 offset0:8 offset1:12
    s_waitcnt lgkmcnt(0)
    s_mov_b32 m0, s93
    v_max3_u32 v7, v32, v33, v34
    v_max_u32 v7, v7, v35
    v_cmp_eq_u32 vcc, -1, v7
    s_cbranch_vccnz Lre2
    s_add_u32 m0, s22, 0x8080
    s_add_u32 s92, s29, 0x808000
    buffer_load_dwordx4 v1, s[4:7], s92 offen sc1 lds
    s_add_u32 m0, s22, 0x8480
    s_add_u32 s92, s29, 0x808400
    buffer_load_dwordx4 v1, s[4:7], s92 offen sc1 lds
    s_add_u32 m0, s22, 0x8880
    s_add_u32 s92, s29, 0x808800
    buffer_load_dwordx4 v1, s[4:7], s92 offen sc1 lds
    s_add_u32 m0, s22, 0x8c80
    s_add_u32 s92, s29, 0x808c00
    buffer_load_dwordx4 v1, s[4:7], s92 offen sc1 lds
    s_add_u32 m0, s22, 0xc0c0
    s_add_u32 s92, s29, 0x80c000
    buffer_load_dwordx4 v1, s[4:7], s92 offen sc1 lds
    s_add_u32 m0, s22, 0xc4c0
    s_add_u32 s92, s29, 0x80c400
    buffer_load_dwordx4 v1, s[4:7], s92 offen sc1 lds
    s_add_u32 m0, s22, 0xc8c0
    s_add_u32 s92, s29, 0x80c800
    buffer_load_dwordx4 v1, s[4:7], s92 offen sc1 lds
    s_add_u32 m0, s22, 0xccc0
    s_add_u32 s92, s29, 0x80cc00
    buffer_load_dwordx4 v1, s[4:7], s92 offen sc1 lds
    s_mov_b32 m0, s93
    s_branch Lok2
Lre3:
    s_cmp_eq_u32 s94, 0
    s_cbranch_scc1 Lok3
    s_sub_u32 s94, s94, 1
    s_mov_b32 s93, m0
    s_waitcnt lgkmcnt(0)
    s_add_u32 m0, s22, 0x4040
    s_add_u32 s92, s29, 0x804000
    buffer_load_dwordx4 v1, s[4:7], s92 offen sc1 lds
    s_add_u32 m0, s22, 0x4440
    s_add_u32 s92, s29, 0x804400
    buffer_load_dwordx4 v1, s[4:7], s92 offen sc1 lds
    s_add_u32 m0, s22, 0x4840
    s_add_u32 s92, s29, 0x804800
    buffer_load_dwordx4 v1, s[4:7], s92 offen sc1 lds
    s_add_u32 m0, s22, 0x4c40
    s_add_u32 s92, s29, 0x804c00
    buffer_load_dwordx4 v1, s[4:7], s92 offen sc1 lds
    s_add_u32 m0, s22, 0x8080
    s_add_u32 s92, s29, 0x808000
    buffer_load_dwordx4 v1, s[4:7], s92 offen sc1 lds
    s_add_u32 m0, s22, 0x8480
    s_add_u32 s92, s29, 0x808400
    buffer_load_dwordx4 v1, s[4:7], s92 offen sc1 lds
    s_add_u32 m0, s22, 0x8880
    s_add_u32 s92, s29, 0x808800
    buffer_load_dwordx4 v1, s[4:7], s92 offen sc1 lds
    s_add_u32 m0, s22, 0x8c80
    s_add_u32 s92, s29, 0x808c00
    buffer_load_dwordx4 v1, s[4:7], s92 offen sc1 lds
    s_waitcnt vmcnt(0)
    ds_read2st64_b32 v[40:41], v44 offset0:0 offset1:4
    ds_read2st64_b32 v[42:43], v44 offset0:8 offset1:12
    s_waitcnt lgkmcnt(0)
    s_mov_b32 m0, s93
    v_max3_u32 v7, v40, v41, v42
    v_max_u32 v7, v7, v43
    v_cmp_eq_u32 vcc, -1, v7
    s_cbranch_vccnz Lre3
    s_add_u32 m0, s22, 0xc0c0
    s_add_u32 s92, s29, 0x80c000
    buffer_load_dwordx4 v1, s[4:7], s92 offen sc1 lds
    s_add_u32 m0, s22, 0xc4c0
    s_add_u32 s92, s29, 0x80c400
    buffer_load_dwordx4 v1, s[4:7], s92 offen sc1 lds
    s_add_u32 m0, s22, 0xc8c0
    s_add_u32 s92, s29, 0x80c800
    buffer_load_dwordx4 v1, s[4:7], s92 offen sc1 lds
    s_add_u32 m0, s22, 0xccc0
    s_add_u32 s92, s29, 0x80cc00
    buffer_load_dwordx4 v1, s[4:7], s92 offen sc1 lds
    s_mov_b32 m0, s93
    s_branch Lok3
Lre4:
    s_cmp_eq_u32 s94, 0
    s_cbranch_scc1 Lok4
    s_sub_u32 s94, s94, 1
    s_waitcnt lgkmcnt(0)
    s_add_u32 s92, s28, 0x800000
    buffer_load_dwordx4 v[96:99], v1, s[4:7], s92 offen sc1
    s_waitcnt vmcnt(0)
    v_cmp_eq_u32 vcc, -1, v96
    s_cbranch_vccnz Lre4
    s_branch Lok4
Lre5:
    s_cmp_eq_u32 s94, 0
    s_cbranch_scc1 Lok5
    s_sub_u32 s94, s94, 1
    s_waitcnt lgkmcnt(0)
    s_mov_b32 s92, 0x740004
    buffer_load_dword v11, v9, s[4:7], s92 offen sc1
    s_waitcnt vmcnt(0)
    v_cmp_ne_u32 vcc, 1, v11
    s_cbranch_vccnz Lre5
    s_branch Lok5
Lre6:
    s_cmp_eq_u32 s94, 0
    s_cbranch_scc1 Lok6
    s_sub_u32 s94, s94, 1
    s_mov_b32 s93, m0
    s_waitcnt lgkmcnt(0)
    s_add_u32 m0, s22, 0x8080
    s_add_u32 s92, s29, 0x808000
    buffer_load_dwordx4 v1, s[4:7], s92 offen sc1 lds
    s_add_u32 m0, s22, 0x8480
    s_add_u32 s92, s29, 0x808400
    buffer_load_dwordx4 v1, s[4:7], s92 offen sc1 lds
    s_add_u32 m0, s22, 0x8880
    s_add_u32 s92, s29, 0x808800
    buffer_load_dwordx4 v1, s[4:7], s92 offen sc1 lds
    s_add_u32 m0, s22, 0x8c80
    s_add_u32 s92, s29, 0x808c00
    buffer_load_dwordx4 v1, s[4:7], s92 offen sc1 lds
    s_add_u32 m0, s22, 0xc0c0
    s_add_u32 s92, s29, 0x80c000
    buffer_load_dwordx4 v1, s[4:7], s92 offen sc1 lds
    s_add_u32 m0, s22, 0xc4c0
    s_add_u32 s92, s29, 0x80c400
    buffer_load_dwordx4 v1, s[4:7], s92 offen sc1 lds
    s_add_u32 m0, s22, 0xc8c0
    s_add_u32 s92, s29, 0x80c800
    buffer_load_dwordx4 v1, s[4:7], s92 offen sc1 lds
    s_add_u32 m0, s22, 0xccc0
    s_add_u32 s92, s29, 0x80cc00
    buffer_load_dwordx4 v1, s[4:7], s92 offen sc1 lds
    s_waitcnt vmcnt(0)
    ds_read2st64_b32 v[104:105], v108 offset0:0 offset1:4
    ds_read2st64_b32 v[106:107], v108 offset0:8 offset1:12
    s_waitcnt lgkmcnt(0)
    s_mov_b32 m0, s93
    v_max3_u32 v7, v104, v105, v106
    v_max_u32 v7, v7, v107
    v_cmp_eq_u32 vcc, -1, v7
    s_cbranch_vccnz Lre6
    s_branch Lok6
Lre7:
    s_cmp_eq_u32 s94, 0
    s_cbranch_scc1 Lok7
    s_sub_u32 s94, s94, 1
    s_mov_b32 s93, m0
    s_waitcnt lgkmcnt(0)
    s_add_u32 m0, s22, 0xc0c0
    s_add_u32 s92, s29, 0x80c000
    buffer_load_dwordx4 v1, s[4:7], s92 offen sc1 lds
    s_add_u32 m0, s22, 0xc4c0
    s_add_u32 s92, s29, 0x80c400
    buffer_load_dwordx4 v1, s[4:7], s92 offen sc1 lds
    s_add_u32 m0, s22, 0xc8c0
    s_add_u32 s92, s29, 0x80c800
    buffer_load_dwordx4 v1, s[4:7], s92 offen sc1 lds
    s_add_u32 m0, s22, 0xccc0
    s_add_u32 s92, s29, 0x80cc00
    buffer_load_dwordx4 v1, s[4:7], s92 offen sc1 lds
    s_waitcnt vmcnt(0)
    ds_read2st64_b32 v[104:105], v108 offset0:0 offset1:4
    ds_read2st64_b32 v[106:107], v108 offset0:8 offset1:12
    s_waitcnt lgkmcnt(0)
    s_mov_b32 m0, s93
    v_max3_u32 v7, v104, v105, v106
    v_max_u32 v7, v7, v107
    v_cmp_eq_u32 vcc, -1, v7
    s_cbranch_vccnz Lre7
    s_branch Lok7
Lre8:
    s_cmp_eq_u32 s94, 0
    s_cbranch_scc1 Lok8
    s_sub_u32 s94, s94, 1
    s_waitcnt lgkmcnt(0)
    s_add_u32 s92, s28, 0x810000
    buffer_load_dwordx4 v[100:103], v1, s[4:7], s92 offen sc1
    s_waitcnt vmcnt(0)
    v_cmp_eq_u32 vcc, -1, v100
    s_cbranch_vccnz Lre8
    s_branch Lok8
Lre9:
    s_cmp_eq_u32 s94, 0
    s_cbranch_scc1 Lok9
    s_sub_u32 s94, s94, 1
    s_mov_b32 s93, m0
    s_waitcnt lgkmcnt(0)
    s_add_u32 m0, s22, 0x10100
    s_add_u32 s92, s29, 0x810000
    buffer_load_dwordx4 v1, s[4:7], s92 offen sc1 lds
    s_add_u32 m0, s22, 0x10500
    s_add_u32 s92, s29, 0x810400
    buffer_load_dwordx4 v1, s[4:7], s92 offen sc1 lds
    s_add_u32 m0, s22, 0x10900
    s_add_u32 s92, s29, 0x810800
    buffer_load_dwordx4 v1, s[4:7], s92 offen sc1 lds
    s_add_u32 m0, s22, 0x10d00
    s_add_u32 s92, s29, 0x810c00
    buffer_load_dwordx4 v1, s[4:7], s92 offen sc1 lds
    s_waitcnt vmcnt(0)
    ds_read2st64_b32 v[104:105], v108 offset0:0 offset1:4
    ds_read2st64_b32 v[106:107], v108 offset0:8 offset1:12
    s_waitcnt lgkmcnt(0)
    s_mov_b32 m0, s93
    v_max3_u32 v7, v104, v105, v106
    v_max_u32 v7, v7, v107
    v_cmp_eq_u32 vcc, -1, v7
    s_cbranch_vccnz Lre9
    s_branch Lok9
Lre10:
    s_cmp_eq_u32 s94, 0
    s_cbranch_scc1 Lok10
    s_sub_u32 s94, s94, 1
    s_mov_b32 s93, m0
    s_waitcnt lgkmcnt(0)
    s_add_u32 m0, s22, 0x14140
    s_add_u32 s92, s29, 0x814000
    buffer_load_dwordx4 v1, s[4:7], s92 offen sc1 lds
    s_add_u32 m0, s22, 0x14540
    s_add_u32 s92, s29, 0x814400
    buffer_load_dwordx4 v1, s[4:7], s92 offen sc1 lds
    s_add_u32 m0, s22, 0x14940
    s_add_u32 s92, s29, 0x814800
    buffer_load_dwordx4 v1, s[4:7], s92 offen sc1 lds
    s_add_u32 m0, s22, 0x14d40
    s_add_u32 s92, s29, 0x814c00
    buffer_load_dwordx4 v1, s[4:7], s92 offen sc1 lds
    s_waitcnt vmcnt(0)
    ds_read2st64_b32 v[104:105], v108 offset0:0 offset1:4
    ds_read2st64_b32 v[106:107], v108 offset0:8 offset1:12
    s_waitcnt lgkmcnt(0)
    s_mov_b32 m0, s93
    v_max3_u32 v7, v104, v105, v106
    v_max_u32 v7, v7, v107
    v_cmp_eq_u32 vcc, -1, v7
    s_cbranch_vccnz Lre10
    s_branch Lok10
Lre11:
    s_cmp_eq_u32 s94, 0
    s_cbranch_scc1 Lok11
    s_sub_u32 s94, s94, 1
    s_waitcnt lgkmcnt(0)
    s_mov_b32 s92, 0x740040
    buffer_load_dword v11, v9, s[4:7], s92 offen sc1
    s_waitcnt vmcnt(0)
    v_cmp_ne_u32 vcc, 1, v11
    s_cbranch_vccnz Lre11
    s_branch Lok11
Lre12:
    s_cmp_eq_u32 s94, 0
    s_cbranch_scc1 Lok12
    s_sub_u32 s94, s94, 1
    s_mov_b32 s93, m0
    s_waitcnt lgkmcnt(0)
    s_add_u32 m0, s22, 0x18180
    s_add_u32 s92, s29, 0x818000
    buffer_load_dwordx4 v1, s[4:7], s92 offen sc1 lds
    s_add_u32 m0, s22, 0x18580
    s_add_u32 s92, s29, 0x818400
    buffer_load_dwordx4 v1, s[4:7], s92 offen sc1 lds
    s_add_u32 m0, s22, 0x18980
    s_add_u32 s92, s29, 0x818800
    buffer_load_dwordx4 v1, s[4:7], s92 offen sc1 lds
    s_add_u32 m0, s22, 0x18d80
    s_add_u32 s92, s29, 0x818c00
    buffer_load_dwordx4 v1, s[4:7], s92 offen sc1 lds
    s_waitcnt vmcnt(0)
    ds_read2st64_b32 v[104:105], v108 offset0:0 offset1:4
    ds_read2st64_b32 v[106:107], v108 offset0:8 offset1:12
    s_waitcnt lgkmcnt(0)
    s_mov_b32 m0, s93
    v_max3_u32 v7, v104, v105, v106
    v_max_u32 v7, v7, v107
    v_cmp_eq_u32 vcc, -1, v7
    s_cbranch_vccnz Lre12
    s_branch Lok12
Lre13:
    s_cmp_eq_u32 s94, 0
    s_cbranch_scc1 Lok13
    s_sub_u32 s94, s94, 1
    s_mov_b32 s93, m0
    s_waitcnt lgkmcnt(0)
    s_add_u32 m0, s22, 0x1c1c0
    s_add_u32 s92, s29, 0x81c000
    buffer_load_dwordx4 v1, s[4:7], s92 offen sc1 lds
    s_add_u32 m0, s22, 0x1c5c0
    s_add_u32 s92, s29, 0x81c400
    buffer_load_dwordx4 v1, s[4:7], s92 offen sc1 lds
    s_add_u32 m0, s22, 0x1c9c0
    s_add_u32 s92, s29, 0x81c800
    buffer_load_dwordx4 v1, s[4:7], s92 offen sc1 lds
    s_add_u32 m0, s22, 0x1cdc0
    s_add_u32 s92, s29, 0x81cc00
    buffer_load_dwordx4 v1, s[4:7], s92 offen sc1 lds
    s_waitcnt vmcnt(0)
    ds_read2st64_b32 v[104:105], v108 offset0:0 offset1:4
    ds_read2st64_b32 v[106:107], v108 offset0:8 offset1:12
    s_waitcnt lgkmcnt(0)
    s_mov_b32 m0, s93
    v_max3_u32 v7, v104, v105, v106
    v_max_u32 v7, v7, v107
    v_cmp_eq_u32 vcc, -1, v7
    s_cbranch_vccnz Lre13
    s_branch Lok13
Lre14:
    s_cmp_eq_u32 s94, 0
    s_cbranch_scc1 Lok14
    s_sub_u32 s94, s94, 1
    s_waitcnt lgkmcnt(0)
    s_mov_b32 s92, 0x5f0000
    buffer_load_dword v105, v104, s[4:7], s92 offen sc1
    s_waitcnt vmcnt(0)
    v_cmp_ne_u32 vcc, 16, v105
    s_cbranch_vccnz Lre14
    s_branch Lok14
Lre15:
    s_cmp_eq_u32 s94, 0
    s_cbranch_scc1 Lok15
    s_sub_u32 s94, s94, 1
    s_waitcnt lgkmcnt(0)
    s_add_u32 s92, s17, 0x1000000
    buffer_load_dwordx4 v[48:51], v1, s[4:7], s92 offen sc1
    s_add_u32 s92, s17, 0x1000400
    buffer_load_dwordx4 v[52:55], v1, s[4:7], s92 offen sc1
    s_add_u32 s92, s17, 0x1000800
    buffer_load_dwordx4 v[56:59], v1, s[4:7], s92 offen sc1
    s_add_u32 s92, s17, 0x1000c00
    buffer_load_dwordx4 v[60:63], v1, s[4:7], s92 offen sc1
    s_add_u32 s92, s17, 0x1001000
    buffer_load_dwordx4 v[96:99], v1, s[4:7], s92 offen sc1
    s_add_u32 s92, s17, 0x1001400
    buffer_load_dwordx4 v[100:103], v1, s[4:7], s92 offen sc1
    s_add_u32 s92, s17, 0x1001800
    buffer_load_dwordx4 v[104:107], v1, s[4:7], s92 offen sc1
    s_add_u32 s92, s17, 0x1001c00
    buffer_load_dwordx4 v[108:111], v1, s[4:7], s92 offen sc1
    s_waitcnt vmcnt(0)
    v_max3_u32 v7, v48, v52, v56
    v_max_u32 v7, v7, v60
    v_cmp_eq_u32 vcc, -1, v7
    s_cbranch_vccnz Lre15
    s_branch Lok15
Lre16:
    s_cmp_eq_u32 s94, 0
    s_cbranch_scc1 Lok16
    s_sub_u32 s94, s94, 1
    s_waitcnt lgkmcnt(0)
    s_add_u32 s92, s17, 0x1001000
    buffer_load_dwordx4 v[96:99], v1, s[4:7], s92 offen sc1
    s_add_u32 s92, s17, 0x1001400
    buffer_load_dwordx4 v[100:103], v1, s[4:7], s92 offen sc1
    s_add_u32 s92, s17, 0x1001800
    buffer_load_dwordx4 v[104:107], v1, s[4:7], s92 offen sc1
    s_add_u32 s92, s17, 0x1001c00
    buffer_load_dwordx4 v[108:111], v1, s[4:7], s92 offen sc1
    s_waitcnt vmcnt(0)
    v_max3_u32 v7, v96, v100, v104
    v_max_u32 v7, v7, v108
    v_cmp_eq_u32 vcc, -1, v7
    s_cbranch_vccnz Lre16
    s_branch Lok16
Lre17:
    buffer_store_dwordx4 v[8:11], v1, s[4:7], s90 offen sc1
    s_branch Lok17
Lre18:
    buffer_store_dword v36, v127, s[4:7], s86 offen sc1
    s_branch Lok18
Lre19:
    s_cmp_eq_u32 s94, 0
    s_cbranch_scc1 Lok19
    s_sub_u32 s94, s94, 1
    s_waitcnt lgkmcnt(0)
    s_add_u32 s92, s17, 0x1008000
    buffer_load_dwordx4 v[64:67], v1, s[4:7], s92 offen sc1
    s_add_u32 s92, s17, 0x1008400
    buffer_load_dwordx4 v[68:71], v1, s[4:7], s92 offen sc1
    s_add_u32 s92, s17, 0x1008800
    buffer_load_dwordx4 v[72:75], v1, s[4:7], s92 offen sc1
    s_add_u32 s92, s17, 0x1008c00
    buffer_load_dwordx4 v[76:79], v1, s[4:7], s92 offen sc1
    s_add_u32 s92, s17, 0x1009000
    buffer_load_dwordx4 v[48:51], v1, s[4:7], s92 offen sc1
    s_add_u32 s92, s17, 0x1009400
    buffer_load_dwordx4 v[52:55], v1, s[4:7], s92 offen sc1
    s_add_u32 s92, s17, 0x1009800
    buffer_load_dwordx4 v[56:59], v1, s[4:7], s92 offen sc1
    s_add_u32 s92, s17, 0x1009c00
    buffer_load_dwordx4 v[60:63], v1, s[4:7], s92 offen sc1
    s_waitcnt vmcnt(0)
    v_max3_u32 v7, v64, v68, v72
    v_max_u32 v7, v7, v76
    v_cmp_eq_u32 vcc, -1, v7
    s_cbranch_vccnz Lre19
    s_branch Lok19
Lre20:
    s_cmp_eq_u32 s94, 0
    s_cbranch_scc1 Lok20
    s_sub_u32 s94, s94, 1
    s_waitcnt lgkmcnt(0)
    s_add_u32 s92, s17, 0x1009000
    buffer_load_dwordx4 v[48:51], v1, s[4:7], s92 offen sc1
    s_add_u32 s92, s17, 0x1009400
    buffer_load_dwordx4 v[52:55], v1, s[4:7], s92 offen sc1
    s_add_u32 s92, s17, 0x1009800
    buffer_load_dwordx4 v[56:59], v1, s[4:7], s92 offen sc1
    s_add_u32 s92, s17, 0x1009c00
    buffer_load_dwordx4 v[60:63], v1, s[4:7], s92 offen sc1
    s_waitcnt vmcnt(0)
    v_max3_u32 v7, v48, v52, v56
    v_max_u32 v7, v7, v60
    v_cmp_eq_u32 vcc, -1, v7
    s_cbranch_vccnz Lre20
    s_branch Lok20
Lre21:
    buffer_store_dwordx4 v[12:15], v1, s[4:7], s80 offen sc1
    s_branch Lok21
Lre22:
    buffer_store_dword v36, v127, s[4:7], s86 offen offset:2048 sc1
    s_branch Lok22
Lre23:
    s_cmp_eq_u32 s94, 0
    s_cbranch_scc1 Lok23
    s_sub_u32 s94, s94, 1
    s_mov_b32 s93, m0
    s_waitcnt lgkmcnt(0)
    s_mov_b32 m0, s22
    s_add_u32 s92, s21, 0x1200000
    buffer_load_dwordx4 v1, s[4:7], s92 offen sc1 lds
    s_add_u32 m0, s22, 0x400
    s_add_u32 s92, s21, 0x1200400
    buffer_load_dwordx4 v1, s[4:7], s92 offen sc1 lds
    s_add_u32 m0, s22, 0x800
    s_add_u32 s92, s21, 0x1200800
    buffer_load_dwordx4 v1, s[4:7], s92 offen sc1 lds
    s_add_u32 m0, s22, 0xc00
    s_add_u32 s92, s21, 0x1200c00
    buffer_load_dwordx4 v1, s[4:7], s92 offen sc1 lds
    s_add_u32 m0, s22, 0x4040
    s_add_u32 s92, s21, 0x1204000
    buffer_load_dwordx4 v1, s[4:7], s92 offen sc1 lds
    s_add_u32 m0, s22, 0x4440
    s_add_u32 s92, s21, 0x1204400
    buffer_load_dwordx4 v1, s[4:7], s92 offen sc1 lds
    s_add_u32 m0, s22, 0x4840
    s_add_u32 s92, s21, 0x1204800
    buffer_load_dwordx4 v1, s[4:7], s92 offen sc1 lds
    s_add_u32 m0, s22, 0x4c40
    s_add_u32 s92, s21, 0x1204c00
    buffer_load_dwordx4 v1, s[4:7], s92 offen sc1 lds
    s_waitcnt vmcnt(0)
    ds_read2st64_b32 v[104:105], v108 offset0:0 offset1:4
    ds_read2st64_b32 v[106:107], v108 offset0:8 offset1:12
    ds_read2st64_b32 v[82:83], v86 offset0:0 offset1:4
    ds_read2st64_b32 v[84:85], v86 offset0:8 offset1:12
    s_waitcnt lgkmcnt(0)
    s_mov_b32 m0, s93
    v_max3_u32 v7, v104, v105, v106
    v_max_u32 v7, v7, v107
    v_cmp_eq_u32 vcc, -1, v7
    s_cbranch_vccnz Lre23
    s_branch Lok23
Lre24:
    s_cmp_eq_u32 s94, 0
    s_cbranch_scc1 Lok24
    s_sub_u32 s94, s94, 1
    s_mov_b32 s93, m0
    s_waitcnt lgkmcnt(0)
    s_add_u32 m0, s22, 0x4040
    s_add_u32 s92, s21, 0x1204000
    buffer_load_dwordx4 v1, s[4:7], s92 offen sc1 lds
    s_add_u32 m0, s22, 0x4440
    s_add_u32 s92, s21, 0x1204400
    buffer_load_dwordx4 v1, s[4:7], s92 offen sc1 lds
    s_add_u32 m0, s22, 0x4840
    s_add_u32 s92, s21, 0x1204800
    buffer_load_dwordx4 v1, s[4:7], s92 offen sc1 lds
    s_add_u32 m0, s22, 0x4c40
    s_add_u32 s92, s21, 0x1204c00
    buffer_load_dwordx4 v1, s[4:7], s92 offen sc1 lds
    s_waitcnt vmcnt(0)
    ds_read2st64_b32 v[82:83], v86 offset0:0 offset1:4
    ds_read2st64_b32 v[84:85], v86 offset0:8 offset1:12
    s_waitcnt lgkmcnt(0)
    s_mov_b32 m0, s93
    v_max3_u32 v7, v82, v83, v84
    v_max_u32 v7, v7, v85
    v_cmp_eq_u32 vcc, -1, v7
    s_cbranch_vccnz Lre24
    s_branch Lok24
Lre25:
    s_cmp_eq_u32 s94, 0
    s_cbranch_scc1 Lok25
    s_sub_u32 s94, s94, 1
    s_waitcnt lgkmcnt(0)
    s_add_u32 s92, s19, 0x620000
    buffer_load_dwordx4 v[64:67], v47, s[4:7], s92 offen sc1
    s_add_u32 s92, s19, 0x620200
    buffer_load_dwordx4 v[68:71], v47, s[4:7], s92 offen sc1
    s_add_u32 s92, s19, 0x620400
    buffer_load_dwordx4 v[72:75], v47, s[4:7], s92 offen sc1
    s_add_u32 s92, s19, 0x620600
    buffer_load_dwordx4 v[76:79], v47, s[4:7], s92 offen sc1
    s_waitcnt vmcnt(0)
    v_max3_u32 v7, v64, v65, v66
    v_max3_u32 v7, v7, v67, v68
    v_max3_u32 v7, v7, v69, v70
    v_max3_u32 v7, v7, v71, v72
    v_max3_u32 v7, v7, v73, v74
    v_max3_u32 v7, v7, v75, v76
    v_max3_u32 v7, v7, v77, v78
    v_max_u32 v7, v7, v79
    v_cmp_eq_u32 vcc, -1, v7
    s_cbranch_vccnz Lre25
    s_branch Lok25
Lre26:
    s_cmp_eq_u32 s94, 0
    s_cbranch_scc1 Lok26
    s_sub_u32 s94, s94, 1
    s_mov_b32 s93, m0
    s_waitcnt lgkmcnt(0)
    s_add_u32 m0, s22, 0x8080
    s_add_u32 s92, s21, 0x1210000
    buffer_load_dwordx4 v1, s[4:7], s92 offen sc1 lds
    s_add_u32 m0, s22, 0x8480
    s_add_u32 s92, s21, 0x1210400
    buffer_load_dwordx4 v1, s[4:7], s92 offen sc1 lds
    s_add_u32 m0, s22, 0x8880
    s_add_u32 s92, s21, 0x1210800
    buffer_load_dwordx4 v1, s[4:7], s92 offen sc1 lds
    s_add_u32 m0, s22, 0x8c80
    s_add_u32 s92, s21, 0x1210c00
    buffer_load_dwordx4 v1, s[4:7], s92 offen sc1 lds
    s_add_u32 m0, s22, 0xc0c0
    s_add_u32 s92, s21, 0x1214000
    buffer_load_dwordx4 v1, s[4:7], s92 offen sc1 lds
    s_add_u32 m0, s22, 0xc4c0
    s_add_u32 s92, s21, 0x1214400
    buffer_load_dwordx4 v1, s[4:7], s92 offen sc1 lds
    s_add_u32 m0, s22, 0xc8c0
    s_add_u32 s92, s21, 0x1214800
    buffer_load_dwordx4 v1, s[4:7], s92 offen sc1 lds
    s_add_u32 m0, s22, 0xccc0
    s_add_u32 s92, s21, 0x1214c00
    buffer_load_dwordx4 v1, s[4:7], s92 offen sc1 lds
    s_waitcnt vmcnt(0)
    ds_read2st64_b32 v[42:43], v46 offset0:0 offset1:4
    ds_read2st64_b32 v[44:45], v46 offset0:8 offset1:12
    ds_read2st64_b32 v[106:107], v110 offset0:0 offset1:4
    ds_read2st64_b32 v[108:109], v110 offset0:8 offset1:12
    s_waitcnt lgkmcnt(0)
    s_mov_b32 m0, s93
    v_max3_u32 v7, v42, v43, v44
    v_max_u32 v7, v7, v45
    v_cmp_eq_u32 vcc, -1, v7
    s_cbranch_vccnz Lre26
    s_branch Lok26
Lre27:
    s_cmp_eq_u32 s94, 0
    s_cbranch_scc1 Lok27
    s_sub_u32 s94, s94, 1
    s_mov_b32 s93, m0
    s_waitcnt lgkmcnt(0)
    s_add_u32 m0, s22, 0xc0c0
    s_add_u32 s92, s21, 0x1214000
    buffer_load_dwordx4 v1, s[4:7], s92 offen sc1 lds
    s_add_u32 m0, s22, 0xc4c0
    s_add_u32 s92, s21, 0x1214400
    buffer_load_dwordx4 v1, s[4:7], s92 offen sc1 lds
    s_add_u32 m0, s22, 0xc8c0
    s_add_u32 s92, s21, 0x1214800
    buffer_load_dwordx4 v1, s[4:7], s92 offen sc1 lds
    s_add_u32 m0, s22, 0xccc0
    s_add_u32 s92, s21, 0x1214c00
    buffer_load_dwordx4 v1, s[4:7], s92 offen sc1 lds
    s_waitcnt vmcnt(0)
    ds_read2st64_b32 v[106:107], v110 offset0:0 offset1:4
    ds_read2st64_b32 v[108:109], v110 offset0:8 offset1:12
    s_waitcnt lgkmcnt(0)
    s_mov_b32 m0, s93
    v_max3_u32 v7, v106, v107, v108
    v_max_u32 v7, v7, v109
    v_cmp_eq_u32 vcc, -1, v7
    s_cbranch_vccnz Lre27
    s_branch Lok27
Lre28:
    buffer_store_dwordx4 v[16:19], v1, s[4:7], s88 offen sc1
    s_branch Lok28
Lre29:
    s_cmp_eq_u32 s94, 0
    s_cbranch_scc1 Lok29
    s_sub_u32 s94, s94, 1
    s_mov_b32 s93, m0
    s_waitcnt lgkmcnt(0)
    s_add_u32 m0, s22, 0x10100
    s_add_u32 s92, s21, 0x1208000
    buffer_load_dwordx4 v1, s[4:7], s92 offen sc1 lds
    s_add_u32 m0, s22, 0x10500
    s_add_u32 s92, s21, 0x1208400
    buffer_load_dwordx4 v1, s[4:7], s92 offen sc1 lds
    s_add_u32 m0, s22, 0x10900
    s_add_u32 s92, s21, 0x1208800
    buffer_load_dwordx4 v1, s[4:7], s92 offen sc1 lds
    s_add_u32 m0, s22, 0x10d00
    s_add_u32 s92, s21, 0x1208c00
    buffer_load_dwordx4 v1, s[4:7], s92 offen sc1 lds
    s_add_u32 m0, s22, 0x14140
    s_add_u32 s92, s21, 0x120c000
    buffer_load_dwordx4 v1, s[4:7], s92 offen sc1 lds
    s_add_u32 m0, s22, 0x14540
    s_add_u32 s92, s21, 0x120c400
    buffer_load_dwordx4 v1, s[4:7], s92 offen sc1 lds
    s_add_u32 m0, s22, 0x14940
    s_add_u32 s92, s21, 0x120c800
    buffer_load_dwordx4 v1, s[4:7], s92 offen sc1 lds
    s_add_u32 m0, s22, 0x14d40
    s_add_u32 s92, s21, 0x120cc00
    buffer_load_dwordx4 v1, s[4:7], s92 offen sc1 lds
    s_waitcnt vmcnt(0)
    ds_read2st64_b32 v[42:43], v46 offset0:0 offset1:4
    ds_read2st64_b32 v[44:45], v46 offset0:8 offset1:12
    ds_read2st64_b32 v[106:107], v110 offset0:0 offset1:4
    ds_read2st64_b32 v[108:109], v110 offset0:8 offset1:12
    s_waitcnt lgkmcnt(0)
    s_mov_b32 m0, s93
    v_max3_u32 v7, v42, v43, v44
    v_max_u32 v7, v7, v45
    v_cmp_eq_u32 vcc, -1, v7
    s_cbranch_vccnz Lre29
    s_branch Lok29
Lre30:
    s_cmp_eq_u32 s94, 0
    s_cbranch_scc1 Lok30
    s_sub_u32 s94, s94, 1
    s_mov_b32 s93, m0
    s_waitcnt lgkmcnt(0)
    s_add_u32 m0, s22, 0x14140
    s_add_u32 s92, s21, 0x120c000
    buffer_load_dwordx4 v1, s[4:7], s92 offen sc1 lds
    s_add_u32 m0, s22, 0x14540
    s_add_u32 s92, s21, 0x120c400
    buffer_load_dwordx4 v1, s[4:7], s92 offen sc1 lds
    s_add_u32 m0, s22, 0x14940
    s_add_u32 s92, s21, 0x120c800
    buffer_load_dwordx4 v1, s[4:7], s92 offen sc1 lds
    s_add_u32 m0, s22, 0x14d40
    s_add_u32 s92, s21, 0x120cc00
    buffer_load_dwordx4 v1, s[4:7], s92 offen sc1 lds
    s_waitcnt vmcnt(0)
    ds_read2st64_b32 v[106:107], v110 offset0:0 offset1:4
    ds_read2st64_b32 v[108:109], v110 offset0:8 offset1:12
    s_waitcnt lgkmcnt(0)
    s_mov_b32 m0, s93
    v_max3_u32 v7, v106, v107, v108
    v_max_u32 v7, v7, v109
    v_cmp_eq_u32 vcc, -1, v7
    s_cbranch_vccnz Lre30
    s_branch Lok30
Lre31:
    buffer_store_dwordx4 v[24:27], v1, s[4:7], s88 offen offset:1024 sc1
    s_branch Lok31
Lre32:
    s_cmp_eq_u32 s94, 0
    s_cbranch_scc1 Lok32
    s_sub_u32 s94, s94, 1
    s_waitcnt lgkmcnt(0)
    s_add_u32 s92, s19, 0x620800
    buffer_load_dwordx4 v[64:67], v47, s[4:7], s92 offen sc1
    s_add_u32 s92, s19, 0x620a00
    buffer_load_dwordx4 v[68:71], v47, s[4:7], s92 offen sc1
    s_add_u32 s92, s19, 0x620c00
    buffer_load_dwordx4 v[72:75], v47, s[4:7], s92 offen sc1
    s_add_u32 s92, s19, 0x620e00
    buffer_load_dwordx4 v[76:79], v47, s[4:7], s92 offen sc1
    s_waitcnt vmcnt(0)
    v_max3_u32 v7, v64, v65, v66
    v_max3_u32 v7, v7, v67, v68
    v_max3_u32 v7, v7, v69, v70
    v_max3_u32 v7, v7, v71, v72
    v_max3_u32 v7, v7, v73, v74
    v_max3_u32 v7, v7, v75, v76
    v_max3_u32 v7, v7, v77, v78
    v_max_u32 v7, v7, v79
    v_cmp_eq_u32 vcc, -1, v7
    s_cbranch_vccnz Lre32
    s_branch Lok32
Lre33:
    buffer_store_dwordx4 v[48:51], v1, s[4:7], s86 offen sc1
    s_branch Lok33
Lre34:
    s_cmp_eq_u32 s94, 0
    s_cbranch_scc1 Lok34
    s_sub_u32 s94, s94, 1
    s_mov_b32 s93, m0
    s_waitcnt lgkmcnt(0)
    s_mov_b32 m0, s22
    s_add_u32 s92, s21, 0x1218000
    buffer_load_dwordx4 v1, s[4:7], s92 offen sc1 lds
    s_add_u32 m0, s22, 0x400
    s_add_u32 s92, s21, 0x1218400
    buffer_load_dwordx4 v1, s[4:7], s92 offen sc1 lds
    s_add_u32 m0, s22, 0x800
    s_add_u32 s92, s21, 0x1218800
    buffer_load_dwordx4 v1, s[4:7], s92 offen sc1 lds
    s_add_u32 m0, s22, 0xc00
    s_add_u32 s92, s21, 0x1218c00
    buffer_load_dwordx4 v1, s[4:7], s92 offen sc1 lds
    s_add_u32 m0, s22, 0x4040
    s_add_u32 s92, s21, 0x121c000
    buffer_load_dwordx4 v1, s[4:7], s92 offen sc1 lds
    s_add_u32 m0, s22, 0x4440
    s_add_u32 s92, s21, 0x121c400
    buffer_load_dwordx4 v1, s[4:7], s92 offen sc1 lds
    s_add_u32 m0, s22, 0x4840
    s_add_u32 s92, s21, 0x121c800
    buffer_load_dwordx4 v1, s[4:7], s92 offen sc1 lds
    s_add_u32 m0, s22, 0x4c40
    s_add_u32 s92, s21, 0x121cc00
    buffer_load_dwordx4 v1, s[4:7], s92 offen sc1 lds
    s_waitcnt vmcnt(0)
    ds_read2st64_b32 v[42:43], v46 offset0:0 offset1:4
    ds_read2st64_b32 v[44:45], v46 offset0:8 offset1:12
    ds_read2st64_b32 v[106:107], v110 offset0:0 offset1:4
    ds_read2st64_b32 v[108:109], v110 offset0:8 offset1:12
    s_waitcnt lgkmcnt(0)
    s_mov_b32 m0, s93
    v_max3_u32 v7, v42, v43, v44
    v_max_u32 v7, v7, v45
    v_cmp_eq_u32 vcc, -1, v7
    s_cbranch_vccnz Lre34
    s_branch Lok34
Lre35:
    s_cmp_eq_u32 s94, 0
    s_cbranch_scc1 Lok35
    s_sub_u32 s94, s94, 1
    s_mov_b32 s93, m0
    s_waitcnt lgkmcnt(0)
    s_add_u32 m0, s22, 0x4040
    s_add_u32 s92, s21, 0x121c000
    buffer_load_dwordx4 v1, s[4:7], s92 offen sc1 lds
    s_add_u32 m0, s22, 0x4440
    s_add_u32 s92, s21, 0x121c400
    buffer_load_dwordx4 v1, s[4:7], s92 offen sc1 lds
    s_add_u32 m0, s22, 0x4840
    s_add_u32 s92, s21, 0x121c800
    buffer_load_dwordx4 v1, s[4:7], s92 offen sc1 lds
    s_add_u32 m0, s22, 0x4c40
    s_add_u32 s92, s21, 0x121cc00
    buffer_load_dwordx4 v1, s[4:7], s92 offen sc1 lds
    s_waitcnt vmcnt(0)
    ds_read2st64_b32 v[106:107], v110 offset0:0 offset1:4
    ds_read2st64_b32 v[108:109], v110 offset0:8 offset1:12
    s_waitcnt lgkmcnt(0)
    s_mov_b32 m0, s93
    v_max3_u32 v7, v106, v107, v108
    v_max_u32 v7, v7, v109
    v_cmp_eq_u32 vcc, -1, v7
    s_cbranch_vccnz Lre35
    s_branch Lok35
Lre36:
    buffer_store_dwordx4 v[56:59], v1, s[4:7], s86 offen offset:1024 sc1
    s_branch Lok36
Lre37:
    buffer_store_dwordx4 v[16:19], v1, s[4:7], s86 offen sc1
    s_branch Lok37
Lre38:
    buffer_store_dwordx4 v[24:27], v1, s[4:7], s86 offen offset:1024 sc1
    s_branch Lok38
Lre39:
    buffer_store_dwordx4 v[48:51], v1, s[4:7], s89 offen sc1
    s_branch Lok39
Lre40:
    s_cmp_eq_u32 s94, 0
    s_cbranch_scc1 Lok40
    s_sub_u32 s94, s94, 1
    s_waitcnt lgkmcnt(0)
    s_add_u32 s92, s24, 0x1400000
    buffer_load_dwordx4 v[128:131], v1, s[4:7], s92 offen sc1
    s_add_u32 s92, s24, 0x1400800
    buffer_load_dwordx4 v[132:135], v1, s[4:7], s92 offen sc1
    s_add_u32 s92, s24, 0x1401000
    buffer_load_dwordx4 v[136:139], v1, s[4:7], s92 offen sc1
    s_add_u32 s92, s24, 0x1401800
    buffer_load_dwordx4 v[140:143], v1, s[4:7], s92 offen sc1
    s_add_u32 s92, s24, 0x1402000
    buffer_load_dwordx4 v[144:147], v1, s[4:7], s92 offen sc1
    s_add_u32 s92, s24, 0x1402800
    buffer_load_dwordx4 v[148:151], v1, s[4:7], s92 offen sc1
    s_add_u32 s92, s24, 0x1403000
    buffer_load_dwordx4 v[152:155], v1, s[4:7], s92 offen sc1
    s_add_u32 s92, s24, 0x1403800
    buffer_load_dwordx4 v[156:159], v1, s[4:7], s92 offen sc1
    s_waitcnt vmcnt(0)
    v_max3_u32 v7, v128, v132, v136
    v_max_u32 v7, v7, v140
    v_cmp_eq_u32 vcc, -1, v7
    s_cbranch_vccnz Lre40
    s_add_u32 s92, s24, 0x1404000
    buffer_load_dwordx4 v[160:163], v1, s[4:7], s92 offen sc1
    s_add_u32 s92, s24, 0x1404800
    buffer_load_dwordx4 v[164:167], v1, s[4:7], s92 offen sc1
    s_add_u32 s92, s24, 0x1405000
    buffer_load_dwordx4 v[168:171], v1, s[4:7], s92 offen sc1
    s_add_u32 s92, s24, 0x1405800
    buffer_load_dwordx4 v[172:175], v1, s[4:7], s92 offen sc1
    s_add_u32 s92, s24, 0x1406000
    buffer_load_dwordx4 v[176:179], v1, s[4:7], s92 offen sc1
    s_add_u32 s92, s24, 0x1406800
    buffer_load_dwordx4 v[180:183], v1, s[4:7], s92 offen sc1
    s_add_u32 s92, s24, 0x1400400
    buffer_load_dwordx4 v[184:187], v1, s[4:7], s92 offen sc1
    s_add_u32 s92, s24, 0x1400c00
    buffer_load_dwordx4 v[188:191], v1, s[4:7], s92 offen sc1
    s_add_u32 s92, s24, 0x1401400
    buffer_load_dwordx4 v[192:195], v1, s[4:7], s92 offen sc1
    s_add_u32 s92, s24, 0x1401c00
    buffer_load_dwordx4 v[196:199], v1, s[4:7], s92 offen sc1
    s_branch Lok40
Lre41:
    s_cmp_eq_u32 s94, 0
    s_cbranch_scc1 Lok41
    s_sub_u32 s94, s94, 1
    s_waitcnt lgkmcnt(0)
    s_add_u32 s92, s24, 0x1402000
    buffer_load_dwordx4 v[144:147], v1, s[4:7], s92 offen sc1
    s_add_u32 s92, s24, 0x1402800
    buffer_load_dwordx4 v[148:151], v1, s[4:7], s92 offen sc1
    s_add_u32 s92, s24, 0x1403000
    buffer_load_dwordx4 v[152:155], v1, s[4:7], s92 offen sc1
    s_add_u32 s92, s24, 0x1403800
    buffer_load_dwordx4 v[156:159], v1, s[4:7], s92 offen sc1
    s_add_u32 s92, s24, 0x1404000
    buffer_load_dwordx4 v[160:163], v1, s[4:7], s92 offen sc1
    s_add_u32 s92, s24, 0x1404800
    buffer_load_dwordx4 v[164:167], v1, s[4:7], s92 offen sc1
    s_add_u32 s92, s24, 0x1405000
    buffer_load_dwordx4 v[168:171], v1, s[4:7], s92 offen sc1
    s_add_u32 s92, s24, 0x1405800
    buffer_load_dwordx4 v[172:175], v1, s[4:7], s92 offen sc1
    s_waitcnt vmcnt(0)
    v_max3_u32 v7, v144, v148, v152
    v_max_u32 v7, v7, v156
    v_cmp_eq_u32 vcc, -1, v7
    s_cbranch_vccnz Lre41
    s_add_u32 s92, s24, 0x1406000
    buffer_load_dwordx4 v[176:179], v1, s[4:7], s92 offen sc1
    s_add_u32 s92, s24, 0x1406800
    buffer_load_dwordx4 v[180:183], v1, s[4:7], s92 offen sc1
    s_add_u32 s92, s24, 0x1400400
    buffer_load_dwordx4 v[184:187], v1, s[4:7], s92 offen sc1
    s_add_u32 s92, s24, 0x1400c00
    buffer_load_dwordx4 v[188:191], v1, s[4:7], s92 offen sc1
    s_add_u32 s92, s24, 0x1401400
    buffer_load_dwordx4 v[192:195], v1, s[4:7], s92 offen sc1
    s_add_u32 s92, s24, 0x1401c00
    buffer_load_dwordx4 v[196:199], v1, s[4:7], s92 offen sc1
    s_add_u32 s92, s24, 0x1402400
    buffer_load_dwordx4 v[200:203], v1, s[4:7], s92 offen sc1
    s_add_u32 s92, s24, 0x1402c00
    buffer_load_dwordx4 v[204:207], v1, s[4:7], s92 offen sc1
    s_add_u32 s92, s24, 0x1403400
    buffer_load_dwordx4 v[208:211], v1, s[4:7], s92 offen sc1
    s_add_u32 s92, s24, 0x1403c00
    buffer_load_dwordx4 v[212:215], v1, s[4:7], s92 offen sc1
    s_branch Lok41
Lre42:
    s_cmp_eq_u32 s94, 0
    s_cbranch_scc1 Lok42
    s_sub_u32 s94, s94, 1
    s_waitcnt lgkmcnt(0)
    s_add_u32 s92, s24, 0x1404000
    buffer_load_dwordx4 v[160:163], v1, s[4:7], s92 offen sc1
    s_add_u32 s92, s24, 0x1404800
    buffer_load_dwordx4 v[164:167], v1, s[4:7], s92 offen sc1
    s_add_u32 s92, s24, 0x1405000
    buffer_load_dwordx4 v[168:171], v1, s[4:7], s92 offen sc1
    s_add_u32 s92, s24, 0x1405800
    buffer_load_dwordx4 v[172:175], v1, s[4:7], s92 offen sc1
    s_add_u32 s92, s24, 0x1406000
    buffer_load_dwordx4 v[176:179], v1, s[4:7], s92 offen sc1
    s_add_u32 s92, s24, 0x1406800
    buffer_load_dwordx4 v[180:183], v1, s[4:7], s92 offen sc1
    s_add_u32 s92, s24, 0x1400400
    buffer_load_dwordx4 v[184:187], v1, s[4:7], s92 offen sc1
    s_add_u32 s92, s24, 0x1400c00
    buffer_load_dwordx4 v[188:191], v1, s[4:7], s92 offen sc1
    s_waitcnt vmcnt(0)
    v_max3_u32 v7, v160, v164, v168
    v_max_u32 v7, v7, v172
    v_cmp_eq_u32 vcc, -1, v7
    s_cbranch_vccnz Lre42
    s_add_u32 s92, s24, 0x1401400
    buffer_load_dwordx4 v[192:195], v1, s[4:7], s92 offen sc1
    s_add_u32 s92, s24, 0x1401c00
    buffer_load_dwordx4 v[196:199], v1, s[4:7], s92 offen sc1
    s_add_u32 s92, s24, 0x1402400
    buffer_load_dwordx4 v[200:203], v1, s[4:7], s92 offen sc1
    s_add_u32 s92, s24, 0x1402c00
    buffer_load_dwordx4 v[204:207], v1, s[4:7], s92 offen sc1
    s_add_u32 s92, s24, 0x1403400
    buffer_load_dwordx4 v[208:211], v1, s[4:7], s92 offen sc1
    s_add_u32 s92, s24, 0x1403c00
    buffer_load_dwordx4 v[212:215], v1, s[4:7], s92 offen sc1
    s_add_u32 s92, s24, 0x1404400
    buffer_load_dwordx4 v[216:219], v1, s[4:7], s92 offen sc1
    s_add_u32 s92, s24, 0x1404c00
    buffer_load_dwordx4 v[220:223], v1, s[4:7], s92 offen sc1
    s_add_u32 s92, s24, 0x1405400
    buffer_load_dwordx4 v[224:227], v1, s[4:7], s92 offen sc1
    s_add_u32 s92, s24, 0x1405c00
    buffer_load_dwordx4 v[228:231], v1, s[4:7], s92 offen sc1
    s_branch Lok42
Lre43:
    buffer_store_dwordx4 v[56:59], v1, s[4:7], s89 offen offset:1024 sc1
    s_branch Lok43
Lre44:
    s_cmp_eq_u32 s94, 0
    s_cbranch_scc1 Lok44
    s_sub_u32 s94, s94, 1
    s_waitcnt lgkmcnt(0)
    s_add_u32 s92, s24, 0x1406000
    buffer_load_dwordx4 v[176:179], v1, s[4:7], s92 offen sc1
    s_add_u32 s92, s24, 0x1406800
    buffer_load_dwordx4 v[180:183], v1, s[4:7], s92 offen sc1
    s_add_u32 s92, s24, 0x1400400
    buffer_load_dwordx4 v[184:187], v1, s[4:7], s92 offen sc1
    s_add_u32 s92, s24, 0x1400c00
    buffer_load_dwordx4 v[188:191], v1, s[4:7], s92 offen sc1
    s_add_u32 s92, s24, 0x1401400
    buffer_load_dwordx4 v[192:195], v1, s[4:7], s92 offen sc1
    s_add_u32 s92, s24, 0x1401c00
    buffer_load_dwordx4 v[196:199], v1, s[4:7], s92 offen sc1
    s_add_u32 s92, s24, 0x1402400
    buffer_load_dwordx4 v[200:203], v1, s[4:7], s92 offen sc1
    s_add_u32 s92, s24, 0x1402c00
    buffer_load_dwordx4 v[204:207], v1, s[4:7], s92 offen sc1
    s_waitcnt vmcnt(0)
    v_max3_u32 v7, v176, v180, v184
    v_max_u32 v7, v7, v188
    v_cmp_eq_u32 vcc, -1, v7
    s_cbranch_vccnz Lre44
    s_add_u32 s92, s24, 0x1403400
    buffer_load_dwordx4 v[208:211], v1, s[4:7], s92 offen sc1
    s_add_u32 s92, s24, 0x1403c00
    buffer_load_dwordx4 v[212:215], v1, s[4:7], s92 offen sc1
    s_add_u32 s92, s24, 0x1404400
    buffer_load_dwordx4 v[216:219], v1, s[4:7], s92 offen sc1
    s_add_u32 s92, s24, 0x1404c00
    buffer_load_dwordx4 v[220:223], v1, s[4:7], s92 offen sc1
    s_add_u32 s92, s24, 0x1405400
    buffer_load_dwordx4 v[224:227], v1, s[4:7], s92 offen sc1
    s_add_u32 s92, s24, 0x1405c00
    buffer_load_dwordx4 v[228:231], v1, s[4:7], s92 offen sc1
    s_add_u32 s92, s24, 0x1406400
    buffer_load_dwordx4 v[232:235], v1, s[4:7], s92 offen sc1
    s_add_u32 s92, s24, 0x1406c00
    buffer_load_dwordx4 v[236:239], v1, s[4:7], s92 offen sc1
    s_branch Lok44
Lre45:
    s_cmp_eq_u32 s94, 0
    s_cbranch_scc1 Lok45
    s_sub_u32 s94, s94, 1
    s_waitcnt lgkmcnt(0)
    s_add_u32 s92, s24, 0x1401400
    buffer_load_dwordx4 v[192:195], v1, s[4:7], s92 offen sc1
    s_add_u32 s92, s24, 0x1401c00
    buffer_load_dwordx4 v[196:199], v1, s[4:7], s92 offen sc1
    s_add_u32 s92, s24, 0x1402400
    buffer_load_dwordx4 v[200:203], v1, s[4:7], s92 offen sc1
    s_add_u32 s92, s24, 0x1402c00
    buffer_load_dwordx4 v[204:207], v1, s[4:7], s92 offen sc1
    s_add_u32 s92, s24, 0x1403400
    buffer_load_dwordx4 v[208:211], v1, s[4:7], s92 offen sc1
    s_add_u32 s92, s24, 0x1403c00
    buffer_load_dwordx4 v[212:215], v1, s[4:7], s92 offen sc1
    s_add_u32 s92, s24, 0x1404400
    buffer_load_dwordx4 v[216:219], v1, s[4:7], s92 offen sc1
    s_add_u32 s92, s24, 0x1404c00
    buffer_load_dwordx4 v[220:223], v1, s[4:7], s92 offen sc1
    s_waitcnt vmcnt(0)
    v_max3_u32 v7, v192, v196, v200
    v_max_u32 v7, v7, v204
    v_cmp_eq_u32 vcc, -1, v7
    s_cbranch_vccnz Lre45
    s_add_u32 s92, s24, 0x1405400
    buffer_load_dwordx4 v[224:227], v1, s[4:7], s92 offen sc1
    s_add_u32 s92, s24, 0x1405c00
    buffer_load_dwordx4 v[228:231], v1, s[4:7], s92 offen sc1
    s_add_u32 s92, s24, 0x1406400
    buffer_load_dwordx4 v[232:235], v1, s[4:7], s92 offen sc1
    s_add_u32 s92, s24, 0x1406c00
    buffer_load_dwordx4 v[236:239], v1, s[4:7], s92 offen sc1
    s_branch Lok45
Lre46:
    s_cmp_eq_u32 s94, 0
    s_cbranch_scc1 Lok46
    s_sub_u32 s94, s94, 1
    s_waitcnt lgkmcnt(0)
    s_add_u32 s92, s24, 0x1403400
    buffer_load_dwordx4 v[208:211], v1, s[4:7], s92 offen sc1
    s_add_u32 s92, s24, 0x1403c00
    buffer_load_dwordx4 v[212:215], v1, s[4:7], s92 offen sc1
    s_add_u32 s92, s24, 0x1404400
    buffer_load_dwordx4 v[216:219], v1, s[4:7], s92 offen sc1
    s_add_u32 s92, s24, 0x1404c00
    buffer_load_dwordx4 v[220:223], v1, s[4:7], s92 offen sc1
    s_add_u32 s92, s24, 0x1405400
    buffer_load_dwordx4 v[224:227], v1, s[4:7], s92 offen sc1
    s_add_u32 s92, s24, 0x1405c00
    buffer_load_dwordx4 v[228:231], v1, s[4:7], s92 offen sc1
    s_add_u32 s92, s24, 0x1406400
    buffer_load_dwordx4 v[232:235], v1, s[4:7], s92 offen sc1
    s_add_u32 s92, s24, 0x1406c00
    buffer_load_dwordx4 v[236:239], v1, s[4:7], s92 offen sc1
    s_waitcnt vmcnt(0)
    v_max3_u32 v7, v208, v212, v216
    v_max_u32 v7, v7, v220
    v_cmp_eq_u32 vcc, -1, v7
    s_cbranch_vccnz Lre46
    s_branch Lok46
Lre47:
    s_cmp_eq_u32 s94, 0
    s_cbranch_scc1 Lok47
    s_sub_u32 s94, s94, 1
    s_waitcnt lgkmcnt(0)
    s_add_u32 s92, s24, 0x1405400
    buffer_load_dwordx4 v[224:227], v1, s[4:7], s92 offen sc1
    s_add_u32 s92, s24, 0x1405c00
    buffer_load_dwordx4 v[228:231], v1, s[4:7], s92 offen sc1
    s_add_u32 s92, s24, 0x1406400
    buffer_load_dwordx4 v[232:235], v1, s[4:7], s92 offen sc1
    s_add_u32 s92, s24, 0x1406c00
    buffer_load_dwordx4 v[236:239], v1, s[4:7], s92 offen sc1
    s_waitcnt vmcnt(0)
    v_max3_u32 v7, v224, v228, v232
    v_max_u32 v7, v7, v236
    v_cmp_eq_u32 vcc, -1, v7
    s_cbranch_vccnz Lre47
    s_branch Lok47
Lre48:
    s_cmp_eq_u32 s94, 0
    s_cbranch_scc1 Lok48
    s_sub_u32 s94, s94, 1
    s_waitcnt lgkmcnt(0)
    s_mov_b32 s92, 0x5f0004
    buffer_load_dword v17, v16, s[4:7], s92 offen sc1
    s_waitcnt vmcnt(0)
    v_cmp_ne_u32 vcc, 16, v17
    s_cbranch_vccnz Lre48
    s_branch Lok48
Lre49:
    s_cmp_eq_u32 s94, 0
    s_cbranch_scc1 Lok49
    s_sub_u32 s94, s94, 1
    s_waitcnt lgkmcnt(0)
    s_add_u32 s92, s24, 0x141c000
    buffer_load_dwordx4 v[240:243], v1, s[4:7], s92 offen sc1
    s_add_u32 s92, s24, 0x141c800
    buffer_load_dwordx4 v[244:247], v1, s[4:7], s92 offen sc1
    s_add_u32 s92, s24, 0x141d000
    buffer_load_dwordx4 v[248:251], v1, s[4:7], s92 offen sc1
    s_add_u32 s92, s24, 0x141d800
    buffer_load_dwordx4 v[252:255], v1, s[4:7], s92 offen sc1
    s_add_u32 s92, s24, 0x141e000
    buffer_load_dwordx4 v[128:131], v1, s[4:7], s92 offen sc1
    s_add_u32 s92, s24, 0x141e800
    buffer_load_dwordx4 v[132:135], v1, s[4:7], s92 offen sc1
    s_add_u32 s92, s24, 0x141f000
    buffer_load_dwordx4 v[136:139], v1, s[4:7], s92 offen sc1
    s_add_u32 s92, s24, 0x141f800
    buffer_load_dwordx4 v[140:143], v1, s[4:7], s92 offen sc1
    s_waitcnt vmcnt(0)
    v_max3_u32 v7, v240, v244, v248
    v_max_u32 v7, v7, v252
    v_cmp_eq_u32 vcc, -1, v7
    s_cbranch_vccnz Lre49
    s_add_u32 s92, s24, 0x1420000
    buffer_load_dwordx4 v[144:147], v1, s[4:7], s92 offen sc1
    s_add_u32 s92, s24, 0x1420800
    buffer_load_dwordx4 v[148:151], v1, s[4:7], s92 offen sc1
    s_add_u32 s92, s24, 0x1421000
    buffer_load_dwordx4 v[152:155], v1, s[4:7], s92 offen sc1
    s_add_u32 s92, s24, 0x1421800
    buffer_load_dwordx4 v[156:159], v1, s[4:7], s92 offen sc1
    s_add_u32 s92, s24, 0x1422000
    buffer_load_dwordx4 v[160:163], v1, s[4:7], s92 offen sc1
    s_add_u32 s92, s24, 0x1422800
    buffer_load_dwordx4 v[164:167], v1, s[4:7], s92 offen sc1
    s_add_u32 s92, s24, 0x141c400
    buffer_load_dwordx4 v[168:171], v1, s[4:7], s92 offen sc1
    s_add_u32 s92, s24, 0x141cc00
    buffer_load_dwordx4 v[172:175], v1, s[4:7], s92 offen sc1
    s_add_u32 s92, s24, 0x141d400
    buffer_load_dwordx4 v[176:179], v1, s[4:7], s92 offen sc1
    s_branch Lok49
Lre50:
    s_cmp_eq_u32 s94, 0
    s_cbranch_scc1 Lok50
    s_sub_u32 s94, s94, 1
    s_waitcnt lgkmcnt(0)
    s_add_u32 s92, s24, 0x141e000
    buffer_load_dwordx4 v[128:131], v1, s[4:7], s92 offen sc1
    s_add_u32 s92, s24, 0x141e800
    buffer_load_dwordx4 v[132:135], v1, s[4:7], s92 offen sc1
    s_add_u32 s92, s24, 0x141f000
    buffer_load_dwordx4 v[136:139], v1, s[4:7], s92 offen sc1
    s_add_u32 s92, s24, 0x141f800
    buffer_load_dwordx4 v[140:143], v1, s[4:7], s92 offen sc1
    s_add_u32 s92, s24, 0x1420000
    buffer_load_dwordx4 v[144:147], v1, s[4:7], s92 offen sc1
    s_add_u32 s92, s24, 0x1420800
    buffer_load_dwordx4 v[148:151], v1, s[4:7], s92 offen sc1
    s_add_u32 s92, s24, 0x1421000
    buffer_load_dwordx4 v[152:155], v1, s[4:7], s92 offen sc1
    s_add_u32 s92, s24, 0x1421800
    buffer_load_dwordx4 v[156:159], v1, s[4:7], s92 offen sc1
    s_waitcnt vmcnt(0)
    v_max3_u32 v7, v128, v132, v136
    v_max_u32 v7, v7, v140
    v_cmp_eq_u32 vcc, -1, v7
    s_cbranch_vccnz Lre50
    s_add_u32 s92, s24, 0x1422000
    buffer_load_dwordx4 v[160:163], v1, s[4:7], s92 offen sc1
    s_add_u32 s92, s24, 0x1422800
    buffer_load_dwordx4 v[164:167], v1, s[4:7], s92 offen sc1
    s_add_u32 s92, s24, 0x141c400
    buffer_load_dwordx4 v[168:171], v1, s[4:7], s92 offen sc1
    s_add_u32 s92, s24, 0x141cc00
    buffer_load_dwordx4 v[172:175], v1, s[4:7], s92 offen sc1
    s_add_u32 s92, s24, 0x141d400
    buffer_load_dwordx4 v[176:179], v1, s[4:7], s92 offen sc1
    s_add_u32 s92, s24, 0x141dc00
    buffer_load_dwordx4 v[180:183], v1, s[4:7], s92 offen sc1
    s_add_u32 s92, s24, 0x141e400
    buffer_load_dwordx4 v[184:187], v1, s[4:7], s92 offen sc1
    s_add_u32 s92, s24, 0x141ec00
    buffer_load_dwordx4 v[188:191], v1, s[4:7], s92 offen sc1
    s_add_u32 s92, s24, 0x141f400
    buffer_load_dwordx4 v[192:195], v1, s[4:7], s92 offen sc1
    s_branch Lok50
Lre51:
    buffer_store_dwordx4 v[8:11], v1, s[4:7], s90 offen sc1
    s_branch Lok51
Lre52:
    s_cmp_eq_u32 s94, 0
    s_cbranch_scc1 Lok52
    s_sub_u32 s94, s94, 1
    s_waitcnt lgkmcnt(0)
    s_add_u32 s92, s24, 0x1420000
    buffer_load_dwordx4 v[144:147], v1, s[4:7], s92 offen sc1
    s_add_u32 s92, s24, 0x1420800
    buffer_load_dwordx4 v[148:151], v1, s[4:7], s92 offen sc1
    s_add_u32 s92, s24, 0x1421000
    buffer_load_dwordx4 v[152:155], v1, s[4:7], s92 offen sc1
    s_add_u32 s92, s24, 0x1421800
    buffer_load_dwordx4 v[156:159], v1, s[4:7], s92 offen sc1
    s_add_u32 s92, s24, 0x1422000
    buffer_load_dwordx4 v[160:163], v1, s[4:7], s92 offen sc1
    s_add_u32 s92, s24, 0x1422800
    buffer_load_dwordx4 v[164:167], v1, s[4:7], s92 offen sc1
    s_add_u32 s92, s24, 0x141c400
    buffer_load_dwordx4 v[168:171], v1, s[4:7], s92 offen sc1
    s_add_u32 s92, s24, 0x141cc00
    buffer_load_dwordx4 v[172:175], v1, s[4:7], s92 offen sc1
    s_waitcnt vmcnt(0)
    v_max3_u32 v7, v144, v148, v152
    v_max_u32 v7, v7, v156
    v_cmp_eq_u32 vcc, -1, v7
    s_cbranch_vccnz Lre52
    s_add_u32 s92, s24, 0x141d400
    buffer_load_dwordx4 v[176:179], v1, s[4:7], s92 offen sc1
    s_add_u32 s92, s24, 0x141dc00
    buffer_load_dwordx4 v[180:183], v1, s[4:7], s92 offen sc1
    s_add_u32 s92, s24, 0x141e400
    buffer_load_dwordx4 v[184:187], v1, s[4:7], s92 offen sc1
    s_add_u32 s92, s24, 0x141ec00
    buffer_load_dwordx4 v[188:191], v1, s[4:7], s92 offen sc1
    s_add_u32 s92, s24, 0x141f400
    buffer_load_dwordx4 v[192:195], v1, s[4:7], s92 offen sc1
    s_add_u32 s92, s24, 0x141fc00
    buffer_load_dwordx4 v[196:199], v1, s[4:7], s92 offen sc1
    s_add_u32 s92, s24, 0x1420400
    buffer_load_dwordx4 v[200:203], v1, s[4:7], s92 offen sc1
    s_add_u32 s92, s24, 0x1420c00
    buffer_load_dwordx4 v[204:207], v1, s[4:7], s92 offen sc1
    s_add_u32 s92, s24, 0x1421400
    buffer_load_dwordx4 v[208:211], v1, s[4:7], s92 offen sc1
    s_branch Lok52
Lre53:
    buffer_store_dword v36, v127, s[4:7], s88 offen sc1
    s_branch Lok53
Lre54:
    s_cmp_eq_u32 s94, 0
    s_cbranch_scc1 Lok54
    s_sub_u32 s94, s94, 1
    s_waitcnt lgkmcnt(0)
    s_add_u32 s92, s24, 0x1422000
    buffer_load_dwordx4 v[160:163], v1, s[4:7], s92 offen sc1
    s_add_u32 s92, s24, 0x1422800
    buffer_load_dwordx4 v[164:167], v1, s[4:7], s92 offen sc1
    s_add_u32 s92, s24, 0x141c400
    buffer_load_dwordx4 v[168:171], v1, s[4:7], s92 offen sc1
    s_add_u32 s92, s24, 0x141cc00
    buffer_load_dwordx4 v[172:175], v1, s[4:7], s92 offen sc1
    s_add_u32 s92, s24, 0x141d400
    buffer_load_dwordx4 v[176:179], v1, s[4:7], s92 offen sc1
    s_add_u32 s92, s24, 0x141dc00
    buffer_load_dwordx4 v[180:183], v1, s[4:7], s92 offen sc1
    s_add_u32 s92, s24, 0x141e400
    buffer_load_dwordx4 v[184:187], v1, s[4:7], s92 offen sc1
    s_add_u32 s92, s24, 0x141ec00
    buffer_load_dwordx4 v[188:191], v1, s[4:7], s92 offen sc1
    s_waitcnt vmcnt(0)
    v_max3_u32 v7, v160, v164, v168
    v_max_u32 v7, v7, v172
    v_cmp_eq_u32 vcc, -1, v7
    s_cbranch_vccnz Lre54
    s_add_u32 s92, s24, 0x141f400
    buffer_load_dwordx4 v[192:195], v1, s[4:7], s92 offen sc1
    s_add_u32 s92, s24, 0x141fc00
    buffer_load_dwordx4 v[196:199], v1, s[4:7], s92 offen sc1
    s_add_u32 s92, s24, 0x1420400
    buffer_load_dwordx4 v[200:203], v1, s[4:7], s92 offen sc1
    s_add_u32 s92, s24, 0x1420c00
    buffer_load_dwordx4 v[204:207], v1, s[4:7], s92 offen sc1
    s_add_u32 s92, s24, 0x1421400
    buffer_load_dwordx4 v[208:211], v1, s[4:7], s92 offen sc1
    s_add_u32 s92, s24, 0x1421c00
    buffer_load_dwordx4 v[212:215], v1, s[4:7], s92 offen sc1
    s_add_u32 s92, s24, 0x1422400
    buffer_load_dwordx4 v[216:219], v1, s[4:7], s92 offen sc1
    s_add_u32 s92, s24, 0x1422c00
    buffer_load_dwordx4 v[220:223], v1, s[4:7], s92 offen sc1
    s_branch Lok54
Lre55:
    s_cmp_eq_u32 s94, 0
    s_cbranch_scc1 Lok55
    s_sub_u32 s94, s94, 1
    s_waitcnt lgkmcnt(0)
    s_add_u32 s92, s24, 0x141d400
    buffer_load_dwordx4 v[176:179], v1, s[4:7], s92 offen sc1
    s_add_u32 s92, s24, 0x141dc00
    buffer_load_dwordx4 v[180:183], v1, s[4:7], s92 offen sc1
    s_add_u32 s92, s24, 0x141e400
    buffer_load_dwordx4 v[184:187], v1, s[4:7], s92 offen sc1
    s_add_u32 s92, s24, 0x141ec00
    buffer_load_dwordx4 v[188:191], v1, s[4:7], s92 offen sc1
    s_add_u32 s92, s24, 0x141f400
    buffer_load_dwordx4 v[192:195], v1, s[4:7], s92 offen sc1
    s_add_u32 s92, s24, 0x141fc00
    buffer_load_dwordx4 v[196:199], v1, s[4:7], s92 offen sc1
    s_add_u32 s92, s24, 0x1420400
    buffer_load_dwordx4 v[200:203], v1, s[4:7], s92 offen sc1
    s_add_u32 s92, s24, 0x1420c00
    buffer_load_dwordx4 v[204:207], v1, s[4:7], s92 offen sc1
    s_waitcnt vmcnt(0)
    v_max3_u32 v7, v176, v180, v184
    v_max_u32 v7, v7, v188
    v_cmp_eq_u32 vcc, -1, v7
    s_cbranch_vccnz Lre55
    s_add_u32 s92, s24, 0x1421400
    buffer_load_dwordx4 v[208:211], v1, s[4:7], s92 offen sc1
    s_add_u32 s92, s24, 0x1421c00
    buffer_load_dwordx4 v[212:215], v1, s[4:7], s92 offen sc1
    s_add_u32 s92, s24, 0x1422400
    buffer_load_dwordx4 v[216:219], v1, s[4:7], s92 offen sc1
    s_add_u32 s92, s24, 0x1422c00
    buffer_load_dwordx4 v[220:223], v1, s[4:7], s92 offen sc1
    s_branch Lok55
Lre56:
    s_cmp_eq_u32 s94, 0
    s_cbranch_scc1 Lok56
    s_sub_u32 s94, s94, 1
    s_waitcnt lgkmcnt(0)
    s_add_u32 s92, s24, 0x141f400
    buffer_load_dwordx4 v[192:195], v1, s[4:7], s92 offen sc1
    s_add_u32 s92, s24, 0x141fc00
    buffer_load_dwordx4 v[196:199], v1, s[4:7], s92 offen sc1
    s_add_u32 s92, s24, 0x1420400
    buffer_load_dwordx4 v[200:203], v1, s[4:7], s92 offen sc1
    s_add_u32 s92, s24, 0x1420c00
    buffer_load_dwordx4 v[204:207], v1, s[4:7], s92 offen sc1
    s_add_u32 s92, s24, 0x1421400
    buffer_load_dwordx4 v[208:211], v1, s[4:7], s92 offen sc1
    s_add_u32 s92, s24, 0x1421c00
    buffer_load_dwordx4 v[212:215], v1, s[4:7], s92 offen sc1
    s_add_u32 s92, s24, 0x1422400
    buffer_load_dwordx4 v[216:219], v1, s[4:7], s92 offen sc1
    s_add_u32 s92, s24, 0x1422c00
    buffer_load_dwordx4 v[220:223], v1, s[4:7], s92 offen sc1
    s_waitcnt vmcnt(0)
    v_max3_u32 v7, v192, v196, v200
    v_max_u32 v7, v7, v204
    v_cmp_eq_u32 vcc, -1, v7
    s_cbranch_vccnz Lre56
    s_branch Lok56
Lre57:
    s_cmp_eq_u32 s94, 0
    s_cbranch_scc1 Lok57
    s_sub_u32 s94, s94, 1
    s_waitcnt lgkmcnt(0)
    s_add_u32 s92, s24, 0x1421400
    buffer_load_dwordx4 v[208:211], v1, s[4:7], s92 offen sc1
    s_add_u32 s92, s24, 0x1421c00
    buffer_load_dwordx4 v[212:215], v1, s[4:7], s92 offen sc1
    s_add_u32 s92, s24, 0x1422400
    buffer_load_dwordx4 v[216:219], v1, s[4:7], s92 offen sc1
    s_add_u32 s92, s24, 0x1422c00
    buffer_load_dwordx4 v[220:223], v1, s[4:7], s92 offen sc1
    s_waitcnt vmcnt(0)
    v_max3_u32 v7, v208, v212, v216
    v_max_u32 v7, v7, v220
    v_cmp_eq_u32 vcc, -1, v7
    s_cbranch_vccnz Lre57
    s_branch Lok57
Lre58:
    s_cmp_eq_u32 s94, 0
    s_cbranch_scc1 Lok58
    s_sub_u32 s94, s94, 1
    s_waitcnt lgkmcnt(0)
    s_add_u32 s92, s25, 0x1b00000
    buffer_load_dwordx4 v[224:227], v3, s[4:7], s92 offen sc1
    s_add_u32 s92, s25, 0x1b00400
    buffer_load_dwordx4 v[228:231], v3, s[4:7], s92 offen sc1
    s_add_u32 s92, s25, 0x1b00800
    buffer_load_dwordx4 v[232:235], v3, s[4:7], s92 offen sc1
    s_add_u32 s92, s25, 0x1b00c00
    buffer_load_dwordx4 v[236:239], v3, s[4:7], s92 offen sc1
    s_add_u32 s92, s25, 0x1b01000
    buffer_load_dwordx4 v[240:243], v3, s[4:7], s92 offen sc1
    s_add_u32 s92, s25, 0x1b01400
    buffer_load_dwordx4 v[244:247], v3, s[4:7], s92 offen sc1
    s_add_u32 s92, s25, 0x1b01800
    buffer_load_dwordx4 v[248:251], v3, s[4:7], s92 offen sc1
    s_add_u32 s92, s25, 0x1b01c00
    buffer_load_dwordx4 v[252:255], v3, s[4:7], s92 offen sc1
    s_waitcnt vmcnt(0)
    v_max3_u32 v7, v224, v228, v232
    v_max_u32 v7, v7, v236
    v_cmp_eq_u32 vcc, -1, v7
    s_cbranch_vccnz Lre58
    s_add_u32 s92, s25, 0x1b02000
    buffer_load_dwordx4 v[128:131], v3, s[4:7], s92 offen sc1
    s_add_u32 s92, s25, 0x1b02400
    buffer_load_dwordx4 v[132:135], v3, s[4:7], s92 offen sc1
    s_add_u32 s92, s25, 0x1b02800
    buffer_load_dwordx4 v[136:139], v3, s[4:7], s92 offen sc1
    s_add_u32 s92, s25, 0x1b02c00
    buffer_load_dwordx4 v[140:143], v3, s[4:7], s92 offen sc1
    s_add_u32 s92, s25, 0x1b03000
    buffer_load_dwordx4 v[144:147], v3, s[4:7], s92 offen sc1
    s_add_u32 s92, s25, 0x1b03400
    buffer_load_dwordx4 v[148:151], v3, s[4:7], s92 offen sc1
    s_add_u32 s92, s25, 0x1b03800
    buffer_load_dwordx4 v[152:155], v3, s[4:7], s92 offen sc1
    s_add_u32 s92, s25, 0x1b03c00
    buffer_load_dwordx4 v[156:159], v3, s[4:7], s92 offen sc1
    s_branch Lok58
Lre59:
    buffer_store_dwordx4 v[12:15], v1, s[4:7], s82 offen sc1
    s_branch Lok59
Lre60:
    buffer_store_dword v52, v127, s[4:7], s88 offen offset:2048 sc1
    s_branch Lok60
Lre61:
    s_cmp_eq_u32 s94, 0
    s_cbranch_scc1 Lok61
    s_sub_u32 s94, s94, 1
    s_waitcnt lgkmcnt(0)
    s_add_u32 s92, s25, 0x1b01000
    buffer_load_dwordx4 v[240:243], v3, s[4:7], s92 offen sc1
    s_add_u32 s92, s25, 0x1b01400
    buffer_load_dwordx4 v[244:247], v3, s[4:7], s92 offen sc1
    s_add_u32 s92, s25, 0x1b01800
    buffer_load_dwordx4 v[248:251], v3, s[4:7], s92 offen sc1
    s_add_u32 s92, s25, 0x1b01c00
    buffer_load_dwordx4 v[252:255], v3, s[4:7], s92 offen sc1
    s_add_u32 s92, s25, 0x1b02000
    buffer_load_dwordx4 v[128:131], v3, s[4:7], s92 offen sc1
    s_add_u32 s92, s25, 0x1b02400
    buffer_load_dwordx4 v[132:135], v3, s[4:7], s92 offen sc1
    s_add_u32 s92, s25, 0x1b02800
    buffer_load_dwordx4 v[136:139], v3, s[4:7], s92 offen sc1
    s_add_u32 s92, s25, 0x1b02c00
    buffer_load_dwordx4 v[140:143], v3, s[4:7], s92 offen sc1
    s_waitcnt vmcnt(0)
    v_max3_u32 v7, v240, v244, v248
    v_max_u32 v7, v7, v252
    v_cmp_eq_u32 vcc, -1, v7
    s_cbranch_vccnz Lre61
    s_add_u32 s92, s25, 0x1b03000
    buffer_load_dwordx4 v[144:147], v3, s[4:7], s92 offen sc1
    s_add_u32 s92, s25, 0x1b03400
    buffer_load_dwordx4 v[148:151], v3, s[4:7], s92 offen sc1
    s_add_u32 s92, s25, 0x1b03800
    buffer_load_dwordx4 v[152:155], v3, s[4:7], s92 offen sc1
    s_add_u32 s92, s25, 0x1b03c00
    buffer_load_dwordx4 v[156:159], v3, s[4:7], s92 offen sc1
    s_branch Lok61
Lre62:
    s_cmp_eq_u32 s94, 0
    s_cbranch_scc1 Lok62
    s_sub_u32 s94, s94, 1
    s_waitcnt lgkmcnt(0)
    s_add_u32 s92, s25, 0x1b02000
    buffer_load_dwordx4 v[128:131], v3, s[4:7], s92 offen sc1
    s_add_u32 s92, s25, 0x1b02400
    buffer_load_dwordx4 v[132:135], v3, s[4:7], s92 offen sc1
    s_add_u32 s92, s25, 0x1b02800
    buffer_load_dwordx4 v[136:139], v3, s[4:7], s92 offen sc1
    s_add_u32 s92, s25, 0x1b02c00
    buffer_load_dwordx4 v[140:143], v3, s[4:7], s92 offen sc1
    s_add_u32 s92, s25, 0x1b03000
    buffer_load_dwordx4 v[144:147], v3, s[4:7], s92 offen sc1
    s_add_u32 s92, s25, 0x1b03400
    buffer_load_dwordx4 v[148:151], v3, s[4:7], s92 offen sc1
    s_add_u32 s92, s25, 0x1b03800
    buffer_load_dwordx4 v[152:155], v3, s[4:7], s92 offen sc1
    s_add_u32 s92, s25, 0x1b03c00
    buffer_load_dwordx4 v[156:159], v3, s[4:7], s92 offen sc1
    s_waitcnt vmcnt(0)
    v_max3_u32 v7, v128, v132, v136
    v_max_u32 v7, v7, v140
    v_cmp_eq_u32 vcc, -1, v7
    s_cbranch_vccnz Lre62
    s_branch Lok62
Lre63:
    s_cmp_eq_u32 s94, 0
    s_cbranch_scc1 Lok63
    s_sub_u32 s94, s94, 1
    s_waitcnt lgkmcnt(0)
    s_add_u32 s92, s20, 0x640000
    buffer_load_dwordx4 v[224:227], v83, s[4:7], s92 offen sc1
    s_add_u32 s92, s20, 0x640200
    buffer_load_dwordx4 v[228:231], v83, s[4:7], s92 offen sc1
    s_waitcnt vmcnt(0)
    v_max3_u32 v7, v224, v225, v226
    v_max3_u32 v7, v7, v227, v228
    v_max3_u32 v7, v7, v229, v230
    v_max_u32 v7, v7, v231
    v_cmp_eq_u32 vcc, -1, v7
    s_cbranch_vccnz Lre63
    s_branch Lok63
Lre64:
    s_cmp_eq_u32 s94, 0
    s_cbranch_scc1 Lok64
    s_sub_u32 s94, s94, 1
    s_waitcnt lgkmcnt(0)
    s_add_u32 s92, s25, 0x1b03000
    buffer_load_dwordx4 v[144:147], v3, s[4:7], s92 offen sc1
    s_add_u32 s92, s25, 0x1b03400
    buffer_load_dwordx4 v[148:151], v3, s[4:7], s92 offen sc1
    s_add_u32 s92, s25, 0x1b03800
    buffer_load_dwordx4 v[152:155], v3, s[4:7], s92 offen sc1
    s_add_u32 s92, s25, 0x1b03c00
    buffer_load_dwordx4 v[156:159], v3, s[4:7], s92 offen sc1
    s_waitcnt vmcnt(0)
    v_max3_u32 v7, v144, v148, v152
    v_max_u32 v7, v7, v156
    v_cmp_eq_u32 vcc, -1, v7
    s_cbranch_vccnz Lre64
    s_branch Lok64
Lre65:
    s_cmp_eq_u32 s94, 0
    s_cbranch_scc1 Lok65
    s_sub_u32 s94, s94, 1
    s_waitcnt lgkmcnt(0)
    s_add_u32 s92, s25, 0x1b08000
    buffer_load_dwordx4 v[160:163], v3, s[4:7], s92 offen sc1
    s_add_u32 s92, s25, 0x1b08400
    buffer_load_dwordx4 v[164:167], v3, s[4:7], s92 offen sc1
    s_add_u32 s92, s25, 0x1b08800
    buffer_load_dwordx4 v[168:171], v3, s[4:7], s92 offen sc1
    s_add_u32 s92, s25, 0x1b08c00
    buffer_load_dwordx4 v[172:175], v3, s[4:7], s92 offen sc1
    s_add_u32 s92, s25, 0x1b09000
    buffer_load_dwordx4 v[176:179], v3, s[4:7], s92 offen sc1
    s_add_u32 s92, s25, 0x1b09400
    buffer_load_dwordx4 v[180:183], v3, s[4:7], s92 offen sc1
    s_add_u32 s92, s25, 0x1b09800
    buffer_load_dwordx4 v[184:187], v3, s[4:7], s92 offen sc1
    s_add_u32 s92, s25, 0x1b09c00
    buffer_load_dwordx4 v[188:191], v3, s[4:7], s92 offen sc1
    s_waitcnt vmcnt(0)
    v_max3_u32 v7, v160, v164, v168
    v_max_u32 v7, v7, v172
    v_cmp_eq_u32 vcc, -1, v7
    s_cbranch_vccnz Lre65
    s_add_u32 s92, s25, 0x1b0a000
    buffer_load_dwordx4 v[192:195], v3, s[4:7], s92 offen sc1
    s_add_u32 s92, s25, 0x1b0a400
    buffer_load_dwordx4 v[196:199], v3, s[4:7], s92 offen sc1
    s_add_u32 s92, s25, 0x1b0a800
    buffer_load_dwordx4 v[200:203], v3, s[4:7], s92 offen sc1
    s_add_u32 s92, s25, 0x1b0ac00
    buffer_load_dwordx4 v[204:207], v3, s[4:7], s92 offen sc1
    s_add_u32 s92, s25, 0x1b0b000
    buffer_load_dwordx4 v[208:211], v3, s[4:7], s92 offen sc1
    s_add_u32 s92, s25, 0x1b0b400
    buffer_load_dwordx4 v[212:215], v3, s[4:7], s92 offen sc1
    s_branch Lok65
Lre66:
    s_cmp_eq_u32 s94, 0
    s_cbranch_scc1 Lok66
    s_sub_u32 s94, s94, 1
    s_waitcnt lgkmcnt(0)
    s_add_u32 s92, s25, 0x1b09000
    buffer_load_dwordx4 v[176:179], v3, s[4:7], s92 offen sc1
    s_add_u32 s92, s25, 0x1b09400
    buffer_load_dwordx4 v[180:183], v3, s[4:7], s92 offen sc1
    s_add_u32 s92, s25, 0x1b09800
    buffer_load_dwordx4 v[184:187], v3, s[4:7], s92 offen sc1
    s_add_u32 s92, s25, 0x1b09c00
    buffer_load_dwordx4 v[188:191], v3, s[4:7], s92 offen sc1
    s_add_u32 s92, s25, 0x1b0a000
    buffer_load_dwordx4 v[192:195], v3, s[4:7], s92 offen sc1
    s_add_u32 s92, s25, 0x1b0a400
    buffer_load_dwordx4 v[196:199], v3, s[4:7], s92 offen sc1
    s_add_u32 s92, s25, 0x1b0a800
    buffer_load_dwordx4 v[200:203], v3, s[4:7], s92 offen sc1
    s_add_u32 s92, s25, 0x1b0ac00
    buffer_load_dwordx4 v[204:207], v3, s[4:7], s92 offen sc1
    s_waitcnt vmcnt(0)
    v_max3_u32 v7, v176, v180, v184
    v_max_u32 v7, v7, v188
    v_cmp_eq_u32 vcc, -1, v7
    s_cbranch_vccnz Lre66
    s_add_u32 s92, s25, 0x1b0b000
    buffer_load_dwordx4 v[208:211], v3, s[4:7], s92 offen sc1
    s_add_u32 s92, s25, 0x1b0b400
    buffer_load_dwordx4 v[212:215], v3, s[4:7], s92 offen sc1
    s_add_u32 s92, s25, 0x1b0b800
    buffer_load_dwordx4 v[216:219], v3, s[4:7], s92 offen sc1
    s_add_u32 s92, s25, 0x1b0bc00
    buffer_load_dwordx4 v[220:223], v3, s[4:7], s92 offen sc1
    s_branch Lok66
Lre67:
    s_cmp_eq_u32 s94, 0
    s_cbranch_scc1 Lok67
    s_sub_u32 s94, s94, 1
    s_waitcnt lgkmcnt(0)
    s_add_u32 s92, s25, 0x1b0a000
    buffer_load_dwordx4 v[192:195], v3, s[4:7], s92 offen sc1
    s_add_u32 s92, s25, 0x1b0a400
    buffer_load_dwordx4 v[196:199], v3, s[4:7], s92 offen sc1
    s_add_u32 s92, s25, 0x1b0a800
    buffer_load_dwordx4 v[200:203], v3, s[4:7], s92 offen sc1
    s_add_u32 s92, s25, 0x1b0ac00
    buffer_load_dwordx4 v[204:207], v3, s[4:7], s92 offen sc1
    s_add_u32 s92, s25, 0x1b0b000
    buffer_load_dwordx4 v[208:211], v3, s[4:7], s92 offen sc1
    s_add_u32 s92, s25, 0x1b0b400
    buffer_load_dwordx4 v[212:215], v3, s[4:7], s92 offen sc1
    s_add_u32 s92, s25, 0x1b0b800
    buffer_load_dwordx4 v[216:219], v3, s[4:7], s92 offen sc1
    s_add_u32 s92, s25, 0x1b0bc00
    buffer_load_dwordx4 v[220:223], v3, s[4:7], s92 offen sc1
    s_waitcnt vmcnt(0)
    v_max3_u32 v7, v192, v196, v200
    v_max_u32 v7, v7, v204
    v_cmp_eq_u32 vcc, -1, v7
    s_cbranch_vccnz Lre67
    s_branch Lok67
Lre68:
    s_cmp_eq_u32 s94, 0
    s_cbranch_scc1 Lok68
    s_sub_u32 s94, s94, 1
    s_waitcnt lgkmcnt(0)
    s_add_u32 s92, s20, 0x640800
    buffer_load_dwordx4 v[160:163], v83, s[4:7], s92 offen sc1
    s_add_u32 s92, s20, 0x640a00
    buffer_load_dwordx4 v[164:167], v83, s[4:7], s92 offen sc1
    s_waitcnt vmcnt(0)
    v_max3_u32 v7, v160, v161, v162
    v_max3_u32 v7, v7, v163, v164
    v_max3_u32 v7, v7, v165, v166
    v_max_u32 v7, v7, v167
    v_cmp_eq_u32 vcc, -1, v7
    s_cbranch_vccnz Lre68
    s_branch Lok68
Lre69:
    s_cmp_eq_u32 s94, 0
    s_cbranch_scc1 Lok69
    s_sub_u32 s94, s94, 1
    s_waitcnt lgkmcnt(0)
    s_add_u32 s92, s25, 0x1b0b000
    buffer_load_dwordx4 v[208:211], v3, s[4:7], s92 offen sc1
    s_add_u32 s92, s25, 0x1b0b400
    buffer_load_dwordx4 v[212:215], v3, s[4:7], s92 offen sc1
    s_add_u32 s92, s25, 0x1b0b800
    buffer_load_dwordx4 v[216:219], v3, s[4:7], s92 offen sc1
    s_add_u32 s92, s25, 0x1b0bc00
    buffer_load_dwordx4 v[220:223], v3, s[4:7], s92 offen sc1
    s_waitcnt vmcnt(0)
    v_max3_u32 v7, v208, v212, v216
    v_max_u32 v7, v7, v220
    v_cmp_eq_u32 vcc, -1, v7
    s_cbranch_vccnz Lre69
    s_branch Lok69
Lre70:
    s_cmp_eq_u32 s94, 0
    s_cbranch_scc1 Lok70
    s_sub_u32 s94, s94, 1
    s_mov_b32 s93, m0
    s_waitcnt lgkmcnt(0)
    s_mov_b32 m0, s22
    s_add_u32 s92, s29, 0x1b00000
    buffer_load_dwordx4 v1, s[4:7], s92 offen sc1 lds
    s_add_u32 m0, s22, 0x400
    s_add_u32 s92, s29, 0x1b00400
    buffer_load_dwordx4 v1, s[4:7], s92 offen sc1 lds
    s_add_u32 m0, s22, 0x800
    s_add_u32 s92, s29, 0x1b00800
    buffer_load_dwordx4 v1, s[4:7], s92 offen sc1 lds
    s_add_u32 m0, s22, 0xc00
    s_add_u32 s92, s29, 0x1b00c00
    buffer_load_dwordx4 v1, s[4:7], s92 offen sc1 lds
    s_add_u32 m0, s22, 0x4040
    s_add_u32 s92, s29, 0x1b04000
    buffer_load_dwordx4 v1, s[4:7], s92 offen sc1 lds
    s_add_u32 m0, s22, 0x4440
    s_add_u32 s92, s29, 0x1b04400
    buffer_load_dwordx4 v1, s[4:7], s92 offen sc1 lds
    s_add_u32 m0, s22, 0x4840
    s_add_u32 s92, s29, 0x1b04800
    buffer_load_dwordx4 v1, s[4:7], s92 offen sc1 lds
    s_add_u32 m0, s22, 0x4c40
    s_add_u32 s92, s29, 0x1b04c00
    buffer_load_dwordx4 v1, s[4:7], s92 offen sc1 lds
    s_waitcnt vmcnt(0)
    ds_read2st64_b32 v[32:33], v36 offset0:0 offset1:4
    ds_read2st64_b32 v[34:35], v36 offset0:8 offset1:12
    ds_read2st64_b32 v[40:41], v44 offset0:0 offset1:4
    ds_read2st64_b32 v[42:43], v44 offset0:8 offset1:12
    s_waitcnt lgkmcnt(0)
    s_mov_b32 m0, s93
    v_max3_u32 v7, v32, v33, v34
    v_max_u32 v7, v7, v35
    v_cmp_eq_u32 vcc, -1, v7
    s_cbranch_vccnz Lre70
    s_add_u32 m0, s22, 0x8080
    s_add_u32 s92, s29, 0x1b08000
    buffer_load_dwordx4 v1, s[4:7], s92 offen sc1 lds
    s_add_u32 m0, s22, 0x8480
    s_add_u32 s92, s29, 0x1b08400
    buffer_load_dwordx4 v1, s[4:7], s92 offen sc1 lds
    s_add_u32 m0, s22, 0x8880
    s_add_u32 s92, s29, 0x1b08800
    buffer_load_dwordx4 v1, s[4:7], s92 offen sc1 lds
    s_add_u32 m0, s22, 0x8c80
    s_add_u32 s92, s29, 0x1b08c00
    buffer_load_dwordx4 v1, s[4:7], s92 offen sc1 lds
    s_add_u32 m0, s22, 0xc0c0
    s_add_u32 s92, s29, 0x1b0c000
    buffer_load_dwordx4 v1, s[4:7], s92 offen sc1 lds
    s_add_u32 m0, s22, 0xc4c0
    s_add_u32 s92, s29, 0x1b0c400
    buffer_load_dwordx4 v1, s[4:7], s92 offen sc1 lds
    s_add_u32 m0, s22, 0xc8c0
    s_add_u32 s92, s29, 0x1b0c800
    buffer_load_dwordx4 v1, s[4:7], s92 offen sc1 lds
    s_add_u32 m0, s22, 0xccc0
    s_add_u32 s92, s29, 0x1b0cc00
    buffer_load_dwordx4 v1, s[4:7], s92 offen sc1 lds
    s_mov_b32 m0, s93
    s_branch Lok70
Lre71:
    s_cmp_eq_u32 s94, 0
    s_cbranch_scc1 Lok71
    s_sub_u32 s94, s94, 1
    s_mov_b32 s93, m0
    s_waitcnt lgkmcnt(0)
    s_add_u32 m0, s22, 0x4040
    s_add_u32 s92, s29, 0x1b04000
    buffer_load_dwordx4 v1, s[4:7], s92 offen sc1 lds
    s_add_u32 m0, s22, 0x4440
    s_add_u32 s92, s29, 0x1b04400
    buffer_load_dwordx4 v1, s[4:7], s92 offen sc1 lds
    s_add_u32 m0, s22, 0x4840
    s_add_u32 s92, s29, 0x1b04800
    buffer_load_dwordx4 v1, s[4:7], s92 offen sc1 lds
    s_add_u32 m0, s22, 0x4c40
    s_add_u32 s92, s29, 0x1b04c00
    buffer_load_dwordx4 v1, s[4:7], s92 offen sc1 lds
    s_add_u32 m0, s22, 0x8080
    s_add_u32 s92, s29, 0x1b08000
    buffer_load_dwordx4 v1, s[4:7], s92 offen sc1 lds
    s_add_u32 m0, s22, 0x8480
    s_add_u32 s92, s29, 0x1b08400
    buffer_load_dwordx4 v1, s[4:7], s92 offen sc1 lds
    s_add_u32 m0, s22, 0x8880
    s_add_u32 s92, s29, 0x1b08800
    buffer_load_dwordx4 v1, s[4:7], s92 offen sc1 lds
    s_add_u32 m0, s22, 0x8c80
    s_add_u32 s92, s29, 0x1b08c00
    buffer_load_dwordx4 v1, s[4:7], s92 offen sc1 lds
    s_waitcnt vmcnt(0)
    ds_read2st64_b32 v[40:41], v44 offset0:0 offset1:4
    ds_read2st64_b32 v[42:43], v44 offset0:8 offset1:12
    s_waitcnt lgkmcnt(0)
    s_mov_b32 m0, s93
    v_max3_u32 v7, v40, v41, v42
    v_max_u32 v7, v7, v43
    v_cmp_eq_u32 vcc, -1, v7
    s_cbranch_vccnz Lre71
    s_add_u32 m0, s22, 0xc0c0
    s_add_u32 s92, s29, 0x1b0c000
    buffer_load_dwordx4 v1, s[4:7], s92 offen sc1 lds
    s_add_u32 m0, s22, 0xc4c0
    s_add_u32 s92, s29, 0x1b0c400
    buffer_load_dwordx4 v1, s[4:7], s92 offen sc1 lds
    s_add_u32 m0, s22, 0xc8c0
    s_add_u32 s92, s29, 0x1b0c800
    buffer_load_dwordx4 v1, s[4:7], s92 offen sc1 lds
    s_add_u32 m0, s22, 0xccc0
    s_add_u32 s92, s29, 0x1b0cc00
    buffer_load_dwordx4 v1, s[4:7], s92 offen sc1 lds
    s_mov_b32 m0, s93
    s_branch Lok71
Lre72:
    s_cmp_eq_u32 s94, 0
    s_cbranch_scc1 Lok72
    s_sub_u32 s94, s94, 1
    s_waitcnt lgkmcnt(0)
    s_add_u32 s92, s28, 0x1b00000
    buffer_load_dwordx4 v[96:99], v1, s[4:7], s92 offen sc1
    s_waitcnt vmcnt(0)
    v_cmp_eq_u32 vcc, -1, v96
    s_cbranch_vccnz Lre72
    s_branch Lok72
Lre73:
    s_cmp_eq_u32 s94, 0
    s_cbranch_scc1 Lok73
    s_sub_u32 s94, s94, 1
    s_mov_b32 s93, m0
    s_waitcnt lgkmcnt(0)
    s_add_u32 m0, s22, 0x8080
    s_add_u32 s92, s29, 0x1b08000
    buffer_load_dwordx4 v1, s[4:7], s92 offen sc1 lds
    s_add_u32 m0, s22, 0x8480
    s_add_u32 s92, s29, 0x1b08400
    buffer_load_dwordx4 v1, s[4:7], s92 offen sc1 lds
    s_add_u32 m0, s22, 0x8880
    s_add_u32 s92, s29, 0x1b08800
    buffer_load_dwordx4 v1, s[4:7], s92 offen sc1 lds
    s_add_u32 m0, s22, 0x8c80
    s_add_u32 s92, s29, 0x1b08c00
    buffer_load_dwordx4 v1, s[4:7], s92 offen sc1 lds
    s_add_u32 m0, s22, 0xc0c0
    s_add_u32 s92, s29, 0x1b0c000
    buffer_load_dwordx4 v1, s[4:7], s92 offen sc1 lds
    s_add_u32 m0, s22, 0xc4c0
    s_add_u32 s92, s29, 0x1b0c400
    buffer_load_dwordx4 v1, s[4:7], s92 offen sc1 lds
    s_add_u32 m0, s22, 0xc8c0
    s_add_u32 s92, s29, 0x1b0c800
    buffer_load_dwordx4 v1, s[4:7], s92 offen sc1 lds
    s_add_u32 m0, s22, 0xccc0
    s_add_u32 s92, s29, 0x1b0cc00
    buffer_load_dwordx4 v1, s[4:7], s92 offen sc1 lds
    s_waitcnt vmcnt(0)
    ds_read2st64_b32 v[104:105], v108 offset0:0 offset1:4
    ds_read2st64_b32 v[106:107], v108 offset0:8 offset1:12
    s_waitcnt lgkmcnt(0)
    s_mov_b32 m0, s93
    v_max3_u32 v7, v104, v105, v106
    v_max_u32 v7, v7, v107
    v_cmp_eq_u32 vcc, -1, v7
    s_cbranch_vccnz Lre73
    s_branch Lok73
Lre74:
    s_cmp_eq_u32 s94, 0
    s_cbranch_scc1 Lok74
    s_sub_u32 s94, s94, 1
    s_mov_b32 s93, m0
    s_waitcnt lgkmcnt(0)
    s_add_u32 m0, s22, 0xc0c0
    s_add_u32 s92, s29, 0x1b0c000
    buffer_load_dwordx4 v1, s[4:7], s92 offen sc1 lds
    s_add_u32 m0, s22, 0xc4c0
    s_add_u32 s92, s29, 0x1b0c400
    buffer_load_dwordx4 v1, s[4:7], s92 offen sc1 lds
    s_add_u32 m0, s22, 0xc8c0
    s_add_u32 s92, s29, 0x1b0c800
    buffer_load_dwordx4 v1, s[4:7], s92 offen sc1 lds
    s_add_u32 m0, s22, 0xccc0
    s_add_u32 s92, s29, 0x1b0cc00
    buffer_load_dwordx4 v1, s[4:7], s92 offen sc1 lds
    s_waitcnt vmcnt(0)
    ds_read2st64_b32 v[104:105], v108 offset0:0 offset1:4
    ds_read2st64_b32 v[106:107], v108 offset0:8 offset1:12
    s_waitcnt lgkmcnt(0)
    s_mov_b32 m0, s93
    v_max3_u32 v7, v104, v105, v106
    v_max_u32 v7, v7, v107
    v_cmp_eq_u32 vcc, -1, v7
    s_cbranch_vccnz Lre74
    s_branch Lok74
Lre75:
    s_cmp_eq_u32 s94, 0
    s_cbranch_scc1 Lok75
    s_sub_u32 s94, s94, 1
    s_waitcnt lgkmcnt(0)
    s_add_u32 s92, s28, 0x1b10000
    buffer_load_dwordx4 v[100:103], v1, s[4:7], s92 offen sc1
    s_waitcnt vmcnt(0)
    v_cmp_eq_u32 vcc, -1, v100
    s_cbranch_vccnz Lre75
    s_branch Lok75
Lre76:
    s_cmp_eq_u32 s94, 0
    s_cbranch_scc1 Lok76
    s_sub_u32 s94, s94, 1
    s_mov_b32 s93, m0
    s_waitcnt lgkmcnt(0)
    s_add_u32 m0, s22, 0x10100
    s_add_u32 s92, s29, 0x1b10000
    buffer_load_dwordx4 v1, s[4:7], s92 offen sc1 lds
    s_add_u32 m0, s22, 0x10500
    s_add_u32 s92, s29, 0x1b10400
    buffer_load_dwordx4 v1, s[4:7], s92 offen sc1 lds
    s_add_u32 m0, s22, 0x10900
    s_add_u32 s92, s29, 0x1b10800
    buffer_load_dwordx4 v1, s[4:7], s92 offen sc1 lds
    s_add_u32 m0, s22, 0x10d00
    s_add_u32 s92, s29, 0x1b10c00
    buffer_load_dwordx4 v1, s[4:7], s92 offen sc1 lds
    s_waitcnt vmcnt(0)
    ds_read2st64_b32 v[104:105], v108 offset0:0 offset1:4
    ds_read2st64_b32 v[106:107], v108 offset0:8 offset1:12
    s_waitcnt lgkmcnt(0)
    s_mov_b32 m0, s93
    v_max3_u32 v7, v104, v105, v106
    v_max_u32 v7, v7, v107
    v_cmp_eq_u32 vcc, -1, v7
    s_cbranch_vccnz Lre76
    s_branch Lok76
Lre77:
    s_cmp_eq_u32 s94, 0
    s_cbranch_scc1 Lok77
    s_sub_u32 s94, s94, 1
    s_mov_b32 s93, m0
    s_waitcnt lgkmcnt(0)
    s_add_u32 m0, s22, 0x14140
    s_add_u32 s92, s29, 0x1b14000
    buffer_load_dwordx4 v1, s[4:7], s92 offen sc1 lds
    s_add_u32 m0, s22, 0x14540
    s_add_u32 s92, s29, 0x1b14400
    buffer_load_dwordx4 v1, s[4:7], s92 offen sc1 lds
    s_add_u32 m0, s22, 0x14940
    s_add_u32 s92, s29, 0x1b14800
    buffer_load_dwordx4 v1, s[4:7], s92 offen sc1 lds
    s_add_u32 m0, s22, 0x14d40
    s_add_u32 s92, s29, 0x1b14c00
    buffer_load_dwordx4 v1, s[4:7], s92 offen sc1 lds
    s_waitcnt vmcnt(0)
    ds_read2st64_b32 v[104:105], v108 offset0:0 offset1:4
    ds_read2st64_b32 v[106:107], v108 offset0:8 offset1:12
    s_waitcnt lgkmcnt(0)
    s_mov_b32 m0, s93
    v_max3_u32 v7, v104, v105, v106
    v_max_u32 v7, v7, v107
    v_cmp_eq_u32 vcc, -1, v7
    s_cbranch_vccnz Lre77
    s_branch Lok77
Lre78:
    s_cmp_eq_u32 s94, 0
    s_cbranch_scc1 Lok78
    s_sub_u32 s94, s94, 1
    s_mov_b32 s93, m0
    s_waitcnt lgkmcnt(0)
    s_add_u32 m0, s22, 0x18180
    s_add_u32 s92, s29, 0x1b18000
    buffer_load_dwordx4 v1, s[4:7], s92 offen sc1 lds
    s_add_u32 m0, s22, 0x18580
    s_add_u32 s92, s29, 0x1b18400
    buffer_load_dwordx4 v1, s[4:7], s92 offen sc1 lds
    s_add_u32 m0, s22, 0x18980
    s_add_u32 s92, s29, 0x1b18800
    buffer_load_dwordx4 v1, s[4:7], s92 offen sc1 lds
    s_add_u32 m0, s22, 0x18d80
    s_add_u32 s92, s29, 0x1b18c00
    buffer_load_dwordx4 v1, s[4:7], s92 offen sc1 lds
    s_waitcnt vmcnt(0)
    ds_read2st64_b32 v[104:105], v108 offset0:0 offset1:4
    ds_read2st64_b32 v[106:107], v108 offset0:8 offset1:12
    s_waitcnt lgkmcnt(0)
    s_mov_b32 m0, s93
    v_max3_u32 v7, v104, v105, v106
    v_max_u32 v7, v7, v107
    v_cmp_eq_u32 vcc, -1, v7
    s_cbranch_vccnz Lre78
    s_branch Lok78
Lre79:
    s_cmp_eq_u32 s94, 0
    s_cbranch_scc1 Lok79
    s_sub_u32 s94, s94, 1
    s_mov_b32 s93, m0
    s_waitcnt lgkmcnt(0)
    s_add_u32 m0, s22, 0x1c1c0
    s_add_u32 s92, s29, 0x1b1c000
    buffer_load_dwordx4 v1, s[4:7], s92 offen sc1 lds
    s_add_u32 m0, s22, 0x1c5c0
    s_add_u32 s92, s29, 0x1b1c400
    buffer_load_dwordx4 v1, s[4:7], s92 offen sc1 lds
    s_add_u32 m0, s22, 0x1c9c0
    s_add_u32 s92, s29, 0x1b1c800
    buffer_load_dwordx4 v1, s[4:7], s92 offen sc1 lds
    s_add_u32 m0, s22, 0x1cdc0
    s_add_u32 s92, s29, 0x1b1cc00
    buffer_load_dwordx4 v1, s[4:7], s92 offen sc1 lds
    s_waitcnt vmcnt(0)
    ds_read2st64_b32 v[104:105], v108 offset0:0 offset1:4
    ds_read2st64_b32 v[106:107], v108 offset0:8 offset1:12
    s_waitcnt lgkmcnt(0)
    s_mov_b32 m0, s93
    v_max3_u32 v7, v104, v105, v106
    v_max_u32 v7, v7, v107
    v_cmp_eq_u32 vcc, -1, v7
    s_cbranch_vccnz Lre79
    s_branch Lok79
Lre80:
    s_cmp_eq_u32 s94, 0
    s_cbranch_scc1 Lok80
    s_sub_u32 s94, s94, 1
    s_waitcnt lgkmcnt(0)
    s_mov_b32 s92, 0x5f4000
    buffer_load_dword v105, v104, s[4:7], s92 offen sc1
    s_waitcnt vmcnt(0)
    v_cmp_ne_u32 vcc, 16, v105
    s_cbranch_vccnz Lre80
    s_branch Lok80
Lre81:
    s_cmp_eq_u32 s94, 0
    s_cbranch_scc1 Lok81
    s_sub_u32 s94, s94, 1
    s_waitcnt lgkmcnt(0)
    s_add_u32 s92, s17, 0x2300000
    buffer_load_dwordx4 v[48:51], v1, s[4:7], s92 offen sc1
    s_add_u32 s92, s17, 0x2300400
    buffer_load_dwordx4 v[52:55], v1, s[4:7], s92 offen sc1
    s_add_u32 s92, s17, 0x2300800
    buffer_load_dwordx4 v[56:59], v1, s[4:7], s92 offen sc1
    s_add_u32 s92, s17, 0x2300c00
    buffer_load_dwordx4 v[60:63], v1, s[4:7], s92 offen sc1
    s_add_u32 s92, s17, 0x2301000
    buffer_load_dwordx4 v[96:99], v1, s[4:7], s92 offen sc1
    s_add_u32 s92, s17, 0x2301400
    buffer_load_dwordx4 v[100:103], v1, s[4:7], s92 offen sc1
    s_add_u32 s92, s17, 0x2301800
    buffer_load_dwordx4 v[104:107], v1, s[4:7], s92 offen sc1
    s_add_u32 s92, s17, 0x2301c00
    buffer_load_dwordx4 v[108:111], v1, s[4:7], s92 offen sc1
    s_waitcnt vmcnt(0)
    v_max3_u32 v7, v48, v52, v56
    v_max_u32 v7, v7, v60
    v_cmp_eq_u32 vcc, -1, v7
    s_cbranch_vccnz Lre81
    s_branch Lok81
Lre82:
    s_cmp_eq_u32 s94, 0
    s_cbranch_scc1 Lok82
    s_sub_u32 s94, s94, 1
    s_waitcnt lgkmcnt(0)
    s_add_u32 s92, s17, 0x2301000
    buffer_load_dwordx4 v[96:99], v1, s[4:7], s92 offen sc1
    s_add_u32 s92, s17, 0x2301400
    buffer_load_dwordx4 v[100:103], v1, s[4:7], s92 offen sc1
    s_add_u32 s92, s17, 0x2301800
    buffer_load_dwordx4 v[104:107], v1, s[4:7], s92 offen sc1
    s_add_u32 s92, s17, 0x2301c00
    buffer_load_dwordx4 v[108:111], v1, s[4:7], s92 offen sc1
    s_waitcnt vmcnt(0)
    v_max3_u32 v7, v96, v100, v104
    v_max_u32 v7, v7, v108
    v_cmp_eq_u32 vcc, -1, v7
    s_cbranch_vccnz Lre82
    s_branch Lok82
Lre83:
    buffer_store_dwordx4 v[8:11], v1, s[4:7], s83 offen sc1
    s_branch Lok83
Lre84:
    buffer_store_dword v36, v127, s[4:7], s91 offen sc1
    s_branch Lok84
Lre85:
    s_cmp_eq_u32 s94, 0
    s_cbranch_scc1 Lok85
    s_sub_u32 s94, s94, 1
    s_waitcnt lgkmcnt(0)
    s_add_u32 s92, s17, 0x2308000
    buffer_load_dwordx4 v[64:67], v1, s[4:7], s92 offen sc1
    s_add_u32 s92, s17, 0x2308400
    buffer_load_dwordx4 v[68:71], v1, s[4:7], s92 offen sc1
    s_add_u32 s92, s17, 0x2308800
    buffer_load_dwordx4 v[72:75], v1, s[4:7], s92 offen sc1
    s_add_u32 s92, s17, 0x2308c00
    buffer_load_dwordx4 v[76:79], v1, s[4:7], s92 offen sc1
    s_add_u32 s92, s17, 0x2309000
    buffer_load_dwordx4 v[48:51], v1, s[4:7], s92 offen sc1
    s_add_u32 s92, s17, 0x2309400
    buffer_load_dwordx4 v[52:55], v1, s[4:7], s92 offen sc1
    s_add_u32 s92, s17, 0x2309800
    buffer_load_dwordx4 v[56:59], v1, s[4:7], s92 offen sc1
    s_add_u32 s92, s17, 0x2309c00
    buffer_load_dwordx4 v[60:63], v1, s[4:7], s92 offen sc1
    s_waitcnt vmcnt(0)
    v_max3_u32 v7, v64, v68, v72
    v_max_u32 v7, v7, v76
    v_cmp_eq_u32 vcc, -1, v7
    s_cbranch_vccnz Lre85
    s_branch Lok85
Lre86:
    s_cmp_eq_u32 s94, 0
    s_cbranch_scc1 Lok86
    s_sub_u32 s94, s94, 1
    s_waitcnt lgkmcnt(0)
    s_add_u32 s92, s17, 0x2309000
    buffer_load_dwordx4 v[48:51], v1, s[4:7], s92 offen sc1
    s_add_u32 s92, s17, 0x2309400
    buffer_load_dwordx4 v[52:55], v1, s[4:7], s92 offen sc1
    s_add_u32 s92, s17, 0x2309800
    buffer_load_dwordx4 v[56:59], v1, s[4:7], s92 offen sc1
    s_add_u32 s92, s17, 0x2309c00
    buffer_load_dwordx4 v[60:63], v1, s[4:7], s92 offen sc1
    s_waitcnt vmcnt(0)
    v_max3_u32 v7, v48, v52, v56
    v_max_u32 v7, v7, v60
    v_cmp_eq_u32 vcc, -1, v7
    s_cbranch_vccnz Lre86
    s_branch Lok86
Lre87:
    buffer_store_dwordx4 v[12:15], v1, s[4:7], s82 offen sc1
    s_branch Lok87
Lre88:
    buffer_store_dword v36, v127, s[4:7], s91 offen offset:2048 sc1
    s_branch Lok88
Lre89:
    s_cmp_eq_u32 s94, 0
    s_cbranch_scc1 Lok89
    s_sub_u32 s94, s94, 1
    s_mov_b32 s93, m0
    s_waitcnt lgkmcnt(0)
    s_mov_b32 m0, s22
    s_add_u32 s92, s21, 0x2500000
    buffer_load_dwordx4 v1, s[4:7], s92 offen sc1 lds
    s_add_u32 m0, s22, 0x400
    s_add_u32 s92, s21, 0x2500400
    buffer_load_dwordx4 v1, s[4:7], s92 offen sc1 lds
    s_add_u32 m0, s22, 0x800
    s_add_u32 s92, s21, 0x2500800
    buffer_load_dwordx4 v1, s[4:7], s92 offen sc1 lds
    s_add_u32 m0, s22, 0xc00
    s_add_u32 s92, s21, 0x2500c00
    buffer_load_dwordx4 v1, s[4:7], s92 offen sc1 lds
    s_add_u32 m0, s22, 0x4040
    s_add_u32 s92, s21, 0x2504000
    buffer_load_dwordx4 v1, s[4:7], s92 offen sc1 lds
    s_add_u32 m0, s22, 0x4440
    s_add_u32 s92, s21, 0x2504400
    buffer_load_dwordx4 v1, s[4:7], s92 offen sc1 lds
    s_add_u32 m0, s22, 0x4840
    s_add_u32 s92, s21, 0x2504800
    buffer_load_dwordx4 v1, s[4:7], s92 offen sc1 lds
    s_add_u32 m0, s22, 0x4c40
    s_add_u32 s92, s21, 0x2504c00
    buffer_load_dwordx4 v1, s[4:7], s92 offen sc1 lds
    s_waitcnt vmcnt(0)
    ds_read2st64_b32 v[104:105], v108 offset0:0 offset1:4
    ds_read2st64_b32 v[106:107], v108 offset0:8 offset1:12
    ds_read2st64_b32 v[82:83], v86 offset0:0 offset1:4
    ds_read2st64_b32 v[84:85], v86 offset0:8 offset1:12
    s_waitcnt lgkmcnt(0)
    s_mov_b32 m0, s93
    v_max3_u32 v7, v104, v105, v106
    v_max_u32 v7, v7, v107
    v_cmp_eq_u32 vcc, -1, v7
    s_cbranch_vccnz Lre89
    s_branch Lok89
Lre90:
    s_cmp_eq_u32 s94, 0
    s_cbranch_scc1 Lok90
    s_sub_u32 s94, s94, 1
    s_mov_b32 s93, m0
    s_waitcnt lgkmcnt(0)
    s_add_u32 m0, s22, 0x4040
    s_add_u32 s92, s21, 0x2504000
    buffer_load_dwordx4 v1, s[4:7], s92 offen sc1 lds
    s_add_u32 m0, s22, 0x4440
    s_add_u32 s92, s21, 0x2504400
    buffer_load_dwordx4 v1, s[4:7], s92 offen sc1 lds
    s_add_u32 m0, s22, 0x4840
    s_add_u32 s92, s21, 0x2504800
    buffer_load_dwordx4 v1, s[4:7], s92 offen sc1 lds
    s_add_u32 m0, s22, 0x4c40
    s_add_u32 s92, s21, 0x2504c00
    buffer_load_dwordx4 v1, s[4:7], s92 offen sc1 lds
    s_waitcnt vmcnt(0)
    ds_read2st64_b32 v[82:83], v86 offset0:0 offset1:4
    ds_read2st64_b32 v[84:85], v86 offset0:8 offset1:12
    s_waitcnt lgkmcnt(0)
    s_mov_b32 m0, s93
    v_max3_u32 v7, v82, v83, v84
    v_max_u32 v7, v7, v85
    v_cmp_eq_u32 vcc, -1, v7
    s_cbranch_vccnz Lre90
    s_branch Lok90
Lre91:
    s_cmp_eq_u32 s94, 0
    s_cbranch_scc1 Lok91
    s_sub_u32 s94, s94, 1
    s_waitcnt lgkmcnt(0)
    s_add_u32 s92, s19, 0x660000
    buffer_load_dwordx4 v[64:67], v47, s[4:7], s92 offen sc1
    s_add_u32 s92, s19, 0x660200
    buffer_load_dwordx4 v[68:71], v47, s[4:7], s92 offen sc1
    s_add_u32 s92, s19, 0x660400
    buffer_load_dwordx4 v[72:75], v47, s[4:7], s92 offen sc1
    s_add_u32 s92, s19, 0x660600
    buffer_load_dwordx4 v[76:79], v47, s[4:7], s92 offen sc1
    s_waitcnt vmcnt(0)
    v_max3_u32 v7, v64, v65, v66
    v_max3_u32 v7, v7, v67, v68
    v_max3_u32 v7, v7, v69, v70
    v_max3_u32 v7, v7, v71, v72
    v_max3_u32 v7, v7, v73, v74
    v_max3_u32 v7, v7, v75, v76
    v_max3_u32 v7, v7, v77, v78
    v_max_u32 v7, v7, v79
    v_cmp_eq_u32 vcc, -1, v7
    s_cbranch_vccnz Lre91
    s_branch Lok91
Lre92:
    s_cmp_eq_u32 s94, 0
    s_cbranch_scc1 Lok92
    s_sub_u32 s94, s94, 1
    s_mov_b32 s93, m0
    s_waitcnt lgkmcnt(0)
    s_add_u32 m0, s22, 0x8080
    s_add_u32 s92, s21, 0x2510000
    buffer_load_dwordx4 v1, s[4:7], s92 offen sc1 lds
    s_add_u32 m0, s22, 0x8480
    s_add_u32 s92, s21, 0x2510400
    buffer_load_dwordx4 v1, s[4:7], s92 offen sc1 lds
    s_add_u32 m0, s22, 0x8880
    s_add_u32 s92, s21, 0x2510800
    buffer_load_dwordx4 v1, s[4:7], s92 offen sc1 lds
    s_add_u32 m0, s22, 0x8c80
    s_add_u32 s92, s21, 0x2510c00
    buffer_load_dwordx4 v1, s[4:7], s92 offen sc1 lds
    s_add_u32 m0, s22, 0xc0c0
    s_add_u32 s92, s21, 0x2514000
    buffer_load_dwordx4 v1, s[4:7], s92 offen sc1 lds
    s_add_u32 m0, s22, 0xc4c0
    s_add_u32 s92, s21, 0x2514400
    buffer_load_dwordx4 v1, s[4:7], s92 offen sc1 lds
    s_add_u32 m0, s22, 0xc8c0
    s_add_u32 s92, s21, 0x2514800
    buffer_load_dwordx4 v1, s[4:7], s92 offen sc1 lds
    s_add_u32 m0, s22, 0xccc0
    s_add_u32 s92, s21, 0x2514c00
    buffer_load_dwordx4 v1, s[4:7], s92 offen sc1 lds
    s_waitcnt vmcnt(0)
    ds_read2st64_b32 v[42:43], v46 offset0:0 offset1:4
    ds_read2st64_b32 v[44:45], v46 offset0:8 offset1:12
    ds_read2st64_b32 v[106:107], v110 offset0:0 offset1:4
    ds_read2st64_b32 v[108:109], v110 offset0:8 offset1:12
    s_waitcnt lgkmcnt(0)
    s_mov_b32 m0, s93
    v_max3_u32 v7, v42, v43, v44
    v_max_u32 v7, v7, v45
    v_cmp_eq_u32 vcc, -1, v7
    s_cbranch_vccnz Lre92
    s_branch Lok92
Lre93:
    s_cmp_eq_u32 s94, 0
    s_cbranch_scc1 Lok93
    s_sub_u32 s94, s94, 1
    s_mov_b32 s93, m0
    s_waitcnt lgkmcnt(0)
    s_add_u32 m0, s22, 0xc0c0
    s_add_u32 s92, s21, 0x2514000
    buffer_load_dwordx4 v1, s[4:7], s92 offen sc1 lds
    s_add_u32 m0, s22, 0xc4c0
    s_add_u32 s92, s21, 0x2514400
    buffer_load_dwordx4 v1, s[4:7], s92 offen sc1 lds
    s_add_u32 m0, s22, 0xc8c0
    s_add_u32 s92, s21, 0x2514800
    buffer_load_dwordx4 v1, s[4:7], s92 offen sc1 lds
    s_add_u32 m0, s22, 0xccc0
    s_add_u32 s92, s21, 0x2514c00
    buffer_load_dwordx4 v1, s[4:7], s92 offen sc1 lds
    s_waitcnt vmcnt(0)
    ds_read2st64_b32 v[106:107], v110 offset0:0 offset1:4
    ds_read2st64_b32 v[108:109], v110 offset0:8 offset1:12
    s_waitcnt lgkmcnt(0)
    s_mov_b32 m0, s93
    v_max3_u32 v7, v106, v107, v108
    v_max_u32 v7, v7, v109
    v_cmp_eq_u32 vcc, -1, v7
    s_cbranch_vccnz Lre93
    s_branch Lok93
Lre94:
    buffer_store_dwordx4 v[16:19], v1, s[4:7], s84 offen sc1
    s_branch Lok94
Lre95:
    s_cmp_eq_u32 s94, 0
    s_cbranch_scc1 Lok95
    s_sub_u32 s94, s94, 1
    s_mov_b32 s93, m0
    s_waitcnt lgkmcnt(0)
    s_add_u32 m0, s22, 0x10100
    s_add_u32 s92, s21, 0x2508000
    buffer_load_dwordx4 v1, s[4:7], s92 offen sc1 lds
    s_add_u32 m0, s22, 0x10500
    s_add_u32 s92, s21, 0x2508400
    buffer_load_dwordx4 v1, s[4:7], s92 offen sc1 lds
    s_add_u32 m0, s22, 0x10900
    s_add_u32 s92, s21, 0x2508800
    buffer_load_dwordx4 v1, s[4:7], s92 offen sc1 lds
    s_add_u32 m0, s22, 0x10d00
    s_add_u32 s92, s21, 0x2508c00
    buffer_load_dwordx4 v1, s[4:7], s92 offen sc1 lds
    s_add_u32 m0, s22, 0x14140
    s_add_u32 s92, s21, 0x250c000
    buffer_load_dwordx4 v1, s[4:7], s92 offen sc1 lds
    s_add_u32 m0, s22, 0x14540
    s_add_u32 s92, s21, 0x250c400
    buffer_load_dwordx4 v1, s[4:7], s92 offen sc1 lds
    s_add_u32 m0, s22, 0x14940
    s_add_u32 s92, s21, 0x250c800
    buffer_load_dwordx4 v1, s[4:7], s92 offen sc1 lds
    s_add_u32 m0, s22, 0x14d40
    s_add_u32 s92, s21, 0x250cc00
    buffer_load_dwordx4 v1, s[4:7], s92 offen sc1 lds
    s_waitcnt vmcnt(0)
    ds_read2st64_b32 v[42:43], v46 offset0:0 offset1:4
    ds_read2st64_b32 v[44:45], v46 offset0:8 offset1:12
    ds_read2st64_b32 v[106:107], v110 offset0:0 offset1:4
    ds_read2st64_b32 v[108:109], v110 offset0:8 offset1:12
    s_waitcnt lgkmcnt(0)
    s_mov_b32 m0, s93
    v_max3_u32 v7, v42, v43, v44
    v_max_u32 v7, v7, v45
    v_cmp_eq_u32 vcc, -1, v7
    s_cbranch_vccnz Lre95
    s_branch Lok95
Lre96:
    s_cmp_eq_u32 s94, 0
    s_cbranch_scc1 Lok96
    s_sub_u32 s94, s94, 1
    s_mov_b32 s93, m0
    s_waitcnt lgkmcnt(0)
    s_add_u32 m0, s22, 0x14140
    s_add_u32 s92, s21, 0x250c000
    buffer_load_dwordx4 v1, s[4:7], s92 offen sc1 lds
    s_add_u32 m0, s22, 0x14540
    s_add_u32 s92, s21, 0x250c400
    buffer_load_dwordx4 v1, s[4:7], s92 offen sc1 lds
    s_add_u32 m0, s22, 0x14940
    s_add_u32 s92, s21, 0x250c800
    buffer_load_dwordx4 v1, s[4:7], s92 offen sc1 lds
    s_add_u32 m0, s22, 0x14d40
    s_add_u32 s92, s21, 0x250cc00
    buffer_load_dwordx4 v1, s[4:7], s92 offen sc1 lds
    s_waitcnt vmcnt(0)
    ds_read2st64_b32 v[106:107], v110 offset0:0 offset1:4
    ds_read2st64_b32 v[108:109], v110 offset0:8 offset1:12
    s_waitcnt lgkmcnt(0)
    s_mov_b32 m0, s93
    v_max3_u32 v7, v106, v107, v108
    v_max_u32 v7, v7, v109
    v_cmp_eq_u32 vcc, -1, v7
    s_cbranch_vccnz Lre96
    s_branch Lok96
Lre97:
    buffer_store_dwordx4 v[24:27], v1, s[4:7], s84 offen offset:1024 sc1
    s_branch Lok97
Lre98:
    s_cmp_eq_u32 s94, 0
    s_cbranch_scc1 Lok98
    s_sub_u32 s94, s94, 1
    s_waitcnt lgkmcnt(0)
    s_add_u32 s92, s19, 0x660800
    buffer_load_dwordx4 v[64:67], v47, s[4:7], s92 offen sc1
    s_add_u32 s92, s19, 0x660a00
    buffer_load_dwordx4 v[68:71], v47, s[4:7], s92 offen sc1
    s_add_u32 s92, s19, 0x660c00
    buffer_load_dwordx4 v[72:75], v47, s[4:7], s92 offen sc1
    s_add_u32 s92, s19, 0x660e00
    buffer_load_dwordx4 v[76:79], v47, s[4:7], s92 offen sc1
    s_waitcnt vmcnt(0)
    v_max3_u32 v7, v64, v65, v66
    v_max3_u32 v7, v7, v67, v68
    v_max3_u32 v7, v7, v69, v70
    v_max3_u32 v7, v7, v71, v72
    v_max3_u32 v7, v7, v73, v74
    v_max3_u32 v7, v7, v75, v76
    v_max3_u32 v7, v7, v77, v78
    v_max_u32 v7, v7, v79
    v_cmp_eq_u32 vcc, -1, v7
    s_cbranch_vccnz Lre98
    s_branch Lok98
Lre99:
    buffer_store_dwordx4 v[48:51], v1, s[4:7], s90 offen sc1
    s_branch Lok99
Lre100:
    s_cmp_eq_u32 s94, 0
    s_cbranch_scc1 Lok100
    s_sub_u32 s94, s94, 1
    s_mov_b32 s93, m0
    s_waitcnt lgkmcnt(0)
    s_mov_b32 m0, s22
    s_add_u32 s92, s21, 0x2518000
    buffer_load_dwordx4 v1, s[4:7], s92 offen sc1 lds
    s_add_u32 m0, s22, 0x400
    s_add_u32 s92, s21, 0x2518400
    buffer_load_dwordx4 v1, s[4:7], s92 offen sc1 lds
    s_add_u32 m0, s22, 0x800
    s_add_u32 s92, s21, 0x2518800
    buffer_load_dwordx4 v1, s[4:7], s92 offen sc1 lds
    s_add_u32 m0, s22, 0xc00
    s_add_u32 s92, s21, 0x2518c00
    buffer_load_dwordx4 v1, s[4:7], s92 offen sc1 lds
    s_add_u32 m0, s22, 0x4040
    s_add_u32 s92, s21, 0x251c000
    buffer_load_dwordx4 v1, s[4:7], s92 offen sc1 lds
    s_add_u32 m0, s22, 0x4440
    s_add_u32 s92, s21, 0x251c400
    buffer_load_dwordx4 v1, s[4:7], s92 offen sc1 lds
    s_add_u32 m0, s22, 0x4840
    s_add_u32 s92, s21, 0x251c800
    buffer_load_dwordx4 v1, s[4:7], s92 offen sc1 lds
    s_add_u32 m0, s22, 0x4c40
    s_add_u32 s92, s21, 0x251cc00
    buffer_load_dwordx4 v1, s[4:7], s92 offen sc1 lds
    s_waitcnt vmcnt(0)
    ds_read2st64_b32 v[42:43], v46 offset0:0 offset1:4
    ds_read2st64_b32 v[44:45], v46 offset0:8 offset1:12
    ds_read2st64_b32 v[106:107], v110 offset0:0 offset1:4
    ds_read2st64_b32 v[108:109], v110 offset0:8 offset1:12
    s_waitcnt lgkmcnt(0)
    s_mov_b32 m0, s93
    v_max3_u32 v7, v42, v43, v44
    v_max_u32 v7, v7, v45
    v_cmp_eq_u32 vcc, -1, v7
    s_cbranch_vccnz Lre100
    s_branch Lok100
Lre101:
    s_cmp_eq_u32 s94, 0
    s_cbranch_scc1 Lok101
    s_sub_u32 s94, s94, 1
    s_mov_b32 s93, m0
    s_waitcnt lgkmcnt(0)
    s_add_u32 m0, s22, 0x4040
    s_add_u32 s92, s21, 0x251c000
    buffer_load_dwordx4 v1, s[4:7], s92 offen sc1 lds
    s_add_u32 m0, s22, 0x4440
    s_add_u32 s92, s21, 0x251c400
    buffer_load_dwordx4 v1, s[4:7], s92 offen sc1 lds
    s_add_u32 m0, s22, 0x4840
    s_add_u32 s92, s21, 0x251c800
    buffer_load_dwordx4 v1, s[4:7], s92 offen sc1 lds
    s_add_u32 m0, s22, 0x4c40
    s_add_u32 s92, s21, 0x251cc00
    buffer_load_dwordx4 v1, s[4:7], s92 offen sc1 lds
    s_waitcnt vmcnt(0)
    ds_read2st64_b32 v[106:107], v110 offset0:0 offset1:4
    ds_read2st64_b32 v[108:109], v110 offset0:8 offset1:12
    s_waitcnt lgkmcnt(0)
    s_mov_b32 m0, s93
    v_max3_u32 v7, v106, v107, v108
    v_max_u32 v7, v7, v109
    v_cmp_eq_u32 vcc, -1, v7
    s_cbranch_vccnz Lre101
    s_branch Lok101
Lre102:
    buffer_store_dwordx4 v[56:59], v1, s[4:7], s90 offen offset:1024 sc1
    s_branch Lok102
Lre103:
    buffer_store_dwordx4 v[16:19], v1, s[4:7], s82 offen sc1
    s_branch Lok103
Lre104:
    buffer_store_dwordx4 v[24:27], v1, s[4:7], s82 offen offset:1024 sc1
    s_branch Lok104
Lre105:
    buffer_store_dwordx4 v[48:51], v1, s[4:7], s89 offen sc1
    s_branch Lok105
Lre106:
    s_cmp_eq_u32 s94, 0
    s_cbranch_scc1 Lok106
    s_sub_u32 s94, s94, 1
    s_waitcnt lgkmcnt(0)
    s_add_u32 s92, s24, 0x2700000
    buffer_load_dwordx4 v[128:131], v1, s[4:7], s92 offen sc1
    s_add_u32 s92, s24, 0x2700800
    buffer_load_dwordx4 v[132:135], v1, s[4:7], s92 offen sc1
    s_add_u32 s92, s24, 0x2701000
    buffer_load_dwordx4 v[136:139], v1, s[4:7], s92 offen sc1
    s_add_u32 s92, s24, 0x2701800
    buffer_load_dwordx4 v[140:143], v1, s[4:7], s92 offen sc1
    s_add_u32 s92, s24, 0x2702000
    buffer_load_dwordx4 v[144:147], v1, s[4:7], s92 offen sc1
    s_add_u32 s92, s24, 0x2702800
    buffer_load_dwordx4 v[148:151], v1, s[4:7], s92 offen sc1
    s_add_u32 s92, s24, 0x2703000
    buffer_load_dwordx4 v[152:155], v1, s[4:7], s92 offen sc1
    s_add_u32 s92, s24, 0x2703800
    buffer_load_dwordx4 v[156:159], v1, s[4:7], s92 offen sc1
    s_waitcnt vmcnt(0)
    v_max3_u32 v7, v128, v132, v136
    v_max_u32 v7, v7, v140
    v_cmp_eq_u32 vcc, -1, v7
    s_cbranch_vccnz Lre106
    s_add_u32 s92, s24, 0x2704000
    buffer_load_dwordx4 v[160:163], v1, s[4:7], s92 offen sc1
    s_add_u32 s92, s24, 0x2704800
    buffer_load_dwordx4 v[164:167], v1, s[4:7], s92 offen sc1
    s_add_u32 s92, s24, 0x2705000
    buffer_load_dwordx4 v[168:171], v1, s[4:7], s92 offen sc1
    s_add_u32 s92, s24, 0x2705800
    buffer_load_dwordx4 v[172:175], v1, s[4:7], s92 offen sc1
    s_add_u32 s92, s24, 0x2706000
    buffer_load_dwordx4 v[176:179], v1, s[4:7], s92 offen sc1
    s_add_u32 s92, s24, 0x2706800
    buffer_load_dwordx4 v[180:183], v1, s[4:7], s92 offen sc1
    s_add_u32 s92, s24, 0x2700400
    buffer_load_dwordx4 v[184:187], v1, s[4:7], s92 offen sc1
    s_add_u32 s92, s24, 0x2700c00
    buffer_load_dwordx4 v[188:191], v1, s[4:7], s92 offen sc1
    s_add_u32 s92, s24, 0x2701400
    buffer_load_dwordx4 v[192:195], v1, s[4:7], s92 offen sc1
    s_add_u32 s92, s24, 0x2701c00
    buffer_load_dwordx4 v[196:199], v1, s[4:7], s92 offen sc1
    s_branch Lok106
Lre107:
    s_cmp_eq_u32 s94, 0
    s_cbranch_scc1 Lok107
    s_sub_u32 s94, s94, 1
    s_waitcnt lgkmcnt(0)
    s_add_u32 s92, s24, 0x2702000
    buffer_load_dwordx4 v[144:147], v1, s[4:7], s92 offen sc1
    s_add_u32 s92, s24, 0x2702800
    buffer_load_dwordx4 v[148:151], v1, s[4:7], s92 offen sc1
    s_add_u32 s92, s24, 0x2703000
    buffer_load_dwordx4 v[152:155], v1, s[4:7], s92 offen sc1
    s_add_u32 s92, s24, 0x2703800
    buffer_load_dwordx4 v[156:159], v1, s[4:7], s92 offen sc1
    s_add_u32 s92, s24, 0x2704000
    buffer_load_dwordx4 v[160:163], v1, s[4:7], s92 offen sc1
    s_add_u32 s92, s24, 0x2704800
    buffer_load_dwordx4 v[164:167], v1, s[4:7], s92 offen sc1
    s_add_u32 s92, s24, 0x2705000
    buffer_load_dwordx4 v[168:171], v1, s[4:7], s92 offen sc1
    s_add_u32 s92, s24, 0x2705800
    buffer_load_dwordx4 v[172:175], v1, s[4:7], s92 offen sc1
    s_waitcnt vmcnt(0)
    v_max3_u32 v7, v144, v148, v152
    v_max_u32 v7, v7, v156
    v_cmp_eq_u32 vcc, -1, v7
    s_cbranch_vccnz Lre107
    s_add_u32 s92, s24, 0x2706000
    buffer_load_dwordx4 v[176:179], v1, s[4:7], s92 offen sc1
    s_add_u32 s92, s24, 0x2706800
    buffer_load_dwordx4 v[180:183], v1, s[4:7], s92 offen sc1
    s_add_u32 s92, s24, 0x2700400
    buffer_load_dwordx4 v[184:187], v1, s[4:7], s92 offen sc1
    s_add_u32 s92, s24, 0x2700c00
    buffer_load_dwordx4 v[188:191], v1, s[4:7], s92 offen sc1
    s_add_u32 s92, s24, 0x2701400
    buffer_load_dwordx4 v[192:195], v1, s[4:7], s92 offen sc1
    s_add_u32 s92, s24, 0x2701c00
    buffer_load_dwordx4 v[196:199], v1, s[4:7], s92 offen sc1
    s_add_u32 s92, s24, 0x2702400
    buffer_load_dwordx4 v[200:203], v1, s[4:7], s92 offen sc1
    s_add_u32 s92, s24, 0x2702c00
    buffer_load_dwordx4 v[204:207], v1, s[4:7], s92 offen sc1
    s_add_u32 s92, s24, 0x2703400
    buffer_load_dwordx4 v[208:211], v1, s[4:7], s92 offen sc1
    s_add_u32 s92, s24, 0x2703c00
    buffer_load_dwordx4 v[212:215], v1, s[4:7], s92 offen sc1
    s_branch Lok107
Lre108:
    s_cmp_eq_u32 s94, 0
    s_cbranch_scc1 Lok108
    s_sub_u32 s94, s94, 1
    s_waitcnt lgkmcnt(0)
    s_add_u32 s92, s24, 0x2704000
    buffer_load_dwordx4 v[160:163], v1, s[4:7], s92 offen sc1
    s_add_u32 s92, s24, 0x2704800
    buffer_load_dwordx4 v[164:167], v1, s[4:7], s92 offen sc1
    s_add_u32 s92, s24, 0x2705000
    buffer_load_dwordx4 v[168:171], v1, s[4:7], s92 offen sc1
    s_add_u32 s92, s24, 0x2705800
    buffer_load_dwordx4 v[172:175], v1, s[4:7], s92 offen sc1
    s_add_u32 s92, s24, 0x2706000
    buffer_load_dwordx4 v[176:179], v1, s[4:7], s92 offen sc1
    s_add_u32 s92, s24, 0x2706800
    buffer_load_dwordx4 v[180:183], v1, s[4:7], s92 offen sc1
    s_add_u32 s92, s24, 0x2700400
    buffer_load_dwordx4 v[184:187], v1, s[4:7], s92 offen sc1
    s_add_u32 s92, s24, 0x2700c00
    buffer_load_dwordx4 v[188:191], v1, s[4:7], s92 offen sc1
    s_waitcnt vmcnt(0)
    v_max3_u32 v7, v160, v164, v168
    v_max_u32 v7, v7, v172
    v_cmp_eq_u32 vcc, -1, v7
    s_cbranch_vccnz Lre108
    s_add_u32 s92, s24, 0x2701400
    buffer_load_dwordx4 v[192:195], v1, s[4:7], s92 offen sc1
    s_add_u32 s92, s24, 0x2701c00
    buffer_load_dwordx4 v[196:199], v1, s[4:7], s92 offen sc1
    s_add_u32 s92, s24, 0x2702400
    buffer_load_dwordx4 v[200:203], v1, s[4:7], s92 offen sc1
    s_add_u32 s92, s24, 0x2702c00
    buffer_load_dwordx4 v[204:207], v1, s[4:7], s92 offen sc1
    s_add_u32 s92, s24, 0x2703400
    buffer_load_dwordx4 v[208:211], v1, s[4:7], s92 offen sc1
    s_add_u32 s92, s24, 0x2703c00
    buffer_load_dwordx4 v[212:215], v1, s[4:7], s92 offen sc1
    s_add_u32 s92, s24, 0x2704400
    buffer_load_dwordx4 v[216:219], v1, s[4:7], s92 offen sc1
    s_add_u32 s92, s24, 0x2704c00
    buffer_load_dwordx4 v[220:223], v1, s[4:7], s92 offen sc1
    s_add_u32 s92, s24, 0x2705400
    buffer_load_dwordx4 v[224:227], v1, s[4:7], s92 offen sc1
    s_add_u32 s92, s24, 0x2705c00
    buffer_load_dwordx4 v[228:231], v1, s[4:7], s92 offen sc1
    s_branch Lok108
Lre109:
    buffer_store_dwordx4 v[56:59], v1, s[4:7], s89 offen offset:1024 sc1
    s_branch Lok109
Lre110:
    s_cmp_eq_u32 s94, 0
    s_cbranch_scc1 Lok110
    s_sub_u32 s94, s94, 1
    s_waitcnt lgkmcnt(0)
    s_add_u32 s92, s24, 0x2706000
    buffer_load_dwordx4 v[176:179], v1, s[4:7], s92 offen sc1
    s_add_u32 s92, s24, 0x2706800
    buffer_load_dwordx4 v[180:183], v1, s[4:7], s92 offen sc1
    s_add_u32 s92, s24, 0x2700400
    buffer_load_dwordx4 v[184:187], v1, s[4:7], s92 offen sc1
    s_add_u32 s92, s24, 0x2700c00
    buffer_load_dwordx4 v[188:191], v1, s[4:7], s92 offen sc1
    s_add_u32 s92, s24, 0x2701400
    buffer_load_dwordx4 v[192:195], v1, s[4:7], s92 offen sc1
    s_add_u32 s92, s24, 0x2701c00
    buffer_load_dwordx4 v[196:199], v1, s[4:7], s92 offen sc1
    s_add_u32 s92, s24, 0x2702400
    buffer_load_dwordx4 v[200:203], v1, s[4:7], s92 offen sc1
    s_add_u32 s92, s24, 0x2702c00
    buffer_load_dwordx4 v[204:207], v1, s[4:7], s92 offen sc1
    s_waitcnt vmcnt(0)
    v_max3_u32 v7, v176, v180, v184
    v_max_u32 v7, v7, v188
    v_cmp_eq_u32 vcc, -1, v7
    s_cbranch_vccnz Lre110
    s_add_u32 s92, s24, 0x2703400
    buffer_load_dwordx4 v[208:211], v1, s[4:7], s92 offen sc1
    s_add_u32 s92, s24, 0x2703c00
    buffer_load_dwordx4 v[212:215], v1, s[4:7], s92 offen sc1
    s_add_u32 s92, s24, 0x2704400
    buffer_load_dwordx4 v[216:219], v1, s[4:7], s92 offen sc1
    s_add_u32 s92, s24, 0x2704c00
    buffer_load_dwordx4 v[220:223], v1, s[4:7], s92 offen sc1
    s_add_u32 s92, s24, 0x2705400
    buffer_load_dwordx4 v[224:227], v1, s[4:7], s92 offen sc1
    s_add_u32 s92, s24, 0x2705c00
    buffer_load_dwordx4 v[228:231], v1, s[4:7], s92 offen sc1
    s_add_u32 s92, s24, 0x2706400
    buffer_load_dwordx4 v[232:235], v1, s[4:7], s92 offen sc1
    s_add_u32 s92, s24, 0x2706c00
    buffer_load_dwordx4 v[236:239], v1, s[4:7], s92 offen sc1
    s_branch Lok110
Lre111:
    s_cmp_eq_u32 s94, 0
    s_cbranch_scc1 Lok111
    s_sub_u32 s94, s94, 1
    s_waitcnt lgkmcnt(0)
    s_add_u32 s92, s24, 0x2701400
    buffer_load_dwordx4 v[192:195], v1, s[4:7], s92 offen sc1
    s_add_u32 s92, s24, 0x2701c00
    buffer_load_dwordx4 v[196:199], v1, s[4:7], s92 offen sc1
    s_add_u32 s92, s24, 0x2702400
    buffer_load_dwordx4 v[200:203], v1, s[4:7], s92 offen sc1
    s_add_u32 s92, s24, 0x2702c00
    buffer_load_dwordx4 v[204:207], v1, s[4:7], s92 offen sc1
    s_add_u32 s92, s24, 0x2703400
    buffer_load_dwordx4 v[208:211], v1, s[4:7], s92 offen sc1
    s_add_u32 s92, s24, 0x2703c00
    buffer_load_dwordx4 v[212:215], v1, s[4:7], s92 offen sc1
    s_add_u32 s92, s24, 0x2704400
    buffer_load_dwordx4 v[216:219], v1, s[4:7], s92 offen sc1
    s_add_u32 s92, s24, 0x2704c00
    buffer_load_dwordx4 v[220:223], v1, s[4:7], s92 offen sc1
    s_waitcnt vmcnt(0)
    v_max3_u32 v7, v192, v196, v200
    v_max_u32 v7, v7, v204
    v_cmp_eq_u32 vcc, -1, v7
    s_cbranch_vccnz Lre111
    s_add_u32 s92, s24, 0x2705400
    buffer_load_dwordx4 v[224:227], v1, s[4:7], s92 offen sc1
    s_add_u32 s92, s24, 0x2705c00
    buffer_load_dwordx4 v[228:231], v1, s[4:7], s92 offen sc1
    s_add_u32 s92, s24, 0x2706400
    buffer_load_dwordx4 v[232:235], v1, s[4:7], s92 offen sc1
    s_add_u32 s92, s24, 0x2706c00
    buffer_load_dwordx4 v[236:239], v1, s[4:7], s92 offen sc1
    s_branch Lok111
Lre112:
    s_cmp_eq_u32 s94, 0
    s_cbranch_scc1 Lok112
    s_sub_u32 s94, s94, 1
    s_waitcnt lgkmcnt(0)
    s_add_u32 s92, s24, 0x2703400
    buffer_load_dwordx4 v[208:211], v1, s[4:7], s92 offen sc1
    s_add_u32 s92, s24, 0x2703c00
    buffer_load_dwordx4 v[212:215], v1, s[4:7], s92 offen sc1
    s_add_u32 s92, s24, 0x2704400
    buffer_load_dwordx4 v[216:219], v1, s[4:7], s92 offen sc1
    s_add_u32 s92, s24, 0x2704c00
    buffer_load_dwordx4 v[220:223], v1, s[4:7], s92 offen sc1
    s_add_u32 s92, s24, 0x2705400
    buffer_load_dwordx4 v[224:227], v1, s[4:7], s92 offen sc1
    s_add_u32 s92, s24, 0x2705c00
    buffer_load_dwordx4 v[228:231], v1, s[4:7], s92 offen sc1
    s_add_u32 s92, s24, 0x2706400
    buffer_load_dwordx4 v[232:235], v1, s[4:7], s92 offen sc1
    s_add_u32 s92, s24, 0x2706c00
    buffer_load_dwordx4 v[236:239], v1, s[4:7], s92 offen sc1
    s_waitcnt vmcnt(0)
    v_max3_u32 v7, v208, v212, v216
    v_max_u32 v7, v7, v220
    v_cmp_eq_u32 vcc, -1, v7
    s_cbranch_vccnz Lre112
    s_branch Lok112
Lre113:
    s_cmp_eq_u32 s94, 0
    s_cbranch_scc1 Lok113
    s_sub_u32 s94, s94, 1
    s_waitcnt lgkmcnt(0)
    s_add_u32 s92, s24, 0x2705400
    buffer_load_dwordx4 v[224:227], v1, s[4:7], s92 offen sc1
    s_add_u32 s92, s24, 0x2705c00
    buffer_load_dwordx4 v[228:231], v1, s[4:7], s92 offen sc1
    s_add_u32 s92, s24, 0x2706400
    buffer_load_dwordx4 v[232:235], v1, s[4:7], s92 offen sc1
    s_add_u32 s92, s24, 0x2706c00
    buffer_load_dwordx4 v[236:239], v1, s[4:7], s92 offen sc1
    s_waitcnt vmcnt(0)
    v_max3_u32 v7, v224, v228, v232
    v_max_u32 v7, v7, v236
    v_cmp_eq_u32 vcc, -1, v7
    s_cbranch_vccnz Lre113
    s_branch Lok113
Lre114:
    s_cmp_eq_u32 s94, 0
    s_cbranch_scc1 Lok114
    s_sub_u32 s94, s94, 1
    s_waitcnt lgkmcnt(0)
    s_add_u32 s92, s24, 0x271c000
    buffer_load_dwordx4 v[240:243], v1, s[4:7], s92 offen sc1
    s_add_u32 s92, s24, 0x271c800
    buffer_load_dwordx4 v[244:247], v1, s[4:7], s92 offen sc1
    s_add_u32 s92, s24, 0x271d000
    buffer_load_dwordx4 v[248:251], v1, s[4:7], s92 offen sc1
    s_add_u32 s92, s24, 0x271d800
    buffer_load_dwordx4 v[252:255], v1, s[4:7], s92 offen sc1
    s_add_u32 s92, s24, 0x271e000
    buffer_load_dwordx4 v[128:131], v1, s[4:7], s92 offen sc1
    s_add_u32 s92, s24, 0x271e800
    buffer_load_dwordx4 v[132:135], v1, s[4:7], s92 offen sc1
    s_add_u32 s92, s24, 0x271f000
    buffer_load_dwordx4 v[136:139], v1, s[4:7], s92 offen sc1
    s_add_u32 s92, s24, 0x271f800
    buffer_load_dwordx4 v[140:143], v1, s[4:7], s92 offen sc1
    s_waitcnt vmcnt(0)
    v_max3_u32 v7, v240, v244, v248
    v_max_u32 v7, v7, v252
    v_cmp_eq_u32 vcc, -1, v7
    s_cbranch_vccnz Lre114
    s_add_u32 s92, s24, 0x2720000
    buffer_load_dwordx4 v[144:147], v1, s[4:7], s92 offen sc1
    s_add_u32 s92, s24, 0x2720800
    buffer_load_dwordx4 v[148:151], v1, s[4:7], s92 offen sc1
    s_add_u32 s92, s24, 0x2721000
    buffer_load_dwordx4 v[152:155], v1, s[4:7], s92 offen sc1
    s_add_u32 s92, s24, 0x2721800
    buffer_load_dwordx4 v[156:159], v1, s[4:7], s92 offen sc1
    s_add_u32 s92, s24, 0x2722000
    buffer_load_dwordx4 v[160:163], v1, s[4:7], s92 offen sc1
    s_add_u32 s92, s24, 0x2722800
    buffer_load_dwordx4 v[164:167], v1, s[4:7], s92 offen sc1
    s_add_u32 s92, s24, 0x271c400
    buffer_load_dwordx4 v[168:171], v1, s[4:7], s92 offen sc1
    s_add_u32 s92, s24, 0x271cc00
    buffer_load_dwordx4 v[172:175], v1, s[4:7], s92 offen sc1
    s_add_u32 s92, s24, 0x271d400
    buffer_load_dwordx4 v[176:179], v1, s[4:7], s92 offen sc1
    s_branch Lok114
Lre115:
    s_cmp_eq_u32 s94, 0
    s_cbranch_scc1 Lok115
    s_sub_u32 s94, s94, 1
    s_waitcnt lgkmcnt(0)
    s_add_u32 s92, s24, 0x271e000
    buffer_load_dwordx4 v[128:131], v1, s[4:7], s92 offen sc1
    s_add_u32 s92, s24, 0x271e800
    buffer_load_dwordx4 v[132:135], v1, s[4:7], s92 offen sc1
    s_add_u32 s92, s24, 0x271f000
    buffer_load_dwordx4 v[136:139], v1, s[4:7], s92 offen sc1
    s_add_u32 s92, s24, 0x271f800
    buffer_load_dwordx4 v[140:143], v1, s[4:7], s92 offen sc1
    s_add_u32 s92, s24, 0x2720000
    buffer_load_dwordx4 v[144:147], v1, s[4:7], s92 offen sc1
    s_add_u32 s92, s24, 0x2720800
    buffer_load_dwordx4 v[148:151], v1, s[4:7], s92 offen sc1
    s_add_u32 s92, s24, 0x2721000
    buffer_load_dwordx4 v[152:155], v1, s[4:7], s92 offen sc1
    s_add_u32 s92, s24, 0x2721800
    buffer_load_dwordx4 v[156:159], v1, s[4:7], s92 offen sc1
    s_waitcnt vmcnt(0)
    v_max3_u32 v7, v128, v132, v136
    v_max_u32 v7, v7, v140
    v_cmp_eq_u32 vcc, -1, v7
    s_cbranch_vccnz Lre115
    s_add_u32 s92, s24, 0x2722000
    buffer_load_dwordx4 v[160:163], v1, s[4:7], s92 offen sc1
    s_add_u32 s92, s24, 0x2722800
    buffer_load_dwordx4 v[164:167], v1, s[4:7], s92 offen sc1
    s_add_u32 s92, s24, 0x271c400
    buffer_load_dwordx4 v[168:171], v1, s[4:7], s92 offen sc1
    s_add_u32 s92, s24, 0x271cc00
    buffer_load_dwordx4 v[172:175], v1, s[4:7], s92 offen sc1
    s_add_u32 s92, s24, 0x271d400
    buffer_load_dwordx4 v[176:179], v1, s[4:7], s92 offen sc1
    s_add_u32 s92, s24, 0x271dc00
    buffer_load_dwordx4 v[180:183], v1, s[4:7], s92 offen sc1
    s_add_u32 s92, s24, 0x271e400
    buffer_load_dwordx4 v[184:187], v1, s[4:7], s92 offen sc1
    s_add_u32 s92, s24, 0x271ec00
    buffer_load_dwordx4 v[188:191], v1, s[4:7], s92 offen sc1
    s_add_u32 s92, s24, 0x271f400
    buffer_load_dwordx4 v[192:195], v1, s[4:7], s92 offen sc1
    s_branch Lok115
Lre116:
    s_cmp_eq_u32 s94, 0
    s_cbranch_scc1 Lok116
    s_sub_u32 s94, s94, 1
    s_waitcnt lgkmcnt(0)
    s_add_u32 s92, s24, 0x2720000
    buffer_load_dwordx4 v[144:147], v1, s[4:7], s92 offen sc1
    s_add_u32 s92, s24, 0x2720800
    buffer_load_dwordx4 v[148:151], v1, s[4:7], s92 offen sc1
    s_add_u32 s92, s24, 0x2721000
    buffer_load_dwordx4 v[152:155], v1, s[4:7], s92 offen sc1
    s_add_u32 s92, s24, 0x2721800
    buffer_load_dwordx4 v[156:159], v1, s[4:7], s92 offen sc1
    s_add_u32 s92, s24, 0x2722000
    buffer_load_dwordx4 v[160:163], v1, s[4:7], s92 offen sc1
    s_add_u32 s92, s24, 0x2722800
    buffer_load_dwordx4 v[164:167], v1, s[4:7], s92 offen sc1
    s_add_u32 s92, s24, 0x271c400
    buffer_load_dwordx4 v[168:171], v1, s[4:7], s92 offen sc1
    s_add_u32 s92, s24, 0x271cc00
    buffer_load_dwordx4 v[172:175], v1, s[4:7], s92 offen sc1
    s_waitcnt vmcnt(0)
    v_max3_u32 v7, v144, v148, v152
    v_max_u32 v7, v7, v156
    v_cmp_eq_u32 vcc, -1, v7
    s_cbranch_vccnz Lre116
    s_add_u32 s92, s24, 0x271d400
    buffer_load_dwordx4 v[176:179], v1, s[4:7], s92 offen sc1
    s_add_u32 s92, s24, 0x271dc00
    buffer_load_dwordx4 v[180:183], v1, s[4:7], s92 offen sc1
    s_add_u32 s92, s24, 0x271e400
    buffer_load_dwordx4 v[184:187], v1, s[4:7], s92 offen sc1
    s_add_u32 s92, s24, 0x271ec00
    buffer_load_dwordx4 v[188:191], v1, s[4:7], s92 offen sc1
    s_add_u32 s92, s24, 0x271f400
    buffer_load_dwordx4 v[192:195], v1, s[4:7], s92 offen sc1
    s_add_u32 s92, s24, 0x271fc00
    buffer_load_dwordx4 v[196:199], v1, s[4:7], s92 offen sc1
    s_add_u32 s92, s24, 0x2720400
    buffer_load_dwordx4 v[200:203], v1, s[4:7], s92 offen sc1
    s_add_u32 s92, s24, 0x2720c00
    buffer_load_dwordx4 v[204:207], v1, s[4:7], s92 offen sc1
    s_add_u32 s92, s24, 0x2721400
    buffer_load_dwordx4 v[208:211], v1, s[4:7], s92 offen sc1
    s_branch Lok116
Lre117:
    s_cmp_eq_u32 s94, 0
    s_cbranch_scc1 Lok117
    s_sub_u32 s94, s94, 1
    s_waitcnt lgkmcnt(0)
    s_add_u32 s92, s24, 0x2722000
    buffer_load_dwordx4 v[160:163], v1, s[4:7], s92 offen sc1
    s_add_u32 s92, s24, 0x2722800
    buffer_load_dwordx4 v[164:167], v1, s[4:7], s92 offen sc1
    s_add_u32 s92, s24, 0x271c400
    buffer_load_dwordx4 v[168:171], v1, s[4:7], s92 offen sc1
    s_add_u32 s92, s24, 0x271cc00
    buffer_load_dwordx4 v[172:175], v1, s[4:7], s92 offen sc1
    s_add_u32 s92, s24, 0x271d400
    buffer_load_dwordx4 v[176:179], v1, s[4:7], s92 offen sc1
    s_add_u32 s92, s24, 0x271dc00
    buffer_load_dwordx4 v[180:183], v1, s[4:7], s92 offen sc1
    s_add_u32 s92, s24, 0x271e400
    buffer_load_dwordx4 v[184:187], v1, s[4:7], s92 offen sc1
    s_add_u32 s92, s24, 0x271ec00
    buffer_load_dwordx4 v[188:191], v1, s[4:7], s92 offen sc1
    s_waitcnt vmcnt(0)
    v_max3_u32 v7, v160, v164, v168
    v_max_u32 v7, v7, v172
    v_cmp_eq_u32 vcc, -1, v7
    s_cbranch_vccnz Lre117
    s_add_u32 s92, s24, 0x271f400
    buffer_load_dwordx4 v[192:195], v1, s[4:7], s92 offen sc1
    s_add_u32 s92, s24, 0x271fc00
    buffer_load_dwordx4 v[196:199], v1, s[4:7], s92 offen sc1
    s_add_u32 s92, s24, 0x2720400
    buffer_load_dwordx4 v[200:203], v1, s[4:7], s92 offen sc1
    s_add_u32 s92, s24, 0x2720c00
    buffer_load_dwordx4 v[204:207], v1, s[4:7], s92 offen sc1
    s_add_u32 s92, s24, 0x2721400
    buffer_load_dwordx4 v[208:211], v1, s[4:7], s92 offen sc1
    s_add_u32 s92, s24, 0x2721c00
    buffer_load_dwordx4 v[212:215], v1, s[4:7], s92 offen sc1
    s_add_u32 s92, s24, 0x2722400
    buffer_load_dwordx4 v[216:219], v1, s[4:7], s92 offen sc1
    s_add_u32 s92, s24, 0x2722c00
    buffer_load_dwordx4 v[220:223], v1, s[4:7], s92 offen sc1
    s_branch Lok117
Lre118:
    s_cmp_eq_u32 s94, 0
    s_cbranch_scc1 Lok118
    s_sub_u32 s94, s94, 1
    s_waitcnt lgkmcnt(0)
    s_add_u32 s92, s24, 0x271d400
    buffer_load_dwordx4 v[176:179], v1, s[4:7], s92 offen sc1
    s_add_u32 s92, s24, 0x271dc00
    buffer_load_dwordx4 v[180:183], v1, s[4:7], s92 offen sc1
    s_add_u32 s92, s24, 0x271e400
    buffer_load_dwordx4 v[184:187], v1, s[4:7], s92 offen sc1
    s_add_u32 s92, s24, 0x271ec00
    buffer_load_dwordx4 v[188:191], v1, s[4:7], s92 offen sc1
    s_add_u32 s92, s24, 0x271f400
    buffer_load_dwordx4 v[192:195], v1, s[4:7], s92 offen sc1
    s_add_u32 s92, s24, 0x271fc00
    buffer_load_dwordx4 v[196:199], v1, s[4:7], s92 offen sc1
    s_add_u32 s92, s24, 0x2720400
    buffer_load_dwordx4 v[200:203], v1, s[4:7], s92 offen sc1
    s_add_u32 s92, s24, 0x2720c00
    buffer_load_dwordx4 v[204:207], v1, s[4:7], s92 offen sc1
    s_waitcnt vmcnt(0)
    v_max3_u32 v7, v176, v180, v184
    v_max_u32 v7, v7, v188
    v_cmp_eq_u32 vcc, -1, v7
    s_cbranch_vccnz Lre118
    s_add_u32 s92, s24, 0x2721400
    buffer_load_dwordx4 v[208:211], v1, s[4:7], s92 offen sc1
    s_add_u32 s92, s24, 0x2721c00
    buffer_load_dwordx4 v[212:215], v1, s[4:7], s92 offen sc1
    s_add_u32 s92, s24, 0x2722400
    buffer_load_dwordx4 v[216:219], v1, s[4:7], s92 offen sc1
    s_add_u32 s92, s24, 0x2722c00
    buffer_load_dwordx4 v[220:223], v1, s[4:7], s92 offen sc1
    s_branch Lok118
Lre119:
    s_cmp_eq_u32 s94, 0
    s_cbranch_scc1 Lok119
    s_sub_u32 s94, s94, 1
    s_waitcnt lgkmcnt(0)
    s_add_u32 s92, s24, 0x271f400
    buffer_load_dwordx4 v[192:195], v1, s[4:7], s92 offen sc1
    s_add_u32 s92, s24, 0x271fc00
    buffer_load_dwordx4 v[196:199], v1, s[4:7], s92 offen sc1
    s_add_u32 s92, s24, 0x2720400
    buffer_load_dwordx4 v[200:203], v1, s[4:7], s92 offen sc1
    s_add_u32 s92, s24, 0x2720c00
    buffer_load_dwordx4 v[204:207], v1, s[4:7], s92 offen sc1
    s_add_u32 s92, s24, 0x2721400
    buffer_load_dwordx4 v[208:211], v1, s[4:7], s92 offen sc1
    s_add_u32 s92, s24, 0x2721c00
    buffer_load_dwordx4 v[212:215], v1, s[4:7], s92 offen sc1
    s_add_u32 s92, s24, 0x2722400
    buffer_load_dwordx4 v[216:219], v1, s[4:7], s92 offen sc1
    s_add_u32 s92, s24, 0x2722c00
    buffer_load_dwordx4 v[220:223], v1, s[4:7], s92 offen sc1
    s_waitcnt vmcnt(0)
    v_max3_u32 v7, v192, v196, v200
    v_max_u32 v7, v7, v204
    v_cmp_eq_u32 vcc, -1, v7
    s_cbranch_vccnz Lre119
    s_branch Lok119
Lre120:
    s_cmp_eq_u32 s94, 0
    s_cbranch_scc1 Lok120
    s_sub_u32 s94, s94, 1
    s_waitcnt lgkmcnt(0)
    s_add_u32 s92, s24, 0x2721400
    buffer_load_dwordx4 v[208:211], v1, s[4:7], s92 offen sc1
    s_add_u32 s92, s24, 0x2721c00
    buffer_load_dwordx4 v[212:215], v1, s[4:7], s92 offen sc1
    s_add_u32 s92, s24, 0x2722400
    buffer_load_dwordx4 v[216:219], v1, s[4:7], s92 offen sc1
    s_add_u32 s92, s24, 0x2722c00
    buffer_load_dwordx4 v[220:223], v1, s[4:7], s92 offen sc1
    s_waitcnt vmcnt(0)
    v_max3_u32 v7, v208, v212, v216
    v_max_u32 v7, v7, v220
    v_cmp_eq_u32 vcc, -1, v7
    s_cbranch_vccnz Lre120
    s_branch Lok120
code_end:
    s_endpgm
.section .rodata,"a"
.p2align 6
.amdhsa_kernel interleave_layers__mha_block__mixer_channel_mlp__prompt_kernel
  .amdhsa_next_free_vgpr 512
  .amdhsa_next_free_sgpr 102
  .amdhsa_accum_offset 256
  .amdhsa_group_segment_fixed_size 0
  .amdhsa_kernarg_size 88
  .amdhsa_user_sgpr_count 2
  .amdhsa_user_sgpr_kernarg_segment_ptr 1
  .amdhsa_system_sgpr_workgroup_id_x 1
.end_amdhsa_kernel
```
